```python
import torch

def _softmax(x, axis=-1):
    return torch.softmax(x, dim=axis)

def _gelu(x):
    return torch.nn.functional.gelu(x, approximate='tanh')

def _silu(x):
    return torch.nn.functional.silu(x)

def _sigmoid(x):
    return torch.sigmoid(x)

def _layernorm(x, axis=-1, eps=1e-05):
    m = x.mean(dim=axis, keepdim=True)
    v = x.var(dim=axis, keepdim=True, unbiased=False)
    return (x - m) / torch.sqrt(v + eps)

def _scatter_add(tgt, idx, src, axis=0):
    return tgt.clone().index_add_(axis, idx, src)

def _segment_sum(src, seg, n):
    out = torch.zeros((n,) + src.shape[1:], dtype=src.dtype)
    return out.index_add_(0, seg, src)

def _pad(x, pw):
    flat = tuple((v for pair in reversed(pw) for v in pair))
    return torch.nn.functional.pad(x, flat)
kernel_name = 'parallel_sum__memory_aug_recurrent_mem_tr__dense_activation_squared_relu__prompt'

def setup_inputs():

    _w = lambda a: (lambda t: t.to(torch.bfloat16) if t.is_floating_point() else t)(torch.as_tensor(a))

    def _A_setup():
        B, S, Dm = (1, 2048, 512)
        H, Dh = (32, 128)
        M, seg = (8, 32)
        seg = min(seg, S)
        S = S // seg * seg
        return {'x': _w((lambda *s: torch.randn(*s, dtype=torch.bfloat16) * 0.05)(B, S, Dm)), 'mem0': _w((lambda *s: torch.randn(*s, dtype=torch.bfloat16) * 1.6)(B, M, Dm)), 'Wq': _w((lambda *s: torch.randn(*s, dtype=torch.bfloat16) * 0.8)(Dm, H, Dh) * Dm ** (-0.5)), 'Wk': _w((lambda *s: torch.randn(*s, dtype=torch.bfloat16) * 0.8)(Dm, H, Dh) * Dm ** (-0.5)), 'Wv': _w((lambda *s: torch.randn(*s, dtype=torch.bfloat16) * 1.6)(Dm, H, Dh) * Dm ** (-0.5)), 'Wo': _w((lambda *s: torch.randn(*s, dtype=torch.bfloat16) * 1.6)(H, Dh, Dm) * (H * Dh) ** (-0.5)), 'seg_len': seg}
    _A_in = _A_setup()

    def _B_setup():
        B, S, D, F = (1, 2048, 512, 1792)
        return {'x': _w((lambda *s: torch.randn(*s, dtype=torch.bfloat16) * 0.05)(B, S, D)), 'w1': _w((lambda *s: torch.randn(*s, dtype=torch.bfloat16) * 0.05)(D, F)), 'b1': _w((lambda *s: torch.randn(*s, dtype=torch.bfloat16) * 0.2)(F)), 'w2': _w((lambda *s: torch.randn(*s, dtype=torch.bfloat16) * 0.05)(F, D)), 'b2': _w((lambda *s: torch.randn(*s, dtype=torch.bfloat16) * 0.8)(D))}
    _B_in = _B_setup()
    return {'A_x': _A_in['x'], 'A_mem0': _A_in['mem0'], 'A_Wq': _A_in['Wq'], 'A_Wk': _A_in['Wk'], 'A_Wv': _A_in['Wv'], 'A_Wo': _A_in['Wo'], 'A_seg_len': _A_in['seg_len'], 'B_x': _B_in['x'], 'B_w1': _B_in['w1'], 'B_b1': _B_in['b1'], 'B_w2': _B_in['w2'], 'B_b2': _B_in['b2']}

def reference(A_x, A_mem0, A_Wq, A_Wk, A_Wv, A_Wo, A_seg_len, B_x, B_w1, B_b1, B_w2, B_b2):

    def _A_ref(x, mem0, Wq, Wk, Wv, Wo, seg_len):
        B, S, Dm = x.shape
        H, Dh = (Wq.shape[1], Wq.shape[2])
        M = mem0.shape[1]
        scale = Dh ** (-0.5)
        n_seg = S // seg_len
        L = M + seg_len
        idx = torch.arange(L)
        mask = (idx[:, None] < M) | (idx[:, None] >= idx[None, :])
        mem = mem0
        outs = []
        for s in range(n_seg):
            xs = x[:, s * seg_len:(s + 1) * seg_len, :].clone()
            h = torch.concatenate([mem, xs], axis=1)
            q = torch.einsum('btd,dhe->bhte', h, Wq)
            k = torch.einsum('btd,dhe->bhte', h, Wk)
            v = torch.einsum('btd,dhe->bhte', h, Wv)
            scores = torch.einsum('bhqe,bhke->bhqk', q, k) * scale
            scores = torch.where(mask[None, None], scores, -1000000000.0)
            p = _softmax(scores, axis=-1)
            o = torch.einsum('bhqk,bhke->bhqe', p, v)
            o = torch.einsum('bhte,hed->btd', o, Wo)
            mem = o[:, :M, :].clone()
            outs.append(o[:, M:, :])
        return torch.concatenate(outs, axis=1)

    def _B_ref(x, w1, b1, w2, b2):
        h = torch.einsum('bsd,df->bsf', x, w1) + b1
        zero = torch.zeros_like(h)
        r = torch.where(h > zero, h, zero)
        h = r * r
        out = torch.einsum('bsf,fd->bsd', h, w2) + b2
        return out
    x = A_x
    xn = _layernorm(x, axis=-1)
    return x + _A_ref(xn, A_mem0, A_Wq, A_Wk, A_Wv, A_Wo, A_seg_len) + _B_ref(xn, B_w1, B_b1, B_w2, B_b2)
```

```asm
; @launch grid=(256,1,1) block=(256,1,1) lds=163840
.amdgcn_target "amdgcn-amd-amdhsa--gfx950"
.text
.globl parallel_sum__memory_aug_recurrent_mem_tr__dense_activation_squared_relu__prompt_kernel
.p2align 8
.type parallel_sum__memory_aug_recurrent_mem_tr__dense_activation_squared_relu__prompt_kernel,@function
parallel_sum__memory_aug_recurrent_mem_tr__dense_activation_squared_relu__prompt_kernel:
s_cmp_ge_u32 s2, 256
s_cbranch_scc1 L_END
s_load_dwordx2 s[8:9], s[0:1], 112
s_load_dwordx2 s[4:5], s[0:1], 104
s_getreg_b32 s87, hwreg(HW_REG_XCC_ID, 0, 4)
s_mov_b32 s10, 268435456
s_mov_b32 s11, 0x20000
s_mov_b32 s6, 256
s_mov_b32 s7, 0x20000
s_mov_b32 s37, 0
s_mov_b32 s84, 0
s_mov_b32 s82, 0
s_mov_b32 s79, 0
v_mov_b32 v250, 0
v_lshrrev_b32 v1, 6, v0
v_lshlrev_b32 v8, 4, v0
v_readfirstlane_b32 s17, v1
v_and_b32 v0, 63, v0
v_mov_b32 v12, -1
v_mov_b32 v13, -1
v_mov_b32 v14, -1
v_mov_b32 v15, -1
s_bfe_u32 s16, s2, 0x50003
s_waitcnt lgkmcnt(0)
s_mov_b32 s83, s16
s_add_u32 s80, s87, 4
s_and_b32 s80, s80, 7
s_min_u32 s80, s80, 6
s_lshl_b32 s81, s80, 2
s_add_u32 s81, s81, 140
s_cmp_eq_u32 s87, 3
s_cselect_b32 s81, 128, s81
s_and_b32 s3, s2, 0x87
s_cmp_lg_u32 s3, 0
s_cbranch_scc1 L_I3
s_xor_b32 s3, s17, s83
s_bitcmp1_b32 s3, 0
s_cbranch_scc0 L_I3
s_lshr_b32 s32, s2, 3
s_lshr_b32 s3, s17, 1
s_lshl_b32 s32, s32, 1
s_add_u32 s32, s32, s3
v_lshlrev_b32 v9, 4, v0
s_lshl_b32 s3, s32, 13
s_add_u32 s3, s3, 90177536
buffer_store_dwordx4 v[12:15], v9, s[8:11], s3 offen offset:0 sc1
buffer_store_dwordx4 v[12:15], v9, s[8:11], s3 offen offset:1024 sc1
buffer_store_dwordx4 v[12:15], v9, s[8:11], s3 offen offset:2048 sc1
buffer_store_dwordx4 v[12:15], v9, s[8:11], s3 offen offset:3072 sc1
s_add_u32 s3, s3, 4096
buffer_store_dwordx4 v[12:15], v9, s[8:11], s3 offen offset:0 sc1
buffer_store_dwordx4 v[12:15], v9, s[8:11], s3 offen offset:1024 sc1
buffer_store_dwordx4 v[12:15], v9, s[8:11], s3 offen offset:2048 sc1
buffer_store_dwordx4 v[12:15], v9, s[8:11], s3 offen offset:3072 sc1
s_lshl_b32 s3, s32, 10
s_add_u32 s3, s3, 91226112
buffer_store_dwordx4 v[12:15], v9, s[8:11], s3 offen sc1
s_mul_i32 s3, s32, 2560
s_add_u32 s3, s3, 91291648
v_mov_b32 v16, 0
v_mov_b32 v17, 0
v_mov_b32 v18, 0
v_mov_b32 v19, 0
buffer_store_dwordx4 v[16:19], v9, s[8:11], s3 offen sc1
buffer_store_dwordx4 v[16:19], v9, s[8:11], s3 offen offset:1024 sc1
s_mov_b64 exec, 0xffffffff
buffer_store_dwordx4 v[16:19], v9, s[8:11], s3 offen offset:2048 sc1
s_mov_b64 exec, -1
s_waitcnt vmcnt(0)
s_mov_b64 exec, 1
v_mov_b32 v20, 1
v_mov_b32 v22, 4
buffer_atomic_add v20, v22, s[4:7], 0 offen
s_mov_b64 exec, -1
L_I3:
s_cmp_lg_u32 s17, 0
s_cbranch_scc1 L_I2
s_mov_b64 exec, 1
s_lshl_b32 s3, 1, s83
v_mov_b32 v250, s3
v_mov_b32 v22, s81
buffer_atomic_or v250, v22, s[4:7], 0 offen sc0
s_mov_b64 exec, -1
L_I2:
s_cmp_lg_u32 s87, 3
s_cbranch_scc1 L_NOSPEC
s_mov_b32 s82, 1
s_branch L_CHAIN
L_CLOST:
s_waitcnt vmcnt(0)
s_cmp_lg_u32 s17, 0
s_cbranch_scc1 L_ROLE
s_mov_b32 s32, s83
s_mov_b32 s18, 128
CLAIM_A:
s_lshl_b32 s34, 1, s32
s_mov_b64 exec, 1
v_mov_b32 v20, s34
v_mov_b32 v22, s18
buffer_atomic_or v20, v22, s[4:7], 0 offen sc0
s_waitcnt vmcnt(0)
v_readfirstlane_b32 s33, v20
s_mov_b64 exec, -1
s_nop 3
CLAIM_A_R:
s_and_b32 s35, s33, s34
s_or_b32 s33, s33, s34
s_mov_b32 s16, s32
s_cmp_eq_u32 s35, 0
s_cbranch_scc1 CLAIM_A_E
s_mov_b32 s16, -1
s_cmp_eq_u32 s33, -1
s_cbranch_scc1 CLAIM_A_E
s_ff0_i32_b32 s32, s33
s_branch CLAIM_A
CLAIM_A_E:
s_cmp_eq_u32 s16, -1
s_cbranch_scc1 L_WCLAIM
s_cmp_lg_u32 s33, -1
s_cbranch_scc1 DECL_1
s_mov_b64 exec, 1
v_mov_b32 v20, 1
v_mov_b32 v21, 0
v_mov_b32 v22, 0
buffer_atomic_cmpswap v[20:21], v22, s[4:7], 0 offen
s_mov_b64 exec, -1
DECL_1:
s_branch L_ROLE
L_NOSPEC:
s_xor_b32 s3, s17, s83
s_bitcmp1_b32 s3, 0
s_cbranch_scc0 L_PF
s_lshr_b32 s3, s80, 1
s_lshl_b32 s3, s3, 1
s_lshr_b32 s44, s83, 4
s_add_u32 s3, s3, s44
s_cmp_eq_u32 s3, 5
s_cbranch_scc1 L_PF
s_load_dwordx4 s[48:51], s[0:1], 16
s_load_dwordx4 s[52:55], s[0:1], 32
s_mov_b32 s42, 0x400000
s_mov_b32 s43, 0x20000
v_lshlrev_b32 v13, 7, v0
s_lshr_b32 s3, s17, 1
s_add_u32 s3, s3, s2
s_and_b32 s3, s3, 255
s_lshl_b32 s3, s3, 14
s_add_u32 s44, s3, 8192
s_waitcnt lgkmcnt(0)
s_mov_b32 s40, s54
s_mov_b32 s41, s55
buffer_load_dword v252, v13, s[40:43], s3 offen
buffer_load_dword v252, v13, s[40:43], s44 offen
s_mov_b32 s40, s50
s_mov_b32 s41, s51
buffer_load_dword v252, v13, s[40:43], s3 offen
buffer_load_dword v252, v13, s[40:43], s44 offen
s_mov_b32 s40, s52
s_mov_b32 s41, s53
buffer_load_dword v252, v13, s[40:43], s3 offen
buffer_load_dword v252, v13, s[40:43], s44 offen
L_PF:
s_lshl_b32 s16, s80, 5
s_add_u32 s16, s16, s83
s_mov_b32 s82, 1
s_branch L_WORK
L_WLOST:
s_waitcnt vmcnt(0) lgkmcnt(0)
s_cmp_lg_u32 s17, 0
s_cbranch_scc1 L_ROLE2
L_WCLAIM:
s_mov_b32 s18, s80
s_mov_b32 s19, 0
s_mov_b32 s32, s83
L_WNEXT:
s_cmp_ge_u32 s18, 7
s_cselect_b32 s33, 7, 0
s_sub_u32 s18, s18, s33
s_cmp_ge_u32 s18, 7
s_cselect_b32 s33, 7, 0
s_sub_u32 s18, s18, s33
s_lshl_b32 s18, s18, 2
s_add_u32 s18, s18, 140
CLAIM_W:
s_lshl_b32 s34, 1, s32
s_mov_b64 exec, 1
v_mov_b32 v20, s34
v_mov_b32 v22, s18
buffer_atomic_or v20, v22, s[4:7], 0 offen sc0
s_waitcnt vmcnt(0)
v_readfirstlane_b32 s33, v20
s_mov_b64 exec, -1
s_nop 3
CLAIM_W_R:
s_and_b32 s35, s33, s34
s_or_b32 s33, s33, s34
s_mov_b32 s16, s32
s_cmp_eq_u32 s35, 0
s_cbranch_scc1 CLAIM_W_E
s_mov_b32 s16, -1
s_cmp_eq_u32 s33, -1
s_cbranch_scc1 CLAIM_W_E
s_ff0_i32_b32 s32, s33
s_branch CLAIM_W
CLAIM_W_E:
s_sub_u32 s18, s18, 140
s_lshr_b32 s18, s18, 2
s_cmp_eq_u32 s16, -1
s_cbranch_scc0 L_WGOT
s_add_u32 s18, s18, 1
s_add_u32 s19, s19, 1
s_mov_b32 s32, 0
s_cmp_lt_u32 s19, 7
s_cbranch_scc1 L_WNEXT
s_mov_b64 exec, 1
v_mov_b32 v20, 2
v_mov_b32 v22, 0
v_mov_b32 v21, 0
buffer_atomic_cmpswap v[20:21], v22, s[4:7], 0 offen sc0
s_waitcnt vmcnt(0)
v_readfirstlane_b32 s33, v20
s_mov_b64 exec, -1
s_nop 3
s_mov_b32 s32, 0
s_mov_b32 s18, 128
CLAIM_B:
s_lshl_b32 s34, 1, s32
s_mov_b64 exec, 1
v_mov_b32 v20, s34
v_mov_b32 v22, s18
buffer_atomic_or v20, v22, s[4:7], 0 offen sc0
s_waitcnt vmcnt(0)
v_readfirstlane_b32 s33, v20
s_mov_b64 exec, -1
s_nop 3
CLAIM_B_R:
s_and_b32 s35, s33, s34
s_or_b32 s33, s33, s34
s_mov_b32 s16, s32
s_cmp_eq_u32 s35, 0
s_cbranch_scc1 CLAIM_B_E
s_mov_b32 s16, -1
s_cmp_eq_u32 s33, -1
s_cbranch_scc1 CLAIM_B_E
s_ff0_i32_b32 s32, s33
s_branch CLAIM_B
CLAIM_B_E:
s_branch L_ROLE
L_WGOT:
s_lshl_b32 s18, s18, 5
s_add_u32 s16, s16, s18
s_add_u32 s16, s16, 32
L_ROLE:
L_ROLE2:
v_mov_b32 v22, 163824
s_cmp_lg_u32 s17, 0
s_cbranch_scc1 BC_2
v_mov_b32 v20, s16
ds_write_b32 v22, v20
s_waitcnt lgkmcnt(0)
BC_2:
s_barrier
ds_read_b32 v20, v22
s_waitcnt lgkmcnt(0)
v_readfirstlane_b32 s16, v20
s_barrier
s_cmp_lt_u32 s16, 32
s_cbranch_scc1 L_CHAIN
s_cmp_eq_u32 s16, -1
s_cbranch_scc1 L_FIN
s_waitcnt vmcnt(0)
s_sub_u32 s16, s16, 32
L_WORK:
s_sub_u32 s3, s16, 128
s_and_b32 s3, s3, 0xffffffd0
s_cmp_lg_u32 s3, 16
s_cbranch_scc1 L_G1
s_and_b32 s18, s16, 15
s_lshr_b32 s3, s16, 1
s_and_b32 s3, s3, 16
s_add_u32 s18, s18, s3
s_load_dwordx2 s[60:61], s[0:1], 16
s_mov_b32 s67, 100663296
s_mov_b32 s19, 8
L_PREP:
s_mov_b32 s62, 0x400000
s_mov_b32 s63, 0x20000
v_lshrrev_b32 v101, 4, v0
v_and_b32 v102, 3, v0
v_bfe_u32 v103, v0, 2, 2
s_lshl_b32 s34, s18, 8
s_lshl_b32 s35, s17, 6
s_add_u32 s34, s34, s35
v_lshrrev_b32 v10, 2, v0
s_lshl_b32 s76, s17, 15
s_mov_b32 s64, s76
s_mov_b32 s65, 0
v_lshlrev_b32 v11, 13, v10
v_xor_b32 v104, 0, v102
v_lshl_add_u32 v11, v104, 4, v11
v_add_u32 v84, s34, v11
v_lshlrev_b32 v11, 13, v10
v_xor_b32 v104, 2, v102
v_lshl_add_u32 v11, v104, 4, v11
v_add_u32 v85, s34, v11
v_lshlrev_b32 v11, 13, v10
v_xor_b32 v104, 0, v102
v_lshl_add_u32 v11, v104, 4, v11
v_add_u32 v86, s34, v11
v_lshlrev_b32 v11, 13, v10
v_xor_b32 v104, 2, v102
v_lshl_add_u32 v11, v104, 4, v11
v_add_u32 v87, s34, v11
s_waitcnt lgkmcnt(0)
s_mov_b32 m0, s64
s_add_u32 s64, s64, 1024
buffer_load_dwordx4 v84, s[60:63], s65 offen lds
s_add_u32 s65, s65, 131072
s_mov_b32 m0, s64
s_add_u32 s64, s64, 1024
buffer_load_dwordx4 v85, s[60:63], s65 offen lds
s_add_u32 s65, s65, 131072
s_mov_b32 m0, s64
s_add_u32 s64, s64, 1024
buffer_load_dwordx4 v86, s[60:63], s65 offen lds
s_add_u32 s65, s65, 131072
s_mov_b32 m0, s64
s_add_u32 s64, s64, 1024
buffer_load_dwordx4 v87, s[60:63], s65 offen lds
s_add_u32 s65, s65, 131072
s_mov_b32 m0, s64
s_add_u32 s64, s64, 1024
buffer_load_dwordx4 v84, s[60:63], s65 offen lds
s_add_u32 s65, s65, 131072
s_mov_b32 m0, s64
s_add_u32 s64, s64, 1024
buffer_load_dwordx4 v85, s[60:63], s65 offen lds
s_add_u32 s65, s65, 131072
s_mov_b32 m0, s64
s_add_u32 s64, s64, 1024
buffer_load_dwordx4 v86, s[60:63], s65 offen lds
s_add_u32 s65, s65, 131072
s_mov_b32 m0, s64
s_add_u32 s64, s64, 1024
buffer_load_dwordx4 v87, s[60:63], s65 offen lds
s_add_u32 s65, s65, 131072
s_mov_b32 m0, s64
s_add_u32 s64, s64, 1024
buffer_load_dwordx4 v84, s[60:63], s65 offen lds
s_add_u32 s65, s65, 131072
s_mov_b32 m0, s64
s_add_u32 s64, s64, 1024
buffer_load_dwordx4 v85, s[60:63], s65 offen lds
s_add_u32 s65, s65, 131072
s_mov_b32 m0, s64
s_add_u32 s64, s64, 1024
buffer_load_dwordx4 v86, s[60:63], s65 offen lds
s_add_u32 s65, s65, 131072
s_mov_b32 m0, s64
s_add_u32 s64, s64, 1024
buffer_load_dwordx4 v87, s[60:63], s65 offen lds
s_add_u32 s65, s65, 131072
s_mov_b32 m0, s64
s_add_u32 s64, s64, 1024
buffer_load_dwordx4 v84, s[60:63], s65 offen lds
s_add_u32 s65, s65, 131072
s_mov_b32 m0, s64
s_add_u32 s64, s64, 1024
buffer_load_dwordx4 v85, s[60:63], s65 offen lds
s_add_u32 s65, s65, 131072
s_mov_b32 m0, s64
s_add_u32 s64, s64, 1024
buffer_load_dwordx4 v86, s[60:63], s65 offen lds
s_add_u32 s65, s65, 131072
s_mov_b32 m0, s64
s_add_u32 s64, s64, 1024
buffer_load_dwordx4 v87, s[60:63], s65 offen lds
s_add_u32 s65, s65, 131072
s_mov_b32 m0, s64
s_add_u32 s64, s64, 1024
buffer_load_dwordx4 v84, s[60:63], s65 offen lds
s_add_u32 s65, s65, 131072
s_mov_b32 m0, s64
s_add_u32 s64, s64, 1024
buffer_load_dwordx4 v85, s[60:63], s65 offen lds
s_add_u32 s65, s65, 131072
s_mov_b32 m0, s64
s_add_u32 s64, s64, 1024
buffer_load_dwordx4 v86, s[60:63], s65 offen lds
s_add_u32 s65, s65, 131072
s_mov_b32 m0, s64
s_add_u32 s64, s64, 1024
buffer_load_dwordx4 v87, s[60:63], s65 offen lds
s_add_u32 s65, s65, 131072
s_mov_b32 m0, s64
s_add_u32 s64, s64, 1024
buffer_load_dwordx4 v84, s[60:63], s65 offen lds
s_add_u32 s65, s65, 131072
s_mov_b32 m0, s64
s_add_u32 s64, s64, 1024
buffer_load_dwordx4 v85, s[60:63], s65 offen lds
s_add_u32 s65, s65, 131072
s_mov_b32 m0, s64
s_add_u32 s64, s64, 1024
buffer_load_dwordx4 v86, s[60:63], s65 offen lds
s_add_u32 s65, s65, 131072
s_mov_b32 m0, s64
s_add_u32 s64, s64, 1024
buffer_load_dwordx4 v87, s[60:63], s65 offen lds
s_add_u32 s65, s65, 131072
s_mov_b32 m0, s64
s_add_u32 s64, s64, 1024
buffer_load_dwordx4 v84, s[60:63], s65 offen lds
s_add_u32 s65, s65, 131072
s_mov_b32 m0, s64
s_add_u32 s64, s64, 1024
buffer_load_dwordx4 v85, s[60:63], s65 offen lds
s_add_u32 s65, s65, 131072
s_mov_b32 m0, s64
s_add_u32 s64, s64, 1024
buffer_load_dwordx4 v86, s[60:63], s65 offen lds
s_add_u32 s65, s65, 131072
s_mov_b32 m0, s64
s_add_u32 s64, s64, 1024
buffer_load_dwordx4 v87, s[60:63], s65 offen lds
s_add_u32 s65, s65, 131072
s_mov_b32 m0, s64
s_add_u32 s64, s64, 1024
buffer_load_dwordx4 v84, s[60:63], s65 offen lds
s_add_u32 s65, s65, 131072
s_mov_b32 m0, s64
s_add_u32 s64, s64, 1024
buffer_load_dwordx4 v85, s[60:63], s65 offen lds
s_add_u32 s65, s65, 131072
s_mov_b32 m0, s64
s_add_u32 s64, s64, 1024
buffer_load_dwordx4 v86, s[60:63], s65 offen lds
s_add_u32 s65, s65, 131072
s_mov_b32 m0, s64
s_add_u32 s64, s64, 1024
buffer_load_dwordx4 v87, s[60:63], s65 offen lds
s_add_u32 s65, s65, 131072
v_and_b32 v105, 1, v101
v_lshrrev_b32 v106, 1, v101
v_and_b32 v107, 1, v103
v_lshrrev_b32 v108, 1, v103
v_lshl_add_u32 v10, v106, 3, v105
v_lshl_add_u32 v10, v108, 4, v10
v_lshl_add_u32 v109, v107, 1, v10
v_lshlrev_b32 v110, 4, v0
s_lshl_b32 s65, s18, 2
s_add_u32 s65, s65, s17
s_lshl_b32 s65, s65, 15
s_add_u32 s65, s65, s67
v_lshlrev_b32 v10, 6, v109
v_xor_b32 v11, 0, v108
v_lshl_add_u32 v10, v11, 5, v10
v_lshl_add_u32 v10, v102, 3, v10
v_add_u32 v90, s76, v10
v_lshlrev_b32 v10, 6, v109
v_xor_b32 v11, 1, v108
v_lshl_add_u32 v10, v11, 5, v10
v_lshl_add_u32 v10, v102, 3, v10
v_add_u32 v91, s76, v10
s_waitcnt vmcnt(24)
ds_read_b64_tr_b16 v[112:113], v90 offset:0
ds_read_b64_tr_b16 v[114:115], v90 offset:256
ds_read_b64_tr_b16 v[116:117], v90 offset:2048
ds_read_b64_tr_b16 v[118:119], v90 offset:2304
ds_read_b64_tr_b16 v[120:121], v91 offset:0
ds_read_b64_tr_b16 v[122:123], v91 offset:256
ds_read_b64_tr_b16 v[124:125], v91 offset:2048
ds_read_b64_tr_b16 v[126:127], v91 offset:2304
ds_read_b64_tr_b16 v[128:129], v90 offset:4096
ds_read_b64_tr_b16 v[130:131], v90 offset:4352
ds_read_b64_tr_b16 v[132:133], v90 offset:6144
ds_read_b64_tr_b16 v[134:135], v90 offset:6400
ds_read_b64_tr_b16 v[136:137], v91 offset:4096
ds_read_b64_tr_b16 v[138:139], v91 offset:4352
ds_read_b64_tr_b16 v[140:141], v91 offset:6144
s_waitcnt lgkmcnt(13)
ds_read_b64_tr_b16 v[142:143], v91 offset:6400
s_waitcnt lgkmcnt(0)
buffer_store_dwordx4 v[112:115], v110, s[8:11], s65 offen offset:0 sc1
buffer_store_dwordx4 v[116:119], v110, s[8:11], s65 offen offset:1024 sc1
buffer_store_dwordx4 v[120:123], v110, s[8:11], s65 offen offset:2048 sc1
buffer_store_dwordx4 v[124:127], v110, s[8:11], s65 offen offset:3072 sc1
s_add_u32 s65, s65, 4096
buffer_store_dwordx4 v[128:131], v110, s[8:11], s65 offen offset:0 sc1
buffer_store_dwordx4 v[132:135], v110, s[8:11], s65 offen offset:1024 sc1
buffer_store_dwordx4 v[136:139], v110, s[8:11], s65 offen offset:2048 sc1
buffer_store_dwordx4 v[140:143], v110, s[8:11], s65 offen offset:3072 sc1
s_add_u32 s65, s65, 4096
s_waitcnt vmcnt(24)
ds_read_b64_tr_b16 v[144:145], v90 offset:8192
ds_read_b64_tr_b16 v[146:147], v90 offset:8448
ds_read_b64_tr_b16 v[148:149], v90 offset:10240
ds_read_b64_tr_b16 v[150:151], v90 offset:10496
ds_read_b64_tr_b16 v[152:153], v91 offset:8192
ds_read_b64_tr_b16 v[154:155], v91 offset:8448
ds_read_b64_tr_b16 v[156:157], v91 offset:10240
ds_read_b64_tr_b16 v[158:159], v91 offset:10496
ds_read_b64_tr_b16 v[160:161], v90 offset:12288
ds_read_b64_tr_b16 v[162:163], v90 offset:12544
ds_read_b64_tr_b16 v[164:165], v90 offset:14336
ds_read_b64_tr_b16 v[166:167], v90 offset:14592
ds_read_b64_tr_b16 v[168:169], v91 offset:12288
ds_read_b64_tr_b16 v[170:171], v91 offset:12544
ds_read_b64_tr_b16 v[172:173], v91 offset:14336
s_waitcnt lgkmcnt(13)
ds_read_b64_tr_b16 v[174:175], v91 offset:14592
s_waitcnt lgkmcnt(0)
buffer_store_dwordx4 v[144:147], v110, s[8:11], s65 offen offset:0 sc1
buffer_store_dwordx4 v[148:151], v110, s[8:11], s65 offen offset:1024 sc1
buffer_store_dwordx4 v[152:155], v110, s[8:11], s65 offen offset:2048 sc1
buffer_store_dwordx4 v[156:159], v110, s[8:11], s65 offen offset:3072 sc1
s_add_u32 s65, s65, 4096
buffer_store_dwordx4 v[160:163], v110, s[8:11], s65 offen offset:0 sc1
buffer_store_dwordx4 v[164:167], v110, s[8:11], s65 offen offset:1024 sc1
buffer_store_dwordx4 v[168:171], v110, s[8:11], s65 offen offset:2048 sc1
buffer_store_dwordx4 v[172:175], v110, s[8:11], s65 offen offset:3072 sc1
s_add_u32 s65, s65, 4096
s_waitcnt vmcnt(24)
ds_read_b64_tr_b16 v[176:177], v90 offset:16384
ds_read_b64_tr_b16 v[178:179], v90 offset:16640
ds_read_b64_tr_b16 v[180:181], v90 offset:18432
ds_read_b64_tr_b16 v[182:183], v90 offset:18688
ds_read_b64_tr_b16 v[184:185], v91 offset:16384
ds_read_b64_tr_b16 v[186:187], v91 offset:16640
ds_read_b64_tr_b16 v[188:189], v91 offset:18432
ds_read_b64_tr_b16 v[190:191], v91 offset:18688
ds_read_b64_tr_b16 v[192:193], v90 offset:20480
ds_read_b64_tr_b16 v[194:195], v90 offset:20736
ds_read_b64_tr_b16 v[196:197], v90 offset:22528
ds_read_b64_tr_b16 v[198:199], v90 offset:22784
ds_read_b64_tr_b16 v[200:201], v91 offset:20480
ds_read_b64_tr_b16 v[202:203], v91 offset:20736
ds_read_b64_tr_b16 v[204:205], v91 offset:22528
s_waitcnt lgkmcnt(13)
ds_read_b64_tr_b16 v[206:207], v91 offset:22784
s_waitcnt lgkmcnt(0)
buffer_store_dwordx4 v[176:179], v110, s[8:11], s65 offen offset:0 sc1
buffer_store_dwordx4 v[180:183], v110, s[8:11], s65 offen offset:1024 sc1
buffer_store_dwordx4 v[184:187], v110, s[8:11], s65 offen offset:2048 sc1
buffer_store_dwordx4 v[188:191], v110, s[8:11], s65 offen offset:3072 sc1
s_add_u32 s65, s65, 4096
buffer_store_dwordx4 v[192:195], v110, s[8:11], s65 offen offset:0 sc1
buffer_store_dwordx4 v[196:199], v110, s[8:11], s65 offen offset:1024 sc1
buffer_store_dwordx4 v[200:203], v110, s[8:11], s65 offen offset:2048 sc1
buffer_store_dwordx4 v[204:207], v110, s[8:11], s65 offen offset:3072 sc1
s_add_u32 s65, s65, 4096
s_waitcnt vmcnt(24)
ds_read_b64_tr_b16 v[208:209], v90 offset:24576
ds_read_b64_tr_b16 v[210:211], v90 offset:24832
ds_read_b64_tr_b16 v[212:213], v90 offset:26624
ds_read_b64_tr_b16 v[214:215], v90 offset:26880
ds_read_b64_tr_b16 v[216:217], v91 offset:24576
ds_read_b64_tr_b16 v[218:219], v91 offset:24832
ds_read_b64_tr_b16 v[220:221], v91 offset:26624
ds_read_b64_tr_b16 v[222:223], v91 offset:26880
ds_read_b64_tr_b16 v[224:225], v90 offset:28672
ds_read_b64_tr_b16 v[226:227], v90 offset:28928
ds_read_b64_tr_b16 v[228:229], v90 offset:30720
ds_read_b64_tr_b16 v[230:231], v90 offset:30976
ds_read_b64_tr_b16 v[232:233], v91 offset:28672
ds_read_b64_tr_b16 v[234:235], v91 offset:28928
ds_read_b64_tr_b16 v[236:237], v91 offset:30720
s_waitcnt lgkmcnt(13)
ds_read_b64_tr_b16 v[238:239], v91 offset:30976
s_waitcnt lgkmcnt(0)
buffer_store_dwordx4 v[208:211], v110, s[8:11], s65 offen offset:0 sc1
buffer_store_dwordx4 v[212:215], v110, s[8:11], s65 offen offset:1024 sc1
buffer_store_dwordx4 v[216:219], v110, s[8:11], s65 offen offset:2048 sc1
buffer_store_dwordx4 v[220:223], v110, s[8:11], s65 offen offset:3072 sc1
s_add_u32 s65, s65, 4096
buffer_store_dwordx4 v[224:227], v110, s[8:11], s65 offen offset:0 sc1
buffer_store_dwordx4 v[228:231], v110, s[8:11], s65 offen offset:1024 sc1
buffer_store_dwordx4 v[232:235], v110, s[8:11], s65 offen offset:2048 sc1
buffer_store_dwordx4 v[236:239], v110, s[8:11], s65 offen offset:3072 sc1
s_add_u32 s65, s65, 4096
s_waitcnt vmcnt(0)
s_barrier
s_cmp_lg_u32 s17, 0
s_cbranch_scc1 L_G1
s_lshl_b32 s3, 1, s18
s_mov_b64 exec, 1
v_mov_b32 v2, s3
buffer_atomic_or v2, off, s[4:7], s19
s_mov_b64 exec, -1
L_G1:
s_lshr_b32 s18, s16, 2
s_and_b32 s19, s16, 3
s_mov_b32 s44, 0
s_cmp_lt_u32 s16, 128
s_cbranch_scc1 G1_MAP
s_add_u32 s18, s18, 8
s_cmp_ge_u32 s16, 160
s_cbranch_scc1 G1_MAP
s_lshr_b32 s18, s16, 1
s_sub_u32 s18, s18, 32
s_and_b32 s19, s16, 1
s_mov_b32 s44, 1
G1_MAP:
s_lshr_b32 s45, 131072, s44
s_sub_u32 s45, s45, 7168
s_lshr_b32 s46, 1048576, s44
s_lshl_b32 s47, 16, s44
s_lshr_b32 s20, s18, 4
s_load_dwordx2 s[48:49], s[0:1], 24
s_load_dwordx2 s[50:51], s[0:1], 32
s_load_dwordx2 s[52:53], s[0:1], 16
s_load_dwordx2 s[54:55], s[0:1], 64
s_load_dwordx2 s[56:57], s[0:1], 72
s_load_dwordx2 s[58:59], s[0:1], 40
s_waitcnt lgkmcnt(0)
s_mov_b32 s12, s48
s_mov_b32 s13, s49
s_mov_b32 s14, 4194304
s_mov_b32 s21, 8192
s_cmp_eq_u32 s20, 1
s_cselect_b32 s12, s50, s12
s_cselect_b32 s13, s51, s13
s_cmp_eq_u32 s20, 2
s_cselect_b32 s12, s52, s12
s_cselect_b32 s13, s53, s13
s_cmp_eq_u32 s20, 3
s_cselect_b32 s12, s54, s12
s_cselect_b32 s13, s55, s13
s_cselect_b32 s14, 1835008, s14
s_cselect_b32 s21, 3584, s21
s_mov_b32 s15, 0x20000
v_and_b32 v240, 15, v0
v_lshrrev_b32 v241, 4, v0
v_and_b32 v242, 3, v0
v_bfe_u32 v243, v0, 2, 2
v_lshrrev_b32 v4, 3, v0
v_mul_lo_u32 v4, v4, s21
v_and_b32 v5, 7, v0
v_bfe_u32 v6, v0, 4, 1
v_lshlrev_b32 v6, 1, v6
v_xor_b32 v5, v5, v6
v_xor_b32 v6, 4, v5
s_and_b32 s32, s18, 15
s_lshl_b32 s32, s32, 9
s_lshl_b32 s33, s17, 7
s_add_u32 s32, s32, s33
v_add_u32 v4, s32, v4
v_lshl_add_u32 v244, v5, 4, v4
v_lshl_add_u32 v245, v6, 4, v4
v_lshl_add_u32 v4, v241, 3, v243
v_lshlrev_b32 v4, 7, v4
v_lshl_add_u32 v4, v242, 3, v4
s_mul_i32 s32, s17, 24576
v_add_u32 v4, s32, v4
v_lshrrev_b32 v5, 1, v243
v_and_b32 v6, 1, v241
v_lshl_add_u32 v5, v6, 1, v5
v_xor_b32 v6, 0, v5
v_lshl_add_u32 v246, v6, 5, v4
v_xor_b32 v6, 1, v5
v_lshl_add_u32 v247, v6, 5, v4
v_xor_b32 v6, 2, v5
v_lshl_add_u32 v248, v6, 5, v4
v_xor_b32 v6, 3, v5
v_lshl_add_u32 v249, v6, 5, v4
s_lshl_b32 s34, s21, 3
s_mov_b32 s23, 0
s_mov_b32 s31, 0
s_cmp_lt_u32 s16, 192
s_cbranch_scc1 G1_LN0
s_mul_i32 s26, s16, 3
s_add_u32 s26, s26, s17
s_sub_u32 s26, s26, 416
s_cmp_lt_u32 s17, 3
s_cbranch_scc1 G1_LN
s_sub_u32 s26, s16, 64
s_cmp_lt_u32 s26, 0
s_cbranch_scc1 G1_LN
s_branch G1_NOLN
G1_LN0:
s_sub_u32 s33, s16, 128
s_cmp_lt_u32 s33, 0
s_cbranch_scc1 G1_NOLN
s_and_b32 s33, s16, 3
s_cmp_lg_u32 s17, s33
s_cbranch_scc1 G1_NOLN
s_mov_b32 s26, s16
s_cmp_lt_u32 s16, 144
s_cbranch_scc1 G1_LN
s_sub_u32 s26, s16, 16
s_and_b32 s33, s16, 0xf0
s_cmp_lg_u32 s33, 160
s_cbranch_scc1 G1_NOLN
G1_LN:
s_load_dwordx2 s[60:61], s[0:1], 0
s_mov_b32 s62, 2097152
s_mov_b32 s63, 0x20000
v_and_b32 v8, 7, v0
v_lshrrev_b32 v9, 3, v0
v_lshlrev_b32 v14, 10, v8
v_lshl_add_u32 v14, v9, 4, v14
s_lshl_b32 s27, s26, 13
s_waitcnt lgkmcnt(0)
buffer_load_dwordx4 v[16:19], v14, s[60:63], s27 offen offset:0
buffer_load_dwordx4 v[20:23], v14, s[60:63], s27 offen offset:128
buffer_load_dwordx4 v[24:27], v14, s[60:63], s27 offen offset:256
buffer_load_dwordx4 v[28:31], v14, s[60:63], s27 offen offset:384
buffer_load_dwordx4 v[32:35], v14, s[60:63], s27 offen offset:512
buffer_load_dwordx4 v[36:39], v14, s[60:63], s27 offen offset:640
buffer_load_dwordx4 v[40:43], v14, s[60:63], s27 offen offset:768
buffer_load_dwordx4 v[44:47], v14, s[60:63], s27 offen offset:896
v_lshrrev_b32 v15, 2, v9
v_lshlrev_b32 v15, 11, v15
v_and_b32 v9, 3, v9
v_lshl_add_u32 v15, v9, 8, v15
v_lshl_add_u32 v15, v8, 4, v15
s_lshr_b32 s27, s26, 2
s_lshl_b32 s27, s27, 15
s_bfe_u32 s28, s26, 0x10001
s_lshl_b32 s28, s28, 10
s_add_u32 s27, s27, s28
s_and_b32 s28, s26, 1
s_lshl_b32 s28, s28, 7
s_add_u32 s27, s27, s28
s_add_u32 s27, s27, 0
v_mov_b32 v10, 0
v_mov_b32 v11, 0
s_waitcnt vmcnt(7)
v_lshlrev_b32 v48, 16, v16
v_and_b32 v49, 0xffff0000, v16
v_pk_add_f32 v[10:11], v[10:11], v[48:49]
v_lshlrev_b32 v50, 16, v17
v_and_b32 v51, 0xffff0000, v17
v_pk_add_f32 v[10:11], v[10:11], v[50:51]
v_lshlrev_b32 v52, 16, v18
v_and_b32 v53, 0xffff0000, v18
v_pk_add_f32 v[10:11], v[10:11], v[52:53]
v_lshlrev_b32 v54, 16, v19
v_and_b32 v55, 0xffff0000, v19
v_pk_add_f32 v[10:11], v[10:11], v[54:55]
s_waitcnt vmcnt(6)
v_lshlrev_b32 v56, 16, v20
v_and_b32 v57, 0xffff0000, v20
v_pk_add_f32 v[10:11], v[10:11], v[56:57]
v_lshlrev_b32 v58, 16, v21
v_and_b32 v59, 0xffff0000, v21
v_pk_add_f32 v[10:11], v[10:11], v[58:59]
v_lshlrev_b32 v60, 16, v22
v_and_b32 v61, 0xffff0000, v22
v_pk_add_f32 v[10:11], v[10:11], v[60:61]
v_lshlrev_b32 v62, 16, v23
v_and_b32 v63, 0xffff0000, v23
v_pk_add_f32 v[10:11], v[10:11], v[62:63]
s_waitcnt vmcnt(5)
v_lshlrev_b32 v64, 16, v24
v_and_b32 v65, 0xffff0000, v24
v_pk_add_f32 v[10:11], v[10:11], v[64:65]
v_lshlrev_b32 v66, 16, v25
v_and_b32 v67, 0xffff0000, v25
v_pk_add_f32 v[10:11], v[10:11], v[66:67]
v_lshlrev_b32 v68, 16, v26
v_and_b32 v69, 0xffff0000, v26
v_pk_add_f32 v[10:11], v[10:11], v[68:69]
v_lshlrev_b32 v70, 16, v27
v_and_b32 v71, 0xffff0000, v27
v_pk_add_f32 v[10:11], v[10:11], v[70:71]
s_waitcnt vmcnt(4)
v_lshlrev_b32 v72, 16, v28
v_and_b32 v73, 0xffff0000, v28
v_pk_add_f32 v[10:11], v[10:11], v[72:73]
v_lshlrev_b32 v74, 16, v29
v_and_b32 v75, 0xffff0000, v29
v_pk_add_f32 v[10:11], v[10:11], v[74:75]
v_lshlrev_b32 v76, 16, v30
v_and_b32 v77, 0xffff0000, v30
v_pk_add_f32 v[10:11], v[10:11], v[76:77]
v_lshlrev_b32 v78, 16, v31
v_and_b32 v79, 0xffff0000, v31
v_pk_add_f32 v[10:11], v[10:11], v[78:79]
s_waitcnt vmcnt(3)
v_lshlrev_b32 v80, 16, v32
v_and_b32 v81, 0xffff0000, v32
v_pk_add_f32 v[10:11], v[10:11], v[80:81]
v_lshlrev_b32 v82, 16, v33
v_and_b32 v83, 0xffff0000, v33
v_pk_add_f32 v[10:11], v[10:11], v[82:83]
v_lshlrev_b32 v84, 16, v34
v_and_b32 v85, 0xffff0000, v34
v_pk_add_f32 v[10:11], v[10:11], v[84:85]
v_lshlrev_b32 v86, 16, v35
v_and_b32 v87, 0xffff0000, v35
v_pk_add_f32 v[10:11], v[10:11], v[86:87]
s_waitcnt vmcnt(2)
v_lshlrev_b32 v88, 16, v36
v_and_b32 v89, 0xffff0000, v36
v_pk_add_f32 v[10:11], v[10:11], v[88:89]
v_lshlrev_b32 v90, 16, v37
v_and_b32 v91, 0xffff0000, v37
v_pk_add_f32 v[10:11], v[10:11], v[90:91]
v_lshlrev_b32 v92, 16, v38
v_and_b32 v93, 0xffff0000, v38
v_pk_add_f32 v[10:11], v[10:11], v[92:93]
v_lshlrev_b32 v94, 16, v39
v_and_b32 v95, 0xffff0000, v39
v_pk_add_f32 v[10:11], v[10:11], v[94:95]
s_waitcnt vmcnt(1)
v_lshlrev_b32 v96, 16, v40
v_and_b32 v97, 0xffff0000, v40
v_pk_add_f32 v[10:11], v[10:11], v[96:97]
v_lshlrev_b32 v98, 16, v41
v_and_b32 v99, 0xffff0000, v41
v_pk_add_f32 v[10:11], v[10:11], v[98:99]
v_lshlrev_b32 v100, 16, v42
v_and_b32 v101, 0xffff0000, v42
v_pk_add_f32 v[10:11], v[10:11], v[100:101]
v_lshlrev_b32 v102, 16, v43
v_and_b32 v103, 0xffff0000, v43
v_pk_add_f32 v[10:11], v[10:11], v[102:103]
s_waitcnt vmcnt(0)
v_lshlrev_b32 v104, 16, v44
v_and_b32 v105, 0xffff0000, v44
v_pk_add_f32 v[10:11], v[10:11], v[104:105]
v_lshlrev_b32 v106, 16, v45
v_and_b32 v107, 0xffff0000, v45
v_pk_add_f32 v[10:11], v[10:11], v[106:107]
v_lshlrev_b32 v108, 16, v46
v_and_b32 v109, 0xffff0000, v46
v_pk_add_f32 v[10:11], v[10:11], v[108:109]
v_lshlrev_b32 v110, 16, v47
v_and_b32 v111, 0xffff0000, v47
v_pk_add_f32 v[10:11], v[10:11], v[110:111]
v_add_f32 v10, v10, v11
s_nop 1
v_add_f32_dpp v10, v10, v10 row_ror:8 row_mask:0xf bank_mask:0xf
v_mov_b32 v11, v10
s_nop 1
v_permlane32_swap_b32 v10, v11
v_add_f32 v10, v10, v11
v_mov_b32 v11, v10
s_nop 1
v_permlane16_swap_b32 v10, v11
v_add_f32 v10, v10, v11
v_mul_f32 v12, 0x3b000000, v10
v_mov_b32 v10, 0
v_mov_b32 v11, 0
v_pk_add_f32 v[48:49], v[48:49], v[12:13] op_sel_hi:[1,0] neg_lo:[0,1] neg_hi:[0,1]
v_pk_fma_f32 v[10:11], v[48:49], v[48:49], v[10:11]
v_pk_add_f32 v[50:51], v[50:51], v[12:13] op_sel_hi:[1,0] neg_lo:[0,1] neg_hi:[0,1]
v_pk_fma_f32 v[10:11], v[50:51], v[50:51], v[10:11]
v_pk_add_f32 v[52:53], v[52:53], v[12:13] op_sel_hi:[1,0] neg_lo:[0,1] neg_hi:[0,1]
v_pk_fma_f32 v[10:11], v[52:53], v[52:53], v[10:11]
v_pk_add_f32 v[54:55], v[54:55], v[12:13] op_sel_hi:[1,0] neg_lo:[0,1] neg_hi:[0,1]
v_pk_fma_f32 v[10:11], v[54:55], v[54:55], v[10:11]
v_pk_add_f32 v[56:57], v[56:57], v[12:13] op_sel_hi:[1,0] neg_lo:[0,1] neg_hi:[0,1]
v_pk_fma_f32 v[10:11], v[56:57], v[56:57], v[10:11]
v_pk_add_f32 v[58:59], v[58:59], v[12:13] op_sel_hi:[1,0] neg_lo:[0,1] neg_hi:[0,1]
v_pk_fma_f32 v[10:11], v[58:59], v[58:59], v[10:11]
v_pk_add_f32 v[60:61], v[60:61], v[12:13] op_sel_hi:[1,0] neg_lo:[0,1] neg_hi:[0,1]
v_pk_fma_f32 v[10:11], v[60:61], v[60:61], v[10:11]
v_pk_add_f32 v[62:63], v[62:63], v[12:13] op_sel_hi:[1,0] neg_lo:[0,1] neg_hi:[0,1]
v_pk_fma_f32 v[10:11], v[62:63], v[62:63], v[10:11]
v_pk_add_f32 v[64:65], v[64:65], v[12:13] op_sel_hi:[1,0] neg_lo:[0,1] neg_hi:[0,1]
v_pk_fma_f32 v[10:11], v[64:65], v[64:65], v[10:11]
v_pk_add_f32 v[66:67], v[66:67], v[12:13] op_sel_hi:[1,0] neg_lo:[0,1] neg_hi:[0,1]
v_pk_fma_f32 v[10:11], v[66:67], v[66:67], v[10:11]
v_pk_add_f32 v[68:69], v[68:69], v[12:13] op_sel_hi:[1,0] neg_lo:[0,1] neg_hi:[0,1]
v_pk_fma_f32 v[10:11], v[68:69], v[68:69], v[10:11]
v_pk_add_f32 v[70:71], v[70:71], v[12:13] op_sel_hi:[1,0] neg_lo:[0,1] neg_hi:[0,1]
v_pk_fma_f32 v[10:11], v[70:71], v[70:71], v[10:11]
v_pk_add_f32 v[72:73], v[72:73], v[12:13] op_sel_hi:[1,0] neg_lo:[0,1] neg_hi:[0,1]
v_pk_fma_f32 v[10:11], v[72:73], v[72:73], v[10:11]
v_pk_add_f32 v[74:75], v[74:75], v[12:13] op_sel_hi:[1,0] neg_lo:[0,1] neg_hi:[0,1]
v_pk_fma_f32 v[10:11], v[74:75], v[74:75], v[10:11]
v_pk_add_f32 v[76:77], v[76:77], v[12:13] op_sel_hi:[1,0] neg_lo:[0,1] neg_hi:[0,1]
v_pk_fma_f32 v[10:11], v[76:77], v[76:77], v[10:11]
v_pk_add_f32 v[78:79], v[78:79], v[12:13] op_sel_hi:[1,0] neg_lo:[0,1] neg_hi:[0,1]
v_pk_fma_f32 v[10:11], v[78:79], v[78:79], v[10:11]
v_pk_add_f32 v[80:81], v[80:81], v[12:13] op_sel_hi:[1,0] neg_lo:[0,1] neg_hi:[0,1]
v_pk_fma_f32 v[10:11], v[80:81], v[80:81], v[10:11]
v_pk_add_f32 v[82:83], v[82:83], v[12:13] op_sel_hi:[1,0] neg_lo:[0,1] neg_hi:[0,1]
v_pk_fma_f32 v[10:11], v[82:83], v[82:83], v[10:11]
v_pk_add_f32 v[84:85], v[84:85], v[12:13] op_sel_hi:[1,0] neg_lo:[0,1] neg_hi:[0,1]
v_pk_fma_f32 v[10:11], v[84:85], v[84:85], v[10:11]
v_pk_add_f32 v[86:87], v[86:87], v[12:13] op_sel_hi:[1,0] neg_lo:[0,1] neg_hi:[0,1]
v_pk_fma_f32 v[10:11], v[86:87], v[86:87], v[10:11]
v_pk_add_f32 v[88:89], v[88:89], v[12:13] op_sel_hi:[1,0] neg_lo:[0,1] neg_hi:[0,1]
v_pk_fma_f32 v[10:11], v[88:89], v[88:89], v[10:11]
v_pk_add_f32 v[90:91], v[90:91], v[12:13] op_sel_hi:[1,0] neg_lo:[0,1] neg_hi:[0,1]
v_pk_fma_f32 v[10:11], v[90:91], v[90:91], v[10:11]
v_pk_add_f32 v[92:93], v[92:93], v[12:13] op_sel_hi:[1,0] neg_lo:[0,1] neg_hi:[0,1]
v_pk_fma_f32 v[10:11], v[92:93], v[92:93], v[10:11]
v_pk_add_f32 v[94:95], v[94:95], v[12:13] op_sel_hi:[1,0] neg_lo:[0,1] neg_hi:[0,1]
v_pk_fma_f32 v[10:11], v[94:95], v[94:95], v[10:11]
v_pk_add_f32 v[96:97], v[96:97], v[12:13] op_sel_hi:[1,0] neg_lo:[0,1] neg_hi:[0,1]
v_pk_fma_f32 v[10:11], v[96:97], v[96:97], v[10:11]
v_pk_add_f32 v[98:99], v[98:99], v[12:13] op_sel_hi:[1,0] neg_lo:[0,1] neg_hi:[0,1]
v_pk_fma_f32 v[10:11], v[98:99], v[98:99], v[10:11]
v_pk_add_f32 v[100:101], v[100:101], v[12:13] op_sel_hi:[1,0] neg_lo:[0,1] neg_hi:[0,1]
v_pk_fma_f32 v[10:11], v[100:101], v[100:101], v[10:11]
v_pk_add_f32 v[102:103], v[102:103], v[12:13] op_sel_hi:[1,0] neg_lo:[0,1] neg_hi:[0,1]
v_pk_fma_f32 v[10:11], v[102:103], v[102:103], v[10:11]
v_pk_add_f32 v[104:105], v[104:105], v[12:13] op_sel_hi:[1,0] neg_lo:[0,1] neg_hi:[0,1]
v_pk_fma_f32 v[10:11], v[104:105], v[104:105], v[10:11]
v_pk_add_f32 v[106:107], v[106:107], v[12:13] op_sel_hi:[1,0] neg_lo:[0,1] neg_hi:[0,1]
v_pk_fma_f32 v[10:11], v[106:107], v[106:107], v[10:11]
v_pk_add_f32 v[108:109], v[108:109], v[12:13] op_sel_hi:[1,0] neg_lo:[0,1] neg_hi:[0,1]
v_pk_fma_f32 v[10:11], v[108:109], v[108:109], v[10:11]
v_pk_add_f32 v[110:111], v[110:111], v[12:13] op_sel_hi:[1,0] neg_lo:[0,1] neg_hi:[0,1]
v_pk_fma_f32 v[10:11], v[110:111], v[110:111], v[10:11]
v_add_f32 v10, v10, v11
s_nop 1
v_add_f32_dpp v10, v10, v10 row_ror:8 row_mask:0xf bank_mask:0xf
v_mov_b32 v11, v10
s_nop 1
v_permlane32_swap_b32 v10, v11
v_add_f32 v10, v10, v11
v_mov_b32 v11, v10
s_nop 1
v_permlane16_swap_b32 v10, v11
v_add_f32 v10, v10, v11
v_mov_b32 v12, 0x3727c5ac
v_fmac_f32 v12, 0x3b000000, v10
v_rsq_f32 v12, v12
s_nop 0
v_pk_mul_f32 v[48:49], v[48:49], v[12:13] op_sel_hi:[1,0]
v_cvt_pk_bf16_f32 v16, v48, v49
v_pk_mul_f32 v[50:51], v[50:51], v[12:13] op_sel_hi:[1,0]
v_cvt_pk_bf16_f32 v17, v50, v51
v_pk_mul_f32 v[52:53], v[52:53], v[12:13] op_sel_hi:[1,0]
v_cvt_pk_bf16_f32 v18, v52, v53
v_pk_mul_f32 v[54:55], v[54:55], v[12:13] op_sel_hi:[1,0]
v_cvt_pk_bf16_f32 v19, v54, v55
buffer_store_dwordx4 v[16:19], v15, s[8:11], s27 offen sc1
s_add_u32 s27, s27, 4096
v_pk_mul_f32 v[56:57], v[56:57], v[12:13] op_sel_hi:[1,0]
v_cvt_pk_bf16_f32 v20, v56, v57
v_pk_mul_f32 v[58:59], v[58:59], v[12:13] op_sel_hi:[1,0]
v_cvt_pk_bf16_f32 v21, v58, v59
v_pk_mul_f32 v[60:61], v[60:61], v[12:13] op_sel_hi:[1,0]
v_cvt_pk_bf16_f32 v22, v60, v61
v_pk_mul_f32 v[62:63], v[62:63], v[12:13] op_sel_hi:[1,0]
v_cvt_pk_bf16_f32 v23, v62, v63
buffer_store_dwordx4 v[20:23], v15, s[8:11], s27 offen sc1
s_add_u32 s27, s27, 4096
v_pk_mul_f32 v[64:65], v[64:65], v[12:13] op_sel_hi:[1,0]
v_cvt_pk_bf16_f32 v24, v64, v65
v_pk_mul_f32 v[66:67], v[66:67], v[12:13] op_sel_hi:[1,0]
v_cvt_pk_bf16_f32 v25, v66, v67
v_pk_mul_f32 v[68:69], v[68:69], v[12:13] op_sel_hi:[1,0]
v_cvt_pk_bf16_f32 v26, v68, v69
v_pk_mul_f32 v[70:71], v[70:71], v[12:13] op_sel_hi:[1,0]
v_cvt_pk_bf16_f32 v27, v70, v71
buffer_store_dwordx4 v[24:27], v15, s[8:11], s27 offen sc1
s_add_u32 s27, s27, 4096
v_pk_mul_f32 v[72:73], v[72:73], v[12:13] op_sel_hi:[1,0]
v_cvt_pk_bf16_f32 v28, v72, v73
v_pk_mul_f32 v[74:75], v[74:75], v[12:13] op_sel_hi:[1,0]
v_cvt_pk_bf16_f32 v29, v74, v75
v_pk_mul_f32 v[76:77], v[76:77], v[12:13] op_sel_hi:[1,0]
v_cvt_pk_bf16_f32 v30, v76, v77
v_pk_mul_f32 v[78:79], v[78:79], v[12:13] op_sel_hi:[1,0]
v_cvt_pk_bf16_f32 v31, v78, v79
buffer_store_dwordx4 v[28:31], v15, s[8:11], s27 offen sc1
s_add_u32 s27, s27, 4096
v_pk_mul_f32 v[80:81], v[80:81], v[12:13] op_sel_hi:[1,0]
v_cvt_pk_bf16_f32 v32, v80, v81
v_pk_mul_f32 v[82:83], v[82:83], v[12:13] op_sel_hi:[1,0]
v_cvt_pk_bf16_f32 v33, v82, v83
v_pk_mul_f32 v[84:85], v[84:85], v[12:13] op_sel_hi:[1,0]
v_cvt_pk_bf16_f32 v34, v84, v85
v_pk_mul_f32 v[86:87], v[86:87], v[12:13] op_sel_hi:[1,0]
v_cvt_pk_bf16_f32 v35, v86, v87
buffer_store_dwordx4 v[32:35], v15, s[8:11], s27 offen sc1
s_add_u32 s27, s27, 4096
v_pk_mul_f32 v[88:89], v[88:89], v[12:13] op_sel_hi:[1,0]
v_cvt_pk_bf16_f32 v36, v88, v89
v_pk_mul_f32 v[90:91], v[90:91], v[12:13] op_sel_hi:[1,0]
v_cvt_pk_bf16_f32 v37, v90, v91
v_pk_mul_f32 v[92:93], v[92:93], v[12:13] op_sel_hi:[1,0]
v_cvt_pk_bf16_f32 v38, v92, v93
v_pk_mul_f32 v[94:95], v[94:95], v[12:13] op_sel_hi:[1,0]
v_cvt_pk_bf16_f32 v39, v94, v95
buffer_store_dwordx4 v[36:39], v15, s[8:11], s27 offen sc1
s_add_u32 s27, s27, 4096
v_pk_mul_f32 v[96:97], v[96:97], v[12:13] op_sel_hi:[1,0]
v_cvt_pk_bf16_f32 v40, v96, v97
v_pk_mul_f32 v[98:99], v[98:99], v[12:13] op_sel_hi:[1,0]
v_cvt_pk_bf16_f32 v41, v98, v99
v_pk_mul_f32 v[100:101], v[100:101], v[12:13] op_sel_hi:[1,0]
v_cvt_pk_bf16_f32 v42, v100, v101
v_pk_mul_f32 v[102:103], v[102:103], v[12:13] op_sel_hi:[1,0]
v_cvt_pk_bf16_f32 v43, v102, v103
buffer_store_dwordx4 v[40:43], v15, s[8:11], s27 offen sc1
s_add_u32 s27, s27, 4096
v_pk_mul_f32 v[104:105], v[104:105], v[12:13] op_sel_hi:[1,0]
v_cvt_pk_bf16_f32 v44, v104, v105
v_pk_mul_f32 v[106:107], v[106:107], v[12:13] op_sel_hi:[1,0]
v_cvt_pk_bf16_f32 v45, v106, v107
v_pk_mul_f32 v[108:109], v[108:109], v[12:13] op_sel_hi:[1,0]
v_cvt_pk_bf16_f32 v46, v108, v109
v_pk_mul_f32 v[110:111], v[110:111], v[12:13] op_sel_hi:[1,0]
v_cvt_pk_bf16_f32 v47, v110, v111
buffer_store_dwordx4 v[44:47], v15, s[8:11], s27 offen sc1
s_add_u32 s27, s27, 4096
s_mov_b32 s31, 1
s_branch G1_LN1
G1_NOLN:
G1_LN1:
s_cmp_ge_u32 s16, 188
s_cbranch_scc1 G1_IDLE
s_lshl_b32 s30, s19, 2
s_add_u32 s30, s30, s17
s_load_dwordx2 s[60:61], s[0:1], 0
s_mov_b32 s62, 2097152
s_mov_b32 s63, 0x20000
v_and_b32 v8, 7, v0
v_lshrrev_b32 v9, 3, v0
v_lshlrev_b32 v14, 10, v8
v_lshl_add_u32 v14, v9, 4, v14
s_lshl_b32 s27, s30, 13
s_waitcnt lgkmcnt(0)
buffer_load_dwordx4 v[16:19], v14, s[60:63], s27 offen offset:0
buffer_load_dwordx4 v[20:23], v14, s[60:63], s27 offen offset:128
buffer_load_dwordx4 v[24:27], v14, s[60:63], s27 offen offset:256
buffer_load_dwordx4 v[28:31], v14, s[60:63], s27 offen offset:384
buffer_load_dwordx4 v[32:35], v14, s[60:63], s27 offen offset:512
buffer_load_dwordx4 v[36:39], v14, s[60:63], s27 offen offset:640
buffer_load_dwordx4 v[40:43], v14, s[60:63], s27 offen offset:768
buffer_load_dwordx4 v[44:47], v14, s[60:63], s27 offen offset:896
v_lshrrev_b32 v15, 2, v9
v_lshlrev_b32 v15, 11, v15
v_and_b32 v9, 3, v9
v_lshl_add_u32 v15, v9, 8, v15
v_lshl_add_u32 v15, v8, 4, v15
s_lshr_b32 s27, s30, 2
s_lshl_b32 s27, s27, 15
s_bfe_u32 s28, s30, 0x10001
s_lshl_b32 s28, s28, 10
s_add_u32 s27, s27, s28
s_and_b32 s28, s30, 1
s_lshl_b32 s28, s28, 7
s_add_u32 s27, s27, s28
s_add_u32 s27, s27, 0
v_mov_b32 v10, 0
v_mov_b32 v11, 0
v_mov_b32 v2, 4
buffer_load_dword v251, v2, s[4:7], 0 offen sc1
s_add_u32 m0, s32, 0
s_nop 0
buffer_load_dwordx4 v244, s[12:15], s23 offen lds
s_add_u32 s23, s23, s34
s_add_u32 m0, s32, 1024
s_nop 0
buffer_load_dwordx4 v245, s[12:15], s23 offen lds
s_add_u32 s23, s23, s34
s_add_u32 m0, s32, 2048
s_nop 0
buffer_load_dwordx4 v244, s[12:15], s23 offen lds
s_add_u32 s23, s23, s34
s_add_u32 m0, s32, 3072
s_nop 0
buffer_load_dwordx4 v245, s[12:15], s23 offen lds
s_add_u32 s23, s23, s34
s_add_u32 m0, s32, 4096
s_nop 0
buffer_load_dwordx4 v244, s[12:15], s23 offen lds
s_add_u32 s23, s23, s34
s_add_u32 m0, s32, 5120
s_nop 0
buffer_load_dwordx4 v245, s[12:15], s23 offen lds
s_add_u32 s23, s23, s34
s_add_u32 m0, s32, 6144
s_nop 0
buffer_load_dwordx4 v244, s[12:15], s23 offen lds
s_add_u32 s23, s23, s34
s_add_u32 m0, s32, 7168
s_nop 0
buffer_load_dwordx4 v245, s[12:15], s23 offen lds
s_add_u32 s23, s23, s34
s_add_u32 m0, s32, 8192
s_nop 0
buffer_load_dwordx4 v244, s[12:15], s23 offen lds
s_add_u32 s23, s23, s34
s_add_u32 m0, s32, 9216
s_nop 0
buffer_load_dwordx4 v245, s[12:15], s23 offen lds
s_add_u32 s23, s23, s34
s_add_u32 m0, s32, 10240
s_nop 0
buffer_load_dwordx4 v244, s[12:15], s23 offen lds
s_add_u32 s23, s23, s34
s_add_u32 m0, s32, 11264
s_nop 0
buffer_load_dwordx4 v245, s[12:15], s23 offen lds
s_add_u32 s23, s23, s34
s_add_u32 m0, s32, 12288
s_nop 0
buffer_load_dwordx4 v244, s[12:15], s23 offen lds
s_add_u32 s23, s23, s34
s_add_u32 m0, s32, 13312
s_nop 0
buffer_load_dwordx4 v245, s[12:15], s23 offen lds
s_add_u32 s23, s23, s34
s_add_u32 m0, s32, 14336
s_nop 0
buffer_load_dwordx4 v244, s[12:15], s23 offen lds
s_add_u32 s23, s23, s34
s_add_u32 m0, s32, 15360
s_nop 0
buffer_load_dwordx4 v245, s[12:15], s23 offen lds
s_add_u32 s23, s23, s34
s_add_u32 m0, s32, 16384
s_nop 0
buffer_load_dwordx4 v244, s[12:15], s23 offen lds
s_add_u32 s23, s23, s34
s_add_u32 m0, s32, 17408
s_nop 0
buffer_load_dwordx4 v245, s[12:15], s23 offen lds
s_add_u32 s23, s23, s34
s_add_u32 m0, s32, 18432
s_nop 0
buffer_load_dwordx4 v244, s[12:15], s23 offen lds
s_add_u32 s23, s23, s34
s_add_u32 m0, s32, 19456
s_nop 0
buffer_load_dwordx4 v245, s[12:15], s23 offen lds
s_add_u32 s23, s23, s34
s_add_u32 m0, s32, 20480
s_nop 0
buffer_load_dwordx4 v244, s[12:15], s23 offen lds
s_add_u32 s23, s23, s34
s_add_u32 m0, s32, 21504
s_nop 0
buffer_load_dwordx4 v245, s[12:15], s23 offen lds
s_add_u32 s23, s23, s34
s_add_u32 m0, s32, 22528
s_nop 0
buffer_load_dwordx4 v244, s[12:15], s23 offen lds
s_add_u32 s23, s23, s34
s_add_u32 m0, s32, 23552
s_nop 0
buffer_load_dwordx4 v245, s[12:15], s23 offen lds
s_add_u32 s23, s23, s34
s_waitcnt vmcnt(32)
v_lshlrev_b32 v48, 16, v16
v_and_b32 v49, 0xffff0000, v16
v_pk_add_f32 v[10:11], v[10:11], v[48:49]
v_lshlrev_b32 v50, 16, v17
v_and_b32 v51, 0xffff0000, v17
v_pk_add_f32 v[10:11], v[10:11], v[50:51]
v_lshlrev_b32 v52, 16, v18
v_and_b32 v53, 0xffff0000, v18
v_pk_add_f32 v[10:11], v[10:11], v[52:53]
v_lshlrev_b32 v54, 16, v19
v_and_b32 v55, 0xffff0000, v19
v_pk_add_f32 v[10:11], v[10:11], v[54:55]
s_waitcnt vmcnt(31)
v_lshlrev_b32 v56, 16, v20
v_and_b32 v57, 0xffff0000, v20
v_pk_add_f32 v[10:11], v[10:11], v[56:57]
v_lshlrev_b32 v58, 16, v21
v_and_b32 v59, 0xffff0000, v21
v_pk_add_f32 v[10:11], v[10:11], v[58:59]
v_lshlrev_b32 v60, 16, v22
v_and_b32 v61, 0xffff0000, v22
v_pk_add_f32 v[10:11], v[10:11], v[60:61]
v_lshlrev_b32 v62, 16, v23
v_and_b32 v63, 0xffff0000, v23
v_pk_add_f32 v[10:11], v[10:11], v[62:63]
s_waitcnt vmcnt(30)
v_lshlrev_b32 v64, 16, v24
v_and_b32 v65, 0xffff0000, v24
v_pk_add_f32 v[10:11], v[10:11], v[64:65]
v_lshlrev_b32 v66, 16, v25
v_and_b32 v67, 0xffff0000, v25
v_pk_add_f32 v[10:11], v[10:11], v[66:67]
v_lshlrev_b32 v68, 16, v26
v_and_b32 v69, 0xffff0000, v26
v_pk_add_f32 v[10:11], v[10:11], v[68:69]
v_lshlrev_b32 v70, 16, v27
v_and_b32 v71, 0xffff0000, v27
v_pk_add_f32 v[10:11], v[10:11], v[70:71]
s_waitcnt vmcnt(29)
v_lshlrev_b32 v72, 16, v28
v_and_b32 v73, 0xffff0000, v28
v_pk_add_f32 v[10:11], v[10:11], v[72:73]
v_lshlrev_b32 v74, 16, v29
v_and_b32 v75, 0xffff0000, v29
v_pk_add_f32 v[10:11], v[10:11], v[74:75]
v_lshlrev_b32 v76, 16, v30
v_and_b32 v77, 0xffff0000, v30
v_pk_add_f32 v[10:11], v[10:11], v[76:77]
v_lshlrev_b32 v78, 16, v31
v_and_b32 v79, 0xffff0000, v31
v_pk_add_f32 v[10:11], v[10:11], v[78:79]
s_waitcnt vmcnt(28)
v_lshlrev_b32 v80, 16, v32
v_and_b32 v81, 0xffff0000, v32
v_pk_add_f32 v[10:11], v[10:11], v[80:81]
v_lshlrev_b32 v82, 16, v33
v_and_b32 v83, 0xffff0000, v33
v_pk_add_f32 v[10:11], v[10:11], v[82:83]
v_lshlrev_b32 v84, 16, v34
v_and_b32 v85, 0xffff0000, v34
v_pk_add_f32 v[10:11], v[10:11], v[84:85]
v_lshlrev_b32 v86, 16, v35
v_and_b32 v87, 0xffff0000, v35
v_pk_add_f32 v[10:11], v[10:11], v[86:87]
s_waitcnt vmcnt(27)
v_lshlrev_b32 v88, 16, v36
v_and_b32 v89, 0xffff0000, v36
v_pk_add_f32 v[10:11], v[10:11], v[88:89]
v_lshlrev_b32 v90, 16, v37
v_and_b32 v91, 0xffff0000, v37
v_pk_add_f32 v[10:11], v[10:11], v[90:91]
v_lshlrev_b32 v92, 16, v38
v_and_b32 v93, 0xffff0000, v38
v_pk_add_f32 v[10:11], v[10:11], v[92:93]
v_lshlrev_b32 v94, 16, v39
v_and_b32 v95, 0xffff0000, v39
v_pk_add_f32 v[10:11], v[10:11], v[94:95]
s_waitcnt vmcnt(26)
v_lshlrev_b32 v96, 16, v40
v_and_b32 v97, 0xffff0000, v40
v_pk_add_f32 v[10:11], v[10:11], v[96:97]
v_lshlrev_b32 v98, 16, v41
v_and_b32 v99, 0xffff0000, v41
v_pk_add_f32 v[10:11], v[10:11], v[98:99]
v_lshlrev_b32 v100, 16, v42
v_and_b32 v101, 0xffff0000, v42
v_pk_add_f32 v[10:11], v[10:11], v[100:101]
v_lshlrev_b32 v102, 16, v43
v_and_b32 v103, 0xffff0000, v43
v_pk_add_f32 v[10:11], v[10:11], v[102:103]
s_waitcnt vmcnt(25)
v_lshlrev_b32 v104, 16, v44
v_and_b32 v105, 0xffff0000, v44
v_pk_add_f32 v[10:11], v[10:11], v[104:105]
v_lshlrev_b32 v106, 16, v45
v_and_b32 v107, 0xffff0000, v45
v_pk_add_f32 v[10:11], v[10:11], v[106:107]
v_lshlrev_b32 v108, 16, v46
v_and_b32 v109, 0xffff0000, v46
v_pk_add_f32 v[10:11], v[10:11], v[108:109]
v_lshlrev_b32 v110, 16, v47
v_and_b32 v111, 0xffff0000, v47
v_pk_add_f32 v[10:11], v[10:11], v[110:111]
s_waitcnt vmcnt(24)
s_cmp_eq_u32 s31, 0
s_cbranch_scc1 LNREP_3
v_readfirstlane_b32 s33, v251
s_nop 3
s_cmp_ge_u32 s33, 32
s_cselect_b32 s84, 1, s84
s_cmp_lg_u32 s84, 0
s_cbranch_scc1 INIT_4
v_mov_b32 v2, 4
s_mov_b32 s35, 0
POLL_INIT_5:
s_cmp_lg_u32 s37, 0
s_cbranch_scc1 POLL_INIT_5_E
buffer_load_dword v3, v2, s[4:7], 0 offen sc1
s_add_u32 s35, s35, 1
s_cmp_gt_u32 s35, 65536
s_cselect_b32 s37, 1, 0
s_waitcnt vmcnt(0)
v_cmp_gt_u32 vcc, 32, v3
s_cbranch_vccz POLL_INIT_5_E
s_sleep 4
s_branch POLL_INIT_5
POLL_INIT_5_E:
s_mov_b32 s84, 1
INIT_4:
s_lshl_b32 s33, s26, 7
s_add_u32 s33, s33, 91340800
v_mov_b32 v2, 1
s_mov_b64 exec, 1
buffer_store_dword v2, off, s[8:11], s33 sc1
s_mov_b64 exec, -1
LNREP_3:
v_add_f32 v10, v10, v11
s_nop 1
v_add_f32_dpp v10, v10, v10 row_ror:8 row_mask:0xf bank_mask:0xf
v_mov_b32 v11, v10
s_nop 1
v_permlane32_swap_b32 v10, v11
v_add_f32 v10, v10, v11
v_mov_b32 v11, v10
s_nop 1
v_permlane16_swap_b32 v10, v11
v_add_f32 v10, v10, v11
v_mul_f32 v12, 0x3b000000, v10
v_mov_b32 v10, 0
v_mov_b32 v11, 0
v_pk_add_f32 v[48:49], v[48:49], v[12:13] op_sel_hi:[1,0] neg_lo:[0,1] neg_hi:[0,1]
v_pk_fma_f32 v[10:11], v[48:49], v[48:49], v[10:11]
v_pk_add_f32 v[50:51], v[50:51], v[12:13] op_sel_hi:[1,0] neg_lo:[0,1] neg_hi:[0,1]
v_pk_fma_f32 v[10:11], v[50:51], v[50:51], v[10:11]
v_pk_add_f32 v[52:53], v[52:53], v[12:13] op_sel_hi:[1,0] neg_lo:[0,1] neg_hi:[0,1]
v_pk_fma_f32 v[10:11], v[52:53], v[52:53], v[10:11]
v_pk_add_f32 v[54:55], v[54:55], v[12:13] op_sel_hi:[1,0] neg_lo:[0,1] neg_hi:[0,1]
v_pk_fma_f32 v[10:11], v[54:55], v[54:55], v[10:11]
v_pk_add_f32 v[56:57], v[56:57], v[12:13] op_sel_hi:[1,0] neg_lo:[0,1] neg_hi:[0,1]
v_pk_fma_f32 v[10:11], v[56:57], v[56:57], v[10:11]
v_pk_add_f32 v[58:59], v[58:59], v[12:13] op_sel_hi:[1,0] neg_lo:[0,1] neg_hi:[0,1]
v_pk_fma_f32 v[10:11], v[58:59], v[58:59], v[10:11]
v_pk_add_f32 v[60:61], v[60:61], v[12:13] op_sel_hi:[1,0] neg_lo:[0,1] neg_hi:[0,1]
v_pk_fma_f32 v[10:11], v[60:61], v[60:61], v[10:11]
v_pk_add_f32 v[62:63], v[62:63], v[12:13] op_sel_hi:[1,0] neg_lo:[0,1] neg_hi:[0,1]
v_pk_fma_f32 v[10:11], v[62:63], v[62:63], v[10:11]
v_pk_add_f32 v[64:65], v[64:65], v[12:13] op_sel_hi:[1,0] neg_lo:[0,1] neg_hi:[0,1]
v_pk_fma_f32 v[10:11], v[64:65], v[64:65], v[10:11]
v_pk_add_f32 v[66:67], v[66:67], v[12:13] op_sel_hi:[1,0] neg_lo:[0,1] neg_hi:[0,1]
v_pk_fma_f32 v[10:11], v[66:67], v[66:67], v[10:11]
v_pk_add_f32 v[68:69], v[68:69], v[12:13] op_sel_hi:[1,0] neg_lo:[0,1] neg_hi:[0,1]
v_pk_fma_f32 v[10:11], v[68:69], v[68:69], v[10:11]
v_pk_add_f32 v[70:71], v[70:71], v[12:13] op_sel_hi:[1,0] neg_lo:[0,1] neg_hi:[0,1]
v_pk_fma_f32 v[10:11], v[70:71], v[70:71], v[10:11]
v_pk_add_f32 v[72:73], v[72:73], v[12:13] op_sel_hi:[1,0] neg_lo:[0,1] neg_hi:[0,1]
v_pk_fma_f32 v[10:11], v[72:73], v[72:73], v[10:11]
v_pk_add_f32 v[74:75], v[74:75], v[12:13] op_sel_hi:[1,0] neg_lo:[0,1] neg_hi:[0,1]
v_pk_fma_f32 v[10:11], v[74:75], v[74:75], v[10:11]
v_pk_add_f32 v[76:77], v[76:77], v[12:13] op_sel_hi:[1,0] neg_lo:[0,1] neg_hi:[0,1]
v_pk_fma_f32 v[10:11], v[76:77], v[76:77], v[10:11]
v_pk_add_f32 v[78:79], v[78:79], v[12:13] op_sel_hi:[1,0] neg_lo:[0,1] neg_hi:[0,1]
v_pk_fma_f32 v[10:11], v[78:79], v[78:79], v[10:11]
v_pk_add_f32 v[80:81], v[80:81], v[12:13] op_sel_hi:[1,0] neg_lo:[0,1] neg_hi:[0,1]
v_pk_fma_f32 v[10:11], v[80:81], v[80:81], v[10:11]
v_pk_add_f32 v[82:83], v[82:83], v[12:13] op_sel_hi:[1,0] neg_lo:[0,1] neg_hi:[0,1]
v_pk_fma_f32 v[10:11], v[82:83], v[82:83], v[10:11]
v_pk_add_f32 v[84:85], v[84:85], v[12:13] op_sel_hi:[1,0] neg_lo:[0,1] neg_hi:[0,1]
v_pk_fma_f32 v[10:11], v[84:85], v[84:85], v[10:11]
v_pk_add_f32 v[86:87], v[86:87], v[12:13] op_sel_hi:[1,0] neg_lo:[0,1] neg_hi:[0,1]
v_pk_fma_f32 v[10:11], v[86:87], v[86:87], v[10:11]
v_pk_add_f32 v[88:89], v[88:89], v[12:13] op_sel_hi:[1,0] neg_lo:[0,1] neg_hi:[0,1]
v_pk_fma_f32 v[10:11], v[88:89], v[88:89], v[10:11]
v_pk_add_f32 v[90:91], v[90:91], v[12:13] op_sel_hi:[1,0] neg_lo:[0,1] neg_hi:[0,1]
v_pk_fma_f32 v[10:11], v[90:91], v[90:91], v[10:11]
v_pk_add_f32 v[92:93], v[92:93], v[12:13] op_sel_hi:[1,0] neg_lo:[0,1] neg_hi:[0,1]
v_pk_fma_f32 v[10:11], v[92:93], v[92:93], v[10:11]
v_pk_add_f32 v[94:95], v[94:95], v[12:13] op_sel_hi:[1,0] neg_lo:[0,1] neg_hi:[0,1]
v_pk_fma_f32 v[10:11], v[94:95], v[94:95], v[10:11]
v_pk_add_f32 v[96:97], v[96:97], v[12:13] op_sel_hi:[1,0] neg_lo:[0,1] neg_hi:[0,1]
v_pk_fma_f32 v[10:11], v[96:97], v[96:97], v[10:11]
v_pk_add_f32 v[98:99], v[98:99], v[12:13] op_sel_hi:[1,0] neg_lo:[0,1] neg_hi:[0,1]
v_pk_fma_f32 v[10:11], v[98:99], v[98:99], v[10:11]
v_pk_add_f32 v[100:101], v[100:101], v[12:13] op_sel_hi:[1,0] neg_lo:[0,1] neg_hi:[0,1]
v_pk_fma_f32 v[10:11], v[100:101], v[100:101], v[10:11]
v_pk_add_f32 v[102:103], v[102:103], v[12:13] op_sel_hi:[1,0] neg_lo:[0,1] neg_hi:[0,1]
v_pk_fma_f32 v[10:11], v[102:103], v[102:103], v[10:11]
v_pk_add_f32 v[104:105], v[104:105], v[12:13] op_sel_hi:[1,0] neg_lo:[0,1] neg_hi:[0,1]
v_pk_fma_f32 v[10:11], v[104:105], v[104:105], v[10:11]
v_pk_add_f32 v[106:107], v[106:107], v[12:13] op_sel_hi:[1,0] neg_lo:[0,1] neg_hi:[0,1]
v_pk_fma_f32 v[10:11], v[106:107], v[106:107], v[10:11]
v_pk_add_f32 v[108:109], v[108:109], v[12:13] op_sel_hi:[1,0] neg_lo:[0,1] neg_hi:[0,1]
v_pk_fma_f32 v[10:11], v[108:109], v[108:109], v[10:11]
v_pk_add_f32 v[110:111], v[110:111], v[12:13] op_sel_hi:[1,0] neg_lo:[0,1] neg_hi:[0,1]
v_pk_fma_f32 v[10:11], v[110:111], v[110:111], v[10:11]
v_add_f32 v10, v10, v11
s_nop 1
v_add_f32_dpp v10, v10, v10 row_ror:8 row_mask:0xf bank_mask:0xf
v_mov_b32 v11, v10
s_nop 1
v_permlane32_swap_b32 v10, v11
v_add_f32 v10, v10, v11
v_mov_b32 v11, v10
s_nop 1
v_permlane16_swap_b32 v10, v11
v_add_f32 v10, v10, v11
v_mov_b32 v12, 0x3727c5ac
v_fmac_f32 v12, 0x3b000000, v10
v_rsq_f32 v12, v12
s_nop 0
v_pk_mul_f32 v[48:49], v[48:49], v[12:13] op_sel_hi:[1,0]
v_cvt_pk_bf16_f32 v16, v48, v49
v_pk_mul_f32 v[50:51], v[50:51], v[12:13] op_sel_hi:[1,0]
v_cvt_pk_bf16_f32 v17, v50, v51
v_pk_mul_f32 v[52:53], v[52:53], v[12:13] op_sel_hi:[1,0]
v_cvt_pk_bf16_f32 v18, v52, v53
v_pk_mul_f32 v[54:55], v[54:55], v[12:13] op_sel_hi:[1,0]
v_cvt_pk_bf16_f32 v19, v54, v55
s_and_b32 s27, s27, 0x7fff
s_add_u32 s27, s27, 98304
v_add_u32 v15, s27, v15
ds_write_b128 v15, v[16:19] offset:0
v_pk_mul_f32 v[56:57], v[56:57], v[12:13] op_sel_hi:[1,0]
v_cvt_pk_bf16_f32 v20, v56, v57
v_pk_mul_f32 v[58:59], v[58:59], v[12:13] op_sel_hi:[1,0]
v_cvt_pk_bf16_f32 v21, v58, v59
v_pk_mul_f32 v[60:61], v[60:61], v[12:13] op_sel_hi:[1,0]
v_cvt_pk_bf16_f32 v22, v60, v61
v_pk_mul_f32 v[62:63], v[62:63], v[12:13] op_sel_hi:[1,0]
v_cvt_pk_bf16_f32 v23, v62, v63
ds_write_b128 v15, v[20:23] offset:4096
v_pk_mul_f32 v[64:65], v[64:65], v[12:13] op_sel_hi:[1,0]
v_cvt_pk_bf16_f32 v24, v64, v65
v_pk_mul_f32 v[66:67], v[66:67], v[12:13] op_sel_hi:[1,0]
v_cvt_pk_bf16_f32 v25, v66, v67
v_pk_mul_f32 v[68:69], v[68:69], v[12:13] op_sel_hi:[1,0]
v_cvt_pk_bf16_f32 v26, v68, v69
v_pk_mul_f32 v[70:71], v[70:71], v[12:13] op_sel_hi:[1,0]
v_cvt_pk_bf16_f32 v27, v70, v71
ds_write_b128 v15, v[24:27] offset:8192
v_pk_mul_f32 v[72:73], v[72:73], v[12:13] op_sel_hi:[1,0]
v_cvt_pk_bf16_f32 v28, v72, v73
v_pk_mul_f32 v[74:75], v[74:75], v[12:13] op_sel_hi:[1,0]
v_cvt_pk_bf16_f32 v29, v74, v75
v_pk_mul_f32 v[76:77], v[76:77], v[12:13] op_sel_hi:[1,0]
v_cvt_pk_bf16_f32 v30, v76, v77
v_pk_mul_f32 v[78:79], v[78:79], v[12:13] op_sel_hi:[1,0]
v_cvt_pk_bf16_f32 v31, v78, v79
ds_write_b128 v15, v[28:31] offset:12288
v_pk_mul_f32 v[80:81], v[80:81], v[12:13] op_sel_hi:[1,0]
v_cvt_pk_bf16_f32 v32, v80, v81
v_pk_mul_f32 v[82:83], v[82:83], v[12:13] op_sel_hi:[1,0]
v_cvt_pk_bf16_f32 v33, v82, v83
v_pk_mul_f32 v[84:85], v[84:85], v[12:13] op_sel_hi:[1,0]
v_cvt_pk_bf16_f32 v34, v84, v85
v_pk_mul_f32 v[86:87], v[86:87], v[12:13] op_sel_hi:[1,0]
v_cvt_pk_bf16_f32 v35, v86, v87
ds_write_b128 v15, v[32:35] offset:16384
v_pk_mul_f32 v[88:89], v[88:89], v[12:13] op_sel_hi:[1,0]
v_cvt_pk_bf16_f32 v36, v88, v89
v_pk_mul_f32 v[90:91], v[90:91], v[12:13] op_sel_hi:[1,0]
v_cvt_pk_bf16_f32 v37, v90, v91
v_pk_mul_f32 v[92:93], v[92:93], v[12:13] op_sel_hi:[1,0]
v_cvt_pk_bf16_f32 v38, v92, v93
v_pk_mul_f32 v[94:95], v[94:95], v[12:13] op_sel_hi:[1,0]
v_cvt_pk_bf16_f32 v39, v94, v95
ds_write_b128 v15, v[36:39] offset:20480
v_pk_mul_f32 v[96:97], v[96:97], v[12:13] op_sel_hi:[1,0]
v_cvt_pk_bf16_f32 v40, v96, v97
v_pk_mul_f32 v[98:99], v[98:99], v[12:13] op_sel_hi:[1,0]
v_cvt_pk_bf16_f32 v41, v98, v99
v_pk_mul_f32 v[100:101], v[100:101], v[12:13] op_sel_hi:[1,0]
v_cvt_pk_bf16_f32 v42, v100, v101
v_pk_mul_f32 v[102:103], v[102:103], v[12:13] op_sel_hi:[1,0]
v_cvt_pk_bf16_f32 v43, v102, v103
ds_write_b128 v15, v[40:43] offset:24576
v_pk_mul_f32 v[104:105], v[104:105], v[12:13] op_sel_hi:[1,0]
v_cvt_pk_bf16_f32 v44, v104, v105
v_pk_mul_f32 v[106:107], v[106:107], v[12:13] op_sel_hi:[1,0]
v_cvt_pk_bf16_f32 v45, v106, v107
v_pk_mul_f32 v[108:109], v[108:109], v[12:13] op_sel_hi:[1,0]
v_cvt_pk_bf16_f32 v46, v108, v109
v_pk_mul_f32 v[110:111], v[110:111], v[12:13] op_sel_hi:[1,0]
v_cvt_pk_bf16_f32 v47, v110, v111
ds_write_b128 v15, v[44:47] offset:28672
s_waitcnt vmcnt(16)
s_cmp_eq_u32 s82, 0
s_cbranch_scc1 VERD_6
s_mov_b32 s82, 0
v_readfirstlane_b32 s33, v250
s_nop 3
s_lshr_b32 s33, s33, s83
s_and_b32 s33, s33, 1
v_mov_b32 v22, 163824
s_cmp_lg_u32 s17, 0
s_cbranch_scc1 BC_7
v_mov_b32 v20, s33
ds_write_b32 v22, v20
s_waitcnt lgkmcnt(0)
BC_7:
s_barrier
ds_read_b32 v20, v22
s_waitcnt lgkmcnt(0)
v_readfirstlane_b32 s33, v20
s_barrier
s_cmp_lg_u32 s33, 0
s_cbranch_scc1 L_WLOST
VERD_6:
ds_read_b64_tr_b16 a[0:1], v246 offset:0
ds_read_b64_tr_b16 a[2:3], v246 offset:512
ds_read_b64_tr_b16 a[64:65], v247 offset:0
ds_read_b64_tr_b16 a[66:67], v247 offset:512
ds_read_b64_tr_b16 a[128:129], v248 offset:0
ds_read_b64_tr_b16 a[130:131], v248 offset:512
ds_read_b64_tr_b16 a[192:193], v249 offset:0
s_waitcnt lgkmcnt(13)
ds_read_b64_tr_b16 a[194:195], v249 offset:512
ds_read_b64_tr_b16 a[4:5], v246 offset:4096
s_waitcnt lgkmcnt(13)
ds_read_b64_tr_b16 a[6:7], v246 offset:4608
ds_read_b64_tr_b16 a[68:69], v247 offset:4096
s_waitcnt lgkmcnt(13)
ds_read_b64_tr_b16 a[70:71], v247 offset:4608
ds_read_b64_tr_b16 a[132:133], v248 offset:4096
s_waitcnt lgkmcnt(13)
ds_read_b64_tr_b16 a[134:135], v248 offset:4608
ds_read_b64_tr_b16 a[196:197], v249 offset:4096
s_waitcnt lgkmcnt(13)
ds_read_b64_tr_b16 a[198:199], v249 offset:4608
s_waitcnt lgkmcnt(0)
s_add_u32 m0, s32, 0
s_nop 0
buffer_load_dwordx4 v244, s[12:15], s23 offen lds
s_add_u32 s23, s23, s34
s_add_u32 m0, s32, 1024
s_nop 0
buffer_load_dwordx4 v245, s[12:15], s23 offen lds
s_add_u32 s23, s23, s34
s_add_u32 m0, s32, 2048
s_nop 0
buffer_load_dwordx4 v244, s[12:15], s23 offen lds
s_add_u32 s23, s23, s34
s_add_u32 m0, s32, 3072
s_nop 0
buffer_load_dwordx4 v245, s[12:15], s23 offen lds
s_add_u32 s23, s23, s34
s_add_u32 m0, s32, 4096
s_nop 0
buffer_load_dwordx4 v244, s[12:15], s23 offen lds
s_add_u32 s23, s23, s34
s_add_u32 m0, s32, 5120
s_nop 0
buffer_load_dwordx4 v245, s[12:15], s23 offen lds
s_add_u32 s23, s23, s34
s_add_u32 m0, s32, 6144
s_nop 0
buffer_load_dwordx4 v244, s[12:15], s23 offen lds
s_add_u32 s23, s23, s34
s_add_u32 m0, s32, 7168
s_nop 0
buffer_load_dwordx4 v245, s[12:15], s23 offen lds
s_add_u32 s23, s23, s34
s_waitcnt vmcnt(16)
ds_read_b64_tr_b16 a[8:9], v246 offset:8192
ds_read_b64_tr_b16 a[10:11], v246 offset:8704
ds_read_b64_tr_b16 a[72:73], v247 offset:8192
ds_read_b64_tr_b16 a[74:75], v247 offset:8704
ds_read_b64_tr_b16 a[136:137], v248 offset:8192
ds_read_b64_tr_b16 a[138:139], v248 offset:8704
ds_read_b64_tr_b16 a[200:201], v249 offset:8192
ds_read_b64_tr_b16 a[202:203], v249 offset:8704
ds_read_b64_tr_b16 a[12:13], v246 offset:12288
ds_read_b64_tr_b16 a[14:15], v246 offset:12800
ds_read_b64_tr_b16 a[76:77], v247 offset:12288
ds_read_b64_tr_b16 a[78:79], v247 offset:12800
ds_read_b64_tr_b16 a[140:141], v248 offset:12288
ds_read_b64_tr_b16 a[142:143], v248 offset:12800
ds_read_b64_tr_b16 a[204:205], v249 offset:12288
s_waitcnt lgkmcnt(13)
ds_read_b64_tr_b16 a[206:207], v249 offset:12800
s_waitcnt lgkmcnt(0)
s_add_u32 m0, s32, 8192
s_nop 0
buffer_load_dwordx4 v244, s[12:15], s23 offen lds
s_add_u32 s23, s23, s34
s_add_u32 m0, s32, 9216
s_nop 0
buffer_load_dwordx4 v245, s[12:15], s23 offen lds
s_add_u32 s23, s23, s34
s_add_u32 m0, s32, 10240
s_nop 0
buffer_load_dwordx4 v244, s[12:15], s23 offen lds
s_add_u32 s23, s23, s34
s_add_u32 m0, s32, 11264
s_nop 0
buffer_load_dwordx4 v245, s[12:15], s23 offen lds
s_add_u32 s23, s23, s34
s_add_u32 m0, s32, 12288
s_nop 0
buffer_load_dwordx4 v244, s[12:15], s23 offen lds
s_add_u32 s23, s23, s34
s_add_u32 m0, s32, 13312
s_nop 0
buffer_load_dwordx4 v245, s[12:15], s23 offen lds
s_add_u32 s23, s23, s34
s_add_u32 m0, s32, 14336
s_nop 0
buffer_load_dwordx4 v244, s[12:15], s23 offen lds
s_add_u32 s23, s23, s34
s_add_u32 m0, s32, 15360
s_nop 0
buffer_load_dwordx4 v245, s[12:15], s23 offen lds
s_add_u32 s23, s23, s34
s_waitcnt vmcnt(16)
ds_read_b64_tr_b16 a[16:17], v246 offset:16384
ds_read_b64_tr_b16 a[18:19], v246 offset:16896
ds_read_b64_tr_b16 a[80:81], v247 offset:16384
ds_read_b64_tr_b16 a[82:83], v247 offset:16896
ds_read_b64_tr_b16 a[144:145], v248 offset:16384
ds_read_b64_tr_b16 a[146:147], v248 offset:16896
ds_read_b64_tr_b16 a[208:209], v249 offset:16384
ds_read_b64_tr_b16 a[210:211], v249 offset:16896
ds_read_b64_tr_b16 a[20:21], v246 offset:20480
ds_read_b64_tr_b16 a[22:23], v246 offset:20992
ds_read_b64_tr_b16 a[84:85], v247 offset:20480
ds_read_b64_tr_b16 a[86:87], v247 offset:20992
ds_read_b64_tr_b16 a[148:149], v248 offset:20480
ds_read_b64_tr_b16 a[150:151], v248 offset:20992
ds_read_b64_tr_b16 a[212:213], v249 offset:20480
s_waitcnt lgkmcnt(13)
ds_read_b64_tr_b16 a[214:215], v249 offset:20992
s_waitcnt lgkmcnt(0)
s_add_u32 m0, s32, 16384
s_nop 0
buffer_load_dwordx4 v244, s[12:15], s23 offen lds
s_add_u32 s23, s23, s34
s_add_u32 m0, s32, 17408
s_nop 0
buffer_load_dwordx4 v245, s[12:15], s23 offen lds
s_add_u32 s23, s23, s34
s_add_u32 m0, s32, 18432
s_nop 0
buffer_load_dwordx4 v244, s[12:15], s23 offen lds
s_add_u32 s23, s23, s34
s_add_u32 m0, s32, 19456
s_nop 0
buffer_load_dwordx4 v245, s[12:15], s23 offen lds
s_add_u32 s23, s23, s34
s_add_u32 m0, s32, 20480
s_nop 0
buffer_load_dwordx4 v244, s[12:15], s23 offen lds
s_add_u32 s23, s23, s34
s_add_u32 m0, s32, 21504
s_nop 0
buffer_load_dwordx4 v245, s[12:15], s23 offen lds
s_add_u32 s23, s23, s34
s_add_u32 m0, s32, 22528
s_nop 0
buffer_load_dwordx4 v244, s[12:15], s23 offen lds
s_add_u32 s23, s23, s34
s_add_u32 m0, s32, 23552
s_nop 0
buffer_load_dwordx4 v245, s[12:15], s23 offen lds
s_add_u32 s23, s23, s34
s_waitcnt vmcnt(16)
ds_read_b64_tr_b16 a[24:25], v246 offset:0
ds_read_b64_tr_b16 a[26:27], v246 offset:512
ds_read_b64_tr_b16 a[88:89], v247 offset:0
ds_read_b64_tr_b16 a[90:91], v247 offset:512
ds_read_b64_tr_b16 a[152:153], v248 offset:0
ds_read_b64_tr_b16 a[154:155], v248 offset:512
ds_read_b64_tr_b16 a[216:217], v249 offset:0
ds_read_b64_tr_b16 a[218:219], v249 offset:512
ds_read_b64_tr_b16 a[28:29], v246 offset:4096
ds_read_b64_tr_b16 a[30:31], v246 offset:4608
ds_read_b64_tr_b16 a[92:93], v247 offset:4096
ds_read_b64_tr_b16 a[94:95], v247 offset:4608
ds_read_b64_tr_b16 a[156:157], v248 offset:4096
ds_read_b64_tr_b16 a[158:159], v248 offset:4608
ds_read_b64_tr_b16 a[220:221], v249 offset:4096
s_waitcnt lgkmcnt(13)
ds_read_b64_tr_b16 a[222:223], v249 offset:4608
s_waitcnt lgkmcnt(0)
s_add_u32 m0, s32, 0
s_nop 0
buffer_load_dwordx4 v244, s[12:15], s23 offen lds
s_add_u32 s23, s23, s34
s_add_u32 m0, s32, 1024
s_nop 0
buffer_load_dwordx4 v245, s[12:15], s23 offen lds
s_add_u32 s23, s23, s34
s_add_u32 m0, s32, 2048
s_nop 0
buffer_load_dwordx4 v244, s[12:15], s23 offen lds
s_add_u32 s23, s23, s34
s_add_u32 m0, s32, 3072
s_nop 0
buffer_load_dwordx4 v245, s[12:15], s23 offen lds
s_add_u32 s23, s23, s34
s_add_u32 m0, s32, 4096
s_nop 0
buffer_load_dwordx4 v244, s[12:15], s23 offen lds
s_add_u32 s23, s23, s34
s_add_u32 m0, s32, 5120
s_nop 0
buffer_load_dwordx4 v245, s[12:15], s23 offen lds
s_add_u32 s23, s23, s34
s_add_u32 m0, s32, 6144
s_nop 0
buffer_load_dwordx4 v244, s[12:15], s23 offen lds
s_add_u32 s23, s23, s34
s_add_u32 m0, s32, 7168
s_nop 0
buffer_load_dwordx4 v245, s[12:15], s23 offen lds
s_add_u32 s23, s23, s34
s_waitcnt vmcnt(16)
ds_read_b64_tr_b16 a[32:33], v246 offset:8192
ds_read_b64_tr_b16 a[34:35], v246 offset:8704
ds_read_b64_tr_b16 a[96:97], v247 offset:8192
ds_read_b64_tr_b16 a[98:99], v247 offset:8704
ds_read_b64_tr_b16 a[160:161], v248 offset:8192
ds_read_b64_tr_b16 a[162:163], v248 offset:8704
ds_read_b64_tr_b16 a[224:225], v249 offset:8192
ds_read_b64_tr_b16 a[226:227], v249 offset:8704
ds_read_b64_tr_b16 a[36:37], v246 offset:12288
ds_read_b64_tr_b16 a[38:39], v246 offset:12800
ds_read_b64_tr_b16 a[100:101], v247 offset:12288
ds_read_b64_tr_b16 a[102:103], v247 offset:12800
ds_read_b64_tr_b16 a[164:165], v248 offset:12288
ds_read_b64_tr_b16 a[166:167], v248 offset:12800
ds_read_b64_tr_b16 a[228:229], v249 offset:12288
s_waitcnt lgkmcnt(13)
ds_read_b64_tr_b16 a[230:231], v249 offset:12800
s_waitcnt lgkmcnt(0)
s_add_u32 m0, s32, 8192
s_nop 0
buffer_load_dwordx4 v244, s[12:15], s23 offen lds
s_add_u32 s23, s23, s34
s_add_u32 m0, s32, 9216
s_nop 0
buffer_load_dwordx4 v245, s[12:15], s23 offen lds
s_add_u32 s23, s23, s34
s_add_u32 m0, s32, 10240
s_nop 0
buffer_load_dwordx4 v244, s[12:15], s23 offen lds
s_add_u32 s23, s23, s34
s_add_u32 m0, s32, 11264
s_nop 0
buffer_load_dwordx4 v245, s[12:15], s23 offen lds
s_add_u32 s23, s23, s34
s_add_u32 m0, s32, 12288
s_nop 0
buffer_load_dwordx4 v244, s[12:15], s23 offen lds
s_add_u32 s23, s23, s34
s_add_u32 m0, s32, 13312
s_nop 0
buffer_load_dwordx4 v245, s[12:15], s23 offen lds
s_add_u32 s23, s23, s34
s_add_u32 m0, s32, 14336
s_nop 0
buffer_load_dwordx4 v244, s[12:15], s23 offen lds
s_add_u32 s23, s23, s34
s_add_u32 m0, s32, 15360
s_nop 0
buffer_load_dwordx4 v245, s[12:15], s23 offen lds
s_add_u32 s23, s23, s34
s_waitcnt vmcnt(16)
ds_read_b64_tr_b16 a[40:41], v246 offset:16384
ds_read_b64_tr_b16 a[42:43], v246 offset:16896
ds_read_b64_tr_b16 a[104:105], v247 offset:16384
ds_read_b64_tr_b16 a[106:107], v247 offset:16896
ds_read_b64_tr_b16 a[168:169], v248 offset:16384
ds_read_b64_tr_b16 a[170:171], v248 offset:16896
ds_read_b64_tr_b16 a[232:233], v249 offset:16384
ds_read_b64_tr_b16 a[234:235], v249 offset:16896
ds_read_b64_tr_b16 a[44:45], v246 offset:20480
ds_read_b64_tr_b16 a[46:47], v246 offset:20992
ds_read_b64_tr_b16 a[108:109], v247 offset:20480
ds_read_b64_tr_b16 a[110:111], v247 offset:20992
ds_read_b64_tr_b16 a[172:173], v248 offset:20480
ds_read_b64_tr_b16 a[174:175], v248 offset:20992
ds_read_b64_tr_b16 a[236:237], v249 offset:20480
s_waitcnt lgkmcnt(13)
ds_read_b64_tr_b16 a[238:239], v249 offset:20992
s_waitcnt lgkmcnt(0)
s_waitcnt vmcnt(8)
ds_read_b64_tr_b16 a[48:49], v246 offset:0
ds_read_b64_tr_b16 a[50:51], v246 offset:512
ds_read_b64_tr_b16 a[112:113], v247 offset:0
ds_read_b64_tr_b16 a[114:115], v247 offset:512
ds_read_b64_tr_b16 a[176:177], v248 offset:0
ds_read_b64_tr_b16 a[178:179], v248 offset:512
ds_read_b64_tr_b16 a[240:241], v249 offset:0
ds_read_b64_tr_b16 a[242:243], v249 offset:512
ds_read_b64_tr_b16 a[52:53], v246 offset:4096
ds_read_b64_tr_b16 a[54:55], v246 offset:4608
ds_read_b64_tr_b16 a[116:117], v247 offset:4096
ds_read_b64_tr_b16 a[118:119], v247 offset:4608
ds_read_b64_tr_b16 a[180:181], v248 offset:4096
ds_read_b64_tr_b16 a[182:183], v248 offset:4608
ds_read_b64_tr_b16 a[244:245], v249 offset:4096
s_waitcnt lgkmcnt(13)
ds_read_b64_tr_b16 a[246:247], v249 offset:4608
s_waitcnt lgkmcnt(0)
s_waitcnt vmcnt(0)
ds_read_b64_tr_b16 a[56:57], v246 offset:8192
ds_read_b64_tr_b16 a[58:59], v246 offset:8704
ds_read_b64_tr_b16 a[120:121], v247 offset:8192
ds_read_b64_tr_b16 a[122:123], v247 offset:8704
ds_read_b64_tr_b16 a[184:185], v248 offset:8192
ds_read_b64_tr_b16 a[186:187], v248 offset:8704
ds_read_b64_tr_b16 a[248:249], v249 offset:8192
ds_read_b64_tr_b16 a[250:251], v249 offset:8704
ds_read_b64_tr_b16 a[60:61], v246 offset:12288
ds_read_b64_tr_b16 a[62:63], v246 offset:12800
ds_read_b64_tr_b16 a[124:125], v247 offset:12288
ds_read_b64_tr_b16 a[126:127], v247 offset:12800
ds_read_b64_tr_b16 a[188:189], v248 offset:12288
ds_read_b64_tr_b16 a[190:191], v248 offset:12800
ds_read_b64_tr_b16 a[252:253], v249 offset:12288
s_waitcnt lgkmcnt(13)
ds_read_b64_tr_b16 a[254:255], v249 offset:12800
s_waitcnt lgkmcnt(0)
v_mov_b32 v112, 0
v_mov_b32 v113, 0
v_mov_b32 v114, 0
v_mov_b32 v115, 0
v_mov_b32 v116, 0
v_mov_b32 v117, 0
v_mov_b32 v118, 0
v_mov_b32 v119, 0
v_mov_b32 v120, 0
v_mov_b32 v121, 0
v_mov_b32 v122, 0
v_mov_b32 v123, 0
v_mov_b32 v124, 0
v_mov_b32 v125, 0
v_mov_b32 v126, 0
v_mov_b32 v127, 0
s_cmp_lg_u32 s20, 3
s_cbranch_scc1 G1_NOBIAS
s_mov_b32 s12, s56
s_mov_b32 s13, s57
s_mov_b32 s14, 3584
s_and_b32 s32, s18, 15
s_lshl_b32 s32, s32, 9
s_lshl_b32 s33, s17, 7
s_add_u32 s32, s32, s33
v_lshlrev_b32 v4, 3, v241
buffer_load_dwordx2 v[8:9], v4, s[12:15], s32 offen offset:0
buffer_load_dwordx2 v[10:11], v4, s[12:15], s32 offen offset:32
buffer_load_dwordx2 v[12:13], v4, s[12:15], s32 offen offset:64
buffer_load_dwordx2 v[14:15], v4, s[12:15], s32 offen offset:96
s_waitcnt vmcnt(0)
v_lshlrev_b32 v112, 16, v8
v_and_b32 v113, 0xffff0000, v8
v_lshlrev_b32 v114, 16, v9
v_and_b32 v115, 0xffff0000, v9
v_lshlrev_b32 v116, 16, v10
v_and_b32 v117, 0xffff0000, v10
v_lshlrev_b32 v118, 16, v11
v_and_b32 v119, 0xffff0000, v11
v_lshlrev_b32 v120, 16, v12
v_and_b32 v121, 0xffff0000, v12
v_lshlrev_b32 v122, 16, v13
v_and_b32 v123, 0xffff0000, v13
v_lshlrev_b32 v124, 16, v14
v_and_b32 v125, 0xffff0000, v14
v_lshlrev_b32 v126, 16, v15
v_and_b32 v127, 0xffff0000, v15
G1_NOBIAS:
v_lshlrev_b32 v4, 4, v0
v_add_u32 v5, 98304, v4
s_lshl_b32 s24, s19, 15
s_lshl_b32 s32, s17, 13
s_add_u32 s24, s24, s32
s_add_u32 s24, s24, 0
s_lshl_b32 s25, s16, 7
s_add_u32 s25, s25, 91291648
s_and_b32 s32, s18, 15
s_lshl_b32 s32, s32, 1
s_lshr_b32 s33, s17, 1
s_add_u32 s32, s32, s33
s_lshl_b32 s33, s19, 5
s_add_u32 s32, s32, s33
s_lshl_b32 s22, s32, 13
s_and_b32 s33, s17, 1
s_lshl_b32 s26, s17, 13
s_add_u32 s24, s24, 7168
s_cmp_eq_u32 s20, 1
s_cbranch_scc1 G1_V
s_cmp_eq_u32 s20, 3
s_cbranch_scc1 G1_H
G1_QK:
s_lshl_b32 s33, s33, 10
s_add_u32 s22, s22, s33
s_mov_b32 s33, 2097152
s_cmp_eq_u32 s20, 0
s_cselect_b32 s33, 18874368, s33
s_add_u32 s22, s22, s33
s_mov_b32 s23, 0
s_waitcnt vmcnt(0) lgkmcnt(0)
s_barrier
ds_read_b128 v[16:19], v5 offset:0
ds_read_b128 v[20:23], v5 offset:1024
ds_read_b128 v[24:27], v5 offset:2048
ds_read_b128 v[28:31], v5 offset:3072
ds_read_b128 v[32:35], v5 offset:4096
ds_read_b128 v[36:39], v5 offset:5120
s_waitcnt lgkmcnt(4)
v_mfma_f32_16x16x32_bf16 v[128:131], a[0:3], v[16:19], 0
v_mfma_f32_16x16x32_bf16 v[132:135], a[64:67], v[16:19], 0
v_mfma_f32_16x16x32_bf16 v[136:139], a[128:131], v[16:19], 0
v_mfma_f32_16x16x32_bf16 v[140:143], a[192:195], v[16:19], 0
v_mfma_f32_16x16x32_bf16 v[144:147], a[0:3], v[20:23], 0
v_mfma_f32_16x16x32_bf16 v[148:151], a[64:67], v[20:23], 0
v_mfma_f32_16x16x32_bf16 v[152:155], a[128:131], v[20:23], 0
v_mfma_f32_16x16x32_bf16 v[156:159], a[192:195], v[20:23], 0
ds_read_b128 v[16:19], v5 offset:6144
ds_read_b128 v[20:23], v5 offset:7168
s_waitcnt lgkmcnt(4)
v_mfma_f32_16x16x32_bf16 v[128:131], a[4:7], v[24:27], v[128:131]
v_mfma_f32_16x16x32_bf16 v[132:135], a[68:71], v[24:27], v[132:135]
v_mfma_f32_16x16x32_bf16 v[136:139], a[132:135], v[24:27], v[136:139]
v_mfma_f32_16x16x32_bf16 v[140:143], a[196:199], v[24:27], v[140:143]
v_mfma_f32_16x16x32_bf16 v[144:147], a[4:7], v[28:31], v[144:147]
v_mfma_f32_16x16x32_bf16 v[148:151], a[68:71], v[28:31], v[148:151]
v_mfma_f32_16x16x32_bf16 v[152:155], a[132:135], v[28:31], v[152:155]
v_mfma_f32_16x16x32_bf16 v[156:159], a[196:199], v[28:31], v[156:159]
ds_read_b128 v[24:27], v5 offset:8192
ds_read_b128 v[28:31], v5 offset:9216
s_waitcnt lgkmcnt(4)
v_mfma_f32_16x16x32_bf16 v[128:131], a[8:11], v[32:35], v[128:131]
v_mfma_f32_16x16x32_bf16 v[132:135], a[72:75], v[32:35], v[132:135]
v_mfma_f32_16x16x32_bf16 v[136:139], a[136:139], v[32:35], v[136:139]
v_mfma_f32_16x16x32_bf16 v[140:143], a[200:203], v[32:35], v[140:143]
v_mfma_f32_16x16x32_bf16 v[144:147], a[8:11], v[36:39], v[144:147]
v_mfma_f32_16x16x32_bf16 v[148:151], a[72:75], v[36:39], v[148:151]
v_mfma_f32_16x16x32_bf16 v[152:155], a[136:139], v[36:39], v[152:155]
v_mfma_f32_16x16x32_bf16 v[156:159], a[200:203], v[36:39], v[156:159]
ds_read_b128 v[32:35], v5 offset:10240
ds_read_b128 v[36:39], v5 offset:11264
s_waitcnt lgkmcnt(4)
v_mfma_f32_16x16x32_bf16 v[128:131], a[12:15], v[16:19], v[128:131]
v_mfma_f32_16x16x32_bf16 v[132:135], a[76:79], v[16:19], v[132:135]
v_mfma_f32_16x16x32_bf16 v[136:139], a[140:143], v[16:19], v[136:139]
v_mfma_f32_16x16x32_bf16 v[140:143], a[204:207], v[16:19], v[140:143]
v_mfma_f32_16x16x32_bf16 v[144:147], a[12:15], v[20:23], v[144:147]
v_mfma_f32_16x16x32_bf16 v[148:151], a[76:79], v[20:23], v[148:151]
v_mfma_f32_16x16x32_bf16 v[152:155], a[140:143], v[20:23], v[152:155]
v_mfma_f32_16x16x32_bf16 v[156:159], a[204:207], v[20:23], v[156:159]
ds_read_b128 v[16:19], v5 offset:12288
ds_read_b128 v[20:23], v5 offset:13312
s_waitcnt lgkmcnt(4)
v_mfma_f32_16x16x32_bf16 v[128:131], a[16:19], v[24:27], v[128:131]
v_mfma_f32_16x16x32_bf16 v[132:135], a[80:83], v[24:27], v[132:135]
v_mfma_f32_16x16x32_bf16 v[136:139], a[144:147], v[24:27], v[136:139]
v_mfma_f32_16x16x32_bf16 v[140:143], a[208:211], v[24:27], v[140:143]
v_mfma_f32_16x16x32_bf16 v[144:147], a[16:19], v[28:31], v[144:147]
v_mfma_f32_16x16x32_bf16 v[148:151], a[80:83], v[28:31], v[148:151]
v_mfma_f32_16x16x32_bf16 v[152:155], a[144:147], v[28:31], v[152:155]
v_mfma_f32_16x16x32_bf16 v[156:159], a[208:211], v[28:31], v[156:159]
ds_read_b128 v[24:27], v5 offset:14336
ds_read_b128 v[28:31], v5 offset:15360
s_waitcnt lgkmcnt(4)
v_mfma_f32_16x16x32_bf16 v[128:131], a[20:23], v[32:35], v[128:131]
v_mfma_f32_16x16x32_bf16 v[132:135], a[84:87], v[32:35], v[132:135]
v_mfma_f32_16x16x32_bf16 v[136:139], a[148:151], v[32:35], v[136:139]
v_mfma_f32_16x16x32_bf16 v[140:143], a[212:215], v[32:35], v[140:143]
v_mfma_f32_16x16x32_bf16 v[144:147], a[20:23], v[36:39], v[144:147]
v_mfma_f32_16x16x32_bf16 v[148:151], a[84:87], v[36:39], v[148:151]
v_mfma_f32_16x16x32_bf16 v[152:155], a[148:151], v[36:39], v[152:155]
v_mfma_f32_16x16x32_bf16 v[156:159], a[212:215], v[36:39], v[156:159]
ds_read_b128 v[32:35], v5 offset:16384
ds_read_b128 v[36:39], v5 offset:17408
s_waitcnt lgkmcnt(4)
v_mfma_f32_16x16x32_bf16 v[128:131], a[24:27], v[16:19], v[128:131]
v_mfma_f32_16x16x32_bf16 v[132:135], a[88:91], v[16:19], v[132:135]
v_mfma_f32_16x16x32_bf16 v[136:139], a[152:155], v[16:19], v[136:139]
v_mfma_f32_16x16x32_bf16 v[140:143], a[216:219], v[16:19], v[140:143]
v_mfma_f32_16x16x32_bf16 v[144:147], a[24:27], v[20:23], v[144:147]
v_mfma_f32_16x16x32_bf16 v[148:151], a[88:91], v[20:23], v[148:151]
v_mfma_f32_16x16x32_bf16 v[152:155], a[152:155], v[20:23], v[152:155]
v_mfma_f32_16x16x32_bf16 v[156:159], a[216:219], v[20:23], v[156:159]
ds_read_b128 v[16:19], v5 offset:18432
ds_read_b128 v[20:23], v5 offset:19456
s_waitcnt lgkmcnt(4)
v_mfma_f32_16x16x32_bf16 v[128:131], a[28:31], v[24:27], v[128:131]
v_mfma_f32_16x16x32_bf16 v[132:135], a[92:95], v[24:27], v[132:135]
v_mfma_f32_16x16x32_bf16 v[136:139], a[156:159], v[24:27], v[136:139]
v_mfma_f32_16x16x32_bf16 v[140:143], a[220:223], v[24:27], v[140:143]
v_mfma_f32_16x16x32_bf16 v[144:147], a[28:31], v[28:31], v[144:147]
v_mfma_f32_16x16x32_bf16 v[148:151], a[92:95], v[28:31], v[148:151]
v_mfma_f32_16x16x32_bf16 v[152:155], a[156:159], v[28:31], v[152:155]
v_mfma_f32_16x16x32_bf16 v[156:159], a[220:223], v[28:31], v[156:159]
ds_read_b128 v[24:27], v5 offset:20480
ds_read_b128 v[28:31], v5 offset:21504
s_waitcnt lgkmcnt(4)
v_mfma_f32_16x16x32_bf16 v[128:131], a[32:35], v[32:35], v[128:131]
v_mfma_f32_16x16x32_bf16 v[132:135], a[96:99], v[32:35], v[132:135]
v_mfma_f32_16x16x32_bf16 v[136:139], a[160:163], v[32:35], v[136:139]
v_mfma_f32_16x16x32_bf16 v[140:143], a[224:227], v[32:35], v[140:143]
v_mfma_f32_16x16x32_bf16 v[144:147], a[32:35], v[36:39], v[144:147]
v_mfma_f32_16x16x32_bf16 v[148:151], a[96:99], v[36:39], v[148:151]
v_mfma_f32_16x16x32_bf16 v[152:155], a[160:163], v[36:39], v[152:155]
v_mfma_f32_16x16x32_bf16 v[156:159], a[224:227], v[36:39], v[156:159]
ds_read_b128 v[32:35], v5 offset:22528
ds_read_b128 v[36:39], v5 offset:23552
s_waitcnt lgkmcnt(4)
v_mfma_f32_16x16x32_bf16 v[128:131], a[36:39], v[16:19], v[128:131]
v_mfma_f32_16x16x32_bf16 v[132:135], a[100:103], v[16:19], v[132:135]
v_mfma_f32_16x16x32_bf16 v[136:139], a[164:167], v[16:19], v[136:139]
v_mfma_f32_16x16x32_bf16 v[140:143], a[228:231], v[16:19], v[140:143]
v_mfma_f32_16x16x32_bf16 v[144:147], a[36:39], v[20:23], v[144:147]
v_mfma_f32_16x16x32_bf16 v[148:151], a[100:103], v[20:23], v[148:151]
v_mfma_f32_16x16x32_bf16 v[152:155], a[164:167], v[20:23], v[152:155]
v_mfma_f32_16x16x32_bf16 v[156:159], a[228:231], v[20:23], v[156:159]
ds_read_b128 v[16:19], v5 offset:24576
ds_read_b128 v[20:23], v5 offset:25600
s_waitcnt lgkmcnt(4)
v_mfma_f32_16x16x32_bf16 v[128:131], a[40:43], v[24:27], v[128:131]
v_mfma_f32_16x16x32_bf16 v[132:135], a[104:107], v[24:27], v[132:135]
v_mfma_f32_16x16x32_bf16 v[136:139], a[168:171], v[24:27], v[136:139]
v_mfma_f32_16x16x32_bf16 v[140:143], a[232:235], v[24:27], v[140:143]
v_mfma_f32_16x16x32_bf16 v[144:147], a[40:43], v[28:31], v[144:147]
v_mfma_f32_16x16x32_bf16 v[148:151], a[104:107], v[28:31], v[148:151]
v_mfma_f32_16x16x32_bf16 v[152:155], a[168:171], v[28:31], v[152:155]
v_mfma_f32_16x16x32_bf16 v[156:159], a[232:235], v[28:31], v[156:159]
ds_read_b128 v[24:27], v5 offset:26624
ds_read_b128 v[28:31], v5 offset:27648
s_waitcnt lgkmcnt(4)
v_mfma_f32_16x16x32_bf16 v[128:131], a[44:47], v[32:35], v[128:131]
v_mfma_f32_16x16x32_bf16 v[132:135], a[108:111], v[32:35], v[132:135]
v_mfma_f32_16x16x32_bf16 v[136:139], a[172:175], v[32:35], v[136:139]
v_mfma_f32_16x16x32_bf16 v[140:143], a[236:239], v[32:35], v[140:143]
v_mfma_f32_16x16x32_bf16 v[144:147], a[44:47], v[36:39], v[144:147]
v_mfma_f32_16x16x32_bf16 v[148:151], a[108:111], v[36:39], v[148:151]
v_mfma_f32_16x16x32_bf16 v[152:155], a[172:175], v[36:39], v[152:155]
v_mfma_f32_16x16x32_bf16 v[156:159], a[236:239], v[36:39], v[156:159]
ds_read_b128 v[32:35], v5 offset:28672
ds_read_b128 v[36:39], v5 offset:29696
s_waitcnt lgkmcnt(4)
v_mfma_f32_16x16x32_bf16 v[128:131], a[48:51], v[16:19], v[128:131]
v_mfma_f32_16x16x32_bf16 v[132:135], a[112:115], v[16:19], v[132:135]
v_mfma_f32_16x16x32_bf16 v[136:139], a[176:179], v[16:19], v[136:139]
v_mfma_f32_16x16x32_bf16 v[140:143], a[240:243], v[16:19], v[140:143]
v_mfma_f32_16x16x32_bf16 v[144:147], a[48:51], v[20:23], v[144:147]
v_mfma_f32_16x16x32_bf16 v[148:151], a[112:115], v[20:23], v[148:151]
v_mfma_f32_16x16x32_bf16 v[152:155], a[176:179], v[20:23], v[152:155]
v_mfma_f32_16x16x32_bf16 v[156:159], a[240:243], v[20:23], v[156:159]
ds_read_b128 v[16:19], v5 offset:30720
ds_read_b128 v[20:23], v5 offset:31744
s_waitcnt lgkmcnt(4)
v_mfma_f32_16x16x32_bf16 v[128:131], a[52:55], v[24:27], v[128:131]
v_mfma_f32_16x16x32_bf16 v[132:135], a[116:119], v[24:27], v[132:135]
v_mfma_f32_16x16x32_bf16 v[136:139], a[180:183], v[24:27], v[136:139]
v_mfma_f32_16x16x32_bf16 v[140:143], a[244:247], v[24:27], v[140:143]
v_mfma_f32_16x16x32_bf16 v[144:147], a[52:55], v[28:31], v[144:147]
v_mfma_f32_16x16x32_bf16 v[148:151], a[116:119], v[28:31], v[148:151]
v_mfma_f32_16x16x32_bf16 v[152:155], a[180:183], v[28:31], v[152:155]
v_mfma_f32_16x16x32_bf16 v[156:159], a[244:247], v[28:31], v[156:159]
s_waitcnt lgkmcnt(2)
v_mfma_f32_16x16x32_bf16 v[128:131], a[56:59], v[32:35], v[128:131]
v_mfma_f32_16x16x32_bf16 v[132:135], a[120:123], v[32:35], v[132:135]
v_mfma_f32_16x16x32_bf16 v[136:139], a[184:187], v[32:35], v[136:139]
v_mfma_f32_16x16x32_bf16 v[140:143], a[248:251], v[32:35], v[140:143]
v_mfma_f32_16x16x32_bf16 v[144:147], a[56:59], v[36:39], v[144:147]
v_mfma_f32_16x16x32_bf16 v[148:151], a[120:123], v[36:39], v[148:151]
v_mfma_f32_16x16x32_bf16 v[152:155], a[184:187], v[36:39], v[152:155]
v_mfma_f32_16x16x32_bf16 v[156:159], a[248:251], v[36:39], v[156:159]
s_waitcnt lgkmcnt(0)
v_mfma_f32_16x16x32_bf16 v[128:131], a[60:63], v[16:19], v[128:131]
v_mfma_f32_16x16x32_bf16 v[132:135], a[124:127], v[16:19], v[132:135]
v_mfma_f32_16x16x32_bf16 v[136:139], a[188:191], v[16:19], v[136:139]
v_mfma_f32_16x16x32_bf16 v[140:143], a[252:255], v[16:19], v[140:143]
v_mfma_f32_16x16x32_bf16 v[144:147], a[60:63], v[20:23], v[144:147]
v_mfma_f32_16x16x32_bf16 v[148:151], a[124:127], v[20:23], v[148:151]
v_mfma_f32_16x16x32_bf16 v[152:155], a[188:191], v[20:23], v[152:155]
v_mfma_f32_16x16x32_bf16 v[156:159], a[252:255], v[20:23], v[156:159]
s_add_u32 s23, s23, 1
s_nop 7
v_cvt_pk_bf16_f32 v48, v128, v129
v_cvt_pk_bf16_f32 v49, v130, v131
v_cvt_pk_bf16_f32 v50, v136, v137
v_cvt_pk_bf16_f32 v51, v138, v139
s_add_u32 s32, s22, 0
buffer_store_dwordx4 v[48:51], v4, s[8:11], s32 offen sc1
v_cvt_pk_bf16_f32 v52, v132, v133
v_cvt_pk_bf16_f32 v53, v134, v135
v_cvt_pk_bf16_f32 v54, v140, v141
v_cvt_pk_bf16_f32 v55, v142, v143
s_add_u32 s32, s22, 2048
buffer_store_dwordx4 v[52:55], v4, s[8:11], s32 offen sc1
v_cvt_pk_bf16_f32 v56, v144, v145
v_cvt_pk_bf16_f32 v57, v146, v147
v_cvt_pk_bf16_f32 v58, v152, v153
v_cvt_pk_bf16_f32 v59, v154, v155
s_add_u32 s32, s22, 4096
buffer_store_dwordx4 v[56:59], v4, s[8:11], s32 offen sc1
v_cvt_pk_bf16_f32 v60, v148, v149
v_cvt_pk_bf16_f32 v61, v150, v151
v_cvt_pk_bf16_f32 v62, v156, v157
v_cvt_pk_bf16_f32 v63, v158, v159
s_add_u32 s32, s22, 6144
buffer_store_dwordx4 v[60:63], v4, s[8:11], s32 offen sc1
s_add_u32 s22, s22, s46
s_cmp_lg_u32 s17, 0
s_cbranch_scc1 G1LN_8
s_cmp_lg_u32 s84, 0
s_cbranch_scc1 INIT_9
v_mov_b32 v8, 4
s_mov_b32 s35, 0
POLL_INIT_10:
s_cmp_lg_u32 s37, 0
s_cbranch_scc1 POLL_INIT_10_E
buffer_load_dword v9, v8, s[4:7], 0 offen sc1
s_add_u32 s35, s35, 1
s_cmp_gt_u32 s35, 65536
s_cselect_b32 s37, 1, 0
s_waitcnt vmcnt(0)
v_cmp_gt_u32 vcc, 32, v9
s_cbranch_vccz POLL_INIT_10_E
s_sleep 4
s_branch POLL_INIT_10
POLL_INIT_10_E:
s_mov_b32 s84, 1
INIT_9:
v_lshrrev_b32 v8, 2, v0
s_sub_u32 s32, 11, s44
v_lshlrev_b32 v8, s32, v8
v_and_b32 v9, 3, v0
v_lshl_add_u32 v8, v9, 7, v8
s_lshl_b32 s32, s19, 9
s_add_u32 s32, s32, 91340800
s_mov_b32 s35, 0
POLL_LN_11:
s_cmp_lg_u32 s37, 0
s_cbranch_scc1 POLL_LN_11_E
buffer_load_dword v9, v8, s[8:11], s32 offen sc1
s_add_u32 s35, s35, 1
s_cmp_gt_u32 s35, 65536
s_cselect_b32 s37, 1, 0
s_waitcnt vmcnt(0)
v_cmp_gt_u32 vcc, 1, v9
s_cbranch_vccz POLL_LN_11_E
s_sleep 2
s_branch POLL_LN_11
POLL_LN_11_E:
s_cmp_eq_u32 s44, 0
s_cbranch_scc1 G1LN_8
s_add_u32 s32, s32, 16384
s_mov_b32 s35, 0
POLL_LN_12:
s_cmp_lg_u32 s37, 0
s_cbranch_scc1 POLL_LN_12_E
buffer_load_dword v9, v8, s[8:11], s32 offen sc1
s_add_u32 s35, s35, 1
s_cmp_gt_u32 s35, 65536
s_cselect_b32 s37, 1, 0
s_waitcnt vmcnt(0)
v_cmp_gt_u32 vcc, 1, v9
s_cbranch_vccz POLL_LN_12_E
s_sleep 2
s_branch POLL_LN_12
POLL_LN_12_E:
G1LN_8:
s_barrier
s_add_u32 m0, s26, 131072
s_add_u32 s24, s24, s45
buffer_load_dwordx4 v4, s[8:11], s24 offen lds
s_add_u32 m0, s26, 132096
s_add_u32 s24, s24, 1024
buffer_load_dwordx4 v4, s[8:11], s24 offen lds
s_add_u32 m0, s26, 133120
s_add_u32 s24, s24, 1024
buffer_load_dwordx4 v4, s[8:11], s24 offen lds
s_add_u32 m0, s26, 134144
s_add_u32 s24, s24, 1024
buffer_load_dwordx4 v4, s[8:11], s24 offen lds
s_add_u32 m0, s26, 135168
s_add_u32 s24, s24, 1024
buffer_load_dwordx4 v4, s[8:11], s24 offen lds
s_add_u32 m0, s26, 136192
s_add_u32 s24, s24, 1024
buffer_load_dwordx4 v4, s[8:11], s24 offen lds
s_add_u32 m0, s26, 137216
s_add_u32 s24, s24, 1024
buffer_load_dwordx4 v4, s[8:11], s24 offen lds
s_add_u32 m0, s26, 138240
s_add_u32 s24, s24, 1024
buffer_load_dwordx4 v4, s[8:11], s24 offen lds
s_waitcnt vmcnt(0) lgkmcnt(0)
s_barrier
ds_read_b128 v[16:19], v5 offset:32768
ds_read_b128 v[20:23], v5 offset:33792
ds_read_b128 v[24:27], v5 offset:34816
ds_read_b128 v[28:31], v5 offset:35840
s_cmp_lg_u32 s17, 0
s_cbranch_scc1 G1F_13
s_cmp_lg_u32 s84, 0
s_cbranch_scc1 INIT_14
v_mov_b32 v8, 4
s_mov_b32 s35, 0
POLL_INIT_15:
s_cmp_lg_u32 s37, 0
s_cbranch_scc1 POLL_INIT_15_E
buffer_load_dword v9, v8, s[4:7], 0 offen sc1
s_add_u32 s35, s35, 1
s_cmp_gt_u32 s35, 65536
s_cselect_b32 s37, 1, 0
s_waitcnt vmcnt(0)
v_cmp_gt_u32 vcc, 32, v9
s_cbranch_vccz POLL_INIT_15_E
s_sleep 4
s_branch POLL_INIT_15
POLL_INIT_15_E:
s_mov_b32 s84, 1
INIT_14:
s_lshr_b32 s32, 1, s44
v_mov_b32 v8, s32
s_mov_b64 exec, 1
buffer_store_dword v8, off, s[8:11], s25 sc1
s_mov_b64 exec, -1
G1F_13:
ds_read_b128 v[32:35], v5 offset:36864
ds_read_b128 v[36:39], v5 offset:37888
s_waitcnt lgkmcnt(4)
v_mfma_f32_16x16x32_bf16 v[160:163], a[0:3], v[16:19], 0
v_mfma_f32_16x16x32_bf16 v[164:167], a[64:67], v[16:19], 0
v_mfma_f32_16x16x32_bf16 v[168:171], a[128:131], v[16:19], 0
v_mfma_f32_16x16x32_bf16 v[172:175], a[192:195], v[16:19], 0
s_add_u32 m0, s26, 98304
s_add_u32 s24, s24, s45
buffer_load_dwordx4 v4, s[8:11], s24 offen lds
v_mfma_f32_16x16x32_bf16 v[176:179], a[0:3], v[20:23], 0
v_mfma_f32_16x16x32_bf16 v[180:183], a[64:67], v[20:23], 0
v_mfma_f32_16x16x32_bf16 v[184:187], a[128:131], v[20:23], 0
v_mfma_f32_16x16x32_bf16 v[188:191], a[192:195], v[20:23], 0
ds_read_b128 v[16:19], v5 offset:38912
ds_read_b128 v[20:23], v5 offset:39936
s_waitcnt lgkmcnt(4)
v_mfma_f32_16x16x32_bf16 v[160:163], a[4:7], v[24:27], v[160:163]
v_mfma_f32_16x16x32_bf16 v[164:167], a[68:71], v[24:27], v[164:167]
v_mfma_f32_16x16x32_bf16 v[168:171], a[132:135], v[24:27], v[168:171]
v_mfma_f32_16x16x32_bf16 v[172:175], a[196:199], v[24:27], v[172:175]
s_add_u32 m0, s26, 99328
s_add_u32 s24, s24, 1024
buffer_load_dwordx4 v4, s[8:11], s24 offen lds
v_mfma_f32_16x16x32_bf16 v[176:179], a[4:7], v[28:31], v[176:179]
v_mfma_f32_16x16x32_bf16 v[180:183], a[68:71], v[28:31], v[180:183]
v_mfma_f32_16x16x32_bf16 v[184:187], a[132:135], v[28:31], v[184:187]
v_mfma_f32_16x16x32_bf16 v[188:191], a[196:199], v[28:31], v[188:191]
ds_read_b128 v[24:27], v5 offset:40960
ds_read_b128 v[28:31], v5 offset:41984
s_waitcnt lgkmcnt(4)
v_mfma_f32_16x16x32_bf16 v[160:163], a[8:11], v[32:35], v[160:163]
v_mfma_f32_16x16x32_bf16 v[164:167], a[72:75], v[32:35], v[164:167]
v_mfma_f32_16x16x32_bf16 v[168:171], a[136:139], v[32:35], v[168:171]
v_mfma_f32_16x16x32_bf16 v[172:175], a[200:203], v[32:35], v[172:175]
s_add_u32 m0, s26, 100352
s_add_u32 s24, s24, 1024
buffer_load_dwordx4 v4, s[8:11], s24 offen lds
v_mfma_f32_16x16x32_bf16 v[176:179], a[8:11], v[36:39], v[176:179]
v_mfma_f32_16x16x32_bf16 v[180:183], a[72:75], v[36:39], v[180:183]
v_mfma_f32_16x16x32_bf16 v[184:187], a[136:139], v[36:39], v[184:187]
v_mfma_f32_16x16x32_bf16 v[188:191], a[200:203], v[36:39], v[188:191]
ds_read_b128 v[32:35], v5 offset:43008
ds_read_b128 v[36:39], v5 offset:44032
s_waitcnt lgkmcnt(4)
v_mfma_f32_16x16x32_bf16 v[160:163], a[12:15], v[16:19], v[160:163]
v_mfma_f32_16x16x32_bf16 v[164:167], a[76:79], v[16:19], v[164:167]
v_mfma_f32_16x16x32_bf16 v[168:171], a[140:143], v[16:19], v[168:171]
v_mfma_f32_16x16x32_bf16 v[172:175], a[204:207], v[16:19], v[172:175]
s_add_u32 m0, s26, 101376
s_add_u32 s24, s24, 1024
buffer_load_dwordx4 v4, s[8:11], s24 offen lds
v_mfma_f32_16x16x32_bf16 v[176:179], a[12:15], v[20:23], v[176:179]
v_mfma_f32_16x16x32_bf16 v[180:183], a[76:79], v[20:23], v[180:183]
v_mfma_f32_16x16x32_bf16 v[184:187], a[140:143], v[20:23], v[184:187]
v_mfma_f32_16x16x32_bf16 v[188:191], a[204:207], v[20:23], v[188:191]
ds_read_b128 v[16:19], v5 offset:45056
ds_read_b128 v[20:23], v5 offset:46080
s_waitcnt lgkmcnt(4)
v_mfma_f32_16x16x32_bf16 v[160:163], a[16:19], v[24:27], v[160:163]
v_mfma_f32_16x16x32_bf16 v[164:167], a[80:83], v[24:27], v[164:167]
v_mfma_f32_16x16x32_bf16 v[168:171], a[144:147], v[24:27], v[168:171]
v_mfma_f32_16x16x32_bf16 v[172:175], a[208:211], v[24:27], v[172:175]
s_add_u32 m0, s26, 102400
s_add_u32 s24, s24, 1024
buffer_load_dwordx4 v4, s[8:11], s24 offen lds
v_mfma_f32_16x16x32_bf16 v[176:179], a[16:19], v[28:31], v[176:179]
v_mfma_f32_16x16x32_bf16 v[180:183], a[80:83], v[28:31], v[180:183]
v_mfma_f32_16x16x32_bf16 v[184:187], a[144:147], v[28:31], v[184:187]
v_mfma_f32_16x16x32_bf16 v[188:191], a[208:211], v[28:31], v[188:191]
ds_read_b128 v[24:27], v5 offset:47104
ds_read_b128 v[28:31], v5 offset:48128
s_waitcnt lgkmcnt(4)
v_mfma_f32_16x16x32_bf16 v[160:163], a[20:23], v[32:35], v[160:163]
v_mfma_f32_16x16x32_bf16 v[164:167], a[84:87], v[32:35], v[164:167]
v_mfma_f32_16x16x32_bf16 v[168:171], a[148:151], v[32:35], v[168:171]
v_mfma_f32_16x16x32_bf16 v[172:175], a[212:215], v[32:35], v[172:175]
s_add_u32 m0, s26, 103424
s_add_u32 s24, s24, 1024
buffer_load_dwordx4 v4, s[8:11], s24 offen lds
v_mfma_f32_16x16x32_bf16 v[176:179], a[20:23], v[36:39], v[176:179]
v_mfma_f32_16x16x32_bf16 v[180:183], a[84:87], v[36:39], v[180:183]
v_mfma_f32_16x16x32_bf16 v[184:187], a[148:151], v[36:39], v[184:187]
v_mfma_f32_16x16x32_bf16 v[188:191], a[212:215], v[36:39], v[188:191]
ds_read_b128 v[32:35], v5 offset:49152
ds_read_b128 v[36:39], v5 offset:50176
s_waitcnt lgkmcnt(4)
v_mfma_f32_16x16x32_bf16 v[160:163], a[24:27], v[16:19], v[160:163]
v_mfma_f32_16x16x32_bf16 v[164:167], a[88:91], v[16:19], v[164:167]
v_mfma_f32_16x16x32_bf16 v[168:171], a[152:155], v[16:19], v[168:171]
v_mfma_f32_16x16x32_bf16 v[172:175], a[216:219], v[16:19], v[172:175]
s_add_u32 m0, s26, 104448
s_add_u32 s24, s24, 1024
buffer_load_dwordx4 v4, s[8:11], s24 offen lds
v_mfma_f32_16x16x32_bf16 v[176:179], a[24:27], v[20:23], v[176:179]
v_mfma_f32_16x16x32_bf16 v[180:183], a[88:91], v[20:23], v[180:183]
v_mfma_f32_16x16x32_bf16 v[184:187], a[152:155], v[20:23], v[184:187]
v_mfma_f32_16x16x32_bf16 v[188:191], a[216:219], v[20:23], v[188:191]
ds_read_b128 v[16:19], v5 offset:51200
ds_read_b128 v[20:23], v5 offset:52224
s_waitcnt lgkmcnt(4)
v_mfma_f32_16x16x32_bf16 v[160:163], a[28:31], v[24:27], v[160:163]
v_mfma_f32_16x16x32_bf16 v[164:167], a[92:95], v[24:27], v[164:167]
v_mfma_f32_16x16x32_bf16 v[168:171], a[156:159], v[24:27], v[168:171]
v_mfma_f32_16x16x32_bf16 v[172:175], a[220:223], v[24:27], v[172:175]
s_add_u32 m0, s26, 105472
s_add_u32 s24, s24, 1024
buffer_load_dwordx4 v4, s[8:11], s24 offen lds
v_mfma_f32_16x16x32_bf16 v[176:179], a[28:31], v[28:31], v[176:179]
v_mfma_f32_16x16x32_bf16 v[180:183], a[92:95], v[28:31], v[180:183]
v_mfma_f32_16x16x32_bf16 v[184:187], a[156:159], v[28:31], v[184:187]
v_mfma_f32_16x16x32_bf16 v[188:191], a[220:223], v[28:31], v[188:191]
ds_read_b128 v[24:27], v5 offset:53248
ds_read_b128 v[28:31], v5 offset:54272
s_waitcnt lgkmcnt(4)
v_mfma_f32_16x16x32_bf16 v[160:163], a[32:35], v[32:35], v[160:163]
v_mfma_f32_16x16x32_bf16 v[164:167], a[96:99], v[32:35], v[164:167]
v_mfma_f32_16x16x32_bf16 v[168:171], a[160:163], v[32:35], v[168:171]
v_mfma_f32_16x16x32_bf16 v[172:175], a[224:227], v[32:35], v[172:175]
v_mfma_f32_16x16x32_bf16 v[176:179], a[32:35], v[36:39], v[176:179]
v_mfma_f32_16x16x32_bf16 v[180:183], a[96:99], v[36:39], v[180:183]
v_mfma_f32_16x16x32_bf16 v[184:187], a[160:163], v[36:39], v[184:187]
v_mfma_f32_16x16x32_bf16 v[188:191], a[224:227], v[36:39], v[188:191]
ds_read_b128 v[32:35], v5 offset:55296
ds_read_b128 v[36:39], v5 offset:56320
s_waitcnt lgkmcnt(4)
v_mfma_f32_16x16x32_bf16 v[160:163], a[36:39], v[16:19], v[160:163]
v_mfma_f32_16x16x32_bf16 v[164:167], a[100:103], v[16:19], v[164:167]
v_mfma_f32_16x16x32_bf16 v[168:171], a[164:167], v[16:19], v[168:171]
v_mfma_f32_16x16x32_bf16 v[172:175], a[228:231], v[16:19], v[172:175]
v_mfma_f32_16x16x32_bf16 v[176:179], a[36:39], v[20:23], v[176:179]
v_mfma_f32_16x16x32_bf16 v[180:183], a[100:103], v[20:23], v[180:183]
v_mfma_f32_16x16x32_bf16 v[184:187], a[164:167], v[20:23], v[184:187]
v_mfma_f32_16x16x32_bf16 v[188:191], a[228:231], v[20:23], v[188:191]
ds_read_b128 v[16:19], v5 offset:57344
ds_read_b128 v[20:23], v5 offset:58368
s_waitcnt lgkmcnt(4)
v_mfma_f32_16x16x32_bf16 v[160:163], a[40:43], v[24:27], v[160:163]
v_mfma_f32_16x16x32_bf16 v[164:167], a[104:107], v[24:27], v[164:167]
v_mfma_f32_16x16x32_bf16 v[168:171], a[168:171], v[24:27], v[168:171]
v_mfma_f32_16x16x32_bf16 v[172:175], a[232:235], v[24:27], v[172:175]
v_mfma_f32_16x16x32_bf16 v[176:179], a[40:43], v[28:31], v[176:179]
v_mfma_f32_16x16x32_bf16 v[180:183], a[104:107], v[28:31], v[180:183]
v_mfma_f32_16x16x32_bf16 v[184:187], a[168:171], v[28:31], v[184:187]
v_mfma_f32_16x16x32_bf16 v[188:191], a[232:235], v[28:31], v[188:191]
ds_read_b128 v[24:27], v5 offset:59392
ds_read_b128 v[28:31], v5 offset:60416
s_waitcnt lgkmcnt(4)
v_mfma_f32_16x16x32_bf16 v[160:163], a[44:47], v[32:35], v[160:163]
v_mfma_f32_16x16x32_bf16 v[164:167], a[108:111], v[32:35], v[164:167]
v_mfma_f32_16x16x32_bf16 v[168:171], a[172:175], v[32:35], v[168:171]
v_mfma_f32_16x16x32_bf16 v[172:175], a[236:239], v[32:35], v[172:175]
v_mfma_f32_16x16x32_bf16 v[176:179], a[44:47], v[36:39], v[176:179]
v_mfma_f32_16x16x32_bf16 v[180:183], a[108:111], v[36:39], v[180:183]
v_mfma_f32_16x16x32_bf16 v[184:187], a[172:175], v[36:39], v[184:187]
v_mfma_f32_16x16x32_bf16 v[188:191], a[236:239], v[36:39], v[188:191]
ds_read_b128 v[32:35], v5 offset:61440
ds_read_b128 v[36:39], v5 offset:62464
s_waitcnt lgkmcnt(4)
v_mfma_f32_16x16x32_bf16 v[160:163], a[48:51], v[16:19], v[160:163]
v_mfma_f32_16x16x32_bf16 v[164:167], a[112:115], v[16:19], v[164:167]
v_mfma_f32_16x16x32_bf16 v[168:171], a[176:179], v[16:19], v[168:171]
v_mfma_f32_16x16x32_bf16 v[172:175], a[240:243], v[16:19], v[172:175]
v_mfma_f32_16x16x32_bf16 v[176:179], a[48:51], v[20:23], v[176:179]
v_mfma_f32_16x16x32_bf16 v[180:183], a[112:115], v[20:23], v[180:183]
v_mfma_f32_16x16x32_bf16 v[184:187], a[176:179], v[20:23], v[184:187]
v_mfma_f32_16x16x32_bf16 v[188:191], a[240:243], v[20:23], v[188:191]
ds_read_b128 v[16:19], v5 offset:63488
ds_read_b128 v[20:23], v5 offset:64512
s_waitcnt lgkmcnt(4)
v_mfma_f32_16x16x32_bf16 v[160:163], a[52:55], v[24:27], v[160:163]
v_mfma_f32_16x16x32_bf16 v[164:167], a[116:119], v[24:27], v[164:167]
v_mfma_f32_16x16x32_bf16 v[168:171], a[180:183], v[24:27], v[168:171]
v_mfma_f32_16x16x32_bf16 v[172:175], a[244:247], v[24:27], v[172:175]
v_mfma_f32_16x16x32_bf16 v[176:179], a[52:55], v[28:31], v[176:179]
v_mfma_f32_16x16x32_bf16 v[180:183], a[116:119], v[28:31], v[180:183]
v_mfma_f32_16x16x32_bf16 v[184:187], a[180:183], v[28:31], v[184:187]
v_mfma_f32_16x16x32_bf16 v[188:191], a[244:247], v[28:31], v[188:191]
s_waitcnt lgkmcnt(2)
v_mfma_f32_16x16x32_bf16 v[160:163], a[56:59], v[32:35], v[160:163]
v_mfma_f32_16x16x32_bf16 v[164:167], a[120:123], v[32:35], v[164:167]
v_mfma_f32_16x16x32_bf16 v[168:171], a[184:187], v[32:35], v[168:171]
v_mfma_f32_16x16x32_bf16 v[172:175], a[248:251], v[32:35], v[172:175]
v_mfma_f32_16x16x32_bf16 v[176:179], a[56:59], v[36:39], v[176:179]
v_mfma_f32_16x16x32_bf16 v[180:183], a[120:123], v[36:39], v[180:183]
v_mfma_f32_16x16x32_bf16 v[184:187], a[184:187], v[36:39], v[184:187]
v_mfma_f32_16x16x32_bf16 v[188:191], a[248:251], v[36:39], v[188:191]
s_waitcnt lgkmcnt(0)
v_mfma_f32_16x16x32_bf16 v[160:163], a[60:63], v[16:19], v[160:163]
v_mfma_f32_16x16x32_bf16 v[164:167], a[124:127], v[16:19], v[164:167]
v_mfma_f32_16x16x32_bf16 v[168:171], a[188:191], v[16:19], v[168:171]
v_mfma_f32_16x16x32_bf16 v[172:175], a[252:255], v[16:19], v[172:175]
v_mfma_f32_16x16x32_bf16 v[176:179], a[60:63], v[20:23], v[176:179]
v_mfma_f32_16x16x32_bf16 v[180:183], a[124:127], v[20:23], v[180:183]
v_mfma_f32_16x16x32_bf16 v[184:187], a[188:191], v[20:23], v[184:187]
v_mfma_f32_16x16x32_bf16 v[188:191], a[252:255], v[20:23], v[188:191]
s_waitcnt vmcnt(0)
s_add_u32 s23, s23, 1
G1_LOOP_QK:
s_waitcnt vmcnt(4)
s_barrier
ds_read_b128 v[16:19], v5 offset:0
ds_read_b128 v[20:23], v5 offset:1024
ds_read_b128 v[24:27], v5 offset:2048
ds_read_b128 v[28:31], v5 offset:3072
s_cmp_lg_u32 s17, 0
s_cbranch_scc1 G1F_16
s_cmp_lg_u32 s84, 0
s_cbranch_scc1 INIT_17
v_mov_b32 v8, 4
s_mov_b32 s35, 0
POLL_INIT_18:
s_cmp_lg_u32 s37, 0
s_cbranch_scc1 POLL_INIT_18_E
buffer_load_dword v9, v8, s[4:7], 0 offen sc1
s_add_u32 s35, s35, 1
s_cmp_gt_u32 s35, 65536
s_cselect_b32 s37, 1, 0
s_waitcnt vmcnt(0)
v_cmp_gt_u32 vcc, 32, v9
s_cbranch_vccz POLL_INIT_18_E
s_sleep 4
s_branch POLL_INIT_18
POLL_INIT_18_E:
s_mov_b32 s84, 1
INIT_17:
s_sub_u32 s32, s23, 2
s_max_u32 s32, s32, 1
s_lshr_b32 s32, s32, s44
v_mov_b32 v8, s32
s_mov_b64 exec, 1
buffer_store_dword v8, off, s[8:11], s25 sc1
s_mov_b64 exec, -1
G1F_16:
ds_read_b128 v[32:35], v5 offset:4096
ds_read_b128 v[36:39], v5 offset:5120
s_waitcnt lgkmcnt(4)
v_mfma_f32_16x16x32_bf16 v[128:131], a[0:3], v[16:19], 0
v_mfma_f32_16x16x32_bf16 v[132:135], a[64:67], v[16:19], 0
v_mfma_f32_16x16x32_bf16 v[136:139], a[128:131], v[16:19], 0
v_mfma_f32_16x16x32_bf16 v[140:143], a[192:195], v[16:19], 0
s_add_u32 m0, s26, 131072
s_add_u32 s24, s24, s45
buffer_load_dwordx4 v4, s[8:11], s24 offen lds
v_mfma_f32_16x16x32_bf16 v[144:147], a[0:3], v[20:23], 0
v_mfma_f32_16x16x32_bf16 v[148:151], a[64:67], v[20:23], 0
v_mfma_f32_16x16x32_bf16 v[152:155], a[128:131], v[20:23], 0
v_mfma_f32_16x16x32_bf16 v[156:159], a[192:195], v[20:23], 0
ds_read_b128 v[16:19], v5 offset:6144
ds_read_b128 v[20:23], v5 offset:7168
s_waitcnt lgkmcnt(4)
v_mfma_f32_16x16x32_bf16 v[128:131], a[4:7], v[24:27], v[128:131]
v_mfma_f32_16x16x32_bf16 v[132:135], a[68:71], v[24:27], v[132:135]
v_mfma_f32_16x16x32_bf16 v[136:139], a[132:135], v[24:27], v[136:139]
v_mfma_f32_16x16x32_bf16 v[140:143], a[196:199], v[24:27], v[140:143]
s_add_u32 m0, s26, 132096
s_add_u32 s24, s24, 1024
buffer_load_dwordx4 v4, s[8:11], s24 offen lds
v_mfma_f32_16x16x32_bf16 v[144:147], a[4:7], v[28:31], v[144:147]
v_mfma_f32_16x16x32_bf16 v[148:151], a[68:71], v[28:31], v[148:151]
v_mfma_f32_16x16x32_bf16 v[152:155], a[132:135], v[28:31], v[152:155]
v_mfma_f32_16x16x32_bf16 v[156:159], a[196:199], v[28:31], v[156:159]
ds_read_b128 v[24:27], v5 offset:8192
ds_read_b128 v[28:31], v5 offset:9216
s_waitcnt lgkmcnt(4)
v_mfma_f32_16x16x32_bf16 v[128:131], a[8:11], v[32:35], v[128:131]
v_mfma_f32_16x16x32_bf16 v[132:135], a[72:75], v[32:35], v[132:135]
v_mfma_f32_16x16x32_bf16 v[136:139], a[136:139], v[32:35], v[136:139]
v_mfma_f32_16x16x32_bf16 v[140:143], a[200:203], v[32:35], v[140:143]
s_add_u32 m0, s26, 133120
s_add_u32 s24, s24, 1024
buffer_load_dwordx4 v4, s[8:11], s24 offen lds
v_mfma_f32_16x16x32_bf16 v[144:147], a[8:11], v[36:39], v[144:147]
v_mfma_f32_16x16x32_bf16 v[148:151], a[72:75], v[36:39], v[148:151]
v_mfma_f32_16x16x32_bf16 v[152:155], a[136:139], v[36:39], v[152:155]
v_mfma_f32_16x16x32_bf16 v[156:159], a[200:203], v[36:39], v[156:159]
ds_read_b128 v[32:35], v5 offset:10240
ds_read_b128 v[36:39], v5 offset:11264
s_waitcnt lgkmcnt(4)
v_mfma_f32_16x16x32_bf16 v[128:131], a[12:15], v[16:19], v[128:131]
v_mfma_f32_16x16x32_bf16 v[132:135], a[76:79], v[16:19], v[132:135]
v_mfma_f32_16x16x32_bf16 v[136:139], a[140:143], v[16:19], v[136:139]
v_mfma_f32_16x16x32_bf16 v[140:143], a[204:207], v[16:19], v[140:143]
s_add_u32 m0, s26, 134144
s_add_u32 s24, s24, 1024
buffer_load_dwordx4 v4, s[8:11], s24 offen lds
v_mfma_f32_16x16x32_bf16 v[144:147], a[12:15], v[20:23], v[144:147]
v_mfma_f32_16x16x32_bf16 v[148:151], a[76:79], v[20:23], v[148:151]
v_mfma_f32_16x16x32_bf16 v[152:155], a[140:143], v[20:23], v[152:155]
v_mfma_f32_16x16x32_bf16 v[156:159], a[204:207], v[20:23], v[156:159]
ds_read_b128 v[16:19], v5 offset:12288
ds_read_b128 v[20:23], v5 offset:13312
s_waitcnt lgkmcnt(4)
v_mfma_f32_16x16x32_bf16 v[128:131], a[16:19], v[24:27], v[128:131]
v_mfma_f32_16x16x32_bf16 v[132:135], a[80:83], v[24:27], v[132:135]
v_mfma_f32_16x16x32_bf16 v[136:139], a[144:147], v[24:27], v[136:139]
v_mfma_f32_16x16x32_bf16 v[140:143], a[208:211], v[24:27], v[140:143]
s_add_u32 m0, s26, 135168
s_add_u32 s24, s24, 1024
buffer_load_dwordx4 v4, s[8:11], s24 offen lds
v_mfma_f32_16x16x32_bf16 v[144:147], a[16:19], v[28:31], v[144:147]
v_mfma_f32_16x16x32_bf16 v[148:151], a[80:83], v[28:31], v[148:151]
v_mfma_f32_16x16x32_bf16 v[152:155], a[144:147], v[28:31], v[152:155]
v_mfma_f32_16x16x32_bf16 v[156:159], a[208:211], v[28:31], v[156:159]
ds_read_b128 v[24:27], v5 offset:14336
ds_read_b128 v[28:31], v5 offset:15360
s_waitcnt lgkmcnt(4)
v_mfma_f32_16x16x32_bf16 v[128:131], a[20:23], v[32:35], v[128:131]
v_mfma_f32_16x16x32_bf16 v[132:135], a[84:87], v[32:35], v[132:135]
v_mfma_f32_16x16x32_bf16 v[136:139], a[148:151], v[32:35], v[136:139]
v_mfma_f32_16x16x32_bf16 v[140:143], a[212:215], v[32:35], v[140:143]
s_add_u32 m0, s26, 136192
s_add_u32 s24, s24, 1024
buffer_load_dwordx4 v4, s[8:11], s24 offen lds
v_mfma_f32_16x16x32_bf16 v[144:147], a[20:23], v[36:39], v[144:147]
v_mfma_f32_16x16x32_bf16 v[148:151], a[84:87], v[36:39], v[148:151]
v_mfma_f32_16x16x32_bf16 v[152:155], a[148:151], v[36:39], v[152:155]
v_mfma_f32_16x16x32_bf16 v[156:159], a[212:215], v[36:39], v[156:159]
ds_read_b128 v[32:35], v5 offset:16384
ds_read_b128 v[36:39], v5 offset:17408
s_waitcnt lgkmcnt(4)
v_mfma_f32_16x16x32_bf16 v[128:131], a[24:27], v[16:19], v[128:131]
v_mfma_f32_16x16x32_bf16 v[132:135], a[88:91], v[16:19], v[132:135]
v_mfma_f32_16x16x32_bf16 v[136:139], a[152:155], v[16:19], v[136:139]
v_mfma_f32_16x16x32_bf16 v[140:143], a[216:219], v[16:19], v[140:143]
s_add_u32 m0, s26, 137216
s_add_u32 s24, s24, 1024
buffer_load_dwordx4 v4, s[8:11], s24 offen lds
v_mfma_f32_16x16x32_bf16 v[144:147], a[24:27], v[20:23], v[144:147]
v_mfma_f32_16x16x32_bf16 v[148:151], a[88:91], v[20:23], v[148:151]
v_mfma_f32_16x16x32_bf16 v[152:155], a[152:155], v[20:23], v[152:155]
v_mfma_f32_16x16x32_bf16 v[156:159], a[216:219], v[20:23], v[156:159]
ds_read_b128 v[16:19], v5 offset:18432
ds_read_b128 v[20:23], v5 offset:19456
s_waitcnt lgkmcnt(4)
v_mfma_f32_16x16x32_bf16 v[128:131], a[28:31], v[24:27], v[128:131]
v_mfma_f32_16x16x32_bf16 v[132:135], a[92:95], v[24:27], v[132:135]
v_mfma_f32_16x16x32_bf16 v[136:139], a[156:159], v[24:27], v[136:139]
v_mfma_f32_16x16x32_bf16 v[140:143], a[220:223], v[24:27], v[140:143]
s_add_u32 m0, s26, 138240
s_add_u32 s24, s24, 1024
buffer_load_dwordx4 v4, s[8:11], s24 offen lds
v_mfma_f32_16x16x32_bf16 v[144:147], a[28:31], v[28:31], v[144:147]
v_mfma_f32_16x16x32_bf16 v[148:151], a[92:95], v[28:31], v[148:151]
v_mfma_f32_16x16x32_bf16 v[152:155], a[156:159], v[28:31], v[152:155]
v_mfma_f32_16x16x32_bf16 v[156:159], a[220:223], v[28:31], v[156:159]
ds_read_b128 v[24:27], v5 offset:20480
ds_read_b128 v[28:31], v5 offset:21504
s_waitcnt lgkmcnt(4)
v_mfma_f32_16x16x32_bf16 v[128:131], a[32:35], v[32:35], v[128:131]
v_cvt_pk_bf16_f32 v48, v160, v161
v_mfma_f32_16x16x32_bf16 v[132:135], a[96:99], v[32:35], v[132:135]
v_cvt_pk_bf16_f32 v49, v162, v163
v_mfma_f32_16x16x32_bf16 v[136:139], a[160:163], v[32:35], v[136:139]
v_cvt_pk_bf16_f32 v50, v168, v169
v_mfma_f32_16x16x32_bf16 v[140:143], a[224:227], v[32:35], v[140:143]
v_cvt_pk_bf16_f32 v51, v170, v171
v_mfma_f32_16x16x32_bf16 v[144:147], a[32:35], v[36:39], v[144:147]
s_add_u32 s32, s22, 0
buffer_store_dwordx4 v[48:51], v4, s[8:11], s32 offen sc1
v_mfma_f32_16x16x32_bf16 v[148:151], a[96:99], v[36:39], v[148:151]
v_cvt_pk_bf16_f32 v52, v164, v165
v_mfma_f32_16x16x32_bf16 v[152:155], a[160:163], v[36:39], v[152:155]
v_cvt_pk_bf16_f32 v53, v166, v167
v_mfma_f32_16x16x32_bf16 v[156:159], a[224:227], v[36:39], v[156:159]
v_cvt_pk_bf16_f32 v54, v172, v173
ds_read_b128 v[32:35], v5 offset:22528
ds_read_b128 v[36:39], v5 offset:23552
s_waitcnt lgkmcnt(4)
v_mfma_f32_16x16x32_bf16 v[128:131], a[36:39], v[16:19], v[128:131]
v_cvt_pk_bf16_f32 v55, v174, v175
v_mfma_f32_16x16x32_bf16 v[132:135], a[100:103], v[16:19], v[132:135]
s_add_u32 s32, s22, 2048
buffer_store_dwordx4 v[52:55], v4, s[8:11], s32 offen sc1
v_mfma_f32_16x16x32_bf16 v[136:139], a[164:167], v[16:19], v[136:139]
v_cvt_pk_bf16_f32 v56, v176, v177
v_mfma_f32_16x16x32_bf16 v[140:143], a[228:231], v[16:19], v[140:143]
v_cvt_pk_bf16_f32 v57, v178, v179
v_mfma_f32_16x16x32_bf16 v[144:147], a[36:39], v[20:23], v[144:147]
v_cvt_pk_bf16_f32 v58, v184, v185
v_mfma_f32_16x16x32_bf16 v[148:151], a[100:103], v[20:23], v[148:151]
v_cvt_pk_bf16_f32 v59, v186, v187
v_mfma_f32_16x16x32_bf16 v[152:155], a[164:167], v[20:23], v[152:155]
s_add_u32 s32, s22, 4096
buffer_store_dwordx4 v[56:59], v4, s[8:11], s32 offen sc1
v_mfma_f32_16x16x32_bf16 v[156:159], a[228:231], v[20:23], v[156:159]
v_cvt_pk_bf16_f32 v60, v180, v181
ds_read_b128 v[16:19], v5 offset:24576
ds_read_b128 v[20:23], v5 offset:25600
s_waitcnt lgkmcnt(4)
v_mfma_f32_16x16x32_bf16 v[128:131], a[40:43], v[24:27], v[128:131]
v_cvt_pk_bf16_f32 v61, v182, v183
v_mfma_f32_16x16x32_bf16 v[132:135], a[104:107], v[24:27], v[132:135]
v_cvt_pk_bf16_f32 v62, v188, v189
v_mfma_f32_16x16x32_bf16 v[136:139], a[168:171], v[24:27], v[136:139]
v_cvt_pk_bf16_f32 v63, v190, v191
v_mfma_f32_16x16x32_bf16 v[140:143], a[232:235], v[24:27], v[140:143]
s_add_u32 s32, s22, 6144
buffer_store_dwordx4 v[60:63], v4, s[8:11], s32 offen sc1
v_mfma_f32_16x16x32_bf16 v[144:147], a[40:43], v[28:31], v[144:147]
s_add_u32 s22, s22, s46
v_mfma_f32_16x16x32_bf16 v[148:151], a[104:107], v[28:31], v[148:151]
v_mfma_f32_16x16x32_bf16 v[152:155], a[168:171], v[28:31], v[152:155]
v_mfma_f32_16x16x32_bf16 v[156:159], a[232:235], v[28:31], v[156:159]
ds_read_b128 v[24:27], v5 offset:26624
ds_read_b128 v[28:31], v5 offset:27648
s_waitcnt lgkmcnt(4)
v_mfma_f32_16x16x32_bf16 v[128:131], a[44:47], v[32:35], v[128:131]
v_mfma_f32_16x16x32_bf16 v[132:135], a[108:111], v[32:35], v[132:135]
v_mfma_f32_16x16x32_bf16 v[136:139], a[172:175], v[32:35], v[136:139]
v_mfma_f32_16x16x32_bf16 v[140:143], a[236:239], v[32:35], v[140:143]
v_mfma_f32_16x16x32_bf16 v[144:147], a[44:47], v[36:39], v[144:147]
v_mfma_f32_16x16x32_bf16 v[148:151], a[108:111], v[36:39], v[148:151]
v_mfma_f32_16x16x32_bf16 v[152:155], a[172:175], v[36:39], v[152:155]
v_mfma_f32_16x16x32_bf16 v[156:159], a[236:239], v[36:39], v[156:159]
ds_read_b128 v[32:35], v5 offset:28672
ds_read_b128 v[36:39], v5 offset:29696
s_waitcnt lgkmcnt(4)
v_mfma_f32_16x16x32_bf16 v[128:131], a[48:51], v[16:19], v[128:131]
v_mfma_f32_16x16x32_bf16 v[132:135], a[112:115], v[16:19], v[132:135]
v_mfma_f32_16x16x32_bf16 v[136:139], a[176:179], v[16:19], v[136:139]
v_mfma_f32_16x16x32_bf16 v[140:143], a[240:243], v[16:19], v[140:143]
v_mfma_f32_16x16x32_bf16 v[144:147], a[48:51], v[20:23], v[144:147]
v_mfma_f32_16x16x32_bf16 v[148:151], a[112:115], v[20:23], v[148:151]
v_mfma_f32_16x16x32_bf16 v[152:155], a[176:179], v[20:23], v[152:155]
v_mfma_f32_16x16x32_bf16 v[156:159], a[240:243], v[20:23], v[156:159]
ds_read_b128 v[16:19], v5 offset:30720
ds_read_b128 v[20:23], v5 offset:31744
s_waitcnt lgkmcnt(4)
v_mfma_f32_16x16x32_bf16 v[128:131], a[52:55], v[24:27], v[128:131]
v_mfma_f32_16x16x32_bf16 v[132:135], a[116:119], v[24:27], v[132:135]
v_mfma_f32_16x16x32_bf16 v[136:139], a[180:183], v[24:27], v[136:139]
v_mfma_f32_16x16x32_bf16 v[140:143], a[244:247], v[24:27], v[140:143]
v_mfma_f32_16x16x32_bf16 v[144:147], a[52:55], v[28:31], v[144:147]
v_mfma_f32_16x16x32_bf16 v[148:151], a[116:119], v[28:31], v[148:151]
v_mfma_f32_16x16x32_bf16 v[152:155], a[180:183], v[28:31], v[152:155]
v_mfma_f32_16x16x32_bf16 v[156:159], a[244:247], v[28:31], v[156:159]
s_waitcnt lgkmcnt(2)
v_mfma_f32_16x16x32_bf16 v[128:131], a[56:59], v[32:35], v[128:131]
v_mfma_f32_16x16x32_bf16 v[132:135], a[120:123], v[32:35], v[132:135]
v_mfma_f32_16x16x32_bf16 v[136:139], a[184:187], v[32:35], v[136:139]
v_mfma_f32_16x16x32_bf16 v[140:143], a[248:251], v[32:35], v[140:143]
v_mfma_f32_16x16x32_bf16 v[144:147], a[56:59], v[36:39], v[144:147]
v_mfma_f32_16x16x32_bf16 v[148:151], a[120:123], v[36:39], v[148:151]
v_mfma_f32_16x16x32_bf16 v[152:155], a[184:187], v[36:39], v[152:155]
v_mfma_f32_16x16x32_bf16 v[156:159], a[248:251], v[36:39], v[156:159]
s_waitcnt lgkmcnt(0)
v_mfma_f32_16x16x32_bf16 v[128:131], a[60:63], v[16:19], v[128:131]
v_mfma_f32_16x16x32_bf16 v[132:135], a[124:127], v[16:19], v[132:135]
v_mfma_f32_16x16x32_bf16 v[136:139], a[188:191], v[16:19], v[136:139]
v_mfma_f32_16x16x32_bf16 v[140:143], a[252:255], v[16:19], v[140:143]
v_mfma_f32_16x16x32_bf16 v[144:147], a[60:63], v[20:23], v[144:147]
v_mfma_f32_16x16x32_bf16 v[148:151], a[124:127], v[20:23], v[148:151]
v_mfma_f32_16x16x32_bf16 v[152:155], a[188:191], v[20:23], v[152:155]
v_mfma_f32_16x16x32_bf16 v[156:159], a[252:255], v[20:23], v[156:159]
s_add_u32 s23, s23, 1
s_waitcnt vmcnt(4)
s_barrier
ds_read_b128 v[16:19], v5 offset:32768
ds_read_b128 v[20:23], v5 offset:33792
ds_read_b128 v[24:27], v5 offset:34816
ds_read_b128 v[28:31], v5 offset:35840
s_cmp_lg_u32 s17, 0
s_cbranch_scc1 G1F_19
s_cmp_lg_u32 s84, 0
s_cbranch_scc1 INIT_20
v_mov_b32 v8, 4
s_mov_b32 s35, 0
POLL_INIT_21:
s_cmp_lg_u32 s37, 0
s_cbranch_scc1 POLL_INIT_21_E
buffer_load_dword v9, v8, s[4:7], 0 offen sc1
s_add_u32 s35, s35, 1
s_cmp_gt_u32 s35, 65536
s_cselect_b32 s37, 1, 0
s_waitcnt vmcnt(0)
v_cmp_gt_u32 vcc, 32, v9
s_cbranch_vccz POLL_INIT_21_E
s_sleep 4
s_branch POLL_INIT_21
POLL_INIT_21_E:
s_mov_b32 s84, 1
INIT_20:
s_sub_u32 s32, s23, 2
s_max_u32 s32, s32, 1
s_lshr_b32 s32, s32, s44
v_mov_b32 v8, s32
s_mov_b64 exec, 1
buffer_store_dword v8, off, s[8:11], s25 sc1
s_mov_b64 exec, -1
G1F_19:
ds_read_b128 v[32:35], v5 offset:36864
ds_read_b128 v[36:39], v5 offset:37888
s_waitcnt lgkmcnt(4)
v_mfma_f32_16x16x32_bf16 v[160:163], a[0:3], v[16:19], 0
v_mfma_f32_16x16x32_bf16 v[164:167], a[64:67], v[16:19], 0
v_mfma_f32_16x16x32_bf16 v[168:171], a[128:131], v[16:19], 0
v_mfma_f32_16x16x32_bf16 v[172:175], a[192:195], v[16:19], 0
s_add_u32 m0, s26, 98304
s_add_u32 s24, s24, s45
buffer_load_dwordx4 v4, s[8:11], s24 offen lds
v_mfma_f32_16x16x32_bf16 v[176:179], a[0:3], v[20:23], 0
v_mfma_f32_16x16x32_bf16 v[180:183], a[64:67], v[20:23], 0
v_mfma_f32_16x16x32_bf16 v[184:187], a[128:131], v[20:23], 0
v_mfma_f32_16x16x32_bf16 v[188:191], a[192:195], v[20:23], 0
ds_read_b128 v[16:19], v5 offset:38912
ds_read_b128 v[20:23], v5 offset:39936
s_waitcnt lgkmcnt(4)
v_mfma_f32_16x16x32_bf16 v[160:163], a[4:7], v[24:27], v[160:163]
v_mfma_f32_16x16x32_bf16 v[164:167], a[68:71], v[24:27], v[164:167]
v_mfma_f32_16x16x32_bf16 v[168:171], a[132:135], v[24:27], v[168:171]
v_mfma_f32_16x16x32_bf16 v[172:175], a[196:199], v[24:27], v[172:175]
s_add_u32 m0, s26, 99328
s_add_u32 s24, s24, 1024
buffer_load_dwordx4 v4, s[8:11], s24 offen lds
v_mfma_f32_16x16x32_bf16 v[176:179], a[4:7], v[28:31], v[176:179]
v_mfma_f32_16x16x32_bf16 v[180:183], a[68:71], v[28:31], v[180:183]
v_mfma_f32_16x16x32_bf16 v[184:187], a[132:135], v[28:31], v[184:187]
v_mfma_f32_16x16x32_bf16 v[188:191], a[196:199], v[28:31], v[188:191]
ds_read_b128 v[24:27], v5 offset:40960
ds_read_b128 v[28:31], v5 offset:41984
s_waitcnt lgkmcnt(4)
v_mfma_f32_16x16x32_bf16 v[160:163], a[8:11], v[32:35], v[160:163]
v_mfma_f32_16x16x32_bf16 v[164:167], a[72:75], v[32:35], v[164:167]
v_mfma_f32_16x16x32_bf16 v[168:171], a[136:139], v[32:35], v[168:171]
v_mfma_f32_16x16x32_bf16 v[172:175], a[200:203], v[32:35], v[172:175]
s_add_u32 m0, s26, 100352
s_add_u32 s24, s24, 1024
buffer_load_dwordx4 v4, s[8:11], s24 offen lds
v_mfma_f32_16x16x32_bf16 v[176:179], a[8:11], v[36:39], v[176:179]
v_mfma_f32_16x16x32_bf16 v[180:183], a[72:75], v[36:39], v[180:183]
v_mfma_f32_16x16x32_bf16 v[184:187], a[136:139], v[36:39], v[184:187]
v_mfma_f32_16x16x32_bf16 v[188:191], a[200:203], v[36:39], v[188:191]
ds_read_b128 v[32:35], v5 offset:43008
ds_read_b128 v[36:39], v5 offset:44032
s_waitcnt lgkmcnt(4)
v_mfma_f32_16x16x32_bf16 v[160:163], a[12:15], v[16:19], v[160:163]
v_mfma_f32_16x16x32_bf16 v[164:167], a[76:79], v[16:19], v[164:167]
v_mfma_f32_16x16x32_bf16 v[168:171], a[140:143], v[16:19], v[168:171]
v_mfma_f32_16x16x32_bf16 v[172:175], a[204:207], v[16:19], v[172:175]
s_add_u32 m0, s26, 101376
s_add_u32 s24, s24, 1024
buffer_load_dwordx4 v4, s[8:11], s24 offen lds
v_mfma_f32_16x16x32_bf16 v[176:179], a[12:15], v[20:23], v[176:179]
v_mfma_f32_16x16x32_bf16 v[180:183], a[76:79], v[20:23], v[180:183]
v_mfma_f32_16x16x32_bf16 v[184:187], a[140:143], v[20:23], v[184:187]
v_mfma_f32_16x16x32_bf16 v[188:191], a[204:207], v[20:23], v[188:191]
ds_read_b128 v[16:19], v5 offset:45056
ds_read_b128 v[20:23], v5 offset:46080
s_waitcnt lgkmcnt(4)
v_mfma_f32_16x16x32_bf16 v[160:163], a[16:19], v[24:27], v[160:163]
v_mfma_f32_16x16x32_bf16 v[164:167], a[80:83], v[24:27], v[164:167]
v_mfma_f32_16x16x32_bf16 v[168:171], a[144:147], v[24:27], v[168:171]
v_mfma_f32_16x16x32_bf16 v[172:175], a[208:211], v[24:27], v[172:175]
s_add_u32 m0, s26, 102400
s_add_u32 s24, s24, 1024
buffer_load_dwordx4 v4, s[8:11], s24 offen lds
v_mfma_f32_16x16x32_bf16 v[176:179], a[16:19], v[28:31], v[176:179]
v_mfma_f32_16x16x32_bf16 v[180:183], a[80:83], v[28:31], v[180:183]
v_mfma_f32_16x16x32_bf16 v[184:187], a[144:147], v[28:31], v[184:187]
v_mfma_f32_16x16x32_bf16 v[188:191], a[208:211], v[28:31], v[188:191]
ds_read_b128 v[24:27], v5 offset:47104
ds_read_b128 v[28:31], v5 offset:48128
s_waitcnt lgkmcnt(4)
v_mfma_f32_16x16x32_bf16 v[160:163], a[20:23], v[32:35], v[160:163]
v_mfma_f32_16x16x32_bf16 v[164:167], a[84:87], v[32:35], v[164:167]
v_mfma_f32_16x16x32_bf16 v[168:171], a[148:151], v[32:35], v[168:171]
v_mfma_f32_16x16x32_bf16 v[172:175], a[212:215], v[32:35], v[172:175]
s_add_u32 m0, s26, 103424
s_add_u32 s24, s24, 1024
buffer_load_dwordx4 v4, s[8:11], s24 offen lds
v_mfma_f32_16x16x32_bf16 v[176:179], a[20:23], v[36:39], v[176:179]
v_mfma_f32_16x16x32_bf16 v[180:183], a[84:87], v[36:39], v[180:183]
v_mfma_f32_16x16x32_bf16 v[184:187], a[148:151], v[36:39], v[184:187]
v_mfma_f32_16x16x32_bf16 v[188:191], a[212:215], v[36:39], v[188:191]
ds_read_b128 v[32:35], v5 offset:49152
ds_read_b128 v[36:39], v5 offset:50176
s_waitcnt lgkmcnt(4)
v_mfma_f32_16x16x32_bf16 v[160:163], a[24:27], v[16:19], v[160:163]
v_mfma_f32_16x16x32_bf16 v[164:167], a[88:91], v[16:19], v[164:167]
v_mfma_f32_16x16x32_bf16 v[168:171], a[152:155], v[16:19], v[168:171]
v_mfma_f32_16x16x32_bf16 v[172:175], a[216:219], v[16:19], v[172:175]
s_add_u32 m0, s26, 104448
s_add_u32 s24, s24, 1024
buffer_load_dwordx4 v4, s[8:11], s24 offen lds
v_mfma_f32_16x16x32_bf16 v[176:179], a[24:27], v[20:23], v[176:179]
v_mfma_f32_16x16x32_bf16 v[180:183], a[88:91], v[20:23], v[180:183]
v_mfma_f32_16x16x32_bf16 v[184:187], a[152:155], v[20:23], v[184:187]
v_mfma_f32_16x16x32_bf16 v[188:191], a[216:219], v[20:23], v[188:191]
ds_read_b128 v[16:19], v5 offset:51200
ds_read_b128 v[20:23], v5 offset:52224
s_waitcnt lgkmcnt(4)
v_mfma_f32_16x16x32_bf16 v[160:163], a[28:31], v[24:27], v[160:163]
v_mfma_f32_16x16x32_bf16 v[164:167], a[92:95], v[24:27], v[164:167]
v_mfma_f32_16x16x32_bf16 v[168:171], a[156:159], v[24:27], v[168:171]
v_mfma_f32_16x16x32_bf16 v[172:175], a[220:223], v[24:27], v[172:175]
s_add_u32 m0, s26, 105472
s_add_u32 s24, s24, 1024
buffer_load_dwordx4 v4, s[8:11], s24 offen lds
v_mfma_f32_16x16x32_bf16 v[176:179], a[28:31], v[28:31], v[176:179]
v_mfma_f32_16x16x32_bf16 v[180:183], a[92:95], v[28:31], v[180:183]
v_mfma_f32_16x16x32_bf16 v[184:187], a[156:159], v[28:31], v[184:187]
v_mfma_f32_16x16x32_bf16 v[188:191], a[220:223], v[28:31], v[188:191]
ds_read_b128 v[24:27], v5 offset:53248
ds_read_b128 v[28:31], v5 offset:54272
s_waitcnt lgkmcnt(4)
v_mfma_f32_16x16x32_bf16 v[160:163], a[32:35], v[32:35], v[160:163]
v_cvt_pk_bf16_f32 v48, v128, v129
v_mfma_f32_16x16x32_bf16 v[164:167], a[96:99], v[32:35], v[164:167]
v_cvt_pk_bf16_f32 v49, v130, v131
v_mfma_f32_16x16x32_bf16 v[168:171], a[160:163], v[32:35], v[168:171]
v_cvt_pk_bf16_f32 v50, v136, v137
v_mfma_f32_16x16x32_bf16 v[172:175], a[224:227], v[32:35], v[172:175]
v_cvt_pk_bf16_f32 v51, v138, v139
v_mfma_f32_16x16x32_bf16 v[176:179], a[32:35], v[36:39], v[176:179]
s_add_u32 s32, s22, 0
buffer_store_dwordx4 v[48:51], v4, s[8:11], s32 offen sc1
v_mfma_f32_16x16x32_bf16 v[180:183], a[96:99], v[36:39], v[180:183]
v_cvt_pk_bf16_f32 v52, v132, v133
v_mfma_f32_16x16x32_bf16 v[184:187], a[160:163], v[36:39], v[184:187]
v_cvt_pk_bf16_f32 v53, v134, v135
v_mfma_f32_16x16x32_bf16 v[188:191], a[224:227], v[36:39], v[188:191]
v_cvt_pk_bf16_f32 v54, v140, v141
ds_read_b128 v[32:35], v5 offset:55296
ds_read_b128 v[36:39], v5 offset:56320
s_waitcnt lgkmcnt(4)
v_mfma_f32_16x16x32_bf16 v[160:163], a[36:39], v[16:19], v[160:163]
v_cvt_pk_bf16_f32 v55, v142, v143
v_mfma_f32_16x16x32_bf16 v[164:167], a[100:103], v[16:19], v[164:167]
s_add_u32 s32, s22, 2048
buffer_store_dwordx4 v[52:55], v4, s[8:11], s32 offen sc1
v_mfma_f32_16x16x32_bf16 v[168:171], a[164:167], v[16:19], v[168:171]
v_cvt_pk_bf16_f32 v56, v144, v145
v_mfma_f32_16x16x32_bf16 v[172:175], a[228:231], v[16:19], v[172:175]
v_cvt_pk_bf16_f32 v57, v146, v147
v_mfma_f32_16x16x32_bf16 v[176:179], a[36:39], v[20:23], v[176:179]
v_cvt_pk_bf16_f32 v58, v152, v153
v_mfma_f32_16x16x32_bf16 v[180:183], a[100:103], v[20:23], v[180:183]
v_cvt_pk_bf16_f32 v59, v154, v155
v_mfma_f32_16x16x32_bf16 v[184:187], a[164:167], v[20:23], v[184:187]
s_add_u32 s32, s22, 4096
buffer_store_dwordx4 v[56:59], v4, s[8:11], s32 offen sc1
v_mfma_f32_16x16x32_bf16 v[188:191], a[228:231], v[20:23], v[188:191]
v_cvt_pk_bf16_f32 v60, v148, v149
ds_read_b128 v[16:19], v5 offset:57344
ds_read_b128 v[20:23], v5 offset:58368
s_waitcnt lgkmcnt(4)
v_mfma_f32_16x16x32_bf16 v[160:163], a[40:43], v[24:27], v[160:163]
v_cvt_pk_bf16_f32 v61, v150, v151
v_mfma_f32_16x16x32_bf16 v[164:167], a[104:107], v[24:27], v[164:167]
v_cvt_pk_bf16_f32 v62, v156, v157
v_mfma_f32_16x16x32_bf16 v[168:171], a[168:171], v[24:27], v[168:171]
v_cvt_pk_bf16_f32 v63, v158, v159
v_mfma_f32_16x16x32_bf16 v[172:175], a[232:235], v[24:27], v[172:175]
s_add_u32 s32, s22, 6144
buffer_store_dwordx4 v[60:63], v4, s[8:11], s32 offen sc1
v_mfma_f32_16x16x32_bf16 v[176:179], a[40:43], v[28:31], v[176:179]
s_add_u32 s22, s22, s46
v_mfma_f32_16x16x32_bf16 v[180:183], a[104:107], v[28:31], v[180:183]
v_mfma_f32_16x16x32_bf16 v[184:187], a[168:171], v[28:31], v[184:187]
v_mfma_f32_16x16x32_bf16 v[188:191], a[232:235], v[28:31], v[188:191]
ds_read_b128 v[24:27], v5 offset:59392
ds_read_b128 v[28:31], v5 offset:60416
s_waitcnt lgkmcnt(4)
v_mfma_f32_16x16x32_bf16 v[160:163], a[44:47], v[32:35], v[160:163]
v_mfma_f32_16x16x32_bf16 v[164:167], a[108:111], v[32:35], v[164:167]
v_mfma_f32_16x16x32_bf16 v[168:171], a[172:175], v[32:35], v[168:171]
v_mfma_f32_16x16x32_bf16 v[172:175], a[236:239], v[32:35], v[172:175]
v_mfma_f32_16x16x32_bf16 v[176:179], a[44:47], v[36:39], v[176:179]
v_mfma_f32_16x16x32_bf16 v[180:183], a[108:111], v[36:39], v[180:183]
v_mfma_f32_16x16x32_bf16 v[184:187], a[172:175], v[36:39], v[184:187]
v_mfma_f32_16x16x32_bf16 v[188:191], a[236:239], v[36:39], v[188:191]
ds_read_b128 v[32:35], v5 offset:61440
ds_read_b128 v[36:39], v5 offset:62464
s_waitcnt lgkmcnt(4)
v_mfma_f32_16x16x32_bf16 v[160:163], a[48:51], v[16:19], v[160:163]
v_mfma_f32_16x16x32_bf16 v[164:167], a[112:115], v[16:19], v[164:167]
v_mfma_f32_16x16x32_bf16 v[168:171], a[176:179], v[16:19], v[168:171]
v_mfma_f32_16x16x32_bf16 v[172:175], a[240:243], v[16:19], v[172:175]
v_mfma_f32_16x16x32_bf16 v[176:179], a[48:51], v[20:23], v[176:179]
v_mfma_f32_16x16x32_bf16 v[180:183], a[112:115], v[20:23], v[180:183]
v_mfma_f32_16x16x32_bf16 v[184:187], a[176:179], v[20:23], v[184:187]
v_mfma_f32_16x16x32_bf16 v[188:191], a[240:243], v[20:23], v[188:191]
ds_read_b128 v[16:19], v5 offset:63488
ds_read_b128 v[20:23], v5 offset:64512
s_waitcnt lgkmcnt(4)
v_mfma_f32_16x16x32_bf16 v[160:163], a[52:55], v[24:27], v[160:163]
v_mfma_f32_16x16x32_bf16 v[164:167], a[116:119], v[24:27], v[164:167]
v_mfma_f32_16x16x32_bf16 v[168:171], a[180:183], v[24:27], v[168:171]
v_mfma_f32_16x16x32_bf16 v[172:175], a[244:247], v[24:27], v[172:175]
v_mfma_f32_16x16x32_bf16 v[176:179], a[52:55], v[28:31], v[176:179]
v_mfma_f32_16x16x32_bf16 v[180:183], a[116:119], v[28:31], v[180:183]
v_mfma_f32_16x16x32_bf16 v[184:187], a[180:183], v[28:31], v[184:187]
v_mfma_f32_16x16x32_bf16 v[188:191], a[244:247], v[28:31], v[188:191]
s_waitcnt lgkmcnt(2)
v_mfma_f32_16x16x32_bf16 v[160:163], a[56:59], v[32:35], v[160:163]
v_mfma_f32_16x16x32_bf16 v[164:167], a[120:123], v[32:35], v[164:167]
v_mfma_f32_16x16x32_bf16 v[168:171], a[184:187], v[32:35], v[168:171]
v_mfma_f32_16x16x32_bf16 v[172:175], a[248:251], v[32:35], v[172:175]
v_mfma_f32_16x16x32_bf16 v[176:179], a[56:59], v[36:39], v[176:179]
v_mfma_f32_16x16x32_bf16 v[180:183], a[120:123], v[36:39], v[180:183]
v_mfma_f32_16x16x32_bf16 v[184:187], a[184:187], v[36:39], v[184:187]
v_mfma_f32_16x16x32_bf16 v[188:191], a[248:251], v[36:39], v[188:191]
s_waitcnt lgkmcnt(0)
v_mfma_f32_16x16x32_bf16 v[160:163], a[60:63], v[16:19], v[160:163]
v_mfma_f32_16x16x32_bf16 v[164:167], a[124:127], v[16:19], v[164:167]
v_mfma_f32_16x16x32_bf16 v[168:171], a[188:191], v[16:19], v[168:171]
v_mfma_f32_16x16x32_bf16 v[172:175], a[252:255], v[16:19], v[172:175]
v_mfma_f32_16x16x32_bf16 v[176:179], a[60:63], v[20:23], v[176:179]
v_mfma_f32_16x16x32_bf16 v[180:183], a[124:127], v[20:23], v[180:183]
v_mfma_f32_16x16x32_bf16 v[184:187], a[188:191], v[20:23], v[184:187]
v_mfma_f32_16x16x32_bf16 v[188:191], a[252:255], v[20:23], v[188:191]
s_add_u32 s23, s23, 1
s_cmp_lt_u32 s23, s47
s_cbranch_scc1 G1_LOOP_QK
G1_END_QK:
s_nop 7
v_cvt_pk_bf16_f32 v48, v160, v161
v_cvt_pk_bf16_f32 v49, v162, v163
v_cvt_pk_bf16_f32 v50, v168, v169
v_cvt_pk_bf16_f32 v51, v170, v171
s_add_u32 s32, s22, 0
buffer_store_dwordx4 v[48:51], v4, s[8:11], s32 offen sc1
v_cvt_pk_bf16_f32 v52, v164, v165
v_cvt_pk_bf16_f32 v53, v166, v167
v_cvt_pk_bf16_f32 v54, v172, v173
v_cvt_pk_bf16_f32 v55, v174, v175
s_add_u32 s32, s22, 2048
buffer_store_dwordx4 v[52:55], v4, s[8:11], s32 offen sc1
v_cvt_pk_bf16_f32 v56, v176, v177
v_cvt_pk_bf16_f32 v57, v178, v179
v_cvt_pk_bf16_f32 v58, v184, v185
v_cvt_pk_bf16_f32 v59, v186, v187
s_add_u32 s32, s22, 4096
buffer_store_dwordx4 v[56:59], v4, s[8:11], s32 offen sc1
v_cvt_pk_bf16_f32 v60, v180, v181
v_cvt_pk_bf16_f32 v61, v182, v183
v_cvt_pk_bf16_f32 v62, v188, v189
v_cvt_pk_bf16_f32 v63, v190, v191
s_add_u32 s32, s22, 6144
buffer_store_dwordx4 v[60:63], v4, s[8:11], s32 offen sc1
s_add_u32 s22, s22, s46
s_waitcnt vmcnt(0)
s_barrier
s_cmp_lg_u32 s17, 0
s_cbranch_scc1 G1F_22
v_mov_b32 v8, 16
s_mov_b64 exec, 1
buffer_store_dword v8, off, s[8:11], s25 sc1
s_mov_b64 exec, -1
G1F_22:
s_branch G1_DONE
G1_V:
s_lshl_b32 s33, s33, 12
s_add_u32 s22, s22, s33
s_add_u32 s22, s22, 35651584
s_mov_b32 s23, 0
s_waitcnt vmcnt(0) lgkmcnt(0)
s_barrier
ds_read_b128 v[16:19], v5 offset:0
ds_read_b128 v[20:23], v5 offset:1024
ds_read_b128 v[24:27], v5 offset:2048
ds_read_b128 v[28:31], v5 offset:3072
ds_read_b128 v[32:35], v5 offset:4096
ds_read_b128 v[36:39], v5 offset:5120
s_waitcnt lgkmcnt(4)
v_mfma_f32_16x16x32_bf16 v[128:131], v[16:19], a[0:3], 0
v_mfma_f32_16x16x32_bf16 v[132:135], v[16:19], a[64:67], 0
v_mfma_f32_16x16x32_bf16 v[136:139], v[16:19], a[128:131], 0
v_mfma_f32_16x16x32_bf16 v[140:143], v[16:19], a[192:195], 0
v_mfma_f32_16x16x32_bf16 v[144:147], v[20:23], a[0:3], 0
v_mfma_f32_16x16x32_bf16 v[148:151], v[20:23], a[64:67], 0
v_mfma_f32_16x16x32_bf16 v[152:155], v[20:23], a[128:131], 0
v_mfma_f32_16x16x32_bf16 v[156:159], v[20:23], a[192:195], 0
ds_read_b128 v[16:19], v5 offset:6144
ds_read_b128 v[20:23], v5 offset:7168
s_waitcnt lgkmcnt(4)
v_mfma_f32_16x16x32_bf16 v[128:131], v[24:27], a[4:7], v[128:131]
v_mfma_f32_16x16x32_bf16 v[132:135], v[24:27], a[68:71], v[132:135]
v_mfma_f32_16x16x32_bf16 v[136:139], v[24:27], a[132:135], v[136:139]
v_mfma_f32_16x16x32_bf16 v[140:143], v[24:27], a[196:199], v[140:143]
v_mfma_f32_16x16x32_bf16 v[144:147], v[28:31], a[4:7], v[144:147]
v_mfma_f32_16x16x32_bf16 v[148:151], v[28:31], a[68:71], v[148:151]
v_mfma_f32_16x16x32_bf16 v[152:155], v[28:31], a[132:135], v[152:155]
v_mfma_f32_16x16x32_bf16 v[156:159], v[28:31], a[196:199], v[156:159]
ds_read_b128 v[24:27], v5 offset:8192
ds_read_b128 v[28:31], v5 offset:9216
s_waitcnt lgkmcnt(4)
v_mfma_f32_16x16x32_bf16 v[128:131], v[32:35], a[8:11], v[128:131]
v_mfma_f32_16x16x32_bf16 v[132:135], v[32:35], a[72:75], v[132:135]
v_mfma_f32_16x16x32_bf16 v[136:139], v[32:35], a[136:139], v[136:139]
v_mfma_f32_16x16x32_bf16 v[140:143], v[32:35], a[200:203], v[140:143]
v_mfma_f32_16x16x32_bf16 v[144:147], v[36:39], a[8:11], v[144:147]
v_mfma_f32_16x16x32_bf16 v[148:151], v[36:39], a[72:75], v[148:151]
v_mfma_f32_16x16x32_bf16 v[152:155], v[36:39], a[136:139], v[152:155]
v_mfma_f32_16x16x32_bf16 v[156:159], v[36:39], a[200:203], v[156:159]
ds_read_b128 v[32:35], v5 offset:10240
ds_read_b128 v[36:39], v5 offset:11264
s_waitcnt lgkmcnt(4)
v_mfma_f32_16x16x32_bf16 v[128:131], v[16:19], a[12:15], v[128:131]
v_mfma_f32_16x16x32_bf16 v[132:135], v[16:19], a[76:79], v[132:135]
v_mfma_f32_16x16x32_bf16 v[136:139], v[16:19], a[140:143], v[136:139]
v_mfma_f32_16x16x32_bf16 v[140:143], v[16:19], a[204:207], v[140:143]
v_mfma_f32_16x16x32_bf16 v[144:147], v[20:23], a[12:15], v[144:147]
v_mfma_f32_16x16x32_bf16 v[148:151], v[20:23], a[76:79], v[148:151]
v_mfma_f32_16x16x32_bf16 v[152:155], v[20:23], a[140:143], v[152:155]
v_mfma_f32_16x16x32_bf16 v[156:159], v[20:23], a[204:207], v[156:159]
ds_read_b128 v[16:19], v5 offset:12288
ds_read_b128 v[20:23], v5 offset:13312
s_waitcnt lgkmcnt(4)
v_mfma_f32_16x16x32_bf16 v[128:131], v[24:27], a[16:19], v[128:131]
v_mfma_f32_16x16x32_bf16 v[132:135], v[24:27], a[80:83], v[132:135]
v_mfma_f32_16x16x32_bf16 v[136:139], v[24:27], a[144:147], v[136:139]
v_mfma_f32_16x16x32_bf16 v[140:143], v[24:27], a[208:211], v[140:143]
v_mfma_f32_16x16x32_bf16 v[144:147], v[28:31], a[16:19], v[144:147]
v_mfma_f32_16x16x32_bf16 v[148:151], v[28:31], a[80:83], v[148:151]
v_mfma_f32_16x16x32_bf16 v[152:155], v[28:31], a[144:147], v[152:155]
v_mfma_f32_16x16x32_bf16 v[156:159], v[28:31], a[208:211], v[156:159]
ds_read_b128 v[24:27], v5 offset:14336
ds_read_b128 v[28:31], v5 offset:15360
s_waitcnt lgkmcnt(4)
v_mfma_f32_16x16x32_bf16 v[128:131], v[32:35], a[20:23], v[128:131]
v_mfma_f32_16x16x32_bf16 v[132:135], v[32:35], a[84:87], v[132:135]
v_mfma_f32_16x16x32_bf16 v[136:139], v[32:35], a[148:151], v[136:139]
v_mfma_f32_16x16x32_bf16 v[140:143], v[32:35], a[212:215], v[140:143]
v_mfma_f32_16x16x32_bf16 v[144:147], v[36:39], a[20:23], v[144:147]
v_mfma_f32_16x16x32_bf16 v[148:151], v[36:39], a[84:87], v[148:151]
v_mfma_f32_16x16x32_bf16 v[152:155], v[36:39], a[148:151], v[152:155]
v_mfma_f32_16x16x32_bf16 v[156:159], v[36:39], a[212:215], v[156:159]
ds_read_b128 v[32:35], v5 offset:16384
ds_read_b128 v[36:39], v5 offset:17408
s_waitcnt lgkmcnt(4)
v_mfma_f32_16x16x32_bf16 v[128:131], v[16:19], a[24:27], v[128:131]
v_mfma_f32_16x16x32_bf16 v[132:135], v[16:19], a[88:91], v[132:135]
v_mfma_f32_16x16x32_bf16 v[136:139], v[16:19], a[152:155], v[136:139]
v_mfma_f32_16x16x32_bf16 v[140:143], v[16:19], a[216:219], v[140:143]
v_mfma_f32_16x16x32_bf16 v[144:147], v[20:23], a[24:27], v[144:147]
v_mfma_f32_16x16x32_bf16 v[148:151], v[20:23], a[88:91], v[148:151]
v_mfma_f32_16x16x32_bf16 v[152:155], v[20:23], a[152:155], v[152:155]
v_mfma_f32_16x16x32_bf16 v[156:159], v[20:23], a[216:219], v[156:159]
ds_read_b128 v[16:19], v5 offset:18432
ds_read_b128 v[20:23], v5 offset:19456
s_waitcnt lgkmcnt(4)
v_mfma_f32_16x16x32_bf16 v[128:131], v[24:27], a[28:31], v[128:131]
v_mfma_f32_16x16x32_bf16 v[132:135], v[24:27], a[92:95], v[132:135]
v_mfma_f32_16x16x32_bf16 v[136:139], v[24:27], a[156:159], v[136:139]
v_mfma_f32_16x16x32_bf16 v[140:143], v[24:27], a[220:223], v[140:143]
v_mfma_f32_16x16x32_bf16 v[144:147], v[28:31], a[28:31], v[144:147]
v_mfma_f32_16x16x32_bf16 v[148:151], v[28:31], a[92:95], v[148:151]
v_mfma_f32_16x16x32_bf16 v[152:155], v[28:31], a[156:159], v[152:155]
v_mfma_f32_16x16x32_bf16 v[156:159], v[28:31], a[220:223], v[156:159]
ds_read_b128 v[24:27], v5 offset:20480
ds_read_b128 v[28:31], v5 offset:21504
s_waitcnt lgkmcnt(4)
v_mfma_f32_16x16x32_bf16 v[128:131], v[32:35], a[32:35], v[128:131]
v_mfma_f32_16x16x32_bf16 v[132:135], v[32:35], a[96:99], v[132:135]
v_mfma_f32_16x16x32_bf16 v[136:139], v[32:35], a[160:163], v[136:139]
v_mfma_f32_16x16x32_bf16 v[140:143], v[32:35], a[224:227], v[140:143]
v_mfma_f32_16x16x32_bf16 v[144:147], v[36:39], a[32:35], v[144:147]
v_mfma_f32_16x16x32_bf16 v[148:151], v[36:39], a[96:99], v[148:151]
v_mfma_f32_16x16x32_bf16 v[152:155], v[36:39], a[160:163], v[152:155]
v_mfma_f32_16x16x32_bf16 v[156:159], v[36:39], a[224:227], v[156:159]
ds_read_b128 v[32:35], v5 offset:22528
ds_read_b128 v[36:39], v5 offset:23552
s_waitcnt lgkmcnt(4)
v_mfma_f32_16x16x32_bf16 v[128:131], v[16:19], a[36:39], v[128:131]
v_mfma_f32_16x16x32_bf16 v[132:135], v[16:19], a[100:103], v[132:135]
v_mfma_f32_16x16x32_bf16 v[136:139], v[16:19], a[164:167], v[136:139]
v_mfma_f32_16x16x32_bf16 v[140:143], v[16:19], a[228:231], v[140:143]
v_mfma_f32_16x16x32_bf16 v[144:147], v[20:23], a[36:39], v[144:147]
v_mfma_f32_16x16x32_bf16 v[148:151], v[20:23], a[100:103], v[148:151]
v_mfma_f32_16x16x32_bf16 v[152:155], v[20:23], a[164:167], v[152:155]
v_mfma_f32_16x16x32_bf16 v[156:159], v[20:23], a[228:231], v[156:159]
ds_read_b128 v[16:19], v5 offset:24576
ds_read_b128 v[20:23], v5 offset:25600
s_waitcnt lgkmcnt(4)
v_mfma_f32_16x16x32_bf16 v[128:131], v[24:27], a[40:43], v[128:131]
v_mfma_f32_16x16x32_bf16 v[132:135], v[24:27], a[104:107], v[132:135]
v_mfma_f32_16x16x32_bf16 v[136:139], v[24:27], a[168:171], v[136:139]
v_mfma_f32_16x16x32_bf16 v[140:143], v[24:27], a[232:235], v[140:143]
v_mfma_f32_16x16x32_bf16 v[144:147], v[28:31], a[40:43], v[144:147]
v_mfma_f32_16x16x32_bf16 v[148:151], v[28:31], a[104:107], v[148:151]
v_mfma_f32_16x16x32_bf16 v[152:155], v[28:31], a[168:171], v[152:155]
v_mfma_f32_16x16x32_bf16 v[156:159], v[28:31], a[232:235], v[156:159]
ds_read_b128 v[24:27], v5 offset:26624
ds_read_b128 v[28:31], v5 offset:27648
s_waitcnt lgkmcnt(4)
v_mfma_f32_16x16x32_bf16 v[128:131], v[32:35], a[44:47], v[128:131]
v_mfma_f32_16x16x32_bf16 v[132:135], v[32:35], a[108:111], v[132:135]
v_mfma_f32_16x16x32_bf16 v[136:139], v[32:35], a[172:175], v[136:139]
v_mfma_f32_16x16x32_bf16 v[140:143], v[32:35], a[236:239], v[140:143]
v_mfma_f32_16x16x32_bf16 v[144:147], v[36:39], a[44:47], v[144:147]
v_mfma_f32_16x16x32_bf16 v[148:151], v[36:39], a[108:111], v[148:151]
v_mfma_f32_16x16x32_bf16 v[152:155], v[36:39], a[172:175], v[152:155]
v_mfma_f32_16x16x32_bf16 v[156:159], v[36:39], a[236:239], v[156:159]
ds_read_b128 v[32:35], v5 offset:28672
ds_read_b128 v[36:39], v5 offset:29696
s_waitcnt lgkmcnt(4)
v_mfma_f32_16x16x32_bf16 v[128:131], v[16:19], a[48:51], v[128:131]
v_mfma_f32_16x16x32_bf16 v[132:135], v[16:19], a[112:115], v[132:135]
v_mfma_f32_16x16x32_bf16 v[136:139], v[16:19], a[176:179], v[136:139]
v_mfma_f32_16x16x32_bf16 v[140:143], v[16:19], a[240:243], v[140:143]
v_mfma_f32_16x16x32_bf16 v[144:147], v[20:23], a[48:51], v[144:147]
v_mfma_f32_16x16x32_bf16 v[148:151], v[20:23], a[112:115], v[148:151]
v_mfma_f32_16x16x32_bf16 v[152:155], v[20:23], a[176:179], v[152:155]
v_mfma_f32_16x16x32_bf16 v[156:159], v[20:23], a[240:243], v[156:159]
ds_read_b128 v[16:19], v5 offset:30720
ds_read_b128 v[20:23], v5 offset:31744
s_waitcnt lgkmcnt(4)
v_mfma_f32_16x16x32_bf16 v[128:131], v[24:27], a[52:55], v[128:131]
v_mfma_f32_16x16x32_bf16 v[132:135], v[24:27], a[116:119], v[132:135]
v_mfma_f32_16x16x32_bf16 v[136:139], v[24:27], a[180:183], v[136:139]
v_mfma_f32_16x16x32_bf16 v[140:143], v[24:27], a[244:247], v[140:143]
v_mfma_f32_16x16x32_bf16 v[144:147], v[28:31], a[52:55], v[144:147]
v_mfma_f32_16x16x32_bf16 v[148:151], v[28:31], a[116:119], v[148:151]
v_mfma_f32_16x16x32_bf16 v[152:155], v[28:31], a[180:183], v[152:155]
v_mfma_f32_16x16x32_bf16 v[156:159], v[28:31], a[244:247], v[156:159]
s_waitcnt lgkmcnt(2)
v_mfma_f32_16x16x32_bf16 v[128:131], v[32:35], a[56:59], v[128:131]
v_mfma_f32_16x16x32_bf16 v[132:135], v[32:35], a[120:123], v[132:135]
v_mfma_f32_16x16x32_bf16 v[136:139], v[32:35], a[184:187], v[136:139]
v_mfma_f32_16x16x32_bf16 v[140:143], v[32:35], a[248:251], v[140:143]
v_mfma_f32_16x16x32_bf16 v[144:147], v[36:39], a[56:59], v[144:147]
v_mfma_f32_16x16x32_bf16 v[148:151], v[36:39], a[120:123], v[148:151]
v_mfma_f32_16x16x32_bf16 v[152:155], v[36:39], a[184:187], v[152:155]
v_mfma_f32_16x16x32_bf16 v[156:159], v[36:39], a[248:251], v[156:159]
s_waitcnt lgkmcnt(0)
v_mfma_f32_16x16x32_bf16 v[128:131], v[16:19], a[60:63], v[128:131]
v_mfma_f32_16x16x32_bf16 v[132:135], v[16:19], a[124:127], v[132:135]
v_mfma_f32_16x16x32_bf16 v[136:139], v[16:19], a[188:191], v[136:139]
v_mfma_f32_16x16x32_bf16 v[140:143], v[16:19], a[252:255], v[140:143]
v_mfma_f32_16x16x32_bf16 v[144:147], v[20:23], a[60:63], v[144:147]
v_mfma_f32_16x16x32_bf16 v[148:151], v[20:23], a[124:127], v[148:151]
v_mfma_f32_16x16x32_bf16 v[152:155], v[20:23], a[188:191], v[152:155]
v_mfma_f32_16x16x32_bf16 v[156:159], v[20:23], a[252:255], v[156:159]
s_add_u32 s23, s23, 1
s_nop 7
v_cvt_pk_bf16_f32 v48, v128, v129
v_cvt_pk_bf16_f32 v49, v130, v131
v_cvt_pk_bf16_f32 v50, v144, v145
v_cvt_pk_bf16_f32 v51, v146, v147
s_add_u32 s32, s22, 0
buffer_store_dwordx4 v[48:51], v4, s[8:11], s32 offen sc1
v_cvt_pk_bf16_f32 v52, v132, v133
v_cvt_pk_bf16_f32 v53, v134, v135
v_cvt_pk_bf16_f32 v54, v148, v149
v_cvt_pk_bf16_f32 v55, v150, v151
s_add_u32 s32, s22, 1024
buffer_store_dwordx4 v[52:55], v4, s[8:11], s32 offen sc1
v_cvt_pk_bf16_f32 v56, v136, v137
v_cvt_pk_bf16_f32 v57, v138, v139
v_cvt_pk_bf16_f32 v58, v152, v153
v_cvt_pk_bf16_f32 v59, v154, v155
s_add_u32 s32, s22, 2048
buffer_store_dwordx4 v[56:59], v4, s[8:11], s32 offen sc1
v_cvt_pk_bf16_f32 v60, v140, v141
v_cvt_pk_bf16_f32 v61, v142, v143
v_cvt_pk_bf16_f32 v62, v156, v157
v_cvt_pk_bf16_f32 v63, v158, v159
s_add_u32 s32, s22, 3072
buffer_store_dwordx4 v[60:63], v4, s[8:11], s32 offen sc1
s_add_u32 s22, s22, 1048576
s_cmp_lg_u32 s17, 0
s_cbranch_scc1 G1LN_23
s_cmp_lg_u32 s84, 0
s_cbranch_scc1 INIT_24
v_mov_b32 v8, 4
s_mov_b32 s35, 0
POLL_INIT_25:
s_cmp_lg_u32 s37, 0
s_cbranch_scc1 POLL_INIT_25_E
buffer_load_dword v9, v8, s[4:7], 0 offen sc1
s_add_u32 s35, s35, 1
s_cmp_gt_u32 s35, 65536
s_cselect_b32 s37, 1, 0
s_waitcnt vmcnt(0)
v_cmp_gt_u32 vcc, 32, v9
s_cbranch_vccz POLL_INIT_25_E
s_sleep 4
s_branch POLL_INIT_25
POLL_INIT_25_E:
s_mov_b32 s84, 1
INIT_24:
v_lshrrev_b32 v8, 2, v0
s_sub_u32 s32, 11, s44
v_lshlrev_b32 v8, s32, v8
v_and_b32 v9, 3, v0
v_lshl_add_u32 v8, v9, 7, v8
s_lshl_b32 s32, s19, 9
s_add_u32 s32, s32, 91340800
s_mov_b32 s35, 0
POLL_LN_26:
s_cmp_lg_u32 s37, 0
s_cbranch_scc1 POLL_LN_26_E
buffer_load_dword v9, v8, s[8:11], s32 offen sc1
s_add_u32 s35, s35, 1
s_cmp_gt_u32 s35, 65536
s_cselect_b32 s37, 1, 0
s_waitcnt vmcnt(0)
v_cmp_gt_u32 vcc, 1, v9
s_cbranch_vccz POLL_LN_26_E
s_sleep 2
s_branch POLL_LN_26
POLL_LN_26_E:
G1LN_23:
s_barrier
s_add_u32 m0, s26, 131072
s_add_u32 s24, s24, s45
buffer_load_dwordx4 v4, s[8:11], s24 offen lds
s_add_u32 m0, s26, 132096
s_add_u32 s24, s24, 1024
buffer_load_dwordx4 v4, s[8:11], s24 offen lds
s_add_u32 m0, s26, 133120
s_add_u32 s24, s24, 1024
buffer_load_dwordx4 v4, s[8:11], s24 offen lds
s_add_u32 m0, s26, 134144
s_add_u32 s24, s24, 1024
buffer_load_dwordx4 v4, s[8:11], s24 offen lds
s_add_u32 m0, s26, 135168
s_add_u32 s24, s24, 1024
buffer_load_dwordx4 v4, s[8:11], s24 offen lds
s_add_u32 m0, s26, 136192
s_add_u32 s24, s24, 1024
buffer_load_dwordx4 v4, s[8:11], s24 offen lds
s_add_u32 m0, s26, 137216
s_add_u32 s24, s24, 1024
buffer_load_dwordx4 v4, s[8:11], s24 offen lds
s_add_u32 m0, s26, 138240
s_add_u32 s24, s24, 1024
buffer_load_dwordx4 v4, s[8:11], s24 offen lds
s_waitcnt vmcnt(0) lgkmcnt(0)
s_barrier
ds_read_b128 v[16:19], v5 offset:32768
ds_read_b128 v[20:23], v5 offset:33792
ds_read_b128 v[24:27], v5 offset:34816
ds_read_b128 v[28:31], v5 offset:35840
s_cmp_lg_u32 s17, 0
s_cbranch_scc1 G1F_27
s_cmp_lg_u32 s84, 0
s_cbranch_scc1 INIT_28
v_mov_b32 v8, 4
s_mov_b32 s35, 0
POLL_INIT_29:
s_cmp_lg_u32 s37, 0
s_cbranch_scc1 POLL_INIT_29_E
buffer_load_dword v9, v8, s[4:7], 0 offen sc1
s_add_u32 s35, s35, 1
s_cmp_gt_u32 s35, 65536
s_cselect_b32 s37, 1, 0
s_waitcnt vmcnt(0)
v_cmp_gt_u32 vcc, 32, v9
s_cbranch_vccz POLL_INIT_29_E
s_sleep 4
s_branch POLL_INIT_29
POLL_INIT_29_E:
s_mov_b32 s84, 1
INIT_28:
s_lshr_b32 s32, 1, s44
v_mov_b32 v8, s32
s_mov_b64 exec, 1
buffer_store_dword v8, off, s[8:11], s25 sc1
s_mov_b64 exec, -1
G1F_27:
ds_read_b128 v[32:35], v5 offset:36864
ds_read_b128 v[36:39], v5 offset:37888
s_waitcnt lgkmcnt(4)
v_mfma_f32_16x16x32_bf16 v[160:163], v[16:19], a[0:3], 0
v_mfma_f32_16x16x32_bf16 v[164:167], v[16:19], a[64:67], 0
v_mfma_f32_16x16x32_bf16 v[168:171], v[16:19], a[128:131], 0
v_mfma_f32_16x16x32_bf16 v[172:175], v[16:19], a[192:195], 0
s_add_u32 m0, s26, 98304
s_add_u32 s24, s24, s45
buffer_load_dwordx4 v4, s[8:11], s24 offen lds
v_mfma_f32_16x16x32_bf16 v[176:179], v[20:23], a[0:3], 0
v_mfma_f32_16x16x32_bf16 v[180:183], v[20:23], a[64:67], 0
v_mfma_f32_16x16x32_bf16 v[184:187], v[20:23], a[128:131], 0
v_mfma_f32_16x16x32_bf16 v[188:191], v[20:23], a[192:195], 0
ds_read_b128 v[16:19], v5 offset:38912
ds_read_b128 v[20:23], v5 offset:39936
s_waitcnt lgkmcnt(4)
v_mfma_f32_16x16x32_bf16 v[160:163], v[24:27], a[4:7], v[160:163]
v_mfma_f32_16x16x32_bf16 v[164:167], v[24:27], a[68:71], v[164:167]
v_mfma_f32_16x16x32_bf16 v[168:171], v[24:27], a[132:135], v[168:171]
v_mfma_f32_16x16x32_bf16 v[172:175], v[24:27], a[196:199], v[172:175]
s_add_u32 m0, s26, 99328
s_add_u32 s24, s24, 1024
buffer_load_dwordx4 v4, s[8:11], s24 offen lds
v_mfma_f32_16x16x32_bf16 v[176:179], v[28:31], a[4:7], v[176:179]
v_mfma_f32_16x16x32_bf16 v[180:183], v[28:31], a[68:71], v[180:183]
v_mfma_f32_16x16x32_bf16 v[184:187], v[28:31], a[132:135], v[184:187]
v_mfma_f32_16x16x32_bf16 v[188:191], v[28:31], a[196:199], v[188:191]
ds_read_b128 v[24:27], v5 offset:40960
ds_read_b128 v[28:31], v5 offset:41984
s_waitcnt lgkmcnt(4)
v_mfma_f32_16x16x32_bf16 v[160:163], v[32:35], a[8:11], v[160:163]
v_mfma_f32_16x16x32_bf16 v[164:167], v[32:35], a[72:75], v[164:167]
v_mfma_f32_16x16x32_bf16 v[168:171], v[32:35], a[136:139], v[168:171]
v_mfma_f32_16x16x32_bf16 v[172:175], v[32:35], a[200:203], v[172:175]
s_add_u32 m0, s26, 100352
s_add_u32 s24, s24, 1024
buffer_load_dwordx4 v4, s[8:11], s24 offen lds
v_mfma_f32_16x16x32_bf16 v[176:179], v[36:39], a[8:11], v[176:179]
v_mfma_f32_16x16x32_bf16 v[180:183], v[36:39], a[72:75], v[180:183]
v_mfma_f32_16x16x32_bf16 v[184:187], v[36:39], a[136:139], v[184:187]
v_mfma_f32_16x16x32_bf16 v[188:191], v[36:39], a[200:203], v[188:191]
ds_read_b128 v[32:35], v5 offset:43008
ds_read_b128 v[36:39], v5 offset:44032
s_waitcnt lgkmcnt(4)
v_mfma_f32_16x16x32_bf16 v[160:163], v[16:19], a[12:15], v[160:163]
v_mfma_f32_16x16x32_bf16 v[164:167], v[16:19], a[76:79], v[164:167]
v_mfma_f32_16x16x32_bf16 v[168:171], v[16:19], a[140:143], v[168:171]
v_mfma_f32_16x16x32_bf16 v[172:175], v[16:19], a[204:207], v[172:175]
s_add_u32 m0, s26, 101376
s_add_u32 s24, s24, 1024
buffer_load_dwordx4 v4, s[8:11], s24 offen lds
v_mfma_f32_16x16x32_bf16 v[176:179], v[20:23], a[12:15], v[176:179]
v_mfma_f32_16x16x32_bf16 v[180:183], v[20:23], a[76:79], v[180:183]
v_mfma_f32_16x16x32_bf16 v[184:187], v[20:23], a[140:143], v[184:187]
v_mfma_f32_16x16x32_bf16 v[188:191], v[20:23], a[204:207], v[188:191]
ds_read_b128 v[16:19], v5 offset:45056
ds_read_b128 v[20:23], v5 offset:46080
s_waitcnt lgkmcnt(4)
v_mfma_f32_16x16x32_bf16 v[160:163], v[24:27], a[16:19], v[160:163]
v_mfma_f32_16x16x32_bf16 v[164:167], v[24:27], a[80:83], v[164:167]
v_mfma_f32_16x16x32_bf16 v[168:171], v[24:27], a[144:147], v[168:171]
v_mfma_f32_16x16x32_bf16 v[172:175], v[24:27], a[208:211], v[172:175]
s_add_u32 m0, s26, 102400
s_add_u32 s24, s24, 1024
buffer_load_dwordx4 v4, s[8:11], s24 offen lds
v_mfma_f32_16x16x32_bf16 v[176:179], v[28:31], a[16:19], v[176:179]
v_mfma_f32_16x16x32_bf16 v[180:183], v[28:31], a[80:83], v[180:183]
v_mfma_f32_16x16x32_bf16 v[184:187], v[28:31], a[144:147], v[184:187]
v_mfma_f32_16x16x32_bf16 v[188:191], v[28:31], a[208:211], v[188:191]
ds_read_b128 v[24:27], v5 offset:47104
ds_read_b128 v[28:31], v5 offset:48128
s_waitcnt lgkmcnt(4)
v_mfma_f32_16x16x32_bf16 v[160:163], v[32:35], a[20:23], v[160:163]
v_mfma_f32_16x16x32_bf16 v[164:167], v[32:35], a[84:87], v[164:167]
v_mfma_f32_16x16x32_bf16 v[168:171], v[32:35], a[148:151], v[168:171]
v_mfma_f32_16x16x32_bf16 v[172:175], v[32:35], a[212:215], v[172:175]
s_add_u32 m0, s26, 103424
s_add_u32 s24, s24, 1024
buffer_load_dwordx4 v4, s[8:11], s24 offen lds
v_mfma_f32_16x16x32_bf16 v[176:179], v[36:39], a[20:23], v[176:179]
v_mfma_f32_16x16x32_bf16 v[180:183], v[36:39], a[84:87], v[180:183]
v_mfma_f32_16x16x32_bf16 v[184:187], v[36:39], a[148:151], v[184:187]
v_mfma_f32_16x16x32_bf16 v[188:191], v[36:39], a[212:215], v[188:191]
ds_read_b128 v[32:35], v5 offset:49152
ds_read_b128 v[36:39], v5 offset:50176
s_waitcnt lgkmcnt(4)
v_mfma_f32_16x16x32_bf16 v[160:163], v[16:19], a[24:27], v[160:163]
v_mfma_f32_16x16x32_bf16 v[164:167], v[16:19], a[88:91], v[164:167]
v_mfma_f32_16x16x32_bf16 v[168:171], v[16:19], a[152:155], v[168:171]
v_mfma_f32_16x16x32_bf16 v[172:175], v[16:19], a[216:219], v[172:175]
s_add_u32 m0, s26, 104448
s_add_u32 s24, s24, 1024
buffer_load_dwordx4 v4, s[8:11], s24 offen lds
v_mfma_f32_16x16x32_bf16 v[176:179], v[20:23], a[24:27], v[176:179]
v_mfma_f32_16x16x32_bf16 v[180:183], v[20:23], a[88:91], v[180:183]
v_mfma_f32_16x16x32_bf16 v[184:187], v[20:23], a[152:155], v[184:187]
v_mfma_f32_16x16x32_bf16 v[188:191], v[20:23], a[216:219], v[188:191]
ds_read_b128 v[16:19], v5 offset:51200
ds_read_b128 v[20:23], v5 offset:52224
s_waitcnt lgkmcnt(4)
v_mfma_f32_16x16x32_bf16 v[160:163], v[24:27], a[28:31], v[160:163]
v_mfma_f32_16x16x32_bf16 v[164:167], v[24:27], a[92:95], v[164:167]
v_mfma_f32_16x16x32_bf16 v[168:171], v[24:27], a[156:159], v[168:171]
v_mfma_f32_16x16x32_bf16 v[172:175], v[24:27], a[220:223], v[172:175]
s_add_u32 m0, s26, 105472
s_add_u32 s24, s24, 1024
buffer_load_dwordx4 v4, s[8:11], s24 offen lds
v_mfma_f32_16x16x32_bf16 v[176:179], v[28:31], a[28:31], v[176:179]
v_mfma_f32_16x16x32_bf16 v[180:183], v[28:31], a[92:95], v[180:183]
v_mfma_f32_16x16x32_bf16 v[184:187], v[28:31], a[156:159], v[184:187]
v_mfma_f32_16x16x32_bf16 v[188:191], v[28:31], a[220:223], v[188:191]
ds_read_b128 v[24:27], v5 offset:53248
ds_read_b128 v[28:31], v5 offset:54272
s_waitcnt lgkmcnt(4)
v_mfma_f32_16x16x32_bf16 v[160:163], v[32:35], a[32:35], v[160:163]
v_mfma_f32_16x16x32_bf16 v[164:167], v[32:35], a[96:99], v[164:167]
v_mfma_f32_16x16x32_bf16 v[168:171], v[32:35], a[160:163], v[168:171]
v_mfma_f32_16x16x32_bf16 v[172:175], v[32:35], a[224:227], v[172:175]
v_mfma_f32_16x16x32_bf16 v[176:179], v[36:39], a[32:35], v[176:179]
v_mfma_f32_16x16x32_bf16 v[180:183], v[36:39], a[96:99], v[180:183]
v_mfma_f32_16x16x32_bf16 v[184:187], v[36:39], a[160:163], v[184:187]
v_mfma_f32_16x16x32_bf16 v[188:191], v[36:39], a[224:227], v[188:191]
ds_read_b128 v[32:35], v5 offset:55296
ds_read_b128 v[36:39], v5 offset:56320
s_waitcnt lgkmcnt(4)
v_mfma_f32_16x16x32_bf16 v[160:163], v[16:19], a[36:39], v[160:163]
v_mfma_f32_16x16x32_bf16 v[164:167], v[16:19], a[100:103], v[164:167]
v_mfma_f32_16x16x32_bf16 v[168:171], v[16:19], a[164:167], v[168:171]
v_mfma_f32_16x16x32_bf16 v[172:175], v[16:19], a[228:231], v[172:175]
v_mfma_f32_16x16x32_bf16 v[176:179], v[20:23], a[36:39], v[176:179]
v_mfma_f32_16x16x32_bf16 v[180:183], v[20:23], a[100:103], v[180:183]
v_mfma_f32_16x16x32_bf16 v[184:187], v[20:23], a[164:167], v[184:187]
v_mfma_f32_16x16x32_bf16 v[188:191], v[20:23], a[228:231], v[188:191]
ds_read_b128 v[16:19], v5 offset:57344
ds_read_b128 v[20:23], v5 offset:58368
s_waitcnt lgkmcnt(4)
v_mfma_f32_16x16x32_bf16 v[160:163], v[24:27], a[40:43], v[160:163]
v_mfma_f32_16x16x32_bf16 v[164:167], v[24:27], a[104:107], v[164:167]
v_mfma_f32_16x16x32_bf16 v[168:171], v[24:27], a[168:171], v[168:171]
v_mfma_f32_16x16x32_bf16 v[172:175], v[24:27], a[232:235], v[172:175]
v_mfma_f32_16x16x32_bf16 v[176:179], v[28:31], a[40:43], v[176:179]
v_mfma_f32_16x16x32_bf16 v[180:183], v[28:31], a[104:107], v[180:183]
v_mfma_f32_16x16x32_bf16 v[184:187], v[28:31], a[168:171], v[184:187]
v_mfma_f32_16x16x32_bf16 v[188:191], v[28:31], a[232:235], v[188:191]
ds_read_b128 v[24:27], v5 offset:59392
ds_read_b128 v[28:31], v5 offset:60416
s_waitcnt lgkmcnt(4)
v_mfma_f32_16x16x32_bf16 v[160:163], v[32:35], a[44:47], v[160:163]
v_mfma_f32_16x16x32_bf16 v[164:167], v[32:35], a[108:111], v[164:167]
v_mfma_f32_16x16x32_bf16 v[168:171], v[32:35], a[172:175], v[168:171]
v_mfma_f32_16x16x32_bf16 v[172:175], v[32:35], a[236:239], v[172:175]
v_mfma_f32_16x16x32_bf16 v[176:179], v[36:39], a[44:47], v[176:179]
v_mfma_f32_16x16x32_bf16 v[180:183], v[36:39], a[108:111], v[180:183]
v_mfma_f32_16x16x32_bf16 v[184:187], v[36:39], a[172:175], v[184:187]
v_mfma_f32_16x16x32_bf16 v[188:191], v[36:39], a[236:239], v[188:191]
ds_read_b128 v[32:35], v5 offset:61440
ds_read_b128 v[36:39], v5 offset:62464
s_waitcnt lgkmcnt(4)
v_mfma_f32_16x16x32_bf16 v[160:163], v[16:19], a[48:51], v[160:163]
v_mfma_f32_16x16x32_bf16 v[164:167], v[16:19], a[112:115], v[164:167]
v_mfma_f32_16x16x32_bf16 v[168:171], v[16:19], a[176:179], v[168:171]
v_mfma_f32_16x16x32_bf16 v[172:175], v[16:19], a[240:243], v[172:175]
v_mfma_f32_16x16x32_bf16 v[176:179], v[20:23], a[48:51], v[176:179]
v_mfma_f32_16x16x32_bf16 v[180:183], v[20:23], a[112:115], v[180:183]
v_mfma_f32_16x16x32_bf16 v[184:187], v[20:23], a[176:179], v[184:187]
v_mfma_f32_16x16x32_bf16 v[188:191], v[20:23], a[240:243], v[188:191]
ds_read_b128 v[16:19], v5 offset:63488
ds_read_b128 v[20:23], v5 offset:64512
s_waitcnt lgkmcnt(4)
v_mfma_f32_16x16x32_bf16 v[160:163], v[24:27], a[52:55], v[160:163]
v_mfma_f32_16x16x32_bf16 v[164:167], v[24:27], a[116:119], v[164:167]
v_mfma_f32_16x16x32_bf16 v[168:171], v[24:27], a[180:183], v[168:171]
v_mfma_f32_16x16x32_bf16 v[172:175], v[24:27], a[244:247], v[172:175]
v_mfma_f32_16x16x32_bf16 v[176:179], v[28:31], a[52:55], v[176:179]
v_mfma_f32_16x16x32_bf16 v[180:183], v[28:31], a[116:119], v[180:183]
v_mfma_f32_16x16x32_bf16 v[184:187], v[28:31], a[180:183], v[184:187]
v_mfma_f32_16x16x32_bf16 v[188:191], v[28:31], a[244:247], v[188:191]
s_waitcnt lgkmcnt(2)
v_mfma_f32_16x16x32_bf16 v[160:163], v[32:35], a[56:59], v[160:163]
v_mfma_f32_16x16x32_bf16 v[164:167], v[32:35], a[120:123], v[164:167]
v_mfma_f32_16x16x32_bf16 v[168:171], v[32:35], a[184:187], v[168:171]
v_mfma_f32_16x16x32_bf16 v[172:175], v[32:35], a[248:251], v[172:175]
v_mfma_f32_16x16x32_bf16 v[176:179], v[36:39], a[56:59], v[176:179]
v_mfma_f32_16x16x32_bf16 v[180:183], v[36:39], a[120:123], v[180:183]
v_mfma_f32_16x16x32_bf16 v[184:187], v[36:39], a[184:187], v[184:187]
v_mfma_f32_16x16x32_bf16 v[188:191], v[36:39], a[248:251], v[188:191]
s_waitcnt lgkmcnt(0)
v_mfma_f32_16x16x32_bf16 v[160:163], v[16:19], a[60:63], v[160:163]
v_mfma_f32_16x16x32_bf16 v[164:167], v[16:19], a[124:127], v[164:167]
v_mfma_f32_16x16x32_bf16 v[168:171], v[16:19], a[188:191], v[168:171]
v_mfma_f32_16x16x32_bf16 v[172:175], v[16:19], a[252:255], v[172:175]
v_mfma_f32_16x16x32_bf16 v[176:179], v[20:23], a[60:63], v[176:179]
v_mfma_f32_16x16x32_bf16 v[180:183], v[20:23], a[124:127], v[180:183]
v_mfma_f32_16x16x32_bf16 v[184:187], v[20:23], a[188:191], v[184:187]
v_mfma_f32_16x16x32_bf16 v[188:191], v[20:23], a[252:255], v[188:191]
s_waitcnt vmcnt(0)
s_add_u32 s23, s23, 1
G1_LOOP_V:
s_waitcnt vmcnt(4)
s_barrier
ds_read_b128 v[16:19], v5 offset:0
ds_read_b128 v[20:23], v5 offset:1024
ds_read_b128 v[24:27], v5 offset:2048
ds_read_b128 v[28:31], v5 offset:3072
s_cmp_lg_u32 s17, 0
s_cbranch_scc1 G1F_30
s_cmp_lg_u32 s84, 0
s_cbranch_scc1 INIT_31
v_mov_b32 v8, 4
s_mov_b32 s35, 0
POLL_INIT_32:
s_cmp_lg_u32 s37, 0
s_cbranch_scc1 POLL_INIT_32_E
buffer_load_dword v9, v8, s[4:7], 0 offen sc1
s_add_u32 s35, s35, 1
s_cmp_gt_u32 s35, 65536
s_cselect_b32 s37, 1, 0
s_waitcnt vmcnt(0)
v_cmp_gt_u32 vcc, 32, v9
s_cbranch_vccz POLL_INIT_32_E
s_sleep 4
s_branch POLL_INIT_32
POLL_INIT_32_E:
s_mov_b32 s84, 1
INIT_31:
s_sub_u32 s32, s23, 2
s_max_u32 s32, s32, 1
s_lshr_b32 s32, s32, s44
v_mov_b32 v8, s32
s_mov_b64 exec, 1
buffer_store_dword v8, off, s[8:11], s25 sc1
s_mov_b64 exec, -1
G1F_30:
ds_read_b128 v[32:35], v5 offset:4096
ds_read_b128 v[36:39], v5 offset:5120
s_waitcnt lgkmcnt(4)
v_mfma_f32_16x16x32_bf16 v[128:131], v[16:19], a[0:3], 0
v_mfma_f32_16x16x32_bf16 v[132:135], v[16:19], a[64:67], 0
v_mfma_f32_16x16x32_bf16 v[136:139], v[16:19], a[128:131], 0
v_mfma_f32_16x16x32_bf16 v[140:143], v[16:19], a[192:195], 0
s_add_u32 m0, s26, 131072
s_add_u32 s24, s24, s45
buffer_load_dwordx4 v4, s[8:11], s24 offen lds
v_mfma_f32_16x16x32_bf16 v[144:147], v[20:23], a[0:3], 0
v_mfma_f32_16x16x32_bf16 v[148:151], v[20:23], a[64:67], 0
v_mfma_f32_16x16x32_bf16 v[152:155], v[20:23], a[128:131], 0
v_mfma_f32_16x16x32_bf16 v[156:159], v[20:23], a[192:195], 0
ds_read_b128 v[16:19], v5 offset:6144
ds_read_b128 v[20:23], v5 offset:7168
s_waitcnt lgkmcnt(4)
v_mfma_f32_16x16x32_bf16 v[128:131], v[24:27], a[4:7], v[128:131]
v_mfma_f32_16x16x32_bf16 v[132:135], v[24:27], a[68:71], v[132:135]
v_mfma_f32_16x16x32_bf16 v[136:139], v[24:27], a[132:135], v[136:139]
v_mfma_f32_16x16x32_bf16 v[140:143], v[24:27], a[196:199], v[140:143]
s_add_u32 m0, s26, 132096
s_add_u32 s24, s24, 1024
buffer_load_dwordx4 v4, s[8:11], s24 offen lds
v_mfma_f32_16x16x32_bf16 v[144:147], v[28:31], a[4:7], v[144:147]
v_mfma_f32_16x16x32_bf16 v[148:151], v[28:31], a[68:71], v[148:151]
v_mfma_f32_16x16x32_bf16 v[152:155], v[28:31], a[132:135], v[152:155]
v_mfma_f32_16x16x32_bf16 v[156:159], v[28:31], a[196:199], v[156:159]
ds_read_b128 v[24:27], v5 offset:8192
ds_read_b128 v[28:31], v5 offset:9216
s_waitcnt lgkmcnt(4)
v_mfma_f32_16x16x32_bf16 v[128:131], v[32:35], a[8:11], v[128:131]
v_mfma_f32_16x16x32_bf16 v[132:135], v[32:35], a[72:75], v[132:135]
v_mfma_f32_16x16x32_bf16 v[136:139], v[32:35], a[136:139], v[136:139]
v_mfma_f32_16x16x32_bf16 v[140:143], v[32:35], a[200:203], v[140:143]
s_add_u32 m0, s26, 133120
s_add_u32 s24, s24, 1024
buffer_load_dwordx4 v4, s[8:11], s24 offen lds
v_mfma_f32_16x16x32_bf16 v[144:147], v[36:39], a[8:11], v[144:147]
v_mfma_f32_16x16x32_bf16 v[148:151], v[36:39], a[72:75], v[148:151]
v_mfma_f32_16x16x32_bf16 v[152:155], v[36:39], a[136:139], v[152:155]
v_mfma_f32_16x16x32_bf16 v[156:159], v[36:39], a[200:203], v[156:159]
ds_read_b128 v[32:35], v5 offset:10240
ds_read_b128 v[36:39], v5 offset:11264
s_waitcnt lgkmcnt(4)
v_mfma_f32_16x16x32_bf16 v[128:131], v[16:19], a[12:15], v[128:131]
v_mfma_f32_16x16x32_bf16 v[132:135], v[16:19], a[76:79], v[132:135]
v_mfma_f32_16x16x32_bf16 v[136:139], v[16:19], a[140:143], v[136:139]
v_mfma_f32_16x16x32_bf16 v[140:143], v[16:19], a[204:207], v[140:143]
s_add_u32 m0, s26, 134144
s_add_u32 s24, s24, 1024
buffer_load_dwordx4 v4, s[8:11], s24 offen lds
v_mfma_f32_16x16x32_bf16 v[144:147], v[20:23], a[12:15], v[144:147]
v_mfma_f32_16x16x32_bf16 v[148:151], v[20:23], a[76:79], v[148:151]
v_mfma_f32_16x16x32_bf16 v[152:155], v[20:23], a[140:143], v[152:155]
v_mfma_f32_16x16x32_bf16 v[156:159], v[20:23], a[204:207], v[156:159]
ds_read_b128 v[16:19], v5 offset:12288
ds_read_b128 v[20:23], v5 offset:13312
s_waitcnt lgkmcnt(4)
v_mfma_f32_16x16x32_bf16 v[128:131], v[24:27], a[16:19], v[128:131]
v_mfma_f32_16x16x32_bf16 v[132:135], v[24:27], a[80:83], v[132:135]
v_mfma_f32_16x16x32_bf16 v[136:139], v[24:27], a[144:147], v[136:139]
v_mfma_f32_16x16x32_bf16 v[140:143], v[24:27], a[208:211], v[140:143]
s_add_u32 m0, s26, 135168
s_add_u32 s24, s24, 1024
buffer_load_dwordx4 v4, s[8:11], s24 offen lds
v_mfma_f32_16x16x32_bf16 v[144:147], v[28:31], a[16:19], v[144:147]
v_mfma_f32_16x16x32_bf16 v[148:151], v[28:31], a[80:83], v[148:151]
v_mfma_f32_16x16x32_bf16 v[152:155], v[28:31], a[144:147], v[152:155]
v_mfma_f32_16x16x32_bf16 v[156:159], v[28:31], a[208:211], v[156:159]
ds_read_b128 v[24:27], v5 offset:14336
ds_read_b128 v[28:31], v5 offset:15360
s_waitcnt lgkmcnt(4)
v_mfma_f32_16x16x32_bf16 v[128:131], v[32:35], a[20:23], v[128:131]
v_mfma_f32_16x16x32_bf16 v[132:135], v[32:35], a[84:87], v[132:135]
v_mfma_f32_16x16x32_bf16 v[136:139], v[32:35], a[148:151], v[136:139]
v_mfma_f32_16x16x32_bf16 v[140:143], v[32:35], a[212:215], v[140:143]
s_add_u32 m0, s26, 136192
s_add_u32 s24, s24, 1024
buffer_load_dwordx4 v4, s[8:11], s24 offen lds
v_mfma_f32_16x16x32_bf16 v[144:147], v[36:39], a[20:23], v[144:147]
v_mfma_f32_16x16x32_bf16 v[148:151], v[36:39], a[84:87], v[148:151]
v_mfma_f32_16x16x32_bf16 v[152:155], v[36:39], a[148:151], v[152:155]
v_mfma_f32_16x16x32_bf16 v[156:159], v[36:39], a[212:215], v[156:159]
ds_read_b128 v[32:35], v5 offset:16384
ds_read_b128 v[36:39], v5 offset:17408
s_waitcnt lgkmcnt(4)
v_mfma_f32_16x16x32_bf16 v[128:131], v[16:19], a[24:27], v[128:131]
v_mfma_f32_16x16x32_bf16 v[132:135], v[16:19], a[88:91], v[132:135]
v_mfma_f32_16x16x32_bf16 v[136:139], v[16:19], a[152:155], v[136:139]
v_mfma_f32_16x16x32_bf16 v[140:143], v[16:19], a[216:219], v[140:143]
s_add_u32 m0, s26, 137216
s_add_u32 s24, s24, 1024
buffer_load_dwordx4 v4, s[8:11], s24 offen lds
v_mfma_f32_16x16x32_bf16 v[144:147], v[20:23], a[24:27], v[144:147]
v_mfma_f32_16x16x32_bf16 v[148:151], v[20:23], a[88:91], v[148:151]
v_mfma_f32_16x16x32_bf16 v[152:155], v[20:23], a[152:155], v[152:155]
v_mfma_f32_16x16x32_bf16 v[156:159], v[20:23], a[216:219], v[156:159]
ds_read_b128 v[16:19], v5 offset:18432
ds_read_b128 v[20:23], v5 offset:19456
s_waitcnt lgkmcnt(4)
v_mfma_f32_16x16x32_bf16 v[128:131], v[24:27], a[28:31], v[128:131]
v_mfma_f32_16x16x32_bf16 v[132:135], v[24:27], a[92:95], v[132:135]
v_mfma_f32_16x16x32_bf16 v[136:139], v[24:27], a[156:159], v[136:139]
v_mfma_f32_16x16x32_bf16 v[140:143], v[24:27], a[220:223], v[140:143]
s_add_u32 m0, s26, 138240
s_add_u32 s24, s24, 1024
buffer_load_dwordx4 v4, s[8:11], s24 offen lds
v_mfma_f32_16x16x32_bf16 v[144:147], v[28:31], a[28:31], v[144:147]
v_mfma_f32_16x16x32_bf16 v[148:151], v[28:31], a[92:95], v[148:151]
v_mfma_f32_16x16x32_bf16 v[152:155], v[28:31], a[156:159], v[152:155]
v_mfma_f32_16x16x32_bf16 v[156:159], v[28:31], a[220:223], v[156:159]
ds_read_b128 v[24:27], v5 offset:20480
ds_read_b128 v[28:31], v5 offset:21504
s_waitcnt lgkmcnt(4)
v_mfma_f32_16x16x32_bf16 v[128:131], v[32:35], a[32:35], v[128:131]
v_cvt_pk_bf16_f32 v48, v160, v161
v_mfma_f32_16x16x32_bf16 v[132:135], v[32:35], a[96:99], v[132:135]
v_cvt_pk_bf16_f32 v49, v162, v163
v_mfma_f32_16x16x32_bf16 v[136:139], v[32:35], a[160:163], v[136:139]
v_cvt_pk_bf16_f32 v50, v176, v177
v_mfma_f32_16x16x32_bf16 v[140:143], v[32:35], a[224:227], v[140:143]
v_cvt_pk_bf16_f32 v51, v178, v179
v_mfma_f32_16x16x32_bf16 v[144:147], v[36:39], a[32:35], v[144:147]
s_add_u32 s32, s22, 0
buffer_store_dwordx4 v[48:51], v4, s[8:11], s32 offen sc1
v_mfma_f32_16x16x32_bf16 v[148:151], v[36:39], a[96:99], v[148:151]
v_cvt_pk_bf16_f32 v52, v164, v165
v_mfma_f32_16x16x32_bf16 v[152:155], v[36:39], a[160:163], v[152:155]
v_cvt_pk_bf16_f32 v53, v166, v167
v_mfma_f32_16x16x32_bf16 v[156:159], v[36:39], a[224:227], v[156:159]
v_cvt_pk_bf16_f32 v54, v180, v181
ds_read_b128 v[32:35], v5 offset:22528
ds_read_b128 v[36:39], v5 offset:23552
s_waitcnt lgkmcnt(4)
v_mfma_f32_16x16x32_bf16 v[128:131], v[16:19], a[36:39], v[128:131]
v_cvt_pk_bf16_f32 v55, v182, v183
v_mfma_f32_16x16x32_bf16 v[132:135], v[16:19], a[100:103], v[132:135]
s_add_u32 s32, s22, 1024
buffer_store_dwordx4 v[52:55], v4, s[8:11], s32 offen sc1
v_mfma_f32_16x16x32_bf16 v[136:139], v[16:19], a[164:167], v[136:139]
v_cvt_pk_bf16_f32 v56, v168, v169
v_mfma_f32_16x16x32_bf16 v[140:143], v[16:19], a[228:231], v[140:143]
v_cvt_pk_bf16_f32 v57, v170, v171
v_mfma_f32_16x16x32_bf16 v[144:147], v[20:23], a[36:39], v[144:147]
v_cvt_pk_bf16_f32 v58, v184, v185
v_mfma_f32_16x16x32_bf16 v[148:151], v[20:23], a[100:103], v[148:151]
v_cvt_pk_bf16_f32 v59, v186, v187
v_mfma_f32_16x16x32_bf16 v[152:155], v[20:23], a[164:167], v[152:155]
s_add_u32 s32, s22, 2048
buffer_store_dwordx4 v[56:59], v4, s[8:11], s32 offen sc1
v_mfma_f32_16x16x32_bf16 v[156:159], v[20:23], a[228:231], v[156:159]
v_cvt_pk_bf16_f32 v60, v172, v173
ds_read_b128 v[16:19], v5 offset:24576
ds_read_b128 v[20:23], v5 offset:25600
s_waitcnt lgkmcnt(4)
v_mfma_f32_16x16x32_bf16 v[128:131], v[24:27], a[40:43], v[128:131]
v_cvt_pk_bf16_f32 v61, v174, v175
v_mfma_f32_16x16x32_bf16 v[132:135], v[24:27], a[104:107], v[132:135]
v_cvt_pk_bf16_f32 v62, v188, v189
v_mfma_f32_16x16x32_bf16 v[136:139], v[24:27], a[168:171], v[136:139]
v_cvt_pk_bf16_f32 v63, v190, v191
v_mfma_f32_16x16x32_bf16 v[140:143], v[24:27], a[232:235], v[140:143]
s_add_u32 s32, s22, 3072
buffer_store_dwordx4 v[60:63], v4, s[8:11], s32 offen sc1
v_mfma_f32_16x16x32_bf16 v[144:147], v[28:31], a[40:43], v[144:147]
s_add_u32 s22, s22, 1048576
v_mfma_f32_16x16x32_bf16 v[148:151], v[28:31], a[104:107], v[148:151]
v_mfma_f32_16x16x32_bf16 v[152:155], v[28:31], a[168:171], v[152:155]
v_mfma_f32_16x16x32_bf16 v[156:159], v[28:31], a[232:235], v[156:159]
ds_read_b128 v[24:27], v5 offset:26624
ds_read_b128 v[28:31], v5 offset:27648
s_waitcnt lgkmcnt(4)
v_mfma_f32_16x16x32_bf16 v[128:131], v[32:35], a[44:47], v[128:131]
v_mfma_f32_16x16x32_bf16 v[132:135], v[32:35], a[108:111], v[132:135]
v_mfma_f32_16x16x32_bf16 v[136:139], v[32:35], a[172:175], v[136:139]
v_mfma_f32_16x16x32_bf16 v[140:143], v[32:35], a[236:239], v[140:143]
v_mfma_f32_16x16x32_bf16 v[144:147], v[36:39], a[44:47], v[144:147]
v_mfma_f32_16x16x32_bf16 v[148:151], v[36:39], a[108:111], v[148:151]
v_mfma_f32_16x16x32_bf16 v[152:155], v[36:39], a[172:175], v[152:155]
v_mfma_f32_16x16x32_bf16 v[156:159], v[36:39], a[236:239], v[156:159]
ds_read_b128 v[32:35], v5 offset:28672
ds_read_b128 v[36:39], v5 offset:29696
s_waitcnt lgkmcnt(4)
v_mfma_f32_16x16x32_bf16 v[128:131], v[16:19], a[48:51], v[128:131]
v_mfma_f32_16x16x32_bf16 v[132:135], v[16:19], a[112:115], v[132:135]
v_mfma_f32_16x16x32_bf16 v[136:139], v[16:19], a[176:179], v[136:139]
v_mfma_f32_16x16x32_bf16 v[140:143], v[16:19], a[240:243], v[140:143]
v_mfma_f32_16x16x32_bf16 v[144:147], v[20:23], a[48:51], v[144:147]
v_mfma_f32_16x16x32_bf16 v[148:151], v[20:23], a[112:115], v[148:151]
v_mfma_f32_16x16x32_bf16 v[152:155], v[20:23], a[176:179], v[152:155]
v_mfma_f32_16x16x32_bf16 v[156:159], v[20:23], a[240:243], v[156:159]
ds_read_b128 v[16:19], v5 offset:30720
ds_read_b128 v[20:23], v5 offset:31744
s_waitcnt lgkmcnt(4)
v_mfma_f32_16x16x32_bf16 v[128:131], v[24:27], a[52:55], v[128:131]
v_mfma_f32_16x16x32_bf16 v[132:135], v[24:27], a[116:119], v[132:135]
v_mfma_f32_16x16x32_bf16 v[136:139], v[24:27], a[180:183], v[136:139]
v_mfma_f32_16x16x32_bf16 v[140:143], v[24:27], a[244:247], v[140:143]
v_mfma_f32_16x16x32_bf16 v[144:147], v[28:31], a[52:55], v[144:147]
v_mfma_f32_16x16x32_bf16 v[148:151], v[28:31], a[116:119], v[148:151]
v_mfma_f32_16x16x32_bf16 v[152:155], v[28:31], a[180:183], v[152:155]
v_mfma_f32_16x16x32_bf16 v[156:159], v[28:31], a[244:247], v[156:159]
s_waitcnt lgkmcnt(2)
v_mfma_f32_16x16x32_bf16 v[128:131], v[32:35], a[56:59], v[128:131]
v_mfma_f32_16x16x32_bf16 v[132:135], v[32:35], a[120:123], v[132:135]
v_mfma_f32_16x16x32_bf16 v[136:139], v[32:35], a[184:187], v[136:139]
v_mfma_f32_16x16x32_bf16 v[140:143], v[32:35], a[248:251], v[140:143]
v_mfma_f32_16x16x32_bf16 v[144:147], v[36:39], a[56:59], v[144:147]
v_mfma_f32_16x16x32_bf16 v[148:151], v[36:39], a[120:123], v[148:151]
v_mfma_f32_16x16x32_bf16 v[152:155], v[36:39], a[184:187], v[152:155]
v_mfma_f32_16x16x32_bf16 v[156:159], v[36:39], a[248:251], v[156:159]
s_waitcnt lgkmcnt(0)
v_mfma_f32_16x16x32_bf16 v[128:131], v[16:19], a[60:63], v[128:131]
v_mfma_f32_16x16x32_bf16 v[132:135], v[16:19], a[124:127], v[132:135]
v_mfma_f32_16x16x32_bf16 v[136:139], v[16:19], a[188:191], v[136:139]
v_mfma_f32_16x16x32_bf16 v[140:143], v[16:19], a[252:255], v[140:143]
v_mfma_f32_16x16x32_bf16 v[144:147], v[20:23], a[60:63], v[144:147]
v_mfma_f32_16x16x32_bf16 v[148:151], v[20:23], a[124:127], v[148:151]
v_mfma_f32_16x16x32_bf16 v[152:155], v[20:23], a[188:191], v[152:155]
v_mfma_f32_16x16x32_bf16 v[156:159], v[20:23], a[252:255], v[156:159]
s_add_u32 s23, s23, 1
s_waitcnt vmcnt(4)
s_barrier
ds_read_b128 v[16:19], v5 offset:32768
ds_read_b128 v[20:23], v5 offset:33792
ds_read_b128 v[24:27], v5 offset:34816
ds_read_b128 v[28:31], v5 offset:35840
s_cmp_lg_u32 s17, 0
s_cbranch_scc1 G1F_33
s_cmp_lg_u32 s84, 0
s_cbranch_scc1 INIT_34
v_mov_b32 v8, 4
s_mov_b32 s35, 0
POLL_INIT_35:
s_cmp_lg_u32 s37, 0
s_cbranch_scc1 POLL_INIT_35_E
buffer_load_dword v9, v8, s[4:7], 0 offen sc1
s_add_u32 s35, s35, 1
s_cmp_gt_u32 s35, 65536
s_cselect_b32 s37, 1, 0
s_waitcnt vmcnt(0)
v_cmp_gt_u32 vcc, 32, v9
s_cbranch_vccz POLL_INIT_35_E
s_sleep 4
s_branch POLL_INIT_35
POLL_INIT_35_E:
s_mov_b32 s84, 1
INIT_34:
s_sub_u32 s32, s23, 2
s_max_u32 s32, s32, 1
s_lshr_b32 s32, s32, s44
v_mov_b32 v8, s32
s_mov_b64 exec, 1
buffer_store_dword v8, off, s[8:11], s25 sc1
s_mov_b64 exec, -1
G1F_33:
ds_read_b128 v[32:35], v5 offset:36864
ds_read_b128 v[36:39], v5 offset:37888
s_waitcnt lgkmcnt(4)
v_mfma_f32_16x16x32_bf16 v[160:163], v[16:19], a[0:3], 0
v_mfma_f32_16x16x32_bf16 v[164:167], v[16:19], a[64:67], 0
v_mfma_f32_16x16x32_bf16 v[168:171], v[16:19], a[128:131], 0
v_mfma_f32_16x16x32_bf16 v[172:175], v[16:19], a[192:195], 0
s_add_u32 m0, s26, 98304
s_add_u32 s24, s24, s45
buffer_load_dwordx4 v4, s[8:11], s24 offen lds
v_mfma_f32_16x16x32_bf16 v[176:179], v[20:23], a[0:3], 0
v_mfma_f32_16x16x32_bf16 v[180:183], v[20:23], a[64:67], 0
v_mfma_f32_16x16x32_bf16 v[184:187], v[20:23], a[128:131], 0
v_mfma_f32_16x16x32_bf16 v[188:191], v[20:23], a[192:195], 0
ds_read_b128 v[16:19], v5 offset:38912
ds_read_b128 v[20:23], v5 offset:39936
s_waitcnt lgkmcnt(4)
v_mfma_f32_16x16x32_bf16 v[160:163], v[24:27], a[4:7], v[160:163]
v_mfma_f32_16x16x32_bf16 v[164:167], v[24:27], a[68:71], v[164:167]
v_mfma_f32_16x16x32_bf16 v[168:171], v[24:27], a[132:135], v[168:171]
v_mfma_f32_16x16x32_bf16 v[172:175], v[24:27], a[196:199], v[172:175]
s_add_u32 m0, s26, 99328
s_add_u32 s24, s24, 1024
buffer_load_dwordx4 v4, s[8:11], s24 offen lds
v_mfma_f32_16x16x32_bf16 v[176:179], v[28:31], a[4:7], v[176:179]
v_mfma_f32_16x16x32_bf16 v[180:183], v[28:31], a[68:71], v[180:183]
v_mfma_f32_16x16x32_bf16 v[184:187], v[28:31], a[132:135], v[184:187]
v_mfma_f32_16x16x32_bf16 v[188:191], v[28:31], a[196:199], v[188:191]
ds_read_b128 v[24:27], v5 offset:40960
ds_read_b128 v[28:31], v5 offset:41984
s_waitcnt lgkmcnt(4)
v_mfma_f32_16x16x32_bf16 v[160:163], v[32:35], a[8:11], v[160:163]
v_mfma_f32_16x16x32_bf16 v[164:167], v[32:35], a[72:75], v[164:167]
v_mfma_f32_16x16x32_bf16 v[168:171], v[32:35], a[136:139], v[168:171]
v_mfma_f32_16x16x32_bf16 v[172:175], v[32:35], a[200:203], v[172:175]
s_add_u32 m0, s26, 100352
s_add_u32 s24, s24, 1024
buffer_load_dwordx4 v4, s[8:11], s24 offen lds
v_mfma_f32_16x16x32_bf16 v[176:179], v[36:39], a[8:11], v[176:179]
v_mfma_f32_16x16x32_bf16 v[180:183], v[36:39], a[72:75], v[180:183]
v_mfma_f32_16x16x32_bf16 v[184:187], v[36:39], a[136:139], v[184:187]
v_mfma_f32_16x16x32_bf16 v[188:191], v[36:39], a[200:203], v[188:191]
ds_read_b128 v[32:35], v5 offset:43008
ds_read_b128 v[36:39], v5 offset:44032
s_waitcnt lgkmcnt(4)
v_mfma_f32_16x16x32_bf16 v[160:163], v[16:19], a[12:15], v[160:163]
v_mfma_f32_16x16x32_bf16 v[164:167], v[16:19], a[76:79], v[164:167]
v_mfma_f32_16x16x32_bf16 v[168:171], v[16:19], a[140:143], v[168:171]
v_mfma_f32_16x16x32_bf16 v[172:175], v[16:19], a[204:207], v[172:175]
s_add_u32 m0, s26, 101376
s_add_u32 s24, s24, 1024
buffer_load_dwordx4 v4, s[8:11], s24 offen lds
v_mfma_f32_16x16x32_bf16 v[176:179], v[20:23], a[12:15], v[176:179]
v_mfma_f32_16x16x32_bf16 v[180:183], v[20:23], a[76:79], v[180:183]
v_mfma_f32_16x16x32_bf16 v[184:187], v[20:23], a[140:143], v[184:187]
v_mfma_f32_16x16x32_bf16 v[188:191], v[20:23], a[204:207], v[188:191]
ds_read_b128 v[16:19], v5 offset:45056
ds_read_b128 v[20:23], v5 offset:46080
s_waitcnt lgkmcnt(4)
v_mfma_f32_16x16x32_bf16 v[160:163], v[24:27], a[16:19], v[160:163]
v_mfma_f32_16x16x32_bf16 v[164:167], v[24:27], a[80:83], v[164:167]
v_mfma_f32_16x16x32_bf16 v[168:171], v[24:27], a[144:147], v[168:171]
v_mfma_f32_16x16x32_bf16 v[172:175], v[24:27], a[208:211], v[172:175]
s_add_u32 m0, s26, 102400
s_add_u32 s24, s24, 1024
buffer_load_dwordx4 v4, s[8:11], s24 offen lds
v_mfma_f32_16x16x32_bf16 v[176:179], v[28:31], a[16:19], v[176:179]
v_mfma_f32_16x16x32_bf16 v[180:183], v[28:31], a[80:83], v[180:183]
v_mfma_f32_16x16x32_bf16 v[184:187], v[28:31], a[144:147], v[184:187]
v_mfma_f32_16x16x32_bf16 v[188:191], v[28:31], a[208:211], v[188:191]
ds_read_b128 v[24:27], v5 offset:47104
ds_read_b128 v[28:31], v5 offset:48128
s_waitcnt lgkmcnt(4)
v_mfma_f32_16x16x32_bf16 v[160:163], v[32:35], a[20:23], v[160:163]
v_mfma_f32_16x16x32_bf16 v[164:167], v[32:35], a[84:87], v[164:167]
v_mfma_f32_16x16x32_bf16 v[168:171], v[32:35], a[148:151], v[168:171]
v_mfma_f32_16x16x32_bf16 v[172:175], v[32:35], a[212:215], v[172:175]
s_add_u32 m0, s26, 103424
s_add_u32 s24, s24, 1024
buffer_load_dwordx4 v4, s[8:11], s24 offen lds
v_mfma_f32_16x16x32_bf16 v[176:179], v[36:39], a[20:23], v[176:179]
v_mfma_f32_16x16x32_bf16 v[180:183], v[36:39], a[84:87], v[180:183]
v_mfma_f32_16x16x32_bf16 v[184:187], v[36:39], a[148:151], v[184:187]
v_mfma_f32_16x16x32_bf16 v[188:191], v[36:39], a[212:215], v[188:191]
ds_read_b128 v[32:35], v5 offset:49152
ds_read_b128 v[36:39], v5 offset:50176
s_waitcnt lgkmcnt(4)
v_mfma_f32_16x16x32_bf16 v[160:163], v[16:19], a[24:27], v[160:163]
v_mfma_f32_16x16x32_bf16 v[164:167], v[16:19], a[88:91], v[164:167]
v_mfma_f32_16x16x32_bf16 v[168:171], v[16:19], a[152:155], v[168:171]
v_mfma_f32_16x16x32_bf16 v[172:175], v[16:19], a[216:219], v[172:175]
s_add_u32 m0, s26, 104448
s_add_u32 s24, s24, 1024
buffer_load_dwordx4 v4, s[8:11], s24 offen lds
v_mfma_f32_16x16x32_bf16 v[176:179], v[20:23], a[24:27], v[176:179]
v_mfma_f32_16x16x32_bf16 v[180:183], v[20:23], a[88:91], v[180:183]
v_mfma_f32_16x16x32_bf16 v[184:187], v[20:23], a[152:155], v[184:187]
v_mfma_f32_16x16x32_bf16 v[188:191], v[20:23], a[216:219], v[188:191]
ds_read_b128 v[16:19], v5 offset:51200
ds_read_b128 v[20:23], v5 offset:52224
s_waitcnt lgkmcnt(4)
v_mfma_f32_16x16x32_bf16 v[160:163], v[24:27], a[28:31], v[160:163]
v_mfma_f32_16x16x32_bf16 v[164:167], v[24:27], a[92:95], v[164:167]
v_mfma_f32_16x16x32_bf16 v[168:171], v[24:27], a[156:159], v[168:171]
v_mfma_f32_16x16x32_bf16 v[172:175], v[24:27], a[220:223], v[172:175]
s_add_u32 m0, s26, 105472
s_add_u32 s24, s24, 1024
buffer_load_dwordx4 v4, s[8:11], s24 offen lds
v_mfma_f32_16x16x32_bf16 v[176:179], v[28:31], a[28:31], v[176:179]
v_mfma_f32_16x16x32_bf16 v[180:183], v[28:31], a[92:95], v[180:183]
v_mfma_f32_16x16x32_bf16 v[184:187], v[28:31], a[156:159], v[184:187]
v_mfma_f32_16x16x32_bf16 v[188:191], v[28:31], a[220:223], v[188:191]
ds_read_b128 v[24:27], v5 offset:53248
ds_read_b128 v[28:31], v5 offset:54272
s_waitcnt lgkmcnt(4)
v_mfma_f32_16x16x32_bf16 v[160:163], v[32:35], a[32:35], v[160:163]
v_cvt_pk_bf16_f32 v48, v128, v129
v_mfma_f32_16x16x32_bf16 v[164:167], v[32:35], a[96:99], v[164:167]
v_cvt_pk_bf16_f32 v49, v130, v131
v_mfma_f32_16x16x32_bf16 v[168:171], v[32:35], a[160:163], v[168:171]
v_cvt_pk_bf16_f32 v50, v144, v145
v_mfma_f32_16x16x32_bf16 v[172:175], v[32:35], a[224:227], v[172:175]
v_cvt_pk_bf16_f32 v51, v146, v147
v_mfma_f32_16x16x32_bf16 v[176:179], v[36:39], a[32:35], v[176:179]
s_add_u32 s32, s22, 0
buffer_store_dwordx4 v[48:51], v4, s[8:11], s32 offen sc1
v_mfma_f32_16x16x32_bf16 v[180:183], v[36:39], a[96:99], v[180:183]
v_cvt_pk_bf16_f32 v52, v132, v133
v_mfma_f32_16x16x32_bf16 v[184:187], v[36:39], a[160:163], v[184:187]
v_cvt_pk_bf16_f32 v53, v134, v135
v_mfma_f32_16x16x32_bf16 v[188:191], v[36:39], a[224:227], v[188:191]
v_cvt_pk_bf16_f32 v54, v148, v149
ds_read_b128 v[32:35], v5 offset:55296
ds_read_b128 v[36:39], v5 offset:56320
s_waitcnt lgkmcnt(4)
v_mfma_f32_16x16x32_bf16 v[160:163], v[16:19], a[36:39], v[160:163]
v_cvt_pk_bf16_f32 v55, v150, v151
v_mfma_f32_16x16x32_bf16 v[164:167], v[16:19], a[100:103], v[164:167]
s_add_u32 s32, s22, 1024
buffer_store_dwordx4 v[52:55], v4, s[8:11], s32 offen sc1
v_mfma_f32_16x16x32_bf16 v[168:171], v[16:19], a[164:167], v[168:171]
v_cvt_pk_bf16_f32 v56, v136, v137
v_mfma_f32_16x16x32_bf16 v[172:175], v[16:19], a[228:231], v[172:175]
v_cvt_pk_bf16_f32 v57, v138, v139
v_mfma_f32_16x16x32_bf16 v[176:179], v[20:23], a[36:39], v[176:179]
v_cvt_pk_bf16_f32 v58, v152, v153
v_mfma_f32_16x16x32_bf16 v[180:183], v[20:23], a[100:103], v[180:183]
v_cvt_pk_bf16_f32 v59, v154, v155
v_mfma_f32_16x16x32_bf16 v[184:187], v[20:23], a[164:167], v[184:187]
s_add_u32 s32, s22, 2048
buffer_store_dwordx4 v[56:59], v4, s[8:11], s32 offen sc1
v_mfma_f32_16x16x32_bf16 v[188:191], v[20:23], a[228:231], v[188:191]
v_cvt_pk_bf16_f32 v60, v140, v141
ds_read_b128 v[16:19], v5 offset:57344
ds_read_b128 v[20:23], v5 offset:58368
s_waitcnt lgkmcnt(4)
v_mfma_f32_16x16x32_bf16 v[160:163], v[24:27], a[40:43], v[160:163]
v_cvt_pk_bf16_f32 v61, v142, v143
v_mfma_f32_16x16x32_bf16 v[164:167], v[24:27], a[104:107], v[164:167]
v_cvt_pk_bf16_f32 v62, v156, v157
v_mfma_f32_16x16x32_bf16 v[168:171], v[24:27], a[168:171], v[168:171]
v_cvt_pk_bf16_f32 v63, v158, v159
v_mfma_f32_16x16x32_bf16 v[172:175], v[24:27], a[232:235], v[172:175]
s_add_u32 s32, s22, 3072
buffer_store_dwordx4 v[60:63], v4, s[8:11], s32 offen sc1
v_mfma_f32_16x16x32_bf16 v[176:179], v[28:31], a[40:43], v[176:179]
s_add_u32 s22, s22, 1048576
v_mfma_f32_16x16x32_bf16 v[180:183], v[28:31], a[104:107], v[180:183]
v_mfma_f32_16x16x32_bf16 v[184:187], v[28:31], a[168:171], v[184:187]
v_mfma_f32_16x16x32_bf16 v[188:191], v[28:31], a[232:235], v[188:191]
ds_read_b128 v[24:27], v5 offset:59392
ds_read_b128 v[28:31], v5 offset:60416
s_waitcnt lgkmcnt(4)
v_mfma_f32_16x16x32_bf16 v[160:163], v[32:35], a[44:47], v[160:163]
v_mfma_f32_16x16x32_bf16 v[164:167], v[32:35], a[108:111], v[164:167]
v_mfma_f32_16x16x32_bf16 v[168:171], v[32:35], a[172:175], v[168:171]
v_mfma_f32_16x16x32_bf16 v[172:175], v[32:35], a[236:239], v[172:175]
v_mfma_f32_16x16x32_bf16 v[176:179], v[36:39], a[44:47], v[176:179]
v_mfma_f32_16x16x32_bf16 v[180:183], v[36:39], a[108:111], v[180:183]
v_mfma_f32_16x16x32_bf16 v[184:187], v[36:39], a[172:175], v[184:187]
v_mfma_f32_16x16x32_bf16 v[188:191], v[36:39], a[236:239], v[188:191]
ds_read_b128 v[32:35], v5 offset:61440
ds_read_b128 v[36:39], v5 offset:62464
s_waitcnt lgkmcnt(4)
v_mfma_f32_16x16x32_bf16 v[160:163], v[16:19], a[48:51], v[160:163]
v_mfma_f32_16x16x32_bf16 v[164:167], v[16:19], a[112:115], v[164:167]
v_mfma_f32_16x16x32_bf16 v[168:171], v[16:19], a[176:179], v[168:171]
v_mfma_f32_16x16x32_bf16 v[172:175], v[16:19], a[240:243], v[172:175]
v_mfma_f32_16x16x32_bf16 v[176:179], v[20:23], a[48:51], v[176:179]
v_mfma_f32_16x16x32_bf16 v[180:183], v[20:23], a[112:115], v[180:183]
v_mfma_f32_16x16x32_bf16 v[184:187], v[20:23], a[176:179], v[184:187]
v_mfma_f32_16x16x32_bf16 v[188:191], v[20:23], a[240:243], v[188:191]
ds_read_b128 v[16:19], v5 offset:63488
ds_read_b128 v[20:23], v5 offset:64512
s_waitcnt lgkmcnt(4)
v_mfma_f32_16x16x32_bf16 v[160:163], v[24:27], a[52:55], v[160:163]
v_mfma_f32_16x16x32_bf16 v[164:167], v[24:27], a[116:119], v[164:167]
v_mfma_f32_16x16x32_bf16 v[168:171], v[24:27], a[180:183], v[168:171]
v_mfma_f32_16x16x32_bf16 v[172:175], v[24:27], a[244:247], v[172:175]
v_mfma_f32_16x16x32_bf16 v[176:179], v[28:31], a[52:55], v[176:179]
v_mfma_f32_16x16x32_bf16 v[180:183], v[28:31], a[116:119], v[180:183]
v_mfma_f32_16x16x32_bf16 v[184:187], v[28:31], a[180:183], v[184:187]
v_mfma_f32_16x16x32_bf16 v[188:191], v[28:31], a[244:247], v[188:191]
s_waitcnt lgkmcnt(2)
v_mfma_f32_16x16x32_bf16 v[160:163], v[32:35], a[56:59], v[160:163]
v_mfma_f32_16x16x32_bf16 v[164:167], v[32:35], a[120:123], v[164:167]
v_mfma_f32_16x16x32_bf16 v[168:171], v[32:35], a[184:187], v[168:171]
v_mfma_f32_16x16x32_bf16 v[172:175], v[32:35], a[248:251], v[172:175]
v_mfma_f32_16x16x32_bf16 v[176:179], v[36:39], a[56:59], v[176:179]
v_mfma_f32_16x16x32_bf16 v[180:183], v[36:39], a[120:123], v[180:183]
v_mfma_f32_16x16x32_bf16 v[184:187], v[36:39], a[184:187], v[184:187]
v_mfma_f32_16x16x32_bf16 v[188:191], v[36:39], a[248:251], v[188:191]
s_waitcnt lgkmcnt(0)
v_mfma_f32_16x16x32_bf16 v[160:163], v[16:19], a[60:63], v[160:163]
v_mfma_f32_16x16x32_bf16 v[164:167], v[16:19], a[124:127], v[164:167]
v_mfma_f32_16x16x32_bf16 v[168:171], v[16:19], a[188:191], v[168:171]
v_mfma_f32_16x16x32_bf16 v[172:175], v[16:19], a[252:255], v[172:175]
v_mfma_f32_16x16x32_bf16 v[176:179], v[20:23], a[60:63], v[176:179]
v_mfma_f32_16x16x32_bf16 v[180:183], v[20:23], a[124:127], v[180:183]
v_mfma_f32_16x16x32_bf16 v[184:187], v[20:23], a[188:191], v[184:187]
v_mfma_f32_16x16x32_bf16 v[188:191], v[20:23], a[252:255], v[188:191]
s_add_u32 s23, s23, 1
s_cmp_lt_u32 s23, s47
s_cbranch_scc1 G1_LOOP_V
G1_END_V:
s_nop 7
v_cvt_pk_bf16_f32 v48, v160, v161
v_cvt_pk_bf16_f32 v49, v162, v163
v_cvt_pk_bf16_f32 v50, v176, v177
v_cvt_pk_bf16_f32 v51, v178, v179
s_add_u32 s32, s22, 0
buffer_store_dwordx4 v[48:51], v4, s[8:11], s32 offen sc1
v_cvt_pk_bf16_f32 v52, v164, v165
v_cvt_pk_bf16_f32 v53, v166, v167
v_cvt_pk_bf16_f32 v54, v180, v181
v_cvt_pk_bf16_f32 v55, v182, v183
s_add_u32 s32, s22, 1024
buffer_store_dwordx4 v[52:55], v4, s[8:11], s32 offen sc1
v_cvt_pk_bf16_f32 v56, v168, v169
v_cvt_pk_bf16_f32 v57, v170, v171
v_cvt_pk_bf16_f32 v58, v184, v185
v_cvt_pk_bf16_f32 v59, v186, v187
s_add_u32 s32, s22, 2048
buffer_store_dwordx4 v[56:59], v4, s[8:11], s32 offen sc1
v_cvt_pk_bf16_f32 v60, v172, v173
v_cvt_pk_bf16_f32 v61, v174, v175
v_cvt_pk_bf16_f32 v62, v188, v189
v_cvt_pk_bf16_f32 v63, v190, v191
s_add_u32 s32, s22, 3072
buffer_store_dwordx4 v[60:63], v4, s[8:11], s32 offen sc1
s_add_u32 s22, s22, 1048576
s_waitcnt vmcnt(0)
s_barrier
s_cmp_lg_u32 s17, 0
s_cbranch_scc1 G1F_36
v_mov_b32 v8, 16
s_mov_b64 exec, 1
buffer_store_dword v8, off, s[8:11], s25 sc1
s_mov_b64 exec, -1
G1F_36:
s_branch G1_DONE
G1_H:
s_and_b32 s32, s18, 15
s_lshl_b32 s32, s32, 2
s_add_u32 s32, s32, s17
s_lshl_b32 s32, s32, 11
s_mul_i32 s33, s19, 114688
s_add_u32 s22, s32, s33
s_add_u32 s22, s22, 81788928
s_mov_b32 s23, 0
s_waitcnt vmcnt(0) lgkmcnt(0)
s_barrier
ds_read_b128 v[16:19], v5 offset:0
ds_read_b128 v[20:23], v5 offset:1024
ds_read_b128 v[24:27], v5 offset:2048
ds_read_b128 v[28:31], v5 offset:3072
ds_read_b128 v[32:35], v5 offset:4096
ds_read_b128 v[36:39], v5 offset:5120
s_waitcnt lgkmcnt(4)
v_mfma_f32_16x16x32_bf16 v[128:131], a[0:3], v[16:19], v[112:115]
v_mfma_f32_16x16x32_bf16 v[132:135], a[64:67], v[16:19], v[116:119]
v_mfma_f32_16x16x32_bf16 v[136:139], a[128:131], v[16:19], v[120:123]
v_mfma_f32_16x16x32_bf16 v[140:143], a[192:195], v[16:19], v[124:127]
v_mfma_f32_16x16x32_bf16 v[144:147], a[0:3], v[20:23], v[112:115]
v_mfma_f32_16x16x32_bf16 v[148:151], a[64:67], v[20:23], v[116:119]
v_mfma_f32_16x16x32_bf16 v[152:155], a[128:131], v[20:23], v[120:123]
v_mfma_f32_16x16x32_bf16 v[156:159], a[192:195], v[20:23], v[124:127]
ds_read_b128 v[16:19], v5 offset:6144
ds_read_b128 v[20:23], v5 offset:7168
s_waitcnt lgkmcnt(4)
v_mfma_f32_16x16x32_bf16 v[128:131], a[4:7], v[24:27], v[128:131]
v_mfma_f32_16x16x32_bf16 v[132:135], a[68:71], v[24:27], v[132:135]
v_mfma_f32_16x16x32_bf16 v[136:139], a[132:135], v[24:27], v[136:139]
v_mfma_f32_16x16x32_bf16 v[140:143], a[196:199], v[24:27], v[140:143]
v_mfma_f32_16x16x32_bf16 v[144:147], a[4:7], v[28:31], v[144:147]
v_mfma_f32_16x16x32_bf16 v[148:151], a[68:71], v[28:31], v[148:151]
v_mfma_f32_16x16x32_bf16 v[152:155], a[132:135], v[28:31], v[152:155]
v_mfma_f32_16x16x32_bf16 v[156:159], a[196:199], v[28:31], v[156:159]
ds_read_b128 v[24:27], v5 offset:8192
ds_read_b128 v[28:31], v5 offset:9216
s_waitcnt lgkmcnt(4)
v_mfma_f32_16x16x32_bf16 v[128:131], a[8:11], v[32:35], v[128:131]
v_mfma_f32_16x16x32_bf16 v[132:135], a[72:75], v[32:35], v[132:135]
v_mfma_f32_16x16x32_bf16 v[136:139], a[136:139], v[32:35], v[136:139]
v_mfma_f32_16x16x32_bf16 v[140:143], a[200:203], v[32:35], v[140:143]
v_mfma_f32_16x16x32_bf16 v[144:147], a[8:11], v[36:39], v[144:147]
v_mfma_f32_16x16x32_bf16 v[148:151], a[72:75], v[36:39], v[148:151]
v_mfma_f32_16x16x32_bf16 v[152:155], a[136:139], v[36:39], v[152:155]
v_mfma_f32_16x16x32_bf16 v[156:159], a[200:203], v[36:39], v[156:159]
ds_read_b128 v[32:35], v5 offset:10240
ds_read_b128 v[36:39], v5 offset:11264
s_waitcnt lgkmcnt(4)
v_mfma_f32_16x16x32_bf16 v[128:131], a[12:15], v[16:19], v[128:131]
v_mfma_f32_16x16x32_bf16 v[132:135], a[76:79], v[16:19], v[132:135]
v_mfma_f32_16x16x32_bf16 v[136:139], a[140:143], v[16:19], v[136:139]
v_mfma_f32_16x16x32_bf16 v[140:143], a[204:207], v[16:19], v[140:143]
v_mfma_f32_16x16x32_bf16 v[144:147], a[12:15], v[20:23], v[144:147]
v_mfma_f32_16x16x32_bf16 v[148:151], a[76:79], v[20:23], v[148:151]
v_mfma_f32_16x16x32_bf16 v[152:155], a[140:143], v[20:23], v[152:155]
v_mfma_f32_16x16x32_bf16 v[156:159], a[204:207], v[20:23], v[156:159]
ds_read_b128 v[16:19], v5 offset:12288
ds_read_b128 v[20:23], v5 offset:13312
s_waitcnt lgkmcnt(4)
v_mfma_f32_16x16x32_bf16 v[128:131], a[16:19], v[24:27], v[128:131]
v_mfma_f32_16x16x32_bf16 v[132:135], a[80:83], v[24:27], v[132:135]
v_mfma_f32_16x16x32_bf16 v[136:139], a[144:147], v[24:27], v[136:139]
v_mfma_f32_16x16x32_bf16 v[140:143], a[208:211], v[24:27], v[140:143]
v_mfma_f32_16x16x32_bf16 v[144:147], a[16:19], v[28:31], v[144:147]
v_mfma_f32_16x16x32_bf16 v[148:151], a[80:83], v[28:31], v[148:151]
v_mfma_f32_16x16x32_bf16 v[152:155], a[144:147], v[28:31], v[152:155]
v_mfma_f32_16x16x32_bf16 v[156:159], a[208:211], v[28:31], v[156:159]
ds_read_b128 v[24:27], v5 offset:14336
ds_read_b128 v[28:31], v5 offset:15360
s_waitcnt lgkmcnt(4)
v_mfma_f32_16x16x32_bf16 v[128:131], a[20:23], v[32:35], v[128:131]
v_mfma_f32_16x16x32_bf16 v[132:135], a[84:87], v[32:35], v[132:135]
v_mfma_f32_16x16x32_bf16 v[136:139], a[148:151], v[32:35], v[136:139]
v_mfma_f32_16x16x32_bf16 v[140:143], a[212:215], v[32:35], v[140:143]
v_mfma_f32_16x16x32_bf16 v[144:147], a[20:23], v[36:39], v[144:147]
v_mfma_f32_16x16x32_bf16 v[148:151], a[84:87], v[36:39], v[148:151]
v_mfma_f32_16x16x32_bf16 v[152:155], a[148:151], v[36:39], v[152:155]
v_mfma_f32_16x16x32_bf16 v[156:159], a[212:215], v[36:39], v[156:159]
ds_read_b128 v[32:35], v5 offset:16384
ds_read_b128 v[36:39], v5 offset:17408
s_waitcnt lgkmcnt(4)
v_mfma_f32_16x16x32_bf16 v[128:131], a[24:27], v[16:19], v[128:131]
v_mfma_f32_16x16x32_bf16 v[132:135], a[88:91], v[16:19], v[132:135]
v_mfma_f32_16x16x32_bf16 v[136:139], a[152:155], v[16:19], v[136:139]
v_mfma_f32_16x16x32_bf16 v[140:143], a[216:219], v[16:19], v[140:143]
v_mfma_f32_16x16x32_bf16 v[144:147], a[24:27], v[20:23], v[144:147]
v_mfma_f32_16x16x32_bf16 v[148:151], a[88:91], v[20:23], v[148:151]
v_mfma_f32_16x16x32_bf16 v[152:155], a[152:155], v[20:23], v[152:155]
v_mfma_f32_16x16x32_bf16 v[156:159], a[216:219], v[20:23], v[156:159]
ds_read_b128 v[16:19], v5 offset:18432
ds_read_b128 v[20:23], v5 offset:19456
s_waitcnt lgkmcnt(4)
v_mfma_f32_16x16x32_bf16 v[128:131], a[28:31], v[24:27], v[128:131]
v_mfma_f32_16x16x32_bf16 v[132:135], a[92:95], v[24:27], v[132:135]
v_mfma_f32_16x16x32_bf16 v[136:139], a[156:159], v[24:27], v[136:139]
v_mfma_f32_16x16x32_bf16 v[140:143], a[220:223], v[24:27], v[140:143]
v_mfma_f32_16x16x32_bf16 v[144:147], a[28:31], v[28:31], v[144:147]
v_mfma_f32_16x16x32_bf16 v[148:151], a[92:95], v[28:31], v[148:151]
v_mfma_f32_16x16x32_bf16 v[152:155], a[156:159], v[28:31], v[152:155]
v_mfma_f32_16x16x32_bf16 v[156:159], a[220:223], v[28:31], v[156:159]
ds_read_b128 v[24:27], v5 offset:20480
ds_read_b128 v[28:31], v5 offset:21504
s_waitcnt lgkmcnt(4)
v_mfma_f32_16x16x32_bf16 v[128:131], a[32:35], v[32:35], v[128:131]
v_mfma_f32_16x16x32_bf16 v[132:135], a[96:99], v[32:35], v[132:135]
v_mfma_f32_16x16x32_bf16 v[136:139], a[160:163], v[32:35], v[136:139]
v_mfma_f32_16x16x32_bf16 v[140:143], a[224:227], v[32:35], v[140:143]
v_mfma_f32_16x16x32_bf16 v[144:147], a[32:35], v[36:39], v[144:147]
v_mfma_f32_16x16x32_bf16 v[148:151], a[96:99], v[36:39], v[148:151]
v_mfma_f32_16x16x32_bf16 v[152:155], a[160:163], v[36:39], v[152:155]
v_mfma_f32_16x16x32_bf16 v[156:159], a[224:227], v[36:39], v[156:159]
ds_read_b128 v[32:35], v5 offset:22528
ds_read_b128 v[36:39], v5 offset:23552
s_waitcnt lgkmcnt(4)
v_mfma_f32_16x16x32_bf16 v[128:131], a[36:39], v[16:19], v[128:131]
v_mfma_f32_16x16x32_bf16 v[132:135], a[100:103], v[16:19], v[132:135]
v_mfma_f32_16x16x32_bf16 v[136:139], a[164:167], v[16:19], v[136:139]
v_mfma_f32_16x16x32_bf16 v[140:143], a[228:231], v[16:19], v[140:143]
v_mfma_f32_16x16x32_bf16 v[144:147], a[36:39], v[20:23], v[144:147]
v_mfma_f32_16x16x32_bf16 v[148:151], a[100:103], v[20:23], v[148:151]
v_mfma_f32_16x16x32_bf16 v[152:155], a[164:167], v[20:23], v[152:155]
v_mfma_f32_16x16x32_bf16 v[156:159], a[228:231], v[20:23], v[156:159]
ds_read_b128 v[16:19], v5 offset:24576
ds_read_b128 v[20:23], v5 offset:25600
s_waitcnt lgkmcnt(4)
v_mfma_f32_16x16x32_bf16 v[128:131], a[40:43], v[24:27], v[128:131]
v_mfma_f32_16x16x32_bf16 v[132:135], a[104:107], v[24:27], v[132:135]
v_mfma_f32_16x16x32_bf16 v[136:139], a[168:171], v[24:27], v[136:139]
v_mfma_f32_16x16x32_bf16 v[140:143], a[232:235], v[24:27], v[140:143]
v_mfma_f32_16x16x32_bf16 v[144:147], a[40:43], v[28:31], v[144:147]
v_mfma_f32_16x16x32_bf16 v[148:151], a[104:107], v[28:31], v[148:151]
v_mfma_f32_16x16x32_bf16 v[152:155], a[168:171], v[28:31], v[152:155]
v_mfma_f32_16x16x32_bf16 v[156:159], a[232:235], v[28:31], v[156:159]
ds_read_b128 v[24:27], v5 offset:26624
ds_read_b128 v[28:31], v5 offset:27648
s_waitcnt lgkmcnt(4)
v_mfma_f32_16x16x32_bf16 v[128:131], a[44:47], v[32:35], v[128:131]
v_mfma_f32_16x16x32_bf16 v[132:135], a[108:111], v[32:35], v[132:135]
v_mfma_f32_16x16x32_bf16 v[136:139], a[172:175], v[32:35], v[136:139]
v_mfma_f32_16x16x32_bf16 v[140:143], a[236:239], v[32:35], v[140:143]
v_mfma_f32_16x16x32_bf16 v[144:147], a[44:47], v[36:39], v[144:147]
v_mfma_f32_16x16x32_bf16 v[148:151], a[108:111], v[36:39], v[148:151]
v_mfma_f32_16x16x32_bf16 v[152:155], a[172:175], v[36:39], v[152:155]
v_mfma_f32_16x16x32_bf16 v[156:159], a[236:239], v[36:39], v[156:159]
ds_read_b128 v[32:35], v5 offset:28672
ds_read_b128 v[36:39], v5 offset:29696
s_waitcnt lgkmcnt(4)
v_mfma_f32_16x16x32_bf16 v[128:131], a[48:51], v[16:19], v[128:131]
v_mfma_f32_16x16x32_bf16 v[132:135], a[112:115], v[16:19], v[132:135]
v_mfma_f32_16x16x32_bf16 v[136:139], a[176:179], v[16:19], v[136:139]
v_mfma_f32_16x16x32_bf16 v[140:143], a[240:243], v[16:19], v[140:143]
v_mfma_f32_16x16x32_bf16 v[144:147], a[48:51], v[20:23], v[144:147]
v_mfma_f32_16x16x32_bf16 v[148:151], a[112:115], v[20:23], v[148:151]
v_mfma_f32_16x16x32_bf16 v[152:155], a[176:179], v[20:23], v[152:155]
v_mfma_f32_16x16x32_bf16 v[156:159], a[240:243], v[20:23], v[156:159]
ds_read_b128 v[16:19], v5 offset:30720
ds_read_b128 v[20:23], v5 offset:31744
s_waitcnt lgkmcnt(4)
v_mfma_f32_16x16x32_bf16 v[128:131], a[52:55], v[24:27], v[128:131]
v_mfma_f32_16x16x32_bf16 v[132:135], a[116:119], v[24:27], v[132:135]
v_mfma_f32_16x16x32_bf16 v[136:139], a[180:183], v[24:27], v[136:139]
v_mfma_f32_16x16x32_bf16 v[140:143], a[244:247], v[24:27], v[140:143]
v_mfma_f32_16x16x32_bf16 v[144:147], a[52:55], v[28:31], v[144:147]
v_mfma_f32_16x16x32_bf16 v[148:151], a[116:119], v[28:31], v[148:151]
v_mfma_f32_16x16x32_bf16 v[152:155], a[180:183], v[28:31], v[152:155]
v_mfma_f32_16x16x32_bf16 v[156:159], a[244:247], v[28:31], v[156:159]
s_waitcnt lgkmcnt(2)
v_mfma_f32_16x16x32_bf16 v[128:131], a[56:59], v[32:35], v[128:131]
v_mfma_f32_16x16x32_bf16 v[132:135], a[120:123], v[32:35], v[132:135]
v_mfma_f32_16x16x32_bf16 v[136:139], a[184:187], v[32:35], v[136:139]
v_mfma_f32_16x16x32_bf16 v[140:143], a[248:251], v[32:35], v[140:143]
v_mfma_f32_16x16x32_bf16 v[144:147], a[56:59], v[36:39], v[144:147]
v_mfma_f32_16x16x32_bf16 v[148:151], a[120:123], v[36:39], v[148:151]
v_mfma_f32_16x16x32_bf16 v[152:155], a[184:187], v[36:39], v[152:155]
v_mfma_f32_16x16x32_bf16 v[156:159], a[248:251], v[36:39], v[156:159]
s_waitcnt lgkmcnt(0)
v_mfma_f32_16x16x32_bf16 v[128:131], a[60:63], v[16:19], v[128:131]
v_mfma_f32_16x16x32_bf16 v[132:135], a[124:127], v[16:19], v[132:135]
v_mfma_f32_16x16x32_bf16 v[136:139], a[188:191], v[16:19], v[136:139]
v_mfma_f32_16x16x32_bf16 v[140:143], a[252:255], v[16:19], v[140:143]
v_mfma_f32_16x16x32_bf16 v[144:147], a[60:63], v[20:23], v[144:147]
v_mfma_f32_16x16x32_bf16 v[148:151], a[124:127], v[20:23], v[148:151]
v_mfma_f32_16x16x32_bf16 v[152:155], a[188:191], v[20:23], v[152:155]
v_mfma_f32_16x16x32_bf16 v[156:159], a[252:255], v[20:23], v[156:159]
s_add_u32 s23, s23, 1
s_nop 7
v_max_f32 v128, 0, v128
v_max_f32 v129, 0, v129
v_mul_f32 v128, v128, v128
v_mul_f32 v129, v129, v129
v_cvt_pk_bf16_f32 v48, v128, v129
v_max_f32 v130, 0, v130
v_max_f32 v131, 0, v131
v_mul_f32 v130, v130, v130
v_mul_f32 v131, v131, v131
v_cvt_pk_bf16_f32 v49, v130, v131
v_max_f32 v132, 0, v132
v_max_f32 v133, 0, v133
v_mul_f32 v132, v132, v132
v_mul_f32 v133, v133, v133
v_cvt_pk_bf16_f32 v50, v132, v133
v_max_f32 v134, 0, v134
v_max_f32 v135, 0, v135
v_mul_f32 v134, v134, v134
v_mul_f32 v135, v135, v135
v_cvt_pk_bf16_f32 v51, v134, v135
s_add_u32 s32, s22, 0
buffer_store_dwordx4 v[48:51], v4, s[8:11], s32 offen sc1
v_max_f32 v136, 0, v136
v_max_f32 v137, 0, v137
v_mul_f32 v136, v136, v136
v_mul_f32 v137, v137, v137
v_cvt_pk_bf16_f32 v52, v136, v137
v_max_f32 v138, 0, v138
v_max_f32 v139, 0, v139
v_mul_f32 v138, v138, v138
v_mul_f32 v139, v139, v139
v_cvt_pk_bf16_f32 v53, v138, v139
v_max_f32 v140, 0, v140
v_max_f32 v141, 0, v141
v_mul_f32 v140, v140, v140
v_mul_f32 v141, v141, v141
v_cvt_pk_bf16_f32 v54, v140, v141
v_max_f32 v142, 0, v142
v_max_f32 v143, 0, v143
v_mul_f32 v142, v142, v142
v_mul_f32 v143, v143, v143
v_cvt_pk_bf16_f32 v55, v142, v143
s_add_u32 s32, s22, 1024
buffer_store_dwordx4 v[52:55], v4, s[8:11], s32 offen sc1
v_max_f32 v144, 0, v144
v_max_f32 v145, 0, v145
v_mul_f32 v144, v144, v144
v_mul_f32 v145, v145, v145
v_cvt_pk_bf16_f32 v56, v144, v145
v_max_f32 v146, 0, v146
v_max_f32 v147, 0, v147
v_mul_f32 v146, v146, v146
v_mul_f32 v147, v147, v147
v_cvt_pk_bf16_f32 v57, v146, v147
v_max_f32 v148, 0, v148
v_max_f32 v149, 0, v149
v_mul_f32 v148, v148, v148
v_mul_f32 v149, v149, v149
v_cvt_pk_bf16_f32 v58, v148, v149
v_max_f32 v150, 0, v150
v_max_f32 v151, 0, v151
v_mul_f32 v150, v150, v150
v_mul_f32 v151, v151, v151
v_cvt_pk_bf16_f32 v59, v150, v151
s_add_u32 s32, s22, 57344
buffer_store_dwordx4 v[56:59], v4, s[8:11], s32 offen sc1
v_max_f32 v152, 0, v152
v_max_f32 v153, 0, v153
v_mul_f32 v152, v152, v152
v_mul_f32 v153, v153, v153
v_cvt_pk_bf16_f32 v60, v152, v153
v_max_f32 v154, 0, v154
v_max_f32 v155, 0, v155
v_mul_f32 v154, v154, v154
v_mul_f32 v155, v155, v155
v_cvt_pk_bf16_f32 v61, v154, v155
v_max_f32 v156, 0, v156
v_max_f32 v157, 0, v157
v_mul_f32 v156, v156, v156
v_mul_f32 v157, v157, v157
v_cvt_pk_bf16_f32 v62, v156, v157
v_max_f32 v158, 0, v158
v_max_f32 v159, 0, v159
v_mul_f32 v158, v158, v158
v_mul_f32 v159, v159, v159
v_cvt_pk_bf16_f32 v63, v158, v159
s_add_u32 s32, s22, 58368
buffer_store_dwordx4 v[60:63], v4, s[8:11], s32 offen sc1
s_add_u32 s22, s22, 458752
s_cmp_lg_u32 s17, 0
s_cbranch_scc1 G1LN_37
s_cmp_lg_u32 s84, 0
s_cbranch_scc1 INIT_38
v_mov_b32 v8, 4
s_mov_b32 s35, 0
POLL_INIT_39:
s_cmp_lg_u32 s37, 0
s_cbranch_scc1 POLL_INIT_39_E
buffer_load_dword v9, v8, s[4:7], 0 offen sc1
s_add_u32 s35, s35, 1
s_cmp_gt_u32 s35, 65536
s_cselect_b32 s37, 1, 0
s_waitcnt vmcnt(0)
v_cmp_gt_u32 vcc, 32, v9
s_cbranch_vccz POLL_INIT_39_E
s_sleep 4
s_branch POLL_INIT_39
POLL_INIT_39_E:
s_mov_b32 s84, 1
INIT_38:
v_lshrrev_b32 v8, 2, v0
s_sub_u32 s32, 11, s44
v_lshlrev_b32 v8, s32, v8
v_and_b32 v9, 3, v0
v_lshl_add_u32 v8, v9, 7, v8
s_lshl_b32 s32, s19, 9
s_add_u32 s32, s32, 91340800
s_mov_b32 s35, 0
POLL_LN_40:
s_cmp_lg_u32 s37, 0
s_cbranch_scc1 POLL_LN_40_E
buffer_load_dword v9, v8, s[8:11], s32 offen sc1
s_add_u32 s35, s35, 1
s_cmp_gt_u32 s35, 65536
s_cselect_b32 s37, 1, 0
s_waitcnt vmcnt(0)
v_cmp_gt_u32 vcc, 1, v9
s_cbranch_vccz POLL_LN_40_E
s_sleep 2
s_branch POLL_LN_40
POLL_LN_40_E:
G1LN_37:
s_barrier
s_add_u32 m0, s26, 131072
s_add_u32 s24, s24, s45
buffer_load_dwordx4 v4, s[8:11], s24 offen lds
s_add_u32 m0, s26, 132096
s_add_u32 s24, s24, 1024
buffer_load_dwordx4 v4, s[8:11], s24 offen lds
s_add_u32 m0, s26, 133120
s_add_u32 s24, s24, 1024
buffer_load_dwordx4 v4, s[8:11], s24 offen lds
s_add_u32 m0, s26, 134144
s_add_u32 s24, s24, 1024
buffer_load_dwordx4 v4, s[8:11], s24 offen lds
s_add_u32 m0, s26, 135168
s_add_u32 s24, s24, 1024
buffer_load_dwordx4 v4, s[8:11], s24 offen lds
s_add_u32 m0, s26, 136192
s_add_u32 s24, s24, 1024
buffer_load_dwordx4 v4, s[8:11], s24 offen lds
s_add_u32 m0, s26, 137216
s_add_u32 s24, s24, 1024
buffer_load_dwordx4 v4, s[8:11], s24 offen lds
s_add_u32 m0, s26, 138240
s_add_u32 s24, s24, 1024
buffer_load_dwordx4 v4, s[8:11], s24 offen lds
s_waitcnt vmcnt(0) lgkmcnt(0)
s_barrier
ds_read_b128 v[16:19], v5 offset:32768
ds_read_b128 v[20:23], v5 offset:33792
ds_read_b128 v[24:27], v5 offset:34816
ds_read_b128 v[28:31], v5 offset:35840
s_cmp_lg_u32 s17, 0
s_cbranch_scc1 G1F_41
s_cmp_lg_u32 s84, 0
s_cbranch_scc1 INIT_42
v_mov_b32 v8, 4
s_mov_b32 s35, 0
POLL_INIT_43:
s_cmp_lg_u32 s37, 0
s_cbranch_scc1 POLL_INIT_43_E
buffer_load_dword v9, v8, s[4:7], 0 offen sc1
s_add_u32 s35, s35, 1
s_cmp_gt_u32 s35, 65536
s_cselect_b32 s37, 1, 0
s_waitcnt vmcnt(0)
v_cmp_gt_u32 vcc, 32, v9
s_cbranch_vccz POLL_INIT_43_E
s_sleep 4
s_branch POLL_INIT_43
POLL_INIT_43_E:
s_mov_b32 s84, 1
INIT_42:
s_lshr_b32 s32, 1, s44
v_mov_b32 v8, s32
s_mov_b64 exec, 1
buffer_store_dword v8, off, s[8:11], s25 sc1
s_mov_b64 exec, -1
G1F_41:
ds_read_b128 v[32:35], v5 offset:36864
ds_read_b128 v[36:39], v5 offset:37888
s_waitcnt lgkmcnt(4)
v_mfma_f32_16x16x32_bf16 v[160:163], a[0:3], v[16:19], v[112:115]
v_mfma_f32_16x16x32_bf16 v[164:167], a[64:67], v[16:19], v[116:119]
v_mfma_f32_16x16x32_bf16 v[168:171], a[128:131], v[16:19], v[120:123]
v_mfma_f32_16x16x32_bf16 v[172:175], a[192:195], v[16:19], v[124:127]
s_add_u32 m0, s26, 98304
s_add_u32 s24, s24, s45
buffer_load_dwordx4 v4, s[8:11], s24 offen lds
v_mfma_f32_16x16x32_bf16 v[176:179], a[0:3], v[20:23], v[112:115]
v_mfma_f32_16x16x32_bf16 v[180:183], a[64:67], v[20:23], v[116:119]
v_mfma_f32_16x16x32_bf16 v[184:187], a[128:131], v[20:23], v[120:123]
v_mfma_f32_16x16x32_bf16 v[188:191], a[192:195], v[20:23], v[124:127]
ds_read_b128 v[16:19], v5 offset:38912
ds_read_b128 v[20:23], v5 offset:39936
s_waitcnt lgkmcnt(4)
v_mfma_f32_16x16x32_bf16 v[160:163], a[4:7], v[24:27], v[160:163]
v_mfma_f32_16x16x32_bf16 v[164:167], a[68:71], v[24:27], v[164:167]
v_mfma_f32_16x16x32_bf16 v[168:171], a[132:135], v[24:27], v[168:171]
v_mfma_f32_16x16x32_bf16 v[172:175], a[196:199], v[24:27], v[172:175]
s_add_u32 m0, s26, 99328
s_add_u32 s24, s24, 1024
buffer_load_dwordx4 v4, s[8:11], s24 offen lds
v_mfma_f32_16x16x32_bf16 v[176:179], a[4:7], v[28:31], v[176:179]
v_mfma_f32_16x16x32_bf16 v[180:183], a[68:71], v[28:31], v[180:183]
v_mfma_f32_16x16x32_bf16 v[184:187], a[132:135], v[28:31], v[184:187]
v_mfma_f32_16x16x32_bf16 v[188:191], a[196:199], v[28:31], v[188:191]
ds_read_b128 v[24:27], v5 offset:40960
ds_read_b128 v[28:31], v5 offset:41984
s_waitcnt lgkmcnt(4)
v_mfma_f32_16x16x32_bf16 v[160:163], a[8:11], v[32:35], v[160:163]
v_mfma_f32_16x16x32_bf16 v[164:167], a[72:75], v[32:35], v[164:167]
v_mfma_f32_16x16x32_bf16 v[168:171], a[136:139], v[32:35], v[168:171]
v_mfma_f32_16x16x32_bf16 v[172:175], a[200:203], v[32:35], v[172:175]
s_add_u32 m0, s26, 100352
s_add_u32 s24, s24, 1024
buffer_load_dwordx4 v4, s[8:11], s24 offen lds
v_mfma_f32_16x16x32_bf16 v[176:179], a[8:11], v[36:39], v[176:179]
v_mfma_f32_16x16x32_bf16 v[180:183], a[72:75], v[36:39], v[180:183]
v_mfma_f32_16x16x32_bf16 v[184:187], a[136:139], v[36:39], v[184:187]
v_mfma_f32_16x16x32_bf16 v[188:191], a[200:203], v[36:39], v[188:191]
ds_read_b128 v[32:35], v5 offset:43008
ds_read_b128 v[36:39], v5 offset:44032
s_waitcnt lgkmcnt(4)
v_mfma_f32_16x16x32_bf16 v[160:163], a[12:15], v[16:19], v[160:163]
v_mfma_f32_16x16x32_bf16 v[164:167], a[76:79], v[16:19], v[164:167]
v_mfma_f32_16x16x32_bf16 v[168:171], a[140:143], v[16:19], v[168:171]
v_mfma_f32_16x16x32_bf16 v[172:175], a[204:207], v[16:19], v[172:175]
s_add_u32 m0, s26, 101376
s_add_u32 s24, s24, 1024
buffer_load_dwordx4 v4, s[8:11], s24 offen lds
v_mfma_f32_16x16x32_bf16 v[176:179], a[12:15], v[20:23], v[176:179]
v_mfma_f32_16x16x32_bf16 v[180:183], a[76:79], v[20:23], v[180:183]
v_mfma_f32_16x16x32_bf16 v[184:187], a[140:143], v[20:23], v[184:187]
v_mfma_f32_16x16x32_bf16 v[188:191], a[204:207], v[20:23], v[188:191]
ds_read_b128 v[16:19], v5 offset:45056
ds_read_b128 v[20:23], v5 offset:46080
s_waitcnt lgkmcnt(4)
v_mfma_f32_16x16x32_bf16 v[160:163], a[16:19], v[24:27], v[160:163]
v_mfma_f32_16x16x32_bf16 v[164:167], a[80:83], v[24:27], v[164:167]
v_mfma_f32_16x16x32_bf16 v[168:171], a[144:147], v[24:27], v[168:171]
v_mfma_f32_16x16x32_bf16 v[172:175], a[208:211], v[24:27], v[172:175]
s_add_u32 m0, s26, 102400
s_add_u32 s24, s24, 1024
buffer_load_dwordx4 v4, s[8:11], s24 offen lds
v_mfma_f32_16x16x32_bf16 v[176:179], a[16:19], v[28:31], v[176:179]
v_mfma_f32_16x16x32_bf16 v[180:183], a[80:83], v[28:31], v[180:183]
v_mfma_f32_16x16x32_bf16 v[184:187], a[144:147], v[28:31], v[184:187]
v_mfma_f32_16x16x32_bf16 v[188:191], a[208:211], v[28:31], v[188:191]
ds_read_b128 v[24:27], v5 offset:47104
ds_read_b128 v[28:31], v5 offset:48128
s_waitcnt lgkmcnt(4)
v_mfma_f32_16x16x32_bf16 v[160:163], a[20:23], v[32:35], v[160:163]
v_mfma_f32_16x16x32_bf16 v[164:167], a[84:87], v[32:35], v[164:167]
v_mfma_f32_16x16x32_bf16 v[168:171], a[148:151], v[32:35], v[168:171]
v_mfma_f32_16x16x32_bf16 v[172:175], a[212:215], v[32:35], v[172:175]
s_add_u32 m0, s26, 103424
s_add_u32 s24, s24, 1024
buffer_load_dwordx4 v4, s[8:11], s24 offen lds
v_mfma_f32_16x16x32_bf16 v[176:179], a[20:23], v[36:39], v[176:179]
v_mfma_f32_16x16x32_bf16 v[180:183], a[84:87], v[36:39], v[180:183]
v_mfma_f32_16x16x32_bf16 v[184:187], a[148:151], v[36:39], v[184:187]
v_mfma_f32_16x16x32_bf16 v[188:191], a[212:215], v[36:39], v[188:191]
ds_read_b128 v[32:35], v5 offset:49152
ds_read_b128 v[36:39], v5 offset:50176
s_waitcnt lgkmcnt(4)
v_mfma_f32_16x16x32_bf16 v[160:163], a[24:27], v[16:19], v[160:163]
v_mfma_f32_16x16x32_bf16 v[164:167], a[88:91], v[16:19], v[164:167]
v_mfma_f32_16x16x32_bf16 v[168:171], a[152:155], v[16:19], v[168:171]
v_mfma_f32_16x16x32_bf16 v[172:175], a[216:219], v[16:19], v[172:175]
s_add_u32 m0, s26, 104448
s_add_u32 s24, s24, 1024
buffer_load_dwordx4 v4, s[8:11], s24 offen lds
v_mfma_f32_16x16x32_bf16 v[176:179], a[24:27], v[20:23], v[176:179]
v_mfma_f32_16x16x32_bf16 v[180:183], a[88:91], v[20:23], v[180:183]
v_mfma_f32_16x16x32_bf16 v[184:187], a[152:155], v[20:23], v[184:187]
v_mfma_f32_16x16x32_bf16 v[188:191], a[216:219], v[20:23], v[188:191]
ds_read_b128 v[16:19], v5 offset:51200
ds_read_b128 v[20:23], v5 offset:52224
s_waitcnt lgkmcnt(4)
v_mfma_f32_16x16x32_bf16 v[160:163], a[28:31], v[24:27], v[160:163]
v_mfma_f32_16x16x32_bf16 v[164:167], a[92:95], v[24:27], v[164:167]
v_mfma_f32_16x16x32_bf16 v[168:171], a[156:159], v[24:27], v[168:171]
v_mfma_f32_16x16x32_bf16 v[172:175], a[220:223], v[24:27], v[172:175]
s_add_u32 m0, s26, 105472
s_add_u32 s24, s24, 1024
buffer_load_dwordx4 v4, s[8:11], s24 offen lds
v_mfma_f32_16x16x32_bf16 v[176:179], a[28:31], v[28:31], v[176:179]
v_mfma_f32_16x16x32_bf16 v[180:183], a[92:95], v[28:31], v[180:183]
v_mfma_f32_16x16x32_bf16 v[184:187], a[156:159], v[28:31], v[184:187]
v_mfma_f32_16x16x32_bf16 v[188:191], a[220:223], v[28:31], v[188:191]
ds_read_b128 v[24:27], v5 offset:53248
ds_read_b128 v[28:31], v5 offset:54272
s_waitcnt lgkmcnt(4)
v_mfma_f32_16x16x32_bf16 v[160:163], a[32:35], v[32:35], v[160:163]
v_mfma_f32_16x16x32_bf16 v[164:167], a[96:99], v[32:35], v[164:167]
v_mfma_f32_16x16x32_bf16 v[168:171], a[160:163], v[32:35], v[168:171]
v_mfma_f32_16x16x32_bf16 v[172:175], a[224:227], v[32:35], v[172:175]
v_mfma_f32_16x16x32_bf16 v[176:179], a[32:35], v[36:39], v[176:179]
v_mfma_f32_16x16x32_bf16 v[180:183], a[96:99], v[36:39], v[180:183]
v_mfma_f32_16x16x32_bf16 v[184:187], a[160:163], v[36:39], v[184:187]
v_mfma_f32_16x16x32_bf16 v[188:191], a[224:227], v[36:39], v[188:191]
ds_read_b128 v[32:35], v5 offset:55296
ds_read_b128 v[36:39], v5 offset:56320
s_waitcnt lgkmcnt(4)
v_mfma_f32_16x16x32_bf16 v[160:163], a[36:39], v[16:19], v[160:163]
v_mfma_f32_16x16x32_bf16 v[164:167], a[100:103], v[16:19], v[164:167]
v_mfma_f32_16x16x32_bf16 v[168:171], a[164:167], v[16:19], v[168:171]
v_mfma_f32_16x16x32_bf16 v[172:175], a[228:231], v[16:19], v[172:175]
v_mfma_f32_16x16x32_bf16 v[176:179], a[36:39], v[20:23], v[176:179]
v_mfma_f32_16x16x32_bf16 v[180:183], a[100:103], v[20:23], v[180:183]
v_mfma_f32_16x16x32_bf16 v[184:187], a[164:167], v[20:23], v[184:187]
v_mfma_f32_16x16x32_bf16 v[188:191], a[228:231], v[20:23], v[188:191]
ds_read_b128 v[16:19], v5 offset:57344
ds_read_b128 v[20:23], v5 offset:58368
s_waitcnt lgkmcnt(4)
v_mfma_f32_16x16x32_bf16 v[160:163], a[40:43], v[24:27], v[160:163]
v_mfma_f32_16x16x32_bf16 v[164:167], a[104:107], v[24:27], v[164:167]
v_mfma_f32_16x16x32_bf16 v[168:171], a[168:171], v[24:27], v[168:171]
v_mfma_f32_16x16x32_bf16 v[172:175], a[232:235], v[24:27], v[172:175]
v_mfma_f32_16x16x32_bf16 v[176:179], a[40:43], v[28:31], v[176:179]
v_mfma_f32_16x16x32_bf16 v[180:183], a[104:107], v[28:31], v[180:183]
v_mfma_f32_16x16x32_bf16 v[184:187], a[168:171], v[28:31], v[184:187]
v_mfma_f32_16x16x32_bf16 v[188:191], a[232:235], v[28:31], v[188:191]
ds_read_b128 v[24:27], v5 offset:59392
ds_read_b128 v[28:31], v5 offset:60416
s_waitcnt lgkmcnt(4)
v_mfma_f32_16x16x32_bf16 v[160:163], a[44:47], v[32:35], v[160:163]
v_mfma_f32_16x16x32_bf16 v[164:167], a[108:111], v[32:35], v[164:167]
v_mfma_f32_16x16x32_bf16 v[168:171], a[172:175], v[32:35], v[168:171]
v_mfma_f32_16x16x32_bf16 v[172:175], a[236:239], v[32:35], v[172:175]
v_mfma_f32_16x16x32_bf16 v[176:179], a[44:47], v[36:39], v[176:179]
v_mfma_f32_16x16x32_bf16 v[180:183], a[108:111], v[36:39], v[180:183]
v_mfma_f32_16x16x32_bf16 v[184:187], a[172:175], v[36:39], v[184:187]
v_mfma_f32_16x16x32_bf16 v[188:191], a[236:239], v[36:39], v[188:191]
ds_read_b128 v[32:35], v5 offset:61440
ds_read_b128 v[36:39], v5 offset:62464
s_waitcnt lgkmcnt(4)
v_mfma_f32_16x16x32_bf16 v[160:163], a[48:51], v[16:19], v[160:163]
v_mfma_f32_16x16x32_bf16 v[164:167], a[112:115], v[16:19], v[164:167]
v_mfma_f32_16x16x32_bf16 v[168:171], a[176:179], v[16:19], v[168:171]
v_mfma_f32_16x16x32_bf16 v[172:175], a[240:243], v[16:19], v[172:175]
v_mfma_f32_16x16x32_bf16 v[176:179], a[48:51], v[20:23], v[176:179]
v_mfma_f32_16x16x32_bf16 v[180:183], a[112:115], v[20:23], v[180:183]
v_mfma_f32_16x16x32_bf16 v[184:187], a[176:179], v[20:23], v[184:187]
v_mfma_f32_16x16x32_bf16 v[188:191], a[240:243], v[20:23], v[188:191]
ds_read_b128 v[16:19], v5 offset:63488
ds_read_b128 v[20:23], v5 offset:64512
s_waitcnt lgkmcnt(4)
v_mfma_f32_16x16x32_bf16 v[160:163], a[52:55], v[24:27], v[160:163]
v_mfma_f32_16x16x32_bf16 v[164:167], a[116:119], v[24:27], v[164:167]
v_mfma_f32_16x16x32_bf16 v[168:171], a[180:183], v[24:27], v[168:171]
v_mfma_f32_16x16x32_bf16 v[172:175], a[244:247], v[24:27], v[172:175]
v_mfma_f32_16x16x32_bf16 v[176:179], a[52:55], v[28:31], v[176:179]
v_mfma_f32_16x16x32_bf16 v[180:183], a[116:119], v[28:31], v[180:183]
v_mfma_f32_16x16x32_bf16 v[184:187], a[180:183], v[28:31], v[184:187]
v_mfma_f32_16x16x32_bf16 v[188:191], a[244:247], v[28:31], v[188:191]
s_waitcnt lgkmcnt(2)
v_mfma_f32_16x16x32_bf16 v[160:163], a[56:59], v[32:35], v[160:163]
v_mfma_f32_16x16x32_bf16 v[164:167], a[120:123], v[32:35], v[164:167]
v_mfma_f32_16x16x32_bf16 v[168:171], a[184:187], v[32:35], v[168:171]
v_mfma_f32_16x16x32_bf16 v[172:175], a[248:251], v[32:35], v[172:175]
v_mfma_f32_16x16x32_bf16 v[176:179], a[56:59], v[36:39], v[176:179]
v_mfma_f32_16x16x32_bf16 v[180:183], a[120:123], v[36:39], v[180:183]
v_mfma_f32_16x16x32_bf16 v[184:187], a[184:187], v[36:39], v[184:187]
v_mfma_f32_16x16x32_bf16 v[188:191], a[248:251], v[36:39], v[188:191]
s_waitcnt lgkmcnt(0)
v_mfma_f32_16x16x32_bf16 v[160:163], a[60:63], v[16:19], v[160:163]
v_mfma_f32_16x16x32_bf16 v[164:167], a[124:127], v[16:19], v[164:167]
v_mfma_f32_16x16x32_bf16 v[168:171], a[188:191], v[16:19], v[168:171]
v_mfma_f32_16x16x32_bf16 v[172:175], a[252:255], v[16:19], v[172:175]
v_mfma_f32_16x16x32_bf16 v[176:179], a[60:63], v[20:23], v[176:179]
v_mfma_f32_16x16x32_bf16 v[180:183], a[124:127], v[20:23], v[180:183]
v_mfma_f32_16x16x32_bf16 v[184:187], a[188:191], v[20:23], v[184:187]
v_mfma_f32_16x16x32_bf16 v[188:191], a[252:255], v[20:23], v[188:191]
s_waitcnt vmcnt(0)
s_add_u32 s23, s23, 1
G1_LOOP_H:
s_waitcnt vmcnt(4)
s_barrier
ds_read_b128 v[16:19], v5 offset:0
ds_read_b128 v[20:23], v5 offset:1024
ds_read_b128 v[24:27], v5 offset:2048
ds_read_b128 v[28:31], v5 offset:3072
s_cmp_lg_u32 s17, 0
s_cbranch_scc1 G1F_44
s_cmp_lg_u32 s84, 0
s_cbranch_scc1 INIT_45
v_mov_b32 v8, 4
s_mov_b32 s35, 0
POLL_INIT_46:
s_cmp_lg_u32 s37, 0
s_cbranch_scc1 POLL_INIT_46_E
buffer_load_dword v9, v8, s[4:7], 0 offen sc1
s_add_u32 s35, s35, 1
s_cmp_gt_u32 s35, 65536
s_cselect_b32 s37, 1, 0
s_waitcnt vmcnt(0)
v_cmp_gt_u32 vcc, 32, v9
s_cbranch_vccz POLL_INIT_46_E
s_sleep 4
s_branch POLL_INIT_46
POLL_INIT_46_E:
s_mov_b32 s84, 1
INIT_45:
s_sub_u32 s32, s23, 2
s_max_u32 s32, s32, 1
s_lshr_b32 s32, s32, s44
v_mov_b32 v8, s32
s_mov_b64 exec, 1
buffer_store_dword v8, off, s[8:11], s25 sc1
s_mov_b64 exec, -1
G1F_44:
ds_read_b128 v[32:35], v5 offset:4096
ds_read_b128 v[36:39], v5 offset:5120
s_waitcnt lgkmcnt(4)
v_mfma_f32_16x16x32_bf16 v[128:131], a[0:3], v[16:19], v[112:115]
v_mfma_f32_16x16x32_bf16 v[132:135], a[64:67], v[16:19], v[116:119]
v_mfma_f32_16x16x32_bf16 v[136:139], a[128:131], v[16:19], v[120:123]
v_mfma_f32_16x16x32_bf16 v[140:143], a[192:195], v[16:19], v[124:127]
s_add_u32 m0, s26, 131072
s_add_u32 s24, s24, s45
buffer_load_dwordx4 v4, s[8:11], s24 offen lds
v_mfma_f32_16x16x32_bf16 v[144:147], a[0:3], v[20:23], v[112:115]
v_mfma_f32_16x16x32_bf16 v[148:151], a[64:67], v[20:23], v[116:119]
v_mfma_f32_16x16x32_bf16 v[152:155], a[128:131], v[20:23], v[120:123]
v_mfma_f32_16x16x32_bf16 v[156:159], a[192:195], v[20:23], v[124:127]
ds_read_b128 v[16:19], v5 offset:6144
ds_read_b128 v[20:23], v5 offset:7168
s_waitcnt lgkmcnt(4)
v_mfma_f32_16x16x32_bf16 v[128:131], a[4:7], v[24:27], v[128:131]
v_mfma_f32_16x16x32_bf16 v[132:135], a[68:71], v[24:27], v[132:135]
v_mfma_f32_16x16x32_bf16 v[136:139], a[132:135], v[24:27], v[136:139]
v_mfma_f32_16x16x32_bf16 v[140:143], a[196:199], v[24:27], v[140:143]
s_add_u32 m0, s26, 132096
s_add_u32 s24, s24, 1024
buffer_load_dwordx4 v4, s[8:11], s24 offen lds
v_mfma_f32_16x16x32_bf16 v[144:147], a[4:7], v[28:31], v[144:147]
v_mfma_f32_16x16x32_bf16 v[148:151], a[68:71], v[28:31], v[148:151]
v_mfma_f32_16x16x32_bf16 v[152:155], a[132:135], v[28:31], v[152:155]
v_mfma_f32_16x16x32_bf16 v[156:159], a[196:199], v[28:31], v[156:159]
ds_read_b128 v[24:27], v5 offset:8192
ds_read_b128 v[28:31], v5 offset:9216
s_waitcnt lgkmcnt(4)
v_mfma_f32_16x16x32_bf16 v[128:131], a[8:11], v[32:35], v[128:131]
v_mfma_f32_16x16x32_bf16 v[132:135], a[72:75], v[32:35], v[132:135]
v_mfma_f32_16x16x32_bf16 v[136:139], a[136:139], v[32:35], v[136:139]
v_mfma_f32_16x16x32_bf16 v[140:143], a[200:203], v[32:35], v[140:143]
s_add_u32 m0, s26, 133120
s_add_u32 s24, s24, 1024
buffer_load_dwordx4 v4, s[8:11], s24 offen lds
v_mfma_f32_16x16x32_bf16 v[144:147], a[8:11], v[36:39], v[144:147]
v_mfma_f32_16x16x32_bf16 v[148:151], a[72:75], v[36:39], v[148:151]
v_mfma_f32_16x16x32_bf16 v[152:155], a[136:139], v[36:39], v[152:155]
v_mfma_f32_16x16x32_bf16 v[156:159], a[200:203], v[36:39], v[156:159]
ds_read_b128 v[32:35], v5 offset:10240
ds_read_b128 v[36:39], v5 offset:11264
s_waitcnt lgkmcnt(4)
v_mfma_f32_16x16x32_bf16 v[128:131], a[12:15], v[16:19], v[128:131]
v_mfma_f32_16x16x32_bf16 v[132:135], a[76:79], v[16:19], v[132:135]
v_mfma_f32_16x16x32_bf16 v[136:139], a[140:143], v[16:19], v[136:139]
v_mfma_f32_16x16x32_bf16 v[140:143], a[204:207], v[16:19], v[140:143]
s_add_u32 m0, s26, 134144
s_add_u32 s24, s24, 1024
buffer_load_dwordx4 v4, s[8:11], s24 offen lds
v_mfma_f32_16x16x32_bf16 v[144:147], a[12:15], v[20:23], v[144:147]
v_mfma_f32_16x16x32_bf16 v[148:151], a[76:79], v[20:23], v[148:151]
v_mfma_f32_16x16x32_bf16 v[152:155], a[140:143], v[20:23], v[152:155]
v_mfma_f32_16x16x32_bf16 v[156:159], a[204:207], v[20:23], v[156:159]
ds_read_b128 v[16:19], v5 offset:12288
ds_read_b128 v[20:23], v5 offset:13312
s_waitcnt lgkmcnt(4)
v_mfma_f32_16x16x32_bf16 v[128:131], a[16:19], v[24:27], v[128:131]
v_mfma_f32_16x16x32_bf16 v[132:135], a[80:83], v[24:27], v[132:135]
v_mfma_f32_16x16x32_bf16 v[136:139], a[144:147], v[24:27], v[136:139]
v_mfma_f32_16x16x32_bf16 v[140:143], a[208:211], v[24:27], v[140:143]
s_add_u32 m0, s26, 135168
s_add_u32 s24, s24, 1024
buffer_load_dwordx4 v4, s[8:11], s24 offen lds
v_mfma_f32_16x16x32_bf16 v[144:147], a[16:19], v[28:31], v[144:147]
v_mfma_f32_16x16x32_bf16 v[148:151], a[80:83], v[28:31], v[148:151]
v_mfma_f32_16x16x32_bf16 v[152:155], a[144:147], v[28:31], v[152:155]
v_mfma_f32_16x16x32_bf16 v[156:159], a[208:211], v[28:31], v[156:159]
ds_read_b128 v[24:27], v5 offset:14336
ds_read_b128 v[28:31], v5 offset:15360
s_waitcnt lgkmcnt(4)
v_mfma_f32_16x16x32_bf16 v[128:131], a[20:23], v[32:35], v[128:131]
v_mfma_f32_16x16x32_bf16 v[132:135], a[84:87], v[32:35], v[132:135]
v_mfma_f32_16x16x32_bf16 v[136:139], a[148:151], v[32:35], v[136:139]
v_mfma_f32_16x16x32_bf16 v[140:143], a[212:215], v[32:35], v[140:143]
s_add_u32 m0, s26, 136192
s_add_u32 s24, s24, 1024
buffer_load_dwordx4 v4, s[8:11], s24 offen lds
v_mfma_f32_16x16x32_bf16 v[144:147], a[20:23], v[36:39], v[144:147]
v_mfma_f32_16x16x32_bf16 v[148:151], a[84:87], v[36:39], v[148:151]
v_mfma_f32_16x16x32_bf16 v[152:155], a[148:151], v[36:39], v[152:155]
v_mfma_f32_16x16x32_bf16 v[156:159], a[212:215], v[36:39], v[156:159]
ds_read_b128 v[32:35], v5 offset:16384
ds_read_b128 v[36:39], v5 offset:17408
s_waitcnt lgkmcnt(4)
v_mfma_f32_16x16x32_bf16 v[128:131], a[24:27], v[16:19], v[128:131]
v_mfma_f32_16x16x32_bf16 v[132:135], a[88:91], v[16:19], v[132:135]
v_mfma_f32_16x16x32_bf16 v[136:139], a[152:155], v[16:19], v[136:139]
v_mfma_f32_16x16x32_bf16 v[140:143], a[216:219], v[16:19], v[140:143]
s_add_u32 m0, s26, 137216
s_add_u32 s24, s24, 1024
buffer_load_dwordx4 v4, s[8:11], s24 offen lds
v_mfma_f32_16x16x32_bf16 v[144:147], a[24:27], v[20:23], v[144:147]
v_mfma_f32_16x16x32_bf16 v[148:151], a[88:91], v[20:23], v[148:151]
v_mfma_f32_16x16x32_bf16 v[152:155], a[152:155], v[20:23], v[152:155]
v_mfma_f32_16x16x32_bf16 v[156:159], a[216:219], v[20:23], v[156:159]
ds_read_b128 v[16:19], v5 offset:18432
ds_read_b128 v[20:23], v5 offset:19456
s_waitcnt lgkmcnt(4)
v_mfma_f32_16x16x32_bf16 v[128:131], a[28:31], v[24:27], v[128:131]
v_mfma_f32_16x16x32_bf16 v[132:135], a[92:95], v[24:27], v[132:135]
v_mfma_f32_16x16x32_bf16 v[136:139], a[156:159], v[24:27], v[136:139]
v_mfma_f32_16x16x32_bf16 v[140:143], a[220:223], v[24:27], v[140:143]
s_add_u32 m0, s26, 138240
s_add_u32 s24, s24, 1024
buffer_load_dwordx4 v4, s[8:11], s24 offen lds
v_mfma_f32_16x16x32_bf16 v[144:147], a[28:31], v[28:31], v[144:147]
v_mfma_f32_16x16x32_bf16 v[148:151], a[92:95], v[28:31], v[148:151]
v_mfma_f32_16x16x32_bf16 v[152:155], a[156:159], v[28:31], v[152:155]
v_mfma_f32_16x16x32_bf16 v[156:159], a[220:223], v[28:31], v[156:159]
ds_read_b128 v[24:27], v5 offset:20480
ds_read_b128 v[28:31], v5 offset:21504
s_waitcnt lgkmcnt(4)
v_mfma_f32_16x16x32_bf16 v[128:131], a[32:35], v[32:35], v[128:131]
v_max_f32 v160, 0, v160
v_max_f32 v161, 0, v161
v_mfma_f32_16x16x32_bf16 v[132:135], a[96:99], v[32:35], v[132:135]
v_mul_f32 v160, v160, v160
v_mul_f32 v161, v161, v161
v_mfma_f32_16x16x32_bf16 v[136:139], a[160:163], v[32:35], v[136:139]
v_cvt_pk_bf16_f32 v48, v160, v161
v_mfma_f32_16x16x32_bf16 v[140:143], a[224:227], v[32:35], v[140:143]
v_max_f32 v162, 0, v162
v_max_f32 v163, 0, v163
v_mfma_f32_16x16x32_bf16 v[144:147], a[32:35], v[36:39], v[144:147]
v_mul_f32 v162, v162, v162
v_mul_f32 v163, v163, v163
v_mfma_f32_16x16x32_bf16 v[148:151], a[96:99], v[36:39], v[148:151]
v_cvt_pk_bf16_f32 v49, v162, v163
v_mfma_f32_16x16x32_bf16 v[152:155], a[160:163], v[36:39], v[152:155]
v_max_f32 v164, 0, v164
v_max_f32 v165, 0, v165
v_mfma_f32_16x16x32_bf16 v[156:159], a[224:227], v[36:39], v[156:159]
v_mul_f32 v164, v164, v164
v_mul_f32 v165, v165, v165
ds_read_b128 v[32:35], v5 offset:22528
ds_read_b128 v[36:39], v5 offset:23552
s_waitcnt lgkmcnt(4)
v_mfma_f32_16x16x32_bf16 v[128:131], a[36:39], v[16:19], v[128:131]
v_cvt_pk_bf16_f32 v50, v164, v165
v_mfma_f32_16x16x32_bf16 v[132:135], a[100:103], v[16:19], v[132:135]
v_max_f32 v166, 0, v166
v_max_f32 v167, 0, v167
v_mfma_f32_16x16x32_bf16 v[136:139], a[164:167], v[16:19], v[136:139]
v_mul_f32 v166, v166, v166
v_mul_f32 v167, v167, v167
v_mfma_f32_16x16x32_bf16 v[140:143], a[228:231], v[16:19], v[140:143]
v_cvt_pk_bf16_f32 v51, v166, v167
v_mfma_f32_16x16x32_bf16 v[144:147], a[36:39], v[20:23], v[144:147]
s_add_u32 s32, s22, 0
buffer_store_dwordx4 v[48:51], v4, s[8:11], s32 offen sc1
v_mfma_f32_16x16x32_bf16 v[148:151], a[100:103], v[20:23], v[148:151]
v_max_f32 v168, 0, v168
v_max_f32 v169, 0, v169
v_mfma_f32_16x16x32_bf16 v[152:155], a[164:167], v[20:23], v[152:155]
v_mul_f32 v168, v168, v168
v_mul_f32 v169, v169, v169
v_mfma_f32_16x16x32_bf16 v[156:159], a[228:231], v[20:23], v[156:159]
v_cvt_pk_bf16_f32 v52, v168, v169
ds_read_b128 v[16:19], v5 offset:24576
ds_read_b128 v[20:23], v5 offset:25600
s_waitcnt lgkmcnt(4)
v_mfma_f32_16x16x32_bf16 v[128:131], a[40:43], v[24:27], v[128:131]
v_max_f32 v170, 0, v170
v_max_f32 v171, 0, v171
v_mfma_f32_16x16x32_bf16 v[132:135], a[104:107], v[24:27], v[132:135]
v_mul_f32 v170, v170, v170
v_mul_f32 v171, v171, v171
v_mfma_f32_16x16x32_bf16 v[136:139], a[168:171], v[24:27], v[136:139]
v_cvt_pk_bf16_f32 v53, v170, v171
v_mfma_f32_16x16x32_bf16 v[140:143], a[232:235], v[24:27], v[140:143]
v_max_f32 v172, 0, v172
v_max_f32 v173, 0, v173
v_mfma_f32_16x16x32_bf16 v[144:147], a[40:43], v[28:31], v[144:147]
v_mul_f32 v172, v172, v172
v_mul_f32 v173, v173, v173
v_mfma_f32_16x16x32_bf16 v[148:151], a[104:107], v[28:31], v[148:151]
v_cvt_pk_bf16_f32 v54, v172, v173
v_mfma_f32_16x16x32_bf16 v[152:155], a[168:171], v[28:31], v[152:155]
v_max_f32 v174, 0, v174
v_max_f32 v175, 0, v175
v_mfma_f32_16x16x32_bf16 v[156:159], a[232:235], v[28:31], v[156:159]
v_mul_f32 v174, v174, v174
v_mul_f32 v175, v175, v175
ds_read_b128 v[24:27], v5 offset:26624
ds_read_b128 v[28:31], v5 offset:27648
s_waitcnt lgkmcnt(4)
v_mfma_f32_16x16x32_bf16 v[128:131], a[44:47], v[32:35], v[128:131]
v_cvt_pk_bf16_f32 v55, v174, v175
v_mfma_f32_16x16x32_bf16 v[132:135], a[108:111], v[32:35], v[132:135]
s_add_u32 s32, s22, 1024
buffer_store_dwordx4 v[52:55], v4, s[8:11], s32 offen sc1
v_mfma_f32_16x16x32_bf16 v[136:139], a[172:175], v[32:35], v[136:139]
v_max_f32 v176, 0, v176
v_max_f32 v177, 0, v177
v_mfma_f32_16x16x32_bf16 v[140:143], a[236:239], v[32:35], v[140:143]
v_mul_f32 v176, v176, v176
v_mul_f32 v177, v177, v177
v_mfma_f32_16x16x32_bf16 v[144:147], a[44:47], v[36:39], v[144:147]
v_cvt_pk_bf16_f32 v56, v176, v177
v_mfma_f32_16x16x32_bf16 v[148:151], a[108:111], v[36:39], v[148:151]
v_max_f32 v178, 0, v178
v_max_f32 v179, 0, v179
v_mfma_f32_16x16x32_bf16 v[152:155], a[172:175], v[36:39], v[152:155]
v_mul_f32 v178, v178, v178
v_mul_f32 v179, v179, v179
v_mfma_f32_16x16x32_bf16 v[156:159], a[236:239], v[36:39], v[156:159]
v_cvt_pk_bf16_f32 v57, v178, v179
ds_read_b128 v[32:35], v5 offset:28672
ds_read_b128 v[36:39], v5 offset:29696
s_waitcnt lgkmcnt(4)
v_mfma_f32_16x16x32_bf16 v[128:131], a[48:51], v[16:19], v[128:131]
v_max_f32 v180, 0, v180
v_max_f32 v181, 0, v181
v_mfma_f32_16x16x32_bf16 v[132:135], a[112:115], v[16:19], v[132:135]
v_mul_f32 v180, v180, v180
v_mul_f32 v181, v181, v181
v_mfma_f32_16x16x32_bf16 v[136:139], a[176:179], v[16:19], v[136:139]
v_cvt_pk_bf16_f32 v58, v180, v181
v_mfma_f32_16x16x32_bf16 v[140:143], a[240:243], v[16:19], v[140:143]
v_max_f32 v182, 0, v182
v_max_f32 v183, 0, v183
v_mfma_f32_16x16x32_bf16 v[144:147], a[48:51], v[20:23], v[144:147]
v_mul_f32 v182, v182, v182
v_mul_f32 v183, v183, v183
v_mfma_f32_16x16x32_bf16 v[148:151], a[112:115], v[20:23], v[148:151]
v_cvt_pk_bf16_f32 v59, v182, v183
v_mfma_f32_16x16x32_bf16 v[152:155], a[176:179], v[20:23], v[152:155]
s_add_u32 s32, s22, 57344
buffer_store_dwordx4 v[56:59], v4, s[8:11], s32 offen sc1
v_mfma_f32_16x16x32_bf16 v[156:159], a[240:243], v[20:23], v[156:159]
v_max_f32 v184, 0, v184
v_max_f32 v185, 0, v185
ds_read_b128 v[16:19], v5 offset:30720
ds_read_b128 v[20:23], v5 offset:31744
s_waitcnt lgkmcnt(4)
v_mfma_f32_16x16x32_bf16 v[128:131], a[52:55], v[24:27], v[128:131]
v_mul_f32 v184, v184, v184
v_mul_f32 v185, v185, v185
v_mfma_f32_16x16x32_bf16 v[132:135], a[116:119], v[24:27], v[132:135]
v_cvt_pk_bf16_f32 v60, v184, v185
v_mfma_f32_16x16x32_bf16 v[136:139], a[180:183], v[24:27], v[136:139]
v_max_f32 v186, 0, v186
v_max_f32 v187, 0, v187
v_mfma_f32_16x16x32_bf16 v[140:143], a[244:247], v[24:27], v[140:143]
v_mul_f32 v186, v186, v186
v_mul_f32 v187, v187, v187
v_mfma_f32_16x16x32_bf16 v[144:147], a[52:55], v[28:31], v[144:147]
v_cvt_pk_bf16_f32 v61, v186, v187
v_mfma_f32_16x16x32_bf16 v[148:151], a[116:119], v[28:31], v[148:151]
v_max_f32 v188, 0, v188
v_max_f32 v189, 0, v189
v_mfma_f32_16x16x32_bf16 v[152:155], a[180:183], v[28:31], v[152:155]
v_mul_f32 v188, v188, v188
v_mul_f32 v189, v189, v189
v_mfma_f32_16x16x32_bf16 v[156:159], a[244:247], v[28:31], v[156:159]
v_cvt_pk_bf16_f32 v62, v188, v189
s_waitcnt lgkmcnt(2)
v_mfma_f32_16x16x32_bf16 v[128:131], a[56:59], v[32:35], v[128:131]
v_max_f32 v190, 0, v190
v_max_f32 v191, 0, v191
v_mfma_f32_16x16x32_bf16 v[132:135], a[120:123], v[32:35], v[132:135]
v_mul_f32 v190, v190, v190
v_mul_f32 v191, v191, v191
v_mfma_f32_16x16x32_bf16 v[136:139], a[184:187], v[32:35], v[136:139]
v_cvt_pk_bf16_f32 v63, v190, v191
v_mfma_f32_16x16x32_bf16 v[140:143], a[248:251], v[32:35], v[140:143]
s_add_u32 s32, s22, 58368
buffer_store_dwordx4 v[60:63], v4, s[8:11], s32 offen sc1
v_mfma_f32_16x16x32_bf16 v[144:147], a[56:59], v[36:39], v[144:147]
s_add_u32 s22, s22, 458752
v_mfma_f32_16x16x32_bf16 v[148:151], a[120:123], v[36:39], v[148:151]
v_mfma_f32_16x16x32_bf16 v[152:155], a[184:187], v[36:39], v[152:155]
v_mfma_f32_16x16x32_bf16 v[156:159], a[248:251], v[36:39], v[156:159]
s_waitcnt lgkmcnt(0)
v_mfma_f32_16x16x32_bf16 v[128:131], a[60:63], v[16:19], v[128:131]
v_mfma_f32_16x16x32_bf16 v[132:135], a[124:127], v[16:19], v[132:135]
v_mfma_f32_16x16x32_bf16 v[136:139], a[188:191], v[16:19], v[136:139]
v_mfma_f32_16x16x32_bf16 v[140:143], a[252:255], v[16:19], v[140:143]
v_mfma_f32_16x16x32_bf16 v[144:147], a[60:63], v[20:23], v[144:147]
v_mfma_f32_16x16x32_bf16 v[148:151], a[124:127], v[20:23], v[148:151]
v_mfma_f32_16x16x32_bf16 v[152:155], a[188:191], v[20:23], v[152:155]
v_mfma_f32_16x16x32_bf16 v[156:159], a[252:255], v[20:23], v[156:159]
s_add_u32 s23, s23, 1
s_waitcnt vmcnt(4)
s_barrier
ds_read_b128 v[16:19], v5 offset:32768
ds_read_b128 v[20:23], v5 offset:33792
ds_read_b128 v[24:27], v5 offset:34816
ds_read_b128 v[28:31], v5 offset:35840
s_cmp_lg_u32 s17, 0
s_cbranch_scc1 G1F_47
s_cmp_lg_u32 s84, 0
s_cbranch_scc1 INIT_48
v_mov_b32 v8, 4
s_mov_b32 s35, 0
POLL_INIT_49:
s_cmp_lg_u32 s37, 0
s_cbranch_scc1 POLL_INIT_49_E
buffer_load_dword v9, v8, s[4:7], 0 offen sc1
s_add_u32 s35, s35, 1
s_cmp_gt_u32 s35, 65536
s_cselect_b32 s37, 1, 0
s_waitcnt vmcnt(0)
v_cmp_gt_u32 vcc, 32, v9
s_cbranch_vccz POLL_INIT_49_E
s_sleep 4
s_branch POLL_INIT_49
POLL_INIT_49_E:
s_mov_b32 s84, 1
INIT_48:
s_sub_u32 s32, s23, 2
s_max_u32 s32, s32, 1
s_lshr_b32 s32, s32, s44
v_mov_b32 v8, s32
s_mov_b64 exec, 1
buffer_store_dword v8, off, s[8:11], s25 sc1
s_mov_b64 exec, -1
G1F_47:
ds_read_b128 v[32:35], v5 offset:36864
ds_read_b128 v[36:39], v5 offset:37888
s_waitcnt lgkmcnt(4)
v_mfma_f32_16x16x32_bf16 v[160:163], a[0:3], v[16:19], v[112:115]
v_mfma_f32_16x16x32_bf16 v[164:167], a[64:67], v[16:19], v[116:119]
v_mfma_f32_16x16x32_bf16 v[168:171], a[128:131], v[16:19], v[120:123]
v_mfma_f32_16x16x32_bf16 v[172:175], a[192:195], v[16:19], v[124:127]
s_add_u32 m0, s26, 98304
s_add_u32 s24, s24, s45
buffer_load_dwordx4 v4, s[8:11], s24 offen lds
v_mfma_f32_16x16x32_bf16 v[176:179], a[0:3], v[20:23], v[112:115]
v_mfma_f32_16x16x32_bf16 v[180:183], a[64:67], v[20:23], v[116:119]
v_mfma_f32_16x16x32_bf16 v[184:187], a[128:131], v[20:23], v[120:123]
v_mfma_f32_16x16x32_bf16 v[188:191], a[192:195], v[20:23], v[124:127]
ds_read_b128 v[16:19], v5 offset:38912
ds_read_b128 v[20:23], v5 offset:39936
s_waitcnt lgkmcnt(4)
v_mfma_f32_16x16x32_bf16 v[160:163], a[4:7], v[24:27], v[160:163]
v_mfma_f32_16x16x32_bf16 v[164:167], a[68:71], v[24:27], v[164:167]
v_mfma_f32_16x16x32_bf16 v[168:171], a[132:135], v[24:27], v[168:171]
v_mfma_f32_16x16x32_bf16 v[172:175], a[196:199], v[24:27], v[172:175]
s_add_u32 m0, s26, 99328
s_add_u32 s24, s24, 1024
buffer_load_dwordx4 v4, s[8:11], s24 offen lds
v_mfma_f32_16x16x32_bf16 v[176:179], a[4:7], v[28:31], v[176:179]
v_mfma_f32_16x16x32_bf16 v[180:183], a[68:71], v[28:31], v[180:183]
v_mfma_f32_16x16x32_bf16 v[184:187], a[132:135], v[28:31], v[184:187]
v_mfma_f32_16x16x32_bf16 v[188:191], a[196:199], v[28:31], v[188:191]
ds_read_b128 v[24:27], v5 offset:40960
ds_read_b128 v[28:31], v5 offset:41984
s_waitcnt lgkmcnt(4)
v_mfma_f32_16x16x32_bf16 v[160:163], a[8:11], v[32:35], v[160:163]
v_mfma_f32_16x16x32_bf16 v[164:167], a[72:75], v[32:35], v[164:167]
v_mfma_f32_16x16x32_bf16 v[168:171], a[136:139], v[32:35], v[168:171]
v_mfma_f32_16x16x32_bf16 v[172:175], a[200:203], v[32:35], v[172:175]
s_add_u32 m0, s26, 100352
s_add_u32 s24, s24, 1024
buffer_load_dwordx4 v4, s[8:11], s24 offen lds
v_mfma_f32_16x16x32_bf16 v[176:179], a[8:11], v[36:39], v[176:179]
v_mfma_f32_16x16x32_bf16 v[180:183], a[72:75], v[36:39], v[180:183]
v_mfma_f32_16x16x32_bf16 v[184:187], a[136:139], v[36:39], v[184:187]
v_mfma_f32_16x16x32_bf16 v[188:191], a[200:203], v[36:39], v[188:191]
ds_read_b128 v[32:35], v5 offset:43008
ds_read_b128 v[36:39], v5 offset:44032
s_waitcnt lgkmcnt(4)
v_mfma_f32_16x16x32_bf16 v[160:163], a[12:15], v[16:19], v[160:163]
v_mfma_f32_16x16x32_bf16 v[164:167], a[76:79], v[16:19], v[164:167]
v_mfma_f32_16x16x32_bf16 v[168:171], a[140:143], v[16:19], v[168:171]
v_mfma_f32_16x16x32_bf16 v[172:175], a[204:207], v[16:19], v[172:175]
s_add_u32 m0, s26, 101376
s_add_u32 s24, s24, 1024
buffer_load_dwordx4 v4, s[8:11], s24 offen lds
v_mfma_f32_16x16x32_bf16 v[176:179], a[12:15], v[20:23], v[176:179]
v_mfma_f32_16x16x32_bf16 v[180:183], a[76:79], v[20:23], v[180:183]
v_mfma_f32_16x16x32_bf16 v[184:187], a[140:143], v[20:23], v[184:187]
v_mfma_f32_16x16x32_bf16 v[188:191], a[204:207], v[20:23], v[188:191]
ds_read_b128 v[16:19], v5 offset:45056
ds_read_b128 v[20:23], v5 offset:46080
s_waitcnt lgkmcnt(4)
v_mfma_f32_16x16x32_bf16 v[160:163], a[16:19], v[24:27], v[160:163]
v_mfma_f32_16x16x32_bf16 v[164:167], a[80:83], v[24:27], v[164:167]
v_mfma_f32_16x16x32_bf16 v[168:171], a[144:147], v[24:27], v[168:171]
v_mfma_f32_16x16x32_bf16 v[172:175], a[208:211], v[24:27], v[172:175]
s_add_u32 m0, s26, 102400
s_add_u32 s24, s24, 1024
buffer_load_dwordx4 v4, s[8:11], s24 offen lds
v_mfma_f32_16x16x32_bf16 v[176:179], a[16:19], v[28:31], v[176:179]
v_mfma_f32_16x16x32_bf16 v[180:183], a[80:83], v[28:31], v[180:183]
v_mfma_f32_16x16x32_bf16 v[184:187], a[144:147], v[28:31], v[184:187]
v_mfma_f32_16x16x32_bf16 v[188:191], a[208:211], v[28:31], v[188:191]
ds_read_b128 v[24:27], v5 offset:47104
ds_read_b128 v[28:31], v5 offset:48128
s_waitcnt lgkmcnt(4)
v_mfma_f32_16x16x32_bf16 v[160:163], a[20:23], v[32:35], v[160:163]
v_mfma_f32_16x16x32_bf16 v[164:167], a[84:87], v[32:35], v[164:167]
v_mfma_f32_16x16x32_bf16 v[168:171], a[148:151], v[32:35], v[168:171]
v_mfma_f32_16x16x32_bf16 v[172:175], a[212:215], v[32:35], v[172:175]
s_add_u32 m0, s26, 103424
s_add_u32 s24, s24, 1024
buffer_load_dwordx4 v4, s[8:11], s24 offen lds
v_mfma_f32_16x16x32_bf16 v[176:179], a[20:23], v[36:39], v[176:179]
v_mfma_f32_16x16x32_bf16 v[180:183], a[84:87], v[36:39], v[180:183]
v_mfma_f32_16x16x32_bf16 v[184:187], a[148:151], v[36:39], v[184:187]
v_mfma_f32_16x16x32_bf16 v[188:191], a[212:215], v[36:39], v[188:191]
ds_read_b128 v[32:35], v5 offset:49152
ds_read_b128 v[36:39], v5 offset:50176
s_waitcnt lgkmcnt(4)
v_mfma_f32_16x16x32_bf16 v[160:163], a[24:27], v[16:19], v[160:163]
v_mfma_f32_16x16x32_bf16 v[164:167], a[88:91], v[16:19], v[164:167]
v_mfma_f32_16x16x32_bf16 v[168:171], a[152:155], v[16:19], v[168:171]
v_mfma_f32_16x16x32_bf16 v[172:175], a[216:219], v[16:19], v[172:175]
s_add_u32 m0, s26, 104448
s_add_u32 s24, s24, 1024
buffer_load_dwordx4 v4, s[8:11], s24 offen lds
v_mfma_f32_16x16x32_bf16 v[176:179], a[24:27], v[20:23], v[176:179]
v_mfma_f32_16x16x32_bf16 v[180:183], a[88:91], v[20:23], v[180:183]
v_mfma_f32_16x16x32_bf16 v[184:187], a[152:155], v[20:23], v[184:187]
v_mfma_f32_16x16x32_bf16 v[188:191], a[216:219], v[20:23], v[188:191]
ds_read_b128 v[16:19], v5 offset:51200
ds_read_b128 v[20:23], v5 offset:52224
s_waitcnt lgkmcnt(4)
v_mfma_f32_16x16x32_bf16 v[160:163], a[28:31], v[24:27], v[160:163]
v_mfma_f32_16x16x32_bf16 v[164:167], a[92:95], v[24:27], v[164:167]
v_mfma_f32_16x16x32_bf16 v[168:171], a[156:159], v[24:27], v[168:171]
v_mfma_f32_16x16x32_bf16 v[172:175], a[220:223], v[24:27], v[172:175]
s_add_u32 m0, s26, 105472
s_add_u32 s24, s24, 1024
buffer_load_dwordx4 v4, s[8:11], s24 offen lds
v_mfma_f32_16x16x32_bf16 v[176:179], a[28:31], v[28:31], v[176:179]
v_mfma_f32_16x16x32_bf16 v[180:183], a[92:95], v[28:31], v[180:183]
v_mfma_f32_16x16x32_bf16 v[184:187], a[156:159], v[28:31], v[184:187]
v_mfma_f32_16x16x32_bf16 v[188:191], a[220:223], v[28:31], v[188:191]
ds_read_b128 v[24:27], v5 offset:53248
ds_read_b128 v[28:31], v5 offset:54272
s_waitcnt lgkmcnt(4)
v_mfma_f32_16x16x32_bf16 v[160:163], a[32:35], v[32:35], v[160:163]
v_max_f32 v128, 0, v128
v_max_f32 v129, 0, v129
v_mfma_f32_16x16x32_bf16 v[164:167], a[96:99], v[32:35], v[164:167]
v_mul_f32 v128, v128, v128
v_mul_f32 v129, v129, v129
v_mfma_f32_16x16x32_bf16 v[168:171], a[160:163], v[32:35], v[168:171]
v_cvt_pk_bf16_f32 v48, v128, v129
v_mfma_f32_16x16x32_bf16 v[172:175], a[224:227], v[32:35], v[172:175]
v_max_f32 v130, 0, v130
v_max_f32 v131, 0, v131
v_mfma_f32_16x16x32_bf16 v[176:179], a[32:35], v[36:39], v[176:179]
v_mul_f32 v130, v130, v130
v_mul_f32 v131, v131, v131
v_mfma_f32_16x16x32_bf16 v[180:183], a[96:99], v[36:39], v[180:183]
v_cvt_pk_bf16_f32 v49, v130, v131
v_mfma_f32_16x16x32_bf16 v[184:187], a[160:163], v[36:39], v[184:187]
v_max_f32 v132, 0, v132
v_max_f32 v133, 0, v133
v_mfma_f32_16x16x32_bf16 v[188:191], a[224:227], v[36:39], v[188:191]
v_mul_f32 v132, v132, v132
v_mul_f32 v133, v133, v133
ds_read_b128 v[32:35], v5 offset:55296
ds_read_b128 v[36:39], v5 offset:56320
s_waitcnt lgkmcnt(4)
v_mfma_f32_16x16x32_bf16 v[160:163], a[36:39], v[16:19], v[160:163]
v_cvt_pk_bf16_f32 v50, v132, v133
v_mfma_f32_16x16x32_bf16 v[164:167], a[100:103], v[16:19], v[164:167]
v_max_f32 v134, 0, v134
v_max_f32 v135, 0, v135
v_mfma_f32_16x16x32_bf16 v[168:171], a[164:167], v[16:19], v[168:171]
v_mul_f32 v134, v134, v134
v_mul_f32 v135, v135, v135
v_mfma_f32_16x16x32_bf16 v[172:175], a[228:231], v[16:19], v[172:175]
v_cvt_pk_bf16_f32 v51, v134, v135
v_mfma_f32_16x16x32_bf16 v[176:179], a[36:39], v[20:23], v[176:179]
s_add_u32 s32, s22, 0
buffer_store_dwordx4 v[48:51], v4, s[8:11], s32 offen sc1
v_mfma_f32_16x16x32_bf16 v[180:183], a[100:103], v[20:23], v[180:183]
v_max_f32 v136, 0, v136
v_max_f32 v137, 0, v137
v_mfma_f32_16x16x32_bf16 v[184:187], a[164:167], v[20:23], v[184:187]
v_mul_f32 v136, v136, v136
v_mul_f32 v137, v137, v137
v_mfma_f32_16x16x32_bf16 v[188:191], a[228:231], v[20:23], v[188:191]
v_cvt_pk_bf16_f32 v52, v136, v137
ds_read_b128 v[16:19], v5 offset:57344
ds_read_b128 v[20:23], v5 offset:58368
s_waitcnt lgkmcnt(4)
v_mfma_f32_16x16x32_bf16 v[160:163], a[40:43], v[24:27], v[160:163]
v_max_f32 v138, 0, v138
v_max_f32 v139, 0, v139
v_mfma_f32_16x16x32_bf16 v[164:167], a[104:107], v[24:27], v[164:167]
v_mul_f32 v138, v138, v138
v_mul_f32 v139, v139, v139
v_mfma_f32_16x16x32_bf16 v[168:171], a[168:171], v[24:27], v[168:171]
v_cvt_pk_bf16_f32 v53, v138, v139
v_mfma_f32_16x16x32_bf16 v[172:175], a[232:235], v[24:27], v[172:175]
v_max_f32 v140, 0, v140
v_max_f32 v141, 0, v141
v_mfma_f32_16x16x32_bf16 v[176:179], a[40:43], v[28:31], v[176:179]
v_mul_f32 v140, v140, v140
v_mul_f32 v141, v141, v141
v_mfma_f32_16x16x32_bf16 v[180:183], a[104:107], v[28:31], v[180:183]
v_cvt_pk_bf16_f32 v54, v140, v141
v_mfma_f32_16x16x32_bf16 v[184:187], a[168:171], v[28:31], v[184:187]
v_max_f32 v142, 0, v142
v_max_f32 v143, 0, v143
v_mfma_f32_16x16x32_bf16 v[188:191], a[232:235], v[28:31], v[188:191]
v_mul_f32 v142, v142, v142
v_mul_f32 v143, v143, v143
ds_read_b128 v[24:27], v5 offset:59392
ds_read_b128 v[28:31], v5 offset:60416
s_waitcnt lgkmcnt(4)
v_mfma_f32_16x16x32_bf16 v[160:163], a[44:47], v[32:35], v[160:163]
v_cvt_pk_bf16_f32 v55, v142, v143
v_mfma_f32_16x16x32_bf16 v[164:167], a[108:111], v[32:35], v[164:167]
s_add_u32 s32, s22, 1024
buffer_store_dwordx4 v[52:55], v4, s[8:11], s32 offen sc1
v_mfma_f32_16x16x32_bf16 v[168:171], a[172:175], v[32:35], v[168:171]
v_max_f32 v144, 0, v144
v_max_f32 v145, 0, v145
v_mfma_f32_16x16x32_bf16 v[172:175], a[236:239], v[32:35], v[172:175]
v_mul_f32 v144, v144, v144
v_mul_f32 v145, v145, v145
v_mfma_f32_16x16x32_bf16 v[176:179], a[44:47], v[36:39], v[176:179]
v_cvt_pk_bf16_f32 v56, v144, v145
v_mfma_f32_16x16x32_bf16 v[180:183], a[108:111], v[36:39], v[180:183]
v_max_f32 v146, 0, v146
v_max_f32 v147, 0, v147
v_mfma_f32_16x16x32_bf16 v[184:187], a[172:175], v[36:39], v[184:187]
v_mul_f32 v146, v146, v146
v_mul_f32 v147, v147, v147
v_mfma_f32_16x16x32_bf16 v[188:191], a[236:239], v[36:39], v[188:191]
v_cvt_pk_bf16_f32 v57, v146, v147
ds_read_b128 v[32:35], v5 offset:61440
ds_read_b128 v[36:39], v5 offset:62464
s_waitcnt lgkmcnt(4)
v_mfma_f32_16x16x32_bf16 v[160:163], a[48:51], v[16:19], v[160:163]
v_max_f32 v148, 0, v148
v_max_f32 v149, 0, v149
v_mfma_f32_16x16x32_bf16 v[164:167], a[112:115], v[16:19], v[164:167]
v_mul_f32 v148, v148, v148
v_mul_f32 v149, v149, v149
v_mfma_f32_16x16x32_bf16 v[168:171], a[176:179], v[16:19], v[168:171]
v_cvt_pk_bf16_f32 v58, v148, v149
v_mfma_f32_16x16x32_bf16 v[172:175], a[240:243], v[16:19], v[172:175]
v_max_f32 v150, 0, v150
v_max_f32 v151, 0, v151
v_mfma_f32_16x16x32_bf16 v[176:179], a[48:51], v[20:23], v[176:179]
v_mul_f32 v150, v150, v150
v_mul_f32 v151, v151, v151
v_mfma_f32_16x16x32_bf16 v[180:183], a[112:115], v[20:23], v[180:183]
v_cvt_pk_bf16_f32 v59, v150, v151
v_mfma_f32_16x16x32_bf16 v[184:187], a[176:179], v[20:23], v[184:187]
s_add_u32 s32, s22, 57344
buffer_store_dwordx4 v[56:59], v4, s[8:11], s32 offen sc1
v_mfma_f32_16x16x32_bf16 v[188:191], a[240:243], v[20:23], v[188:191]
v_max_f32 v152, 0, v152
v_max_f32 v153, 0, v153
ds_read_b128 v[16:19], v5 offset:63488
ds_read_b128 v[20:23], v5 offset:64512
s_waitcnt lgkmcnt(4)
v_mfma_f32_16x16x32_bf16 v[160:163], a[52:55], v[24:27], v[160:163]
v_mul_f32 v152, v152, v152
v_mul_f32 v153, v153, v153
v_mfma_f32_16x16x32_bf16 v[164:167], a[116:119], v[24:27], v[164:167]
v_cvt_pk_bf16_f32 v60, v152, v153
v_mfma_f32_16x16x32_bf16 v[168:171], a[180:183], v[24:27], v[168:171]
v_max_f32 v154, 0, v154
v_max_f32 v155, 0, v155
v_mfma_f32_16x16x32_bf16 v[172:175], a[244:247], v[24:27], v[172:175]
v_mul_f32 v154, v154, v154
v_mul_f32 v155, v155, v155
v_mfma_f32_16x16x32_bf16 v[176:179], a[52:55], v[28:31], v[176:179]
v_cvt_pk_bf16_f32 v61, v154, v155
v_mfma_f32_16x16x32_bf16 v[180:183], a[116:119], v[28:31], v[180:183]
v_max_f32 v156, 0, v156
v_max_f32 v157, 0, v157
v_mfma_f32_16x16x32_bf16 v[184:187], a[180:183], v[28:31], v[184:187]
v_mul_f32 v156, v156, v156
v_mul_f32 v157, v157, v157
v_mfma_f32_16x16x32_bf16 v[188:191], a[244:247], v[28:31], v[188:191]
v_cvt_pk_bf16_f32 v62, v156, v157
s_waitcnt lgkmcnt(2)
v_mfma_f32_16x16x32_bf16 v[160:163], a[56:59], v[32:35], v[160:163]
v_max_f32 v158, 0, v158
v_max_f32 v159, 0, v159
v_mfma_f32_16x16x32_bf16 v[164:167], a[120:123], v[32:35], v[164:167]
v_mul_f32 v158, v158, v158
v_mul_f32 v159, v159, v159
v_mfma_f32_16x16x32_bf16 v[168:171], a[184:187], v[32:35], v[168:171]
v_cvt_pk_bf16_f32 v63, v158, v159
v_mfma_f32_16x16x32_bf16 v[172:175], a[248:251], v[32:35], v[172:175]
s_add_u32 s32, s22, 58368
buffer_store_dwordx4 v[60:63], v4, s[8:11], s32 offen sc1
v_mfma_f32_16x16x32_bf16 v[176:179], a[56:59], v[36:39], v[176:179]
s_add_u32 s22, s22, 458752
v_mfma_f32_16x16x32_bf16 v[180:183], a[120:123], v[36:39], v[180:183]
v_mfma_f32_16x16x32_bf16 v[184:187], a[184:187], v[36:39], v[184:187]
v_mfma_f32_16x16x32_bf16 v[188:191], a[248:251], v[36:39], v[188:191]
s_waitcnt lgkmcnt(0)
v_mfma_f32_16x16x32_bf16 v[160:163], a[60:63], v[16:19], v[160:163]
v_mfma_f32_16x16x32_bf16 v[164:167], a[124:127], v[16:19], v[164:167]
v_mfma_f32_16x16x32_bf16 v[168:171], a[188:191], v[16:19], v[168:171]
v_mfma_f32_16x16x32_bf16 v[172:175], a[252:255], v[16:19], v[172:175]
v_mfma_f32_16x16x32_bf16 v[176:179], a[60:63], v[20:23], v[176:179]
v_mfma_f32_16x16x32_bf16 v[180:183], a[124:127], v[20:23], v[180:183]
v_mfma_f32_16x16x32_bf16 v[184:187], a[188:191], v[20:23], v[184:187]
v_mfma_f32_16x16x32_bf16 v[188:191], a[252:255], v[20:23], v[188:191]
s_add_u32 s23, s23, 1
s_cmp_lt_u32 s23, s47
s_cbranch_scc1 G1_LOOP_H
G1_END_H:
s_nop 7
v_max_f32 v160, 0, v160
v_max_f32 v161, 0, v161
v_mul_f32 v160, v160, v160
v_mul_f32 v161, v161, v161
v_cvt_pk_bf16_f32 v48, v160, v161
v_max_f32 v162, 0, v162
v_max_f32 v163, 0, v163
v_mul_f32 v162, v162, v162
v_mul_f32 v163, v163, v163
v_cvt_pk_bf16_f32 v49, v162, v163
v_max_f32 v164, 0, v164
v_max_f32 v165, 0, v165
v_mul_f32 v164, v164, v164
v_mul_f32 v165, v165, v165
v_cvt_pk_bf16_f32 v50, v164, v165
v_max_f32 v166, 0, v166
v_max_f32 v167, 0, v167
v_mul_f32 v166, v166, v166
v_mul_f32 v167, v167, v167
v_cvt_pk_bf16_f32 v51, v166, v167
s_add_u32 s32, s22, 0
buffer_store_dwordx4 v[48:51], v4, s[8:11], s32 offen sc1
v_max_f32 v168, 0, v168
v_max_f32 v169, 0, v169
v_mul_f32 v168, v168, v168
v_mul_f32 v169, v169, v169
v_cvt_pk_bf16_f32 v52, v168, v169
v_max_f32 v170, 0, v170
v_max_f32 v171, 0, v171
v_mul_f32 v170, v170, v170
v_mul_f32 v171, v171, v171
v_cvt_pk_bf16_f32 v53, v170, v171
v_max_f32 v172, 0, v172
v_max_f32 v173, 0, v173
v_mul_f32 v172, v172, v172
v_mul_f32 v173, v173, v173
v_cvt_pk_bf16_f32 v54, v172, v173
v_max_f32 v174, 0, v174
v_max_f32 v175, 0, v175
v_mul_f32 v174, v174, v174
v_mul_f32 v175, v175, v175
v_cvt_pk_bf16_f32 v55, v174, v175
s_add_u32 s32, s22, 1024
buffer_store_dwordx4 v[52:55], v4, s[8:11], s32 offen sc1
v_max_f32 v176, 0, v176
v_max_f32 v177, 0, v177
v_mul_f32 v176, v176, v176
v_mul_f32 v177, v177, v177
v_cvt_pk_bf16_f32 v56, v176, v177
v_max_f32 v178, 0, v178
v_max_f32 v179, 0, v179
v_mul_f32 v178, v178, v178
v_mul_f32 v179, v179, v179
v_cvt_pk_bf16_f32 v57, v178, v179
v_max_f32 v180, 0, v180
v_max_f32 v181, 0, v181
v_mul_f32 v180, v180, v180
v_mul_f32 v181, v181, v181
v_cvt_pk_bf16_f32 v58, v180, v181
v_max_f32 v182, 0, v182
v_max_f32 v183, 0, v183
v_mul_f32 v182, v182, v182
v_mul_f32 v183, v183, v183
v_cvt_pk_bf16_f32 v59, v182, v183
s_add_u32 s32, s22, 57344
buffer_store_dwordx4 v[56:59], v4, s[8:11], s32 offen sc1
v_max_f32 v184, 0, v184
v_max_f32 v185, 0, v185
v_mul_f32 v184, v184, v184
v_mul_f32 v185, v185, v185
v_cvt_pk_bf16_f32 v60, v184, v185
v_max_f32 v186, 0, v186
v_max_f32 v187, 0, v187
v_mul_f32 v186, v186, v186
v_mul_f32 v187, v187, v187
v_cvt_pk_bf16_f32 v61, v186, v187
v_max_f32 v188, 0, v188
v_max_f32 v189, 0, v189
v_mul_f32 v188, v188, v188
v_mul_f32 v189, v189, v189
v_cvt_pk_bf16_f32 v62, v188, v189
v_max_f32 v190, 0, v190
v_max_f32 v191, 0, v191
v_mul_f32 v190, v190, v190
v_mul_f32 v191, v191, v191
v_cvt_pk_bf16_f32 v63, v190, v191
s_add_u32 s32, s22, 58368
buffer_store_dwordx4 v[60:63], v4, s[8:11], s32 offen sc1
s_add_u32 s22, s22, 458752
s_waitcnt vmcnt(0)
s_barrier
s_cmp_lg_u32 s17, 0
s_cbranch_scc1 G1F_50
v_mov_b32 v8, 16
s_mov_b64 exec, 1
buffer_store_dword v8, off, s[8:11], s25 sc1
s_mov_b64 exec, -1
G1F_50:
s_branch G1_DONE
G1_IDLE:
v_mov_b32 v2, 4
buffer_load_dword v251, v2, s[4:7], 0 offen sc1
s_waitcnt vmcnt(0)
s_cmp_eq_u32 s31, 0
s_cbranch_scc1 LNREP_51
v_readfirstlane_b32 s33, v251
s_nop 3
s_cmp_ge_u32 s33, 32
s_cselect_b32 s84, 1, s84
s_cmp_lg_u32 s84, 0
s_cbranch_scc1 INIT_52
v_mov_b32 v2, 4
s_mov_b32 s35, 0
POLL_INIT_53:
s_cmp_lg_u32 s37, 0
s_cbranch_scc1 POLL_INIT_53_E
buffer_load_dword v3, v2, s[4:7], 0 offen sc1
s_add_u32 s35, s35, 1
s_cmp_gt_u32 s35, 65536
s_cselect_b32 s37, 1, 0
s_waitcnt vmcnt(0)
v_cmp_gt_u32 vcc, 32, v3
s_cbranch_vccz POLL_INIT_53_E
s_sleep 4
s_branch POLL_INIT_53
POLL_INIT_53_E:
s_mov_b32 s84, 1
INIT_52:
s_lshl_b32 s33, s26, 7
s_add_u32 s33, s33, 91340800
v_mov_b32 v2, 1
s_mov_b64 exec, 1
buffer_store_dword v2, off, s[8:11], s33 sc1
s_mov_b64 exec, -1
LNREP_51:
s_cmp_eq_u32 s82, 0
s_cbranch_scc1 VERD_54
s_mov_b32 s82, 0
v_readfirstlane_b32 s33, v250
s_nop 3
s_lshr_b32 s33, s33, s83
s_and_b32 s33, s33, 1
v_mov_b32 v22, 163824
s_cmp_lg_u32 s17, 0
s_cbranch_scc1 BC_55
v_mov_b32 v20, s33
ds_write_b32 v22, v20
s_waitcnt lgkmcnt(0)
BC_55:
s_barrier
ds_read_b32 v20, v22
s_waitcnt lgkmcnt(0)
v_readfirstlane_b32 s33, v20
s_barrier
s_cmp_lg_u32 s33, 0
s_cbranch_scc1 L_WLOST
VERD_54:
G1_DONE:
s_cmp_lg_u32 s84, 0
s_cbranch_scc1 INIT_56
v_mov_b32 v2, 4
s_mov_b32 s35, 0
POLL_INIT_57:
s_cmp_lg_u32 s37, 0
s_cbranch_scc1 POLL_INIT_57_E
buffer_load_dword v3, v2, s[4:7], 0 offen sc1
s_add_u32 s35, s35, 1
s_cmp_gt_u32 s35, 65536
s_cselect_b32 s37, 1, 0
s_waitcnt vmcnt(0)
v_cmp_gt_u32 vcc, 32, v3
s_cbranch_vccz POLL_INIT_57_E
s_sleep 4
s_branch POLL_INIT_57
POLL_INIT_57_E:
s_mov_b32 s84, 1
INIT_56:
s_cmp_ge_u32 s16, 192
s_cbranch_scc1 L_FIN
s_cmp_lt_u32 s16, 160
s_cbranch_scc1 L_G2
s_sub_u32 s16, s16, 160
s_mov_b32 s30, 0x3e0293ee
s_mov_b32 s31, 0x3e0293ee
v_lshlrev_b32 v4, 4, v0
v_and_b32 v5, 0x3d, v0
v_lshlrev_b32 v5, 4, v5
v_bfe_u32 v6, v0, 1, 1
v_lshl_add_u32 v5, v6, 3, v5
v_and_b32 v6, 15, v0
v_lshrrev_b32 v7, 4, v0
v_lshlrev_b32 v7, 2, v7
v_add_u32 v8, 0, v7
v_cmp_le_u32 s[40:41], v8, v6
v_add_u32 v8, 1, v7
v_cmp_le_u32 s[42:43], v8, v6
v_add_u32 v8, 2, v7
v_cmp_le_u32 s[44:45], v8, v6
v_add_u32 v8, 3, v7
v_cmp_le_u32 s[46:47], v8, v6
s_lshr_b32 s32, s16, 1
s_lshl_b32 s33, s32, 1
s_and_b32 s34, s17, 1
s_add_u32 s33, s33, s34
s_add_u32 s33, s33, 128
s_lshl_b32 s32, s32, 2
s_add_u32 s32, s32, s17
v_and_b32 v8, 1, v0
v_lshl_add_u32 v8, v8, 6, s32
v_mov_b32 v9, s33
v_cmp_gt_u32 vcc, 2, v0
s_mov_b32 s32, 91291648
s_nop 0
v_cndmask_b32 v8, v9, v8, vcc
v_lshlrev_b32 v8, 7, v8
s_mov_b32 s21, 0
v_mov_b32 v252, v8
s_mov_b32 s18, s17
s_lshl_b32 s32, s17, 5
s_add_u32 s32, s32, s16
s_lshl_b32 s19, s32, 13
s_lshl_b32 s20, s32, 12
s_add_u32 s20, s20, 52428800
s_lshl_b32 s22, s17, 18
s_lshl_b32 s33, s16, 12
s_add_u32 s22, s22, s33
s_add_u32 s22, s22, 65011712
s_lshl_b32 s23, s16, 7
s_add_u32 s23, s23, 91320320
s_lshl_b32 s24, s32, 7
s_add_u32 s24, s24, 91324416
s_mov_b32 s25, 0
v_mov_b32 v10, 0
v_mov_b32 v136, 0x3f803f80
v_mov_b32 v137, 0x3f803f80
v_mov_b32 v138, 0x3f803f80
v_mov_b32 v139, 0x3f803f80
v_mov_b32 v173, 0
v_mov_b32 v174, 0
v_mov_b32 v177, 0
v_mov_b32 v178, 0
v_mov_b32 v48, -1
v_mov_b32 v49, -1
v_mov_b32 v50, -1
v_mov_b32 v51, -1
s_add_u32 s32, s22, 15728640
buffer_store_dwordx4 v[48:51], v4, s[8:11], s32 offen offset:0 sc1
buffer_store_dwordx4 v[48:51], v4, s[8:11], s32 offen offset:1024 sc1
buffer_store_dwordx4 v[48:51], v4, s[8:11], s32 offen offset:2048 sc1
buffer_store_dwordx4 v[48:51], v4, s[8:11], s32 offen offset:3072 sc1
s_add_u32 s32, s22, 15859712
buffer_store_dwordx4 v[48:51], v4, s[8:11], s32 offen offset:0 sc1
buffer_store_dwordx4 v[48:51], v4, s[8:11], s32 offen offset:1024 sc1
buffer_store_dwordx4 v[48:51], v4, s[8:11], s32 offen offset:2048 sc1
buffer_store_dwordx4 v[48:51], v4, s[8:11], s32 offen offset:3072 sc1
s_nop 1
AT_LOOP:
s_lshr_b32 s33, s18, 2
s_add_u32 s33, s33, 1
s_cmp_ge_u32 s21, s33
s_cbranch_scc1 AT_IN
s_mov_b32 s32, 91291648
s_mov_b32 s35, 0
POLL_QKV_58:
s_cmp_lg_u32 s37, 0
s_cbranch_scc1 POLL_QKV_58_E
buffer_load_dword v9, v252, s[8:11], s32 offen sc1
s_add_u32 s35, s35, 1
s_cmp_gt_u32 s35, 65536
s_cselect_b32 s37, 1, 0
s_waitcnt vmcnt(0)
v_cmp_gt_u32 vcc, s33, v9
s_cbranch_vccz POLL_QKV_58_E
s_sleep 4
s_branch POLL_QKV_58
POLL_QKV_58_E:
v_cmp_gt_u32 vcc, 16, v9
s_nop 1
s_cmp_eq_u64 vcc, 0
s_cselect_b32 s21, 16, 0
AT_IN:
s_add_u32 s32, s19, 18874368
buffer_load_dwordx4 v[48:51], v4, s[8:11], s32 offen offset:0 sc1
buffer_load_dwordx4 v[52:55], v4, s[8:11], s32 offen offset:1024 sc1
buffer_load_dwordx4 v[56:59], v4, s[8:11], s32 offen offset:2048 sc1
buffer_load_dwordx4 v[60:63], v4, s[8:11], s32 offen offset:3072 sc1
s_add_u32 s32, s19, 18878464
buffer_load_dwordx4 v[64:67], v4, s[8:11], s32 offen offset:0 sc1
buffer_load_dwordx4 v[68:71], v4, s[8:11], s32 offen offset:1024 sc1
buffer_load_dwordx4 v[72:75], v4, s[8:11], s32 offen offset:2048 sc1
buffer_load_dwordx4 v[76:79], v4, s[8:11], s32 offen offset:3072 sc1
s_add_u32 s32, s19, 2097152
buffer_load_dwordx4 v[16:19], v4, s[8:11], s32 offen offset:0 sc1
buffer_load_dwordx4 v[20:23], v4, s[8:11], s32 offen offset:1024 sc1
buffer_load_dwordx4 v[24:27], v4, s[8:11], s32 offen offset:2048 sc1
buffer_load_dwordx4 v[28:31], v4, s[8:11], s32 offen offset:3072 sc1
s_add_u32 s32, s19, 2101248
buffer_load_dwordx4 v[32:35], v4, s[8:11], s32 offen offset:0 sc1
buffer_load_dwordx4 v[36:39], v4, s[8:11], s32 offen offset:1024 sc1
buffer_load_dwordx4 v[40:43], v4, s[8:11], s32 offen offset:2048 sc1
buffer_load_dwordx4 v[44:47], v4, s[8:11], s32 offen offset:3072 sc1
s_add_u32 s32, s19, 35651584
buffer_load_dwordx4 v[80:83], v4, s[8:11], s32 offen offset:0 sc1
buffer_load_dwordx4 v[84:87], v4, s[8:11], s32 offen offset:1024 sc1
buffer_load_dwordx4 v[88:91], v4, s[8:11], s32 offen offset:2048 sc1
buffer_load_dwordx4 v[92:95], v4, s[8:11], s32 offen offset:3072 sc1
s_add_u32 s32, s19, 35655680
buffer_load_dwordx4 v[96:99], v4, s[8:11], s32 offen offset:0 sc1
buffer_load_dwordx4 v[100:103], v4, s[8:11], s32 offen offset:1024 sc1
buffer_load_dwordx4 v[104:107], v4, s[8:11], s32 offen offset:2048 sc1
buffer_load_dwordx4 v[108:111], v4, s[8:11], s32 offen offset:3072 sc1
s_waitcnt vmcnt(8)
v_mfma_f32_16x16x32_bf16 v[140:143], v[48:51], v[16:19], 0
v_mfma_f32_16x16x32_bf16 v[140:143], v[52:55], v[20:23], v[140:143]
v_mfma_f32_16x16x32_bf16 v[140:143], v[56:59], v[24:27], v[140:143]
v_mfma_f32_16x16x32_bf16 v[140:143], v[60:63], v[28:31], v[140:143]
v_mfma_f32_16x16x32_bf16 v[152:155], v[48:51], v[32:35], 0
v_mfma_f32_16x16x32_bf16 v[152:155], v[52:55], v[36:39], v[152:155]
v_mfma_f32_16x16x32_bf16 v[152:155], v[56:59], v[40:43], v[152:155]
v_mfma_f32_16x16x32_bf16 v[152:155], v[60:63], v[44:47], v[152:155]
v_mfma_f32_16x16x32_bf16 v[156:159], v[64:67], v[32:35], 0
v_mfma_f32_16x16x32_bf16 v[156:159], v[68:71], v[36:39], v[156:159]
v_mfma_f32_16x16x32_bf16 v[156:159], v[72:75], v[40:43], v[156:159]
v_mfma_f32_16x16x32_bf16 v[156:159], v[76:79], v[44:47], v[156:159]
s_add_u32 s33, s18, 1
s_min_u32 s33, s33, 61
s_mov_b32 s35, 0
POLL_CH_59:
s_cmp_lg_u32 s37, 0
s_cbranch_scc1 POLL_CH_59_E
buffer_load_dword v9, v10, s[8:11], s23 offen sc1
s_add_u32 s35, s35, 1
s_cmp_gt_u32 s35, 65536
s_cselect_b32 s37, 1, 0
s_waitcnt vmcnt(0)
v_cmp_gt_u32 vcc, s33, v9
s_cbranch_vccz POLL_CH_59_E
s_sleep 1
s_branch POLL_CH_59
POLL_CH_59_E:
buffer_load_dwordx4 v[112:115], v4, s[8:11], s20 offen offset:0 sc1
buffer_load_dwordx4 v[116:119], v4, s[8:11], s20 offen offset:1024 sc1
buffer_load_dwordx4 v[120:123], v4, s[8:11], s20 offen offset:2048 sc1
buffer_load_dwordx4 v[124:127], v4, s[8:11], s20 offen offset:3072 sc1
buffer_load_dwordx2 v[128:129], v5, s[8:11], s20 offen offset:0 sc1
buffer_load_dwordx2 v[130:131], v5, s[8:11], s20 offen offset:1024 sc1
buffer_load_dwordx2 v[132:133], v5, s[8:11], s20 offen offset:2048 sc1
buffer_load_dwordx2 v[134:135], v5, s[8:11], s20 offen offset:3072 sc1
v_mov_b32 v11, 0xff800000
v_cndmask_b32 v140, v11, v140, s[40:41]
v_cndmask_b32 v141, v11, v141, s[42:43]
v_cndmask_b32 v142, v11, v142, s[44:45]
v_cndmask_b32 v143, v11, v143, s[46:47]
v_cndmask_b32 v156, v11, v156, s[40:41]
v_cndmask_b32 v157, v11, v157, s[42:43]
v_cndmask_b32 v158, v11, v158, s[44:45]
v_cndmask_b32 v159, v11, v159, s[46:47]
v_max3_f32 v12, v140, v141, v142
v_max_f32 v12, v12, v143
v_max3_f32 v14, v152, v153, v154
v_max3_f32 v14, v14, v155, v156
v_max3_f32 v14, v14, v157, v158
v_max_f32 v14, v14, v159
s_cmp_lt_u32 s18, 60
s_cbranch_scc1 AT_KMOK
s_mov_b32 s35, 0
AT_KMCHK:
s_waitcnt vmcnt(0)
v_max3_u32 v13, v112, v113, v114
v_max3_u32 v15, v115, v116, v117
v_max3_u32 v13, v13, v118, v119
v_max3_u32 v15, v15, v120, v121
v_max3_u32 v13, v13, v122, v123
v_max3_u32 v15, v15, v124, v125
v_max3_u32 v13, v13, v126, v127
v_max3_u32 v15, v15, v128, v129
v_max3_u32 v13, v13, v130, v131
v_max3_u32 v15, v15, v132, v133
v_max3_u32 v13, v13, v134, v135
v_max_u32 v13, v13, v15
v_cmp_eq_u32 vcc, -1, v13
s_cbranch_vccz AT_KMOK
s_add_u32 s35, s35, 1
s_cmp_gt_u32 s35, 65536
s_cbranch_scc1 AT_KMOK
buffer_load_dwordx4 v[112:115], v4, s[8:11], s20 offen offset:0 sc1
buffer_load_dwordx4 v[116:119], v4, s[8:11], s20 offen offset:1024 sc1
buffer_load_dwordx4 v[120:123], v4, s[8:11], s20 offen offset:2048 sc1
buffer_load_dwordx4 v[124:127], v4, s[8:11], s20 offen offset:3072 sc1
buffer_load_dwordx2 v[128:129], v5, s[8:11], s20 offen offset:0 sc1
buffer_load_dwordx2 v[130:131], v5, s[8:11], s20 offen offset:1024 sc1
buffer_load_dwordx2 v[132:133], v5, s[8:11], s20 offen offset:2048 sc1
buffer_load_dwordx2 v[134:135], v5, s[8:11], s20 offen offset:3072 sc1
s_branch AT_KMCHK
AT_KMOK:
s_waitcnt vmcnt(4)
v_mfma_f32_16x16x32_bf16 v[148:151], v[112:115], v[16:19], 0
v_mfma_f32_16x16x32_bf16 v[148:151], v[116:119], v[20:23], v[148:151]
v_mfma_f32_16x16x32_bf16 v[148:151], v[120:123], v[24:27], v[148:151]
v_mfma_f32_16x16x32_bf16 v[148:151], v[124:127], v[28:31], v[148:151]
v_mfma_f32_16x16x32_bf16 v[160:163], v[112:115], v[32:35], 0
v_mfma_f32_16x16x32_bf16 v[160:163], v[116:119], v[36:39], v[160:163]
v_mfma_f32_16x16x32_bf16 v[160:163], v[120:123], v[40:43], v[160:163]
v_mfma_f32_16x16x32_bf16 v[160:163], v[124:127], v[44:47], v[160:163]
s_nop 7
v_max3_f32 v12, v12, v150, v151
v_max3_f32 v14, v14, v162, v163
v_mov_b32 v13, v12
v_mov_b32 v15, v14
s_nop 0
v_permlane32_swap_b32 v12, v13
v_permlane32_swap_b32 v14, v15
v_max_f32 v12, v12, v13
v_max_f32 v14, v14, v15
v_mov_b32 v13, v12
v_mov_b32 v15, v14
s_nop 0
v_permlane16_swap_b32 v12, v13
v_permlane16_swap_b32 v14, v15
v_max_f32 v12, v12, v13
v_max_f32 v14, v14, v15
v_mul_f32 v12, s30, v12
v_mul_f32 v14, s30, v14
v_pk_fma_f32 v[150:151], v[150:151], s[30:31], v[12:13] op_sel_hi:[1,1,0] neg_lo:[0,0,1] neg_hi:[0,0,1]
v_pk_fma_f32 v[140:141], v[140:141], s[30:31], v[12:13] op_sel_hi:[1,1,0] neg_lo:[0,0,1] neg_hi:[0,0,1]
v_pk_fma_f32 v[142:143], v[142:143], s[30:31], v[12:13] op_sel_hi:[1,1,0] neg_lo:[0,0,1] neg_hi:[0,0,1]
v_exp_f32 v150, v150
v_exp_f32 v151, v151
v_exp_f32 v140, v140
v_exp_f32 v141, v141
v_exp_f32 v142, v142
v_exp_f32 v143, v143
s_nop 0
v_cvt_pk_bf16_f32 v172, v150, v151
v_cvt_pk_bf16_f32 v175, v150, v151
v_cvt_pk_bf16_f32 v164, v140, v141
v_cvt_pk_bf16_f32 v165, v142, v143
v_pk_fma_f32 v[162:163], v[162:163], s[30:31], v[14:15] op_sel_hi:[1,1,0] neg_lo:[0,0,1] neg_hi:[0,0,1]
v_pk_fma_f32 v[152:153], v[152:153], s[30:31], v[14:15] op_sel_hi:[1,1,0] neg_lo:[0,0,1] neg_hi:[0,0,1]
v_pk_fma_f32 v[154:155], v[154:155], s[30:31], v[14:15] op_sel_hi:[1,1,0] neg_lo:[0,0,1] neg_hi:[0,0,1]
v_pk_fma_f32 v[156:157], v[156:157], s[30:31], v[14:15] op_sel_hi:[1,1,0] neg_lo:[0,0,1] neg_hi:[0,0,1]
v_pk_fma_f32 v[158:159], v[158:159], s[30:31], v[14:15] op_sel_hi:[1,1,0] neg_lo:[0,0,1] neg_hi:[0,0,1]
v_exp_f32 v162, v162
v_exp_f32 v163, v163
v_exp_f32 v152, v152
v_exp_f32 v153, v153
v_exp_f32 v154, v154
v_exp_f32 v155, v155
v_exp_f32 v156, v156
v_exp_f32 v157, v157
v_exp_f32 v158, v158
v_exp_f32 v159, v159
s_nop 0
v_cvt_pk_bf16_f32 v176, v162, v163
v_cvt_pk_bf16_f32 v179, v162, v163
v_cvt_pk_bf16_f32 v168, v152, v153
v_cvt_pk_bf16_f32 v169, v154, v155
v_cvt_pk_bf16_f32 v170, v156, v157
v_cvt_pk_bf16_f32 v171, v158, v159
s_waitcnt vmcnt(0)
s_nop 1
v_mfma_f32_16x16x16_bf16 v[180:183], v[136:137], v[172:173], 0
v_mfma_f32_16x16x16_bf16 v[188:191], v[128:129], v[172:173], 0
v_mfma_f32_16x16x16_bf16 v[192:195], v[128:129], v[174:175], 0
v_mfma_f32_16x16x16_bf16 v[196:199], v[130:131], v[172:173], 0
v_mfma_f32_16x16x16_bf16 v[200:203], v[130:131], v[174:175], 0
v_mfma_f32_16x16x16_bf16 v[204:207], v[132:133], v[172:173], 0
v_mfma_f32_16x16x16_bf16 v[208:211], v[132:133], v[174:175], 0
v_mfma_f32_16x16x16_bf16 v[212:215], v[134:135], v[172:173], 0
v_mfma_f32_16x16x16_bf16 v[216:219], v[134:135], v[174:175], 0
v_mfma_f32_16x16x16_bf16 v[180:183], v[136:137], v[164:165], v[180:183]
v_mfma_f32_16x16x16_bf16 v[188:191], v[80:81], v[164:165], v[188:191]
v_mfma_f32_16x16x16_bf16 v[192:195], v[84:85], v[164:165], v[192:195]
v_mfma_f32_16x16x16_bf16 v[196:199], v[88:89], v[164:165], v[196:199]
v_mfma_f32_16x16x16_bf16 v[200:203], v[92:93], v[164:165], v[200:203]
v_mfma_f32_16x16x16_bf16 v[204:207], v[96:97], v[164:165], v[204:207]
v_mfma_f32_16x16x16_bf16 v[208:211], v[100:101], v[164:165], v[208:211]
v_mfma_f32_16x16x16_bf16 v[212:215], v[104:105], v[164:165], v[212:215]
v_mfma_f32_16x16x16_bf16 v[216:219], v[108:109], v[164:165], v[216:219]
v_mfma_f32_16x16x16_bf16 v[184:187], v[136:137], v[176:177], 0
v_mfma_f32_16x16x16_bf16 v[220:223], v[128:129], v[176:177], 0
v_mfma_f32_16x16x16_bf16 v[224:227], v[128:129], v[178:179], 0
v_mfma_f32_16x16x16_bf16 v[228:231], v[130:131], v[176:177], 0
v_mfma_f32_16x16x16_bf16 v[232:235], v[130:131], v[178:179], 0
v_mfma_f32_16x16x16_bf16 v[236:239], v[132:133], v[176:177], 0
v_mfma_f32_16x16x16_bf16 v[240:243], v[132:133], v[178:179], 0
v_mfma_f32_16x16x16_bf16 v[244:247], v[134:135], v[176:177], 0
v_mfma_f32_16x16x16_bf16 v[248:251], v[134:135], v[178:179], 0
v_mfma_f32_16x16x32_bf16 v[184:187], v[136:139], v[168:171], v[184:187]
v_mfma_f32_16x16x32_bf16 v[220:223], v[80:83], v[168:171], v[220:223]
v_mfma_f32_16x16x32_bf16 v[224:227], v[84:87], v[168:171], v[224:227]
v_mfma_f32_16x16x32_bf16 v[228:231], v[88:91], v[168:171], v[228:231]
v_mfma_f32_16x16x32_bf16 v[232:235], v[92:95], v[168:171], v[232:235]
v_mfma_f32_16x16x32_bf16 v[236:239], v[96:99], v[168:171], v[236:239]
v_mfma_f32_16x16x32_bf16 v[240:243], v[100:103], v[168:171], v[240:243]
v_mfma_f32_16x16x32_bf16 v[244:247], v[104:107], v[168:171], v[244:247]
v_mfma_f32_16x16x32_bf16 v[248:251], v[108:111], v[168:171], v[248:251]
v_rcp_f32 v12, v180
s_nop 0
v_pk_mul_f32 v[188:189], v[188:189], v[12:13] op_sel_hi:[1,0]
v_cvt_pk_bf16_f32 v48, v188, v189
v_pk_mul_f32 v[190:191], v[190:191], v[12:13] op_sel_hi:[1,0]
v_cvt_pk_bf16_f32 v49, v190, v191
v_pk_mul_f32 v[192:193], v[192:193], v[12:13] op_sel_hi:[1,0]
v_cvt_pk_bf16_f32 v50, v192, v193
v_pk_mul_f32 v[194:195], v[194:195], v[12:13] op_sel_hi:[1,0]
v_cvt_pk_bf16_f32 v51, v194, v195
buffer_store_dwordx4 v[48:51], v4, s[8:11], s22 offen offset:0 sc1
v_pk_mul_f32 v[196:197], v[196:197], v[12:13] op_sel_hi:[1,0]
v_cvt_pk_bf16_f32 v52, v196, v197
v_pk_mul_f32 v[198:199], v[198:199], v[12:13] op_sel_hi:[1,0]
v_cvt_pk_bf16_f32 v53, v198, v199
v_pk_mul_f32 v[200:201], v[200:201], v[12:13] op_sel_hi:[1,0]
v_cvt_pk_bf16_f32 v54, v200, v201
v_pk_mul_f32 v[202:203], v[202:203], v[12:13] op_sel_hi:[1,0]
v_cvt_pk_bf16_f32 v55, v202, v203
buffer_store_dwordx4 v[52:55], v4, s[8:11], s22 offen offset:1024 sc1
v_pk_mul_f32 v[204:205], v[204:205], v[12:13] op_sel_hi:[1,0]
v_cvt_pk_bf16_f32 v56, v204, v205
v_pk_mul_f32 v[206:207], v[206:207], v[12:13] op_sel_hi:[1,0]
v_cvt_pk_bf16_f32 v57, v206, v207
v_pk_mul_f32 v[208:209], v[208:209], v[12:13] op_sel_hi:[1,0]
v_cvt_pk_bf16_f32 v58, v208, v209
v_pk_mul_f32 v[210:211], v[210:211], v[12:13] op_sel_hi:[1,0]
v_cvt_pk_bf16_f32 v59, v210, v211
buffer_store_dwordx4 v[56:59], v4, s[8:11], s22 offen offset:2048 sc1
v_pk_mul_f32 v[212:213], v[212:213], v[12:13] op_sel_hi:[1,0]
v_cvt_pk_bf16_f32 v60, v212, v213
v_pk_mul_f32 v[214:215], v[214:215], v[12:13] op_sel_hi:[1,0]
v_cvt_pk_bf16_f32 v61, v214, v215
v_pk_mul_f32 v[216:217], v[216:217], v[12:13] op_sel_hi:[1,0]
v_cvt_pk_bf16_f32 v62, v216, v217
v_pk_mul_f32 v[218:219], v[218:219], v[12:13] op_sel_hi:[1,0]
v_cvt_pk_bf16_f32 v63, v218, v219
buffer_store_dwordx4 v[60:63], v4, s[8:11], s22 offen offset:3072 sc1
s_nop 3
v_rcp_f32 v12, v184
s_add_u32 s32, s22, 131072
v_pk_mul_f32 v[220:221], v[220:221], v[12:13] op_sel_hi:[1,0]
v_cvt_pk_bf16_f32 v64, v220, v221
v_pk_mul_f32 v[222:223], v[222:223], v[12:13] op_sel_hi:[1,0]
v_cvt_pk_bf16_f32 v65, v222, v223
v_pk_mul_f32 v[224:225], v[224:225], v[12:13] op_sel_hi:[1,0]
v_cvt_pk_bf16_f32 v66, v224, v225
v_pk_mul_f32 v[226:227], v[226:227], v[12:13] op_sel_hi:[1,0]
v_cvt_pk_bf16_f32 v67, v226, v227
buffer_store_dwordx4 v[64:67], v4, s[8:11], s32 offen offset:0 sc1
v_pk_mul_f32 v[228:229], v[228:229], v[12:13] op_sel_hi:[1,0]
v_cvt_pk_bf16_f32 v68, v228, v229
v_pk_mul_f32 v[230:231], v[230:231], v[12:13] op_sel_hi:[1,0]
v_cvt_pk_bf16_f32 v69, v230, v231
v_pk_mul_f32 v[232:233], v[232:233], v[12:13] op_sel_hi:[1,0]
v_cvt_pk_bf16_f32 v70, v232, v233
v_pk_mul_f32 v[234:235], v[234:235], v[12:13] op_sel_hi:[1,0]
v_cvt_pk_bf16_f32 v71, v234, v235
buffer_store_dwordx4 v[68:71], v4, s[8:11], s32 offen offset:1024 sc1
v_pk_mul_f32 v[236:237], v[236:237], v[12:13] op_sel_hi:[1,0]
v_cvt_pk_bf16_f32 v72, v236, v237
v_pk_mul_f32 v[238:239], v[238:239], v[12:13] op_sel_hi:[1,0]
v_cvt_pk_bf16_f32 v73, v238, v239
v_pk_mul_f32 v[240:241], v[240:241], v[12:13] op_sel_hi:[1,0]
v_cvt_pk_bf16_f32 v74, v240, v241
v_pk_mul_f32 v[242:243], v[242:243], v[12:13] op_sel_hi:[1,0]
v_cvt_pk_bf16_f32 v75, v242, v243
buffer_store_dwordx4 v[72:75], v4, s[8:11], s32 offen offset:2048 sc1
v_pk_mul_f32 v[244:245], v[244:245], v[12:13] op_sel_hi:[1,0]
v_cvt_pk_bf16_f32 v76, v244, v245
v_pk_mul_f32 v[246:247], v[246:247], v[12:13] op_sel_hi:[1,0]
v_cvt_pk_bf16_f32 v77, v246, v247
v_pk_mul_f32 v[248:249], v[248:249], v[12:13] op_sel_hi:[1,0]
v_cvt_pk_bf16_f32 v78, v248, v249
v_pk_mul_f32 v[250:251], v[250:251], v[12:13] op_sel_hi:[1,0]
v_cvt_pk_bf16_f32 v79, v250, v251
buffer_store_dwordx4 v[76:79], v4, s[8:11], s32 offen offset:3072 sc1
s_add_u32 s25, s25, 1
s_cmp_ge_u32 s18, 60
s_cbranch_scc1 AT_FLAG
s_waitcnt vmcnt(0)
AT_FLAG:
v_mov_b32 v8, s25
s_mov_b64 exec, 1
buffer_store_dword v8, off, s[8:11], s24 sc1
s_mov_b64 exec, -1
s_add_u32 s19, s19, 1048576
s_add_u32 s20, s20, 524288
s_add_u32 s22, s22, 1048576
s_add_u32 s18, s18, 4
s_cmp_lt_u32 s18, 64
s_cbranch_scc1 AT_LOOP
s_branch L_FIN
L_G2:
s_load_dwordx2 s[12:13], s[0:1], 40
s_mov_b32 s14, 4194304
s_mov_b32 s15, 0x20000
s_load_dwordx2 s[48:49], s[0:1], 80
s_mov_b32 s50, 1835008
s_mov_b32 s51, 0x20000
s_load_dwordx2 s[52:53], s[0:1], 0
s_mov_b32 s54, 2097152
s_mov_b32 s55, 0x20000
s_load_dwordx2 s[56:57], s[0:1], 96
s_mov_b32 s58, 2097152
s_mov_b32 s59, 0x20000
s_load_dwordx2 s[60:61], s[0:1], 88
s_mov_b32 s62, 1024
s_mov_b32 s63, 0x20000
s_and_b32 s18, s16, 15
s_lshr_b32 s19, s16, 4
v_and_b32 v100, 15, v0
v_lshrrev_b32 v101, 4, v0
v_and_b32 v102, 3, v0
v_bfe_u32 v103, v0, 2, 2
v_lshrrev_b32 v4, 2, v0
v_lshlrev_b32 v4, 10, v4
v_lshl_add_u32 v4, v102, 4, v4
s_lshl_b32 s32, s18, 6
v_add_u32 v104, s32, v4
v_lshl_add_u32 v4, v101, 2, v103
v_lshlrev_b32 v4, 6, v4
v_lshl_add_u32 v4, v102, 4, v4
s_mul_i32 s32, s17, 32768
v_add_u32 v105, s32, v4
s_waitcnt lgkmcnt(0)
s_lshl_b32 s23, s17, 20
s_mul_i32 s33, s17, 458752
s_add_u32 m0, s32, 0
s_nop 0
buffer_load_dwordx4 v104, s[12:15], s23 offen lds
s_add_u32 s23, s23, 16384
s_add_u32 m0, s32, 1024
s_nop 0
buffer_load_dwordx4 v104, s[12:15], s23 offen lds
s_add_u32 s23, s23, 16384
s_add_u32 m0, s32, 2048
s_nop 0
buffer_load_dwordx4 v104, s[12:15], s23 offen lds
s_add_u32 s23, s23, 16384
s_add_u32 m0, s32, 3072
s_nop 0
buffer_load_dwordx4 v104, s[12:15], s23 offen lds
s_add_u32 s23, s23, 16384
s_add_u32 m0, s32, 4096
s_nop 0
buffer_load_dwordx4 v104, s[12:15], s23 offen lds
s_add_u32 s23, s23, 16384
s_add_u32 m0, s32, 5120
s_nop 0
buffer_load_dwordx4 v104, s[12:15], s23 offen lds
s_add_u32 s23, s23, 16384
s_add_u32 m0, s32, 6144
s_nop 0
buffer_load_dwordx4 v104, s[12:15], s23 offen lds
s_add_u32 s23, s23, 16384
s_add_u32 m0, s32, 7168
s_nop 0
buffer_load_dwordx4 v104, s[12:15], s23 offen lds
s_add_u32 s23, s23, 16384
s_add_u32 m0, s32, 8192
s_nop 0
buffer_load_dwordx4 v104, s[12:15], s23 offen lds
s_add_u32 s23, s23, 16384
s_add_u32 m0, s32, 9216
s_nop 0
buffer_load_dwordx4 v104, s[12:15], s23 offen lds
s_add_u32 s23, s23, 16384
s_add_u32 m0, s32, 10240
s_nop 0
buffer_load_dwordx4 v104, s[12:15], s23 offen lds
s_add_u32 s23, s23, 16384
s_add_u32 m0, s32, 11264
s_nop 0
buffer_load_dwordx4 v104, s[12:15], s23 offen lds
s_add_u32 s23, s23, 16384
s_add_u32 m0, s32, 12288
s_nop 0
buffer_load_dwordx4 v104, s[12:15], s23 offen lds
s_add_u32 s23, s23, 16384
s_add_u32 m0, s32, 13312
s_nop 0
buffer_load_dwordx4 v104, s[12:15], s23 offen lds
s_add_u32 s23, s23, 16384
s_add_u32 m0, s32, 14336
s_nop 0
buffer_load_dwordx4 v104, s[12:15], s23 offen lds
s_add_u32 s23, s23, 16384
s_add_u32 m0, s32, 15360
s_nop 0
buffer_load_dwordx4 v104, s[12:15], s23 offen lds
s_add_u32 s23, s23, 16384
s_add_u32 m0, s32, 16384
s_nop 0
buffer_load_dwordx4 v104, s[12:15], s23 offen lds
s_add_u32 s23, s23, 16384
s_add_u32 m0, s32, 17408
s_nop 0
buffer_load_dwordx4 v104, s[12:15], s23 offen lds
s_add_u32 s23, s23, 16384
s_add_u32 m0, s32, 18432
s_nop 0
buffer_load_dwordx4 v104, s[12:15], s23 offen lds
s_add_u32 s23, s23, 16384
s_add_u32 m0, s32, 19456
s_nop 0
buffer_load_dwordx4 v104, s[12:15], s23 offen lds
s_add_u32 s23, s23, 16384
s_add_u32 m0, s32, 20480
s_nop 0
buffer_load_dwordx4 v104, s[12:15], s23 offen lds
s_add_u32 s23, s23, 16384
s_add_u32 m0, s32, 21504
s_nop 0
buffer_load_dwordx4 v104, s[12:15], s23 offen lds
s_add_u32 s23, s23, 16384
s_add_u32 m0, s32, 22528
s_nop 0
buffer_load_dwordx4 v104, s[12:15], s23 offen lds
s_add_u32 s23, s23, 16384
s_add_u32 m0, s32, 23552
s_nop 0
buffer_load_dwordx4 v104, s[12:15], s23 offen lds
s_add_u32 s23, s23, 16384
s_add_u32 m0, s32, 24576
s_nop 0
buffer_load_dwordx4 v104, s[12:15], s23 offen lds
s_add_u32 s23, s23, 16384
s_add_u32 m0, s32, 25600
s_nop 0
buffer_load_dwordx4 v104, s[12:15], s23 offen lds
s_add_u32 s23, s23, 16384
s_add_u32 m0, s32, 26624
s_nop 0
buffer_load_dwordx4 v104, s[12:15], s23 offen lds
s_add_u32 s23, s23, 16384
s_add_u32 m0, s32, 27648
s_nop 0
buffer_load_dwordx4 v104, s[12:15], s23 offen lds
s_add_u32 s23, s23, 16384
s_add_u32 m0, s32, 28672
s_nop 0
buffer_load_dwordx4 v104, s[12:15], s23 offen lds
s_add_u32 s23, s23, 16384
s_add_u32 m0, s32, 29696
s_nop 0
buffer_load_dwordx4 v104, s[12:15], s23 offen lds
s_add_u32 s23, s23, 16384
s_add_u32 m0, s32, 30720
s_nop 0
buffer_load_dwordx4 v104, s[12:15], s23 offen lds
s_add_u32 s23, s23, 16384
s_add_u32 m0, s32, 31744
s_nop 0
buffer_load_dwordx4 v104, s[12:15], s23 offen lds
s_add_u32 s23, s23, 16384
s_waitcnt vmcnt(24)
ds_read_b64_tr_b16 a[0:1], v105 offset:0
ds_read_b64_tr_b16 a[2:3], v105 offset:1024
ds_read_b64_tr_b16 a[4:5], v105 offset:8
ds_read_b64_tr_b16 a[6:7], v105 offset:1032
ds_read_b64_tr_b16 a[8:9], v105 offset:2048
ds_read_b64_tr_b16 a[10:11], v105 offset:3072
ds_read_b64_tr_b16 a[12:13], v105 offset:2056
ds_read_b64_tr_b16 a[14:15], v105 offset:3080
ds_read_b64_tr_b16 a[16:17], v105 offset:4096
ds_read_b64_tr_b16 a[18:19], v105 offset:5120
ds_read_b64_tr_b16 a[20:21], v105 offset:4104
ds_read_b64_tr_b16 a[22:23], v105 offset:5128
ds_read_b64_tr_b16 a[24:25], v105 offset:6144
ds_read_b64_tr_b16 a[26:27], v105 offset:7168
ds_read_b64_tr_b16 a[28:29], v105 offset:6152
s_waitcnt lgkmcnt(13)
ds_read_b64_tr_b16 a[30:31], v105 offset:7176
s_waitcnt lgkmcnt(0)
s_add_u32 m0, s32, 0
s_nop 0
buffer_load_dwordx4 v104, s[12:15], s23 offen lds
s_add_u32 s23, s23, 16384
s_add_u32 m0, s32, 1024
s_nop 0
buffer_load_dwordx4 v104, s[12:15], s23 offen lds
s_add_u32 s23, s23, 16384
s_add_u32 m0, s32, 2048
s_nop 0
buffer_load_dwordx4 v104, s[12:15], s23 offen lds
s_add_u32 s23, s23, 16384
s_add_u32 m0, s32, 3072
s_nop 0
buffer_load_dwordx4 v104, s[12:15], s23 offen lds
s_add_u32 s23, s23, 16384
s_add_u32 m0, s32, 4096
s_nop 0
buffer_load_dwordx4 v104, s[12:15], s23 offen lds
s_add_u32 s23, s23, 16384
s_add_u32 m0, s32, 5120
s_nop 0
buffer_load_dwordx4 v104, s[12:15], s23 offen lds
s_add_u32 s23, s23, 16384
s_add_u32 m0, s32, 6144
s_nop 0
buffer_load_dwordx4 v104, s[12:15], s23 offen lds
s_add_u32 s23, s23, 16384
s_add_u32 m0, s32, 7168
s_nop 0
buffer_load_dwordx4 v104, s[12:15], s23 offen lds
s_add_u32 s23, s23, 16384
s_waitcnt vmcnt(24)
ds_read_b64_tr_b16 a[32:33], v105 offset:8192
ds_read_b64_tr_b16 a[34:35], v105 offset:9216
ds_read_b64_tr_b16 a[36:37], v105 offset:8200
ds_read_b64_tr_b16 a[38:39], v105 offset:9224
ds_read_b64_tr_b16 a[40:41], v105 offset:10240
ds_read_b64_tr_b16 a[42:43], v105 offset:11264
ds_read_b64_tr_b16 a[44:45], v105 offset:10248
ds_read_b64_tr_b16 a[46:47], v105 offset:11272
ds_read_b64_tr_b16 a[48:49], v105 offset:12288
ds_read_b64_tr_b16 a[50:51], v105 offset:13312
ds_read_b64_tr_b16 a[52:53], v105 offset:12296
ds_read_b64_tr_b16 a[54:55], v105 offset:13320
ds_read_b64_tr_b16 a[56:57], v105 offset:14336
ds_read_b64_tr_b16 a[58:59], v105 offset:15360
ds_read_b64_tr_b16 a[60:61], v105 offset:14344
s_waitcnt lgkmcnt(13)
ds_read_b64_tr_b16 a[62:63], v105 offset:15368
s_waitcnt lgkmcnt(0)
s_add_u32 m0, s32, 8192
s_nop 0
buffer_load_dwordx4 v104, s[12:15], s23 offen lds
s_add_u32 s23, s23, 16384
s_add_u32 m0, s32, 9216
s_nop 0
buffer_load_dwordx4 v104, s[12:15], s23 offen lds
s_add_u32 s23, s23, 16384
s_add_u32 m0, s32, 10240
s_nop 0
buffer_load_dwordx4 v104, s[12:15], s23 offen lds
s_add_u32 s23, s23, 16384
s_add_u32 m0, s32, 11264
s_nop 0
buffer_load_dwordx4 v104, s[12:15], s23 offen lds
s_add_u32 s23, s23, 16384
s_add_u32 m0, s32, 12288
s_nop 0
buffer_load_dwordx4 v104, s[12:15], s23 offen lds
s_add_u32 s23, s23, 16384
s_add_u32 m0, s32, 13312
s_nop 0
buffer_load_dwordx4 v104, s[12:15], s23 offen lds
s_add_u32 s23, s23, 16384
s_add_u32 m0, s32, 14336
s_nop 0
buffer_load_dwordx4 v104, s[12:15], s23 offen lds
s_add_u32 s23, s23, 16384
s_add_u32 m0, s32, 15360
s_nop 0
buffer_load_dwordx4 v104, s[12:15], s23 offen lds
s_add_u32 s23, s23, 16384
s_waitcnt vmcnt(24)
ds_read_b64_tr_b16 a[64:65], v105 offset:16384
ds_read_b64_tr_b16 a[66:67], v105 offset:17408
ds_read_b64_tr_b16 a[68:69], v105 offset:16392
ds_read_b64_tr_b16 a[70:71], v105 offset:17416
ds_read_b64_tr_b16 a[72:73], v105 offset:18432
ds_read_b64_tr_b16 a[74:75], v105 offset:19456
ds_read_b64_tr_b16 a[76:77], v105 offset:18440
ds_read_b64_tr_b16 a[78:79], v105 offset:19464
ds_read_b64_tr_b16 a[80:81], v105 offset:20480
ds_read_b64_tr_b16 a[82:83], v105 offset:21504
ds_read_b64_tr_b16 a[84:85], v105 offset:20488
ds_read_b64_tr_b16 a[86:87], v105 offset:21512
ds_read_b64_tr_b16 a[88:89], v105 offset:22528
ds_read_b64_tr_b16 a[90:91], v105 offset:23552
ds_read_b64_tr_b16 a[92:93], v105 offset:22536
s_waitcnt lgkmcnt(13)
ds_read_b64_tr_b16 a[94:95], v105 offset:23560
s_waitcnt lgkmcnt(0)
s_add_u32 m0, s32, 16384
s_nop 0
buffer_load_dwordx4 v104, s[12:15], s23 offen lds
s_add_u32 s23, s23, 16384
s_add_u32 m0, s32, 17408
s_nop 0
buffer_load_dwordx4 v104, s[12:15], s23 offen lds
s_add_u32 s23, s23, 16384
s_add_u32 m0, s32, 18432
s_nop 0
buffer_load_dwordx4 v104, s[12:15], s23 offen lds
s_add_u32 s23, s23, 16384
s_add_u32 m0, s32, 19456
s_nop 0
buffer_load_dwordx4 v104, s[12:15], s23 offen lds
s_add_u32 s23, s23, 16384
s_add_u32 m0, s32, 20480
s_nop 0
buffer_load_dwordx4 v104, s[12:15], s23 offen lds
s_add_u32 s23, s23, 16384
s_add_u32 m0, s32, 21504
s_nop 0
buffer_load_dwordx4 v104, s[12:15], s23 offen lds
s_add_u32 s23, s23, 16384
s_add_u32 m0, s32, 22528
s_nop 0
buffer_load_dwordx4 v104, s[12:15], s23 offen lds
s_add_u32 s23, s23, 16384
s_add_u32 m0, s32, 23552
s_nop 0
buffer_load_dwordx4 v104, s[12:15], s23 offen lds
s_add_u32 s23, s23, 16384
s_waitcnt vmcnt(24)
ds_read_b64_tr_b16 a[96:97], v105 offset:24576
ds_read_b64_tr_b16 a[98:99], v105 offset:25600
ds_read_b64_tr_b16 a[100:101], v105 offset:24584
ds_read_b64_tr_b16 a[102:103], v105 offset:25608
ds_read_b64_tr_b16 a[104:105], v105 offset:26624
ds_read_b64_tr_b16 a[106:107], v105 offset:27648
ds_read_b64_tr_b16 a[108:109], v105 offset:26632
ds_read_b64_tr_b16 a[110:111], v105 offset:27656
ds_read_b64_tr_b16 a[112:113], v105 offset:28672
ds_read_b64_tr_b16 a[114:115], v105 offset:29696
ds_read_b64_tr_b16 a[116:117], v105 offset:28680
ds_read_b64_tr_b16 a[118:119], v105 offset:29704
ds_read_b64_tr_b16 a[120:121], v105 offset:30720
ds_read_b64_tr_b16 a[122:123], v105 offset:31744
ds_read_b64_tr_b16 a[124:125], v105 offset:30728
s_waitcnt lgkmcnt(13)
ds_read_b64_tr_b16 a[126:127], v105 offset:31752
s_waitcnt lgkmcnt(0)
s_add_u32 m0, s32, 24576
s_nop 0
buffer_load_dwordx4 v104, s[12:15], s23 offen lds
s_add_u32 s23, s23, 16384
s_add_u32 m0, s32, 25600
s_nop 0
buffer_load_dwordx4 v104, s[12:15], s23 offen lds
s_add_u32 s23, s23, 16384
s_add_u32 m0, s32, 26624
s_nop 0
buffer_load_dwordx4 v104, s[12:15], s23 offen lds
s_add_u32 s23, s23, 16384
s_add_u32 m0, s32, 27648
s_nop 0
buffer_load_dwordx4 v104, s[12:15], s23 offen lds
s_add_u32 s23, s23, 16384
s_add_u32 m0, s32, 28672
s_nop 0
buffer_load_dwordx4 v104, s[12:15], s23 offen lds
s_add_u32 s23, s23, 16384
s_add_u32 m0, s32, 29696
s_nop 0
buffer_load_dwordx4 v104, s[12:15], s23 offen lds
s_add_u32 s23, s23, 16384
s_add_u32 m0, s32, 30720
s_nop 0
buffer_load_dwordx4 v104, s[12:15], s23 offen lds
s_add_u32 s23, s23, 16384
s_add_u32 m0, s32, 31744
s_nop 0
buffer_load_dwordx4 v104, s[12:15], s23 offen lds
s_add_u32 s23, s23, 16384
s_waitcnt vmcnt(24)
ds_read_b64_tr_b16 a[128:129], v105 offset:0
ds_read_b64_tr_b16 a[130:131], v105 offset:1024
ds_read_b64_tr_b16 a[132:133], v105 offset:8
ds_read_b64_tr_b16 a[134:135], v105 offset:1032
ds_read_b64_tr_b16 a[136:137], v105 offset:2048
ds_read_b64_tr_b16 a[138:139], v105 offset:3072
ds_read_b64_tr_b16 a[140:141], v105 offset:2056
ds_read_b64_tr_b16 a[142:143], v105 offset:3080
ds_read_b64_tr_b16 a[144:145], v105 offset:4096
ds_read_b64_tr_b16 a[146:147], v105 offset:5120
ds_read_b64_tr_b16 a[148:149], v105 offset:4104
ds_read_b64_tr_b16 a[150:151], v105 offset:5128
ds_read_b64_tr_b16 a[152:153], v105 offset:6144
ds_read_b64_tr_b16 a[154:155], v105 offset:7168
ds_read_b64_tr_b16 a[156:157], v105 offset:6152
s_waitcnt lgkmcnt(13)
ds_read_b64_tr_b16 a[158:159], v105 offset:7176
s_waitcnt lgkmcnt(0)
s_add_u32 m0, s32, 0
s_nop 0
buffer_load_dwordx4 v104, s[48:51], s33 offen lds
s_add_u32 s33, s33, 16384
s_add_u32 m0, s32, 1024
s_nop 0
buffer_load_dwordx4 v104, s[48:51], s33 offen lds
s_add_u32 s33, s33, 16384
s_add_u32 m0, s32, 2048
s_nop 0
buffer_load_dwordx4 v104, s[48:51], s33 offen lds
s_add_u32 s33, s33, 16384
s_add_u32 m0, s32, 3072
s_nop 0
buffer_load_dwordx4 v104, s[48:51], s33 offen lds
s_add_u32 s33, s33, 16384
s_add_u32 m0, s32, 4096
s_nop 0
buffer_load_dwordx4 v104, s[48:51], s33 offen lds
s_add_u32 s33, s33, 16384
s_add_u32 m0, s32, 5120
s_nop 0
buffer_load_dwordx4 v104, s[48:51], s33 offen lds
s_add_u32 s33, s33, 16384
s_add_u32 m0, s32, 6144
s_nop 0
buffer_load_dwordx4 v104, s[48:51], s33 offen lds
s_add_u32 s33, s33, 16384
s_add_u32 m0, s32, 7168
s_nop 0
buffer_load_dwordx4 v104, s[48:51], s33 offen lds
s_add_u32 s33, s33, 16384
s_waitcnt vmcnt(24)
ds_read_b64_tr_b16 a[160:161], v105 offset:8192
ds_read_b64_tr_b16 a[162:163], v105 offset:9216
ds_read_b64_tr_b16 a[164:165], v105 offset:8200
ds_read_b64_tr_b16 a[166:167], v105 offset:9224
ds_read_b64_tr_b16 a[168:169], v105 offset:10240
ds_read_b64_tr_b16 a[170:171], v105 offset:11264
ds_read_b64_tr_b16 a[172:173], v105 offset:10248
ds_read_b64_tr_b16 a[174:175], v105 offset:11272
ds_read_b64_tr_b16 a[176:177], v105 offset:12288
ds_read_b64_tr_b16 a[178:179], v105 offset:13312
ds_read_b64_tr_b16 a[180:181], v105 offset:12296
ds_read_b64_tr_b16 a[182:183], v105 offset:13320
ds_read_b64_tr_b16 a[184:185], v105 offset:14336
ds_read_b64_tr_b16 a[186:187], v105 offset:15360
ds_read_b64_tr_b16 a[188:189], v105 offset:14344
s_waitcnt lgkmcnt(13)
ds_read_b64_tr_b16 a[190:191], v105 offset:15368
s_waitcnt lgkmcnt(0)
s_add_u32 m0, s32, 8192
s_nop 0
buffer_load_dwordx4 v104, s[48:51], s33 offen lds
s_add_u32 s33, s33, 16384
s_add_u32 m0, s32, 9216
s_nop 0
buffer_load_dwordx4 v104, s[48:51], s33 offen lds
s_add_u32 s33, s33, 16384
s_add_u32 m0, s32, 10240
s_nop 0
buffer_load_dwordx4 v104, s[48:51], s33 offen lds
s_add_u32 s33, s33, 16384
s_add_u32 m0, s32, 11264
s_nop 0
buffer_load_dwordx4 v104, s[48:51], s33 offen lds
s_add_u32 s33, s33, 16384
s_add_u32 m0, s32, 12288
s_nop 0
buffer_load_dwordx4 v104, s[48:51], s33 offen lds
s_add_u32 s33, s33, 16384
s_add_u32 m0, s32, 13312
s_nop 0
buffer_load_dwordx4 v104, s[48:51], s33 offen lds
s_add_u32 s33, s33, 16384
s_add_u32 m0, s32, 14336
s_nop 0
buffer_load_dwordx4 v104, s[48:51], s33 offen lds
s_add_u32 s33, s33, 16384
s_add_u32 m0, s32, 15360
s_nop 0
buffer_load_dwordx4 v104, s[48:51], s33 offen lds
s_add_u32 s33, s33, 16384
s_waitcnt vmcnt(24)
ds_read_b64_tr_b16 a[192:193], v105 offset:16384
ds_read_b64_tr_b16 a[194:195], v105 offset:17408
ds_read_b64_tr_b16 a[196:197], v105 offset:16392
ds_read_b64_tr_b16 a[198:199], v105 offset:17416
ds_read_b64_tr_b16 a[200:201], v105 offset:18432
ds_read_b64_tr_b16 a[202:203], v105 offset:19456
ds_read_b64_tr_b16 a[204:205], v105 offset:18440
ds_read_b64_tr_b16 a[206:207], v105 offset:19464
ds_read_b64_tr_b16 a[208:209], v105 offset:20480
ds_read_b64_tr_b16 a[210:211], v105 offset:21504
ds_read_b64_tr_b16 a[212:213], v105 offset:20488
ds_read_b64_tr_b16 a[214:215], v105 offset:21512
ds_read_b64_tr_b16 a[216:217], v105 offset:22528
ds_read_b64_tr_b16 a[218:219], v105 offset:23552
ds_read_b64_tr_b16 a[220:221], v105 offset:22536
s_waitcnt lgkmcnt(13)
ds_read_b64_tr_b16 a[222:223], v105 offset:23560
s_waitcnt lgkmcnt(0)
s_add_u32 m0, s32, 16384
s_nop 0
buffer_load_dwordx4 v104, s[48:51], s33 offen lds
s_add_u32 s33, s33, 16384
s_add_u32 m0, s32, 17408
s_nop 0
buffer_load_dwordx4 v104, s[48:51], s33 offen lds
s_add_u32 s33, s33, 16384
s_add_u32 m0, s32, 18432
s_nop 0
buffer_load_dwordx4 v104, s[48:51], s33 offen lds
s_add_u32 s33, s33, 16384
s_add_u32 m0, s32, 19456
s_nop 0
buffer_load_dwordx4 v104, s[48:51], s33 offen lds
s_add_u32 s33, s33, 16384
s_add_u32 m0, s32, 20480
s_nop 0
buffer_load_dwordx4 v104, s[48:51], s33 offen lds
s_add_u32 s33, s33, 16384
s_add_u32 m0, s32, 21504
s_nop 0
buffer_load_dwordx4 v104, s[48:51], s33 offen lds
s_add_u32 s33, s33, 16384
s_add_u32 m0, s32, 22528
s_nop 0
buffer_load_dwordx4 v104, s[48:51], s33 offen lds
s_add_u32 s33, s33, 16384
s_add_u32 m0, s32, 23552
s_nop 0
buffer_load_dwordx4 v104, s[48:51], s33 offen lds
s_add_u32 s33, s33, 16384
s_waitcnt vmcnt(24)
ds_read_b64_tr_b16 a[224:225], v105 offset:24576
ds_read_b64_tr_b16 a[226:227], v105 offset:25600
ds_read_b64_tr_b16 a[228:229], v105 offset:24584
ds_read_b64_tr_b16 a[230:231], v105 offset:25608
ds_read_b64_tr_b16 a[232:233], v105 offset:26624
ds_read_b64_tr_b16 a[234:235], v105 offset:27648
ds_read_b64_tr_b16 a[236:237], v105 offset:26632
ds_read_b64_tr_b16 a[238:239], v105 offset:27656
ds_read_b64_tr_b16 a[240:241], v105 offset:28672
ds_read_b64_tr_b16 a[242:243], v105 offset:29696
ds_read_b64_tr_b16 a[244:245], v105 offset:28680
ds_read_b64_tr_b16 a[246:247], v105 offset:29704
ds_read_b64_tr_b16 a[248:249], v105 offset:30720
ds_read_b64_tr_b16 a[250:251], v105 offset:31744
ds_read_b64_tr_b16 a[252:253], v105 offset:30728
s_waitcnt lgkmcnt(13)
ds_read_b64_tr_b16 a[254:255], v105 offset:31752
s_waitcnt lgkmcnt(0)
s_add_u32 m0, s32, 24576
s_nop 0
buffer_load_dwordx4 v104, s[48:51], s33 offen lds
s_add_u32 s33, s33, 16384
s_add_u32 m0, s32, 25600
s_nop 0
buffer_load_dwordx4 v104, s[48:51], s33 offen lds
s_add_u32 s33, s33, 16384
s_add_u32 m0, s32, 26624
s_nop 0
buffer_load_dwordx4 v104, s[48:51], s33 offen lds
s_add_u32 s33, s33, 16384
s_add_u32 m0, s32, 27648
s_nop 0
buffer_load_dwordx4 v104, s[48:51], s33 offen lds
s_add_u32 s33, s33, 16384
s_waitcnt vmcnt(20)
ds_read_b64_tr_b16 v[144:145], v105 offset:0
ds_read_b64_tr_b16 v[146:147], v105 offset:1024
ds_read_b64_tr_b16 v[148:149], v105 offset:8
ds_read_b64_tr_b16 v[150:151], v105 offset:1032
ds_read_b64_tr_b16 v[152:153], v105 offset:2048
ds_read_b64_tr_b16 v[154:155], v105 offset:3072
ds_read_b64_tr_b16 v[156:157], v105 offset:2056
ds_read_b64_tr_b16 v[158:159], v105 offset:3080
ds_read_b64_tr_b16 v[160:161], v105 offset:4096
ds_read_b64_tr_b16 v[162:163], v105 offset:5120
ds_read_b64_tr_b16 v[164:165], v105 offset:4104
ds_read_b64_tr_b16 v[166:167], v105 offset:5128
ds_read_b64_tr_b16 v[168:169], v105 offset:6144
ds_read_b64_tr_b16 v[170:171], v105 offset:7168
ds_read_b64_tr_b16 v[172:173], v105 offset:6152
s_waitcnt lgkmcnt(13)
ds_read_b64_tr_b16 v[174:175], v105 offset:7176
s_waitcnt lgkmcnt(0)
s_waitcnt vmcnt(12)
ds_read_b64_tr_b16 v[176:177], v105 offset:8192
ds_read_b64_tr_b16 v[178:179], v105 offset:9216
ds_read_b64_tr_b16 v[180:181], v105 offset:8200
ds_read_b64_tr_b16 v[182:183], v105 offset:9224
ds_read_b64_tr_b16 v[184:185], v105 offset:10240
ds_read_b64_tr_b16 v[186:187], v105 offset:11264
ds_read_b64_tr_b16 v[188:189], v105 offset:10248
ds_read_b64_tr_b16 v[190:191], v105 offset:11272
ds_read_b64_tr_b16 v[192:193], v105 offset:12288
ds_read_b64_tr_b16 v[194:195], v105 offset:13312
ds_read_b64_tr_b16 v[196:197], v105 offset:12296
ds_read_b64_tr_b16 v[198:199], v105 offset:13320
ds_read_b64_tr_b16 v[200:201], v105 offset:14336
ds_read_b64_tr_b16 v[202:203], v105 offset:15360
ds_read_b64_tr_b16 v[204:205], v105 offset:14344
s_waitcnt lgkmcnt(13)
ds_read_b64_tr_b16 v[206:207], v105 offset:15368
s_waitcnt lgkmcnt(0)
s_waitcnt vmcnt(4)
ds_read_b64_tr_b16 v[208:209], v105 offset:16384
ds_read_b64_tr_b16 v[210:211], v105 offset:17408
ds_read_b64_tr_b16 v[212:213], v105 offset:16392
ds_read_b64_tr_b16 v[214:215], v105 offset:17416
ds_read_b64_tr_b16 v[216:217], v105 offset:18432
ds_read_b64_tr_b16 v[218:219], v105 offset:19456
ds_read_b64_tr_b16 v[220:221], v105 offset:18440
ds_read_b64_tr_b16 v[222:223], v105 offset:19464
ds_read_b64_tr_b16 v[224:225], v105 offset:20480
ds_read_b64_tr_b16 v[226:227], v105 offset:21504
ds_read_b64_tr_b16 v[228:229], v105 offset:20488
ds_read_b64_tr_b16 v[230:231], v105 offset:21512
ds_read_b64_tr_b16 v[232:233], v105 offset:22528
ds_read_b64_tr_b16 v[234:235], v105 offset:23552
ds_read_b64_tr_b16 v[236:237], v105 offset:22536
s_waitcnt lgkmcnt(13)
ds_read_b64_tr_b16 v[238:239], v105 offset:23560
s_waitcnt lgkmcnt(0)
s_waitcnt vmcnt(0)
ds_read_b64_tr_b16 v[240:241], v105 offset:24576
ds_read_b64_tr_b16 v[242:243], v105 offset:25600
ds_read_b64_tr_b16 v[244:245], v105 offset:24584
ds_read_b64_tr_b16 v[246:247], v105 offset:25608
ds_read_b64_tr_b16 v[248:249], v105 offset:26624
ds_read_b64_tr_b16 v[250:251], v105 offset:27648
ds_read_b64_tr_b16 v[252:253], v105 offset:26632
ds_read_b64_tr_b16 v[254:255], v105 offset:27656
s_waitcnt lgkmcnt(0)
v_lshlrev_b32 v4, 4, v101
s_lshl_b32 s32, s18, 6
buffer_load_dwordx4 v[16:19], v4, s[60:63], s32 offen
v_and_b32 v7, 7, v0
v_lshl_add_u32 v6, v7, 10, v4
v_add_u32 v6, s32, v6
v_lshlrev_b32 v5, 4, v0
v_add_u32 v5, 131072, v5
v_lshl_add_u32 v4, v101, 4, v7
v_lshlrev_b32 v4, 4, v4
v_lshrrev_b32 v3, 3, v100
v_lshl_add_u32 v4, v3, 10, v4
v_lshlrev_b32 v7, 7, v7
s_mov_b32 s26, 0x00ff00ff
s_mov_b32 s27, 0x00ff00ff
s_waitcnt vmcnt(0)
v_lshlrev_b32 v8, 16, v16
v_and_b32 v9, 0xffff0000, v16
v_lshlrev_b32 v10, 16, v17
v_and_b32 v11, 0xffff0000, v17
v_lshlrev_b32 v12, 16, v18
v_and_b32 v13, 0xffff0000, v18
v_lshlrev_b32 v14, 16, v19
v_and_b32 v15, 0xffff0000, v19
v_min_u32 v16, 27, v0
v_lshlrev_b32 v16, 7, v16
s_mov_b32 s32, 91312128
s_mov_b32 s35, 0
POLL_H_60:
s_cmp_lg_u32 s37, 0
s_cbranch_scc1 POLL_H_60_E
buffer_load_dword v17, v16, s[8:11], s32 offen sc1
s_add_u32 s35, s35, 1
s_cmp_gt_u32 s35, 65536
s_cselect_b32 s37, 1, 0
s_waitcnt vmcnt(0)
v_cmp_gt_u32 vcc, 16, v17
s_cbranch_vccz POLL_H_60_E
s_sleep 1
s_branch POLL_H_60
POLL_H_60_E:
s_mov_b32 s24, 0
s_barrier
s_add_u32 s25, s19, 250
s_cmp_ge_u32 s25, 256
s_cselect_b32 s33, 10, 0
s_sub_u32 s25, s25, s33
s_lshr_b32 s33, s25, 1
s_and_b32 s34, s25, 1
s_lshl_b32 s34, s34, 7
s_mul_i32 s21, s33, 57344
s_mul_i32 s32, s17, 14336
s_add_u32 s21, s21, s32
s_add_u32 s21, s21, s34
s_add_u32 s21, s21, 81788928
s_add_u32 s28, s21, 0
buffer_load_dwordx4 v[64:67], v4, s[8:11], s28 offen offset:0 sc1
s_add_u32 s28, s21, 0
buffer_load_dwordx4 v[68:71], v4, s[8:11], s28 offen offset:2048 sc1
s_add_u32 s28, s21, 4096
buffer_load_dwordx4 v[72:75], v4, s[8:11], s28 offen offset:0 sc1
s_add_u32 s28, s21, 4096
buffer_load_dwordx4 v[76:79], v4, s[8:11], s28 offen offset:2048 sc1
s_add_u32 s28, s21, 8192
buffer_load_dwordx4 v[80:83], v4, s[8:11], s28 offen offset:0 sc1
s_add_u32 s28, s21, 8192
buffer_load_dwordx4 v[84:87], v4, s[8:11], s28 offen offset:2048 sc1
s_add_u32 s28, s21, 12288
buffer_load_dwordx4 v[88:91], v4, s[8:11], s28 offen offset:0 sc1
s_waitcnt vmcnt(6)
v_mfma_f32_16x16x32_bf16 v[24:27], v[144:147], v[64:67], 0
v_mfma_f32_16x16x32_bf16 v[28:31], v[148:151], v[64:67], 0
v_mfma_f32_16x16x32_bf16 v[128:131], v[152:155], v[64:67], 0
v_mfma_f32_16x16x32_bf16 v[132:135], v[156:159], v[64:67], 0
s_waitcnt vmcnt(5)
v_mfma_f32_16x16x32_bf16 v[24:27], v[160:163], v[68:71], v[24:27]
v_mfma_f32_16x16x32_bf16 v[28:31], v[164:167], v[68:71], v[28:31]
v_mfma_f32_16x16x32_bf16 v[128:131], v[168:171], v[68:71], v[128:131]
v_mfma_f32_16x16x32_bf16 v[132:135], v[172:175], v[68:71], v[132:135]
s_waitcnt vmcnt(4)
v_mfma_f32_16x16x32_bf16 v[24:27], v[176:179], v[72:75], v[24:27]
v_mfma_f32_16x16x32_bf16 v[28:31], v[180:183], v[72:75], v[28:31]
v_mfma_f32_16x16x32_bf16 v[128:131], v[184:187], v[72:75], v[128:131]
v_mfma_f32_16x16x32_bf16 v[132:135], v[188:191], v[72:75], v[132:135]
s_waitcnt vmcnt(3)
v_mfma_f32_16x16x32_bf16 v[24:27], v[192:195], v[76:79], v[24:27]
v_mfma_f32_16x16x32_bf16 v[28:31], v[196:199], v[76:79], v[28:31]
v_mfma_f32_16x16x32_bf16 v[128:131], v[200:203], v[76:79], v[128:131]
v_mfma_f32_16x16x32_bf16 v[132:135], v[204:207], v[76:79], v[132:135]
s_waitcnt vmcnt(2)
v_mfma_f32_16x16x32_bf16 v[24:27], v[208:211], v[80:83], v[24:27]
v_mfma_f32_16x16x32_bf16 v[28:31], v[212:215], v[80:83], v[28:31]
v_mfma_f32_16x16x32_bf16 v[128:131], v[216:219], v[80:83], v[128:131]
v_mfma_f32_16x16x32_bf16 v[132:135], v[220:223], v[80:83], v[132:135]
s_waitcnt vmcnt(1)
v_mfma_f32_16x16x32_bf16 v[24:27], v[224:227], v[84:87], v[24:27]
v_mfma_f32_16x16x32_bf16 v[28:31], v[228:231], v[84:87], v[28:31]
v_mfma_f32_16x16x32_bf16 v[128:131], v[232:235], v[84:87], v[128:131]
v_mfma_f32_16x16x32_bf16 v[132:135], v[236:239], v[84:87], v[132:135]
s_waitcnt vmcnt(0)
v_mfma_f32_16x16x32_bf16 v[24:27], v[240:243], v[88:91], v[24:27]
v_mfma_f32_16x16x32_bf16 v[28:31], v[244:247], v[88:91], v[28:31]
v_mfma_f32_16x16x32_bf16 v[128:131], v[248:251], v[88:91], v[128:131]
v_mfma_f32_16x16x32_bf16 v[132:135], v[252:255], v[88:91], v[132:135]
s_nop 7
v_mov_b32 v56, v24
v_mov_b32 v136, v128
v_mov_b32 v57, v25
v_mov_b32 v137, v129
v_mov_b32 v58, v26
v_mov_b32 v138, v130
v_mov_b32 v59, v27
v_mov_b32 v139, v131
v_mov_b32 v60, v28
v_mov_b32 v140, v132
v_mov_b32 v61, v29
v_mov_b32 v141, v133
v_mov_b32 v62, v30
v_mov_b32 v142, v134
v_mov_b32 v63, v31
v_mov_b32 v143, v135
G2_LOOP:
s_lshr_b32 s33, s19, 2
s_and_b32 s30, s33, 3
s_lshl_b32 s30, s30, 12
s_lshl_b32 s34, s17, 10
s_add_u32 s30, s30, s34
s_add_u32 s30, s30, 91324416
buffer_load_dword v17, v7, s[8:11], s30 offen sc1
s_lshr_b32 s31, s33, 2
s_add_u32 s31, s31, 1
s_lshl_b32 s22, s19, 13
buffer_load_dwordx4 v[20:23], v6, s[52:55], s22 offen
s_lshr_b32 s33, s19, 1
s_and_b32 s34, s19, 1
s_lshl_b32 s34, s34, 7
s_lshl_b32 s20, s33, 17
s_lshl_b32 s32, s17, 15
s_add_u32 s20, s20, s32
s_add_u32 s20, s20, s34
s_add_u32 s20, s20, 65011712
s_mov_b32 s23, 0
s_cmp_lg_u32 s19, s25
s_cbranch_scc1 G2_H
v_mov_b32 v24, v56
v_mov_b32 v128, v136
v_mov_b32 v25, v57
v_mov_b32 v129, v137
v_mov_b32 v26, v58
v_mov_b32 v130, v138
v_mov_b32 v27, v59
v_mov_b32 v131, v139
v_mov_b32 v28, v60
v_mov_b32 v132, v140
v_mov_b32 v29, v61
v_mov_b32 v133, v141
v_mov_b32 v30, v62
v_mov_b32 v134, v142
v_mov_b32 v31, v63
v_mov_b32 v135, v143
s_branch G2_HE
G2_H:
s_lshr_b32 s33, s19, 1
s_and_b32 s34, s19, 1
s_lshl_b32 s34, s34, 7
s_mul_i32 s21, s33, 57344
s_mul_i32 s32, s17, 14336
s_add_u32 s21, s21, s32
s_add_u32 s21, s21, s34
s_add_u32 s21, s21, 81788928
s_add_u32 s28, s21, 0
buffer_load_dwordx4 v[64:67], v4, s[8:11], s28 offen offset:0 sc1
s_add_u32 s28, s21, 0
buffer_load_dwordx4 v[68:71], v4, s[8:11], s28 offen offset:2048 sc1
s_add_u32 s28, s21, 4096
buffer_load_dwordx4 v[72:75], v4, s[8:11], s28 offen offset:0 sc1
s_add_u32 s28, s21, 4096
buffer_load_dwordx4 v[76:79], v4, s[8:11], s28 offen offset:2048 sc1
s_add_u32 s28, s21, 8192
buffer_load_dwordx4 v[80:83], v4, s[8:11], s28 offen offset:0 sc1
s_add_u32 s28, s21, 8192
buffer_load_dwordx4 v[84:87], v4, s[8:11], s28 offen offset:2048 sc1
s_add_u32 s28, s21, 12288
buffer_load_dwordx4 v[88:91], v4, s[8:11], s28 offen offset:0 sc1
s_cmp_ge_u32 s19, 240
s_cbranch_scc1 G2_SLOW
s_waitcnt vmcnt(8)
v_cmp_gt_u32 vcc, s31, v17
s_cbranch_vccnz G2_SLOW
s_add_u32 s28, s20, 12288
buffer_load_dwordx4 v[92:95], v4, s[8:11], s28 offen offset:2048 sc1
s_add_u32 s28, s20, 16384
buffer_load_dwordx4 v[96:99], v4, s[8:11], s28 offen offset:0 sc1
s_add_u32 s28, s20, 16384
buffer_load_dwordx4 v[100:103], v4, s[8:11], s28 offen offset:2048 sc1
s_add_u32 s28, s20, 20480
buffer_load_dwordx4 v[104:107], v4, s[8:11], s28 offen offset:0 sc1
s_add_u32 s28, s20, 20480
buffer_load_dwordx4 v[108:111], v4, s[8:11], s28 offen offset:2048 sc1
s_add_u32 s28, s20, 24576
buffer_load_dwordx4 v[112:115], v4, s[8:11], s28 offen offset:0 sc1
s_add_u32 s28, s20, 24576
buffer_load_dwordx4 v[116:119], v4, s[8:11], s28 offen offset:2048 sc1
s_add_u32 s28, s20, 28672
buffer_load_dwordx4 v[120:123], v4, s[8:11], s28 offen offset:0 sc1
s_add_u32 s28, s20, 28672
buffer_load_dwordx4 v[124:127], v4, s[8:11], s28 offen offset:2048 sc1
s_waitcnt vmcnt(15)
v_mfma_f32_16x16x32_bf16 v[24:27], v[144:147], v[64:67], 0
v_mfma_f32_16x16x32_bf16 v[28:31], v[148:151], v[64:67], 0
v_mfma_f32_16x16x32_bf16 v[128:131], v[152:155], v[64:67], 0
v_mfma_f32_16x16x32_bf16 v[132:135], v[156:159], v[64:67], 0
s_waitcnt vmcnt(14)
v_mfma_f32_16x16x32_bf16 v[24:27], v[160:163], v[68:71], v[24:27]
v_mfma_f32_16x16x32_bf16 v[28:31], v[164:167], v[68:71], v[28:31]
v_mfma_f32_16x16x32_bf16 v[128:131], v[168:171], v[68:71], v[128:131]
v_mfma_f32_16x16x32_bf16 v[132:135], v[172:175], v[68:71], v[132:135]
s_waitcnt vmcnt(13)
v_mfma_f32_16x16x32_bf16 v[24:27], v[176:179], v[72:75], v[24:27]
v_mfma_f32_16x16x32_bf16 v[28:31], v[180:183], v[72:75], v[28:31]
v_mfma_f32_16x16x32_bf16 v[128:131], v[184:187], v[72:75], v[128:131]
v_mfma_f32_16x16x32_bf16 v[132:135], v[188:191], v[72:75], v[132:135]
s_waitcnt vmcnt(12)
v_mfma_f32_16x16x32_bf16 v[24:27], v[192:195], v[76:79], v[24:27]
v_mfma_f32_16x16x32_bf16 v[28:31], v[196:199], v[76:79], v[28:31]
v_mfma_f32_16x16x32_bf16 v[128:131], v[200:203], v[76:79], v[128:131]
v_mfma_f32_16x16x32_bf16 v[132:135], v[204:207], v[76:79], v[132:135]
s_waitcnt vmcnt(11)
v_mfma_f32_16x16x32_bf16 v[24:27], v[208:211], v[80:83], v[24:27]
v_mfma_f32_16x16x32_bf16 v[28:31], v[212:215], v[80:83], v[28:31]
v_mfma_f32_16x16x32_bf16 v[128:131], v[216:219], v[80:83], v[128:131]
v_mfma_f32_16x16x32_bf16 v[132:135], v[220:223], v[80:83], v[132:135]
s_waitcnt vmcnt(10)
v_mfma_f32_16x16x32_bf16 v[24:27], v[224:227], v[84:87], v[24:27]
v_mfma_f32_16x16x32_bf16 v[28:31], v[228:231], v[84:87], v[28:31]
v_mfma_f32_16x16x32_bf16 v[128:131], v[232:235], v[84:87], v[128:131]
v_mfma_f32_16x16x32_bf16 v[132:135], v[236:239], v[84:87], v[132:135]
s_waitcnt vmcnt(9)
v_mfma_f32_16x16x32_bf16 v[24:27], v[240:243], v[88:91], v[24:27]
v_mfma_f32_16x16x32_bf16 v[28:31], v[244:247], v[88:91], v[28:31]
v_mfma_f32_16x16x32_bf16 v[128:131], v[248:251], v[88:91], v[128:131]
v_mfma_f32_16x16x32_bf16 v[132:135], v[252:255], v[88:91], v[132:135]
s_add_u32 s28, s20, 0
buffer_load_dwordx4 v[64:67], v4, s[8:11], s28 offen offset:0 sc1
s_add_u32 s28, s20, 0
buffer_load_dwordx4 v[68:71], v4, s[8:11], s28 offen offset:2048 sc1
s_add_u32 s28, s20, 4096
buffer_load_dwordx4 v[72:75], v4, s[8:11], s28 offen offset:0 sc1
s_add_u32 s28, s20, 4096
buffer_load_dwordx4 v[76:79], v4, s[8:11], s28 offen offset:2048 sc1
s_add_u32 s28, s20, 8192
buffer_load_dwordx4 v[80:83], v4, s[8:11], s28 offen offset:0 sc1
s_add_u32 s28, s20, 8192
buffer_load_dwordx4 v[84:87], v4, s[8:11], s28 offen offset:2048 sc1
s_add_u32 s28, s20, 12288
buffer_load_dwordx4 v[88:91], v4, s[8:11], s28 offen offset:0 sc1
s_waitcnt vmcnt(15)
v_mfma_f32_16x16x32_bf16 v[24:27], a[112:115], v[92:95], v[24:27]
v_mfma_f32_16x16x32_bf16 v[28:31], a[116:119], v[92:95], v[28:31]
v_mfma_f32_16x16x32_bf16 v[128:131], a[120:123], v[92:95], v[128:131]
v_mfma_f32_16x16x32_bf16 v[132:135], a[124:127], v[92:95], v[132:135]
s_waitcnt vmcnt(14)
v_mfma_f32_16x16x32_bf16 v[24:27], a[128:131], v[96:99], v[24:27]
v_mfma_f32_16x16x32_bf16 v[28:31], a[132:135], v[96:99], v[28:31]
v_mfma_f32_16x16x32_bf16 v[128:131], a[136:139], v[96:99], v[128:131]
v_mfma_f32_16x16x32_bf16 v[132:135], a[140:143], v[96:99], v[132:135]
s_waitcnt vmcnt(13)
v_mfma_f32_16x16x32_bf16 v[24:27], a[144:147], v[100:103], v[24:27]
v_mfma_f32_16x16x32_bf16 v[28:31], a[148:151], v[100:103], v[28:31]
v_mfma_f32_16x16x32_bf16 v[128:131], a[152:155], v[100:103], v[128:131]
v_mfma_f32_16x16x32_bf16 v[132:135], a[156:159], v[100:103], v[132:135]
s_waitcnt vmcnt(12)
v_mfma_f32_16x16x32_bf16 v[24:27], a[160:163], v[104:107], v[24:27]
v_mfma_f32_16x16x32_bf16 v[28:31], a[164:167], v[104:107], v[28:31]
v_mfma_f32_16x16x32_bf16 v[128:131], a[168:171], v[104:107], v[128:131]
v_mfma_f32_16x16x32_bf16 v[132:135], a[172:175], v[104:107], v[132:135]
s_waitcnt vmcnt(11)
v_mfma_f32_16x16x32_bf16 v[24:27], a[176:179], v[108:111], v[24:27]
v_mfma_f32_16x16x32_bf16 v[28:31], a[180:183], v[108:111], v[28:31]
v_mfma_f32_16x16x32_bf16 v[128:131], a[184:187], v[108:111], v[128:131]
v_mfma_f32_16x16x32_bf16 v[132:135], a[188:191], v[108:111], v[132:135]
s_waitcnt vmcnt(10)
v_mfma_f32_16x16x32_bf16 v[24:27], a[192:195], v[112:115], v[24:27]
v_mfma_f32_16x16x32_bf16 v[28:31], a[196:199], v[112:115], v[28:31]
v_mfma_f32_16x16x32_bf16 v[128:131], a[200:203], v[112:115], v[128:131]
v_mfma_f32_16x16x32_bf16 v[132:135], a[204:207], v[112:115], v[132:135]
s_waitcnt vmcnt(9)
v_mfma_f32_16x16x32_bf16 v[24:27], a[208:211], v[116:119], v[24:27]
v_mfma_f32_16x16x32_bf16 v[28:31], a[212:215], v[116:119], v[28:31]
v_mfma_f32_16x16x32_bf16 v[128:131], a[216:219], v[116:119], v[128:131]
v_mfma_f32_16x16x32_bf16 v[132:135], a[220:223], v[116:119], v[132:135]
s_waitcnt vmcnt(8)
v_mfma_f32_16x16x32_bf16 v[24:27], a[224:227], v[120:123], v[24:27]
v_mfma_f32_16x16x32_bf16 v[28:31], a[228:231], v[120:123], v[28:31]
v_mfma_f32_16x16x32_bf16 v[128:131], a[232:235], v[120:123], v[128:131]
v_mfma_f32_16x16x32_bf16 v[132:135], a[236:239], v[120:123], v[132:135]
s_waitcnt vmcnt(7)
v_mfma_f32_16x16x32_bf16 v[24:27], a[240:243], v[124:127], v[24:27]
v_mfma_f32_16x16x32_bf16 v[28:31], a[244:247], v[124:127], v[28:31]
v_mfma_f32_16x16x32_bf16 v[128:131], a[248:251], v[124:127], v[128:131]
v_mfma_f32_16x16x32_bf16 v[132:135], a[252:255], v[124:127], v[132:135]
s_waitcnt vmcnt(6)
v_mfma_f32_16x16x32_bf16 v[24:27], a[0:3], v[64:67], v[24:27]
v_mfma_f32_16x16x32_bf16 v[28:31], a[4:7], v[64:67], v[28:31]
v_mfma_f32_16x16x32_bf16 v[128:131], a[8:11], v[64:67], v[128:131]
v_mfma_f32_16x16x32_bf16 v[132:135], a[12:15], v[64:67], v[132:135]
s_waitcnt vmcnt(5)
v_mfma_f32_16x16x32_bf16 v[24:27], a[16:19], v[68:71], v[24:27]
v_mfma_f32_16x16x32_bf16 v[28:31], a[20:23], v[68:71], v[28:31]
v_mfma_f32_16x16x32_bf16 v[128:131], a[24:27], v[68:71], v[128:131]
v_mfma_f32_16x16x32_bf16 v[132:135], a[28:31], v[68:71], v[132:135]
s_waitcnt vmcnt(4)
v_mfma_f32_16x16x32_bf16 v[24:27], a[32:35], v[72:75], v[24:27]
v_mfma_f32_16x16x32_bf16 v[28:31], a[36:39], v[72:75], v[28:31]
v_mfma_f32_16x16x32_bf16 v[128:131], a[40:43], v[72:75], v[128:131]
v_mfma_f32_16x16x32_bf16 v[132:135], a[44:47], v[72:75], v[132:135]
s_waitcnt vmcnt(3)
v_mfma_f32_16x16x32_bf16 v[24:27], a[48:51], v[76:79], v[24:27]
v_mfma_f32_16x16x32_bf16 v[28:31], a[52:55], v[76:79], v[28:31]
v_mfma_f32_16x16x32_bf16 v[128:131], a[56:59], v[76:79], v[128:131]
v_mfma_f32_16x16x32_bf16 v[132:135], a[60:63], v[76:79], v[132:135]
s_waitcnt vmcnt(2)
v_mfma_f32_16x16x32_bf16 v[24:27], a[64:67], v[80:83], v[24:27]
v_mfma_f32_16x16x32_bf16 v[28:31], a[68:71], v[80:83], v[28:31]
v_mfma_f32_16x16x32_bf16 v[128:131], a[72:75], v[80:83], v[128:131]
v_mfma_f32_16x16x32_bf16 v[132:135], a[76:79], v[80:83], v[132:135]
s_waitcnt vmcnt(1)
v_mfma_f32_16x16x32_bf16 v[24:27], a[80:83], v[84:87], v[24:27]
v_mfma_f32_16x16x32_bf16 v[28:31], a[84:87], v[84:87], v[28:31]
v_mfma_f32_16x16x32_bf16 v[128:131], a[88:91], v[84:87], v[128:131]
v_mfma_f32_16x16x32_bf16 v[132:135], a[92:95], v[84:87], v[132:135]
s_waitcnt vmcnt(0)
v_mfma_f32_16x16x32_bf16 v[24:27], a[96:99], v[88:91], v[24:27]
v_mfma_f32_16x16x32_bf16 v[28:31], a[100:103], v[88:91], v[28:31]
v_mfma_f32_16x16x32_bf16 v[128:131], a[104:107], v[88:91], v[128:131]
v_mfma_f32_16x16x32_bf16 v[132:135], a[108:111], v[88:91], v[132:135]
s_branch G2_ODONE
G2_SLOW:
s_waitcnt vmcnt(6)
v_mfma_f32_16x16x32_bf16 v[24:27], v[144:147], v[64:67], 0
v_mfma_f32_16x16x32_bf16 v[28:31], v[148:151], v[64:67], 0
v_mfma_f32_16x16x32_bf16 v[128:131], v[152:155], v[64:67], 0
v_mfma_f32_16x16x32_bf16 v[132:135], v[156:159], v[64:67], 0
s_waitcnt vmcnt(5)
v_mfma_f32_16x16x32_bf16 v[24:27], v[160:163], v[68:71], v[24:27]
v_mfma_f32_16x16x32_bf16 v[28:31], v[164:167], v[68:71], v[28:31]
v_mfma_f32_16x16x32_bf16 v[128:131], v[168:171], v[68:71], v[128:131]
v_mfma_f32_16x16x32_bf16 v[132:135], v[172:175], v[68:71], v[132:135]
s_waitcnt vmcnt(4)
v_mfma_f32_16x16x32_bf16 v[24:27], v[176:179], v[72:75], v[24:27]
v_mfma_f32_16x16x32_bf16 v[28:31], v[180:183], v[72:75], v[28:31]
v_mfma_f32_16x16x32_bf16 v[128:131], v[184:187], v[72:75], v[128:131]
v_mfma_f32_16x16x32_bf16 v[132:135], v[188:191], v[72:75], v[132:135]
s_waitcnt vmcnt(3)
v_mfma_f32_16x16x32_bf16 v[24:27], v[192:195], v[76:79], v[24:27]
v_mfma_f32_16x16x32_bf16 v[28:31], v[196:199], v[76:79], v[28:31]
v_mfma_f32_16x16x32_bf16 v[128:131], v[200:203], v[76:79], v[128:131]
v_mfma_f32_16x16x32_bf16 v[132:135], v[204:207], v[76:79], v[132:135]
s_waitcnt vmcnt(2)
v_mfma_f32_16x16x32_bf16 v[24:27], v[208:211], v[80:83], v[24:27]
v_mfma_f32_16x16x32_bf16 v[28:31], v[212:215], v[80:83], v[28:31]
v_mfma_f32_16x16x32_bf16 v[128:131], v[216:219], v[80:83], v[128:131]
v_mfma_f32_16x16x32_bf16 v[132:135], v[220:223], v[80:83], v[132:135]
s_waitcnt vmcnt(1)
v_mfma_f32_16x16x32_bf16 v[24:27], v[224:227], v[84:87], v[24:27]
v_mfma_f32_16x16x32_bf16 v[28:31], v[228:231], v[84:87], v[28:31]
v_mfma_f32_16x16x32_bf16 v[128:131], v[232:235], v[84:87], v[128:131]
v_mfma_f32_16x16x32_bf16 v[132:135], v[236:239], v[84:87], v[132:135]
s_waitcnt vmcnt(0)
v_mfma_f32_16x16x32_bf16 v[24:27], v[240:243], v[88:91], v[24:27]
v_mfma_f32_16x16x32_bf16 v[28:31], v[244:247], v[88:91], v[28:31]
v_mfma_f32_16x16x32_bf16 v[128:131], v[248:251], v[88:91], v[128:131]
v_mfma_f32_16x16x32_bf16 v[132:135], v[252:255], v[88:91], v[132:135]
s_nop 7
G2_HE:
v_mov_b32 v40, v24
v_mov_b32 v48, v128
v_mov_b32 v41, v25
v_mov_b32 v49, v129
v_mov_b32 v42, v26
v_mov_b32 v50, v130
v_mov_b32 v43, v27
v_mov_b32 v51, v131
v_mov_b32 v44, v28
v_mov_b32 v52, v132
v_mov_b32 v45, v29
v_mov_b32 v53, v133
v_mov_b32 v46, v30
v_mov_b32 v54, v134
v_mov_b32 v47, v31
v_mov_b32 v55, v135
s_mov_b32 s35, 0
POLL_AT_61:
s_cmp_lg_u32 s37, 0
s_cbranch_scc1 POLL_AT_61_E
buffer_load_dword v17, v7, s[8:11], s30 offen sc1
s_add_u32 s35, s35, 1
s_cmp_gt_u32 s35, 65536
s_cselect_b32 s37, 1, 0
s_waitcnt vmcnt(0)
v_cmp_gt_u32 vcc, s31, v17
s_cbranch_vccz POLL_AT_61_E
s_sleep 1
s_branch POLL_AT_61
POLL_AT_61_E:
G2_OPART:
s_add_u32 s28, s20, 12288
buffer_load_dwordx4 v[92:95], v4, s[8:11], s28 offen offset:2048 sc1
s_add_u32 s28, s20, 16384
buffer_load_dwordx4 v[96:99], v4, s[8:11], s28 offen offset:0 sc1
s_add_u32 s28, s20, 16384
buffer_load_dwordx4 v[100:103], v4, s[8:11], s28 offen offset:2048 sc1
s_add_u32 s28, s20, 20480
buffer_load_dwordx4 v[104:107], v4, s[8:11], s28 offen offset:0 sc1
s_add_u32 s28, s20, 20480
buffer_load_dwordx4 v[108:111], v4, s[8:11], s28 offen offset:2048 sc1
s_add_u32 s28, s20, 24576
buffer_load_dwordx4 v[112:115], v4, s[8:11], s28 offen offset:0 sc1
s_add_u32 s28, s20, 24576
buffer_load_dwordx4 v[116:119], v4, s[8:11], s28 offen offset:2048 sc1
s_add_u32 s28, s20, 28672
buffer_load_dwordx4 v[120:123], v4, s[8:11], s28 offen offset:0 sc1
s_add_u32 s28, s20, 28672
buffer_load_dwordx4 v[124:127], v4, s[8:11], s28 offen offset:2048 sc1
s_add_u32 s28, s20, 0
buffer_load_dwordx4 v[64:67], v4, s[8:11], s28 offen offset:0 sc1
s_add_u32 s28, s20, 0
buffer_load_dwordx4 v[68:71], v4, s[8:11], s28 offen offset:2048 sc1
s_add_u32 s28, s20, 4096
buffer_load_dwordx4 v[72:75], v4, s[8:11], s28 offen offset:0 sc1
s_add_u32 s28, s20, 4096
buffer_load_dwordx4 v[76:79], v4, s[8:11], s28 offen offset:2048 sc1
s_add_u32 s28, s20, 8192
buffer_load_dwordx4 v[80:83], v4, s[8:11], s28 offen offset:0 sc1
s_add_u32 s28, s20, 8192
buffer_load_dwordx4 v[84:87], v4, s[8:11], s28 offen offset:2048 sc1
s_add_u32 s28, s20, 12288
buffer_load_dwordx4 v[88:91], v4, s[8:11], s28 offen offset:0 sc1
s_waitcnt vmcnt(15)
v_mfma_f32_16x16x32_bf16 v[24:27], a[112:115], v[92:95], v[24:27]
v_mfma_f32_16x16x32_bf16 v[28:31], a[116:119], v[92:95], v[28:31]
v_mfma_f32_16x16x32_bf16 v[128:131], a[120:123], v[92:95], v[128:131]
v_mfma_f32_16x16x32_bf16 v[132:135], a[124:127], v[92:95], v[132:135]
s_waitcnt vmcnt(14)
v_mfma_f32_16x16x32_bf16 v[24:27], a[128:131], v[96:99], v[24:27]
v_mfma_f32_16x16x32_bf16 v[28:31], a[132:135], v[96:99], v[28:31]
v_mfma_f32_16x16x32_bf16 v[128:131], a[136:139], v[96:99], v[128:131]
v_mfma_f32_16x16x32_bf16 v[132:135], a[140:143], v[96:99], v[132:135]
s_waitcnt vmcnt(13)
v_mfma_f32_16x16x32_bf16 v[24:27], a[144:147], v[100:103], v[24:27]
v_mfma_f32_16x16x32_bf16 v[28:31], a[148:151], v[100:103], v[28:31]
v_mfma_f32_16x16x32_bf16 v[128:131], a[152:155], v[100:103], v[128:131]
v_mfma_f32_16x16x32_bf16 v[132:135], a[156:159], v[100:103], v[132:135]
s_waitcnt vmcnt(12)
v_mfma_f32_16x16x32_bf16 v[24:27], a[160:163], v[104:107], v[24:27]
v_mfma_f32_16x16x32_bf16 v[28:31], a[164:167], v[104:107], v[28:31]
v_mfma_f32_16x16x32_bf16 v[128:131], a[168:171], v[104:107], v[128:131]
v_mfma_f32_16x16x32_bf16 v[132:135], a[172:175], v[104:107], v[132:135]
s_waitcnt vmcnt(11)
v_mfma_f32_16x16x32_bf16 v[24:27], a[176:179], v[108:111], v[24:27]
v_mfma_f32_16x16x32_bf16 v[28:31], a[180:183], v[108:111], v[28:31]
v_mfma_f32_16x16x32_bf16 v[128:131], a[184:187], v[108:111], v[128:131]
v_mfma_f32_16x16x32_bf16 v[132:135], a[188:191], v[108:111], v[132:135]
s_waitcnt vmcnt(10)
v_mfma_f32_16x16x32_bf16 v[24:27], a[192:195], v[112:115], v[24:27]
v_mfma_f32_16x16x32_bf16 v[28:31], a[196:199], v[112:115], v[28:31]
v_mfma_f32_16x16x32_bf16 v[128:131], a[200:203], v[112:115], v[128:131]
v_mfma_f32_16x16x32_bf16 v[132:135], a[204:207], v[112:115], v[132:135]
s_waitcnt vmcnt(9)
v_mfma_f32_16x16x32_bf16 v[24:27], a[208:211], v[116:119], v[24:27]
v_mfma_f32_16x16x32_bf16 v[28:31], a[212:215], v[116:119], v[28:31]
v_mfma_f32_16x16x32_bf16 v[128:131], a[216:219], v[116:119], v[128:131]
v_mfma_f32_16x16x32_bf16 v[132:135], a[220:223], v[116:119], v[132:135]
s_waitcnt vmcnt(8)
v_mfma_f32_16x16x32_bf16 v[24:27], a[224:227], v[120:123], v[24:27]
v_mfma_f32_16x16x32_bf16 v[28:31], a[228:231], v[120:123], v[28:31]
v_mfma_f32_16x16x32_bf16 v[128:131], a[232:235], v[120:123], v[128:131]
v_mfma_f32_16x16x32_bf16 v[132:135], a[236:239], v[120:123], v[132:135]
s_waitcnt vmcnt(7)
v_mfma_f32_16x16x32_bf16 v[24:27], a[240:243], v[124:127], v[24:27]
v_mfma_f32_16x16x32_bf16 v[28:31], a[244:247], v[124:127], v[28:31]
v_mfma_f32_16x16x32_bf16 v[128:131], a[248:251], v[124:127], v[128:131]
v_mfma_f32_16x16x32_bf16 v[132:135], a[252:255], v[124:127], v[132:135]
s_waitcnt vmcnt(6)
v_mfma_f32_16x16x32_bf16 v[24:27], a[0:3], v[64:67], v[24:27]
v_mfma_f32_16x16x32_bf16 v[28:31], a[4:7], v[64:67], v[28:31]
v_mfma_f32_16x16x32_bf16 v[128:131], a[8:11], v[64:67], v[128:131]
v_mfma_f32_16x16x32_bf16 v[132:135], a[12:15], v[64:67], v[132:135]
s_waitcnt vmcnt(5)
v_mfma_f32_16x16x32_bf16 v[24:27], a[16:19], v[68:71], v[24:27]
v_mfma_f32_16x16x32_bf16 v[28:31], a[20:23], v[68:71], v[28:31]
v_mfma_f32_16x16x32_bf16 v[128:131], a[24:27], v[68:71], v[128:131]
v_mfma_f32_16x16x32_bf16 v[132:135], a[28:31], v[68:71], v[132:135]
s_waitcnt vmcnt(4)
v_mfma_f32_16x16x32_bf16 v[24:27], a[32:35], v[72:75], v[24:27]
v_mfma_f32_16x16x32_bf16 v[28:31], a[36:39], v[72:75], v[28:31]
v_mfma_f32_16x16x32_bf16 v[128:131], a[40:43], v[72:75], v[128:131]
v_mfma_f32_16x16x32_bf16 v[132:135], a[44:47], v[72:75], v[132:135]
s_waitcnt vmcnt(3)
v_mfma_f32_16x16x32_bf16 v[24:27], a[48:51], v[76:79], v[24:27]
v_mfma_f32_16x16x32_bf16 v[28:31], a[52:55], v[76:79], v[28:31]
v_mfma_f32_16x16x32_bf16 v[128:131], a[56:59], v[76:79], v[128:131]
v_mfma_f32_16x16x32_bf16 v[132:135], a[60:63], v[76:79], v[132:135]
s_waitcnt vmcnt(2)
v_mfma_f32_16x16x32_bf16 v[24:27], a[64:67], v[80:83], v[24:27]
v_mfma_f32_16x16x32_bf16 v[28:31], a[68:71], v[80:83], v[28:31]
v_mfma_f32_16x16x32_bf16 v[128:131], a[72:75], v[80:83], v[128:131]
v_mfma_f32_16x16x32_bf16 v[132:135], a[76:79], v[80:83], v[132:135]
s_waitcnt vmcnt(1)
v_mfma_f32_16x16x32_bf16 v[24:27], a[80:83], v[84:87], v[24:27]
v_mfma_f32_16x16x32_bf16 v[28:31], a[84:87], v[84:87], v[28:31]
v_mfma_f32_16x16x32_bf16 v[128:131], a[88:91], v[84:87], v[128:131]
v_mfma_f32_16x16x32_bf16 v[132:135], a[92:95], v[84:87], v[132:135]
s_waitcnt vmcnt(0)
v_mfma_f32_16x16x32_bf16 v[24:27], a[96:99], v[88:91], v[24:27]
v_mfma_f32_16x16x32_bf16 v[28:31], a[100:103], v[88:91], v[28:31]
v_mfma_f32_16x16x32_bf16 v[128:131], a[104:107], v[88:91], v[128:131]
v_mfma_f32_16x16x32_bf16 v[132:135], a[108:111], v[88:91], v[132:135]
G2_ODONE:
s_lshl_b32 s32, s17, 11
s_add_u32 s32, s32, s24
v_add_u32 v16, s32, v5
s_nop 5
s_cmp_lt_u32 s19, 240
s_cbranch_scc1 G2_OOK
v_cmp_u_f32 vcc, v24, v24
s_cbranch_vccz G2_OOK
s_add_u32 s23, s23, 1
s_cmp_gt_u32 s23, 256
s_cbranch_scc1 G2_OOK
v_mov_b32 v24, v40
v_mov_b32 v128, v48
v_mov_b32 v25, v41
v_mov_b32 v129, v49
v_mov_b32 v26, v42
v_mov_b32 v130, v50
v_mov_b32 v27, v43
v_mov_b32 v131, v51
v_mov_b32 v28, v44
v_mov_b32 v132, v52
v_mov_b32 v29, v45
v_mov_b32 v133, v53
v_mov_b32 v30, v46
v_mov_b32 v134, v54
v_mov_b32 v31, v47
v_mov_b32 v135, v55
s_branch G2_OPART
G2_OOK:
v_add_f32_dpp v24, v128, v24 row_ror:8 row_mask:0xf bank_mask:0xf
v_add_f32_dpp v25, v129, v25 row_ror:8 row_mask:0xf bank_mask:0xf
v_add_f32_dpp v26, v130, v26 row_ror:8 row_mask:0xf bank_mask:0xf
v_add_f32_dpp v27, v131, v27 row_ror:8 row_mask:0xf bank_mask:0xf
v_add_f32_dpp v28, v132, v28 row_ror:8 row_mask:0xf bank_mask:0xf
v_add_f32_dpp v29, v133, v29 row_ror:8 row_mask:0xf bank_mask:0xf
v_add_f32_dpp v30, v134, v30 row_ror:8 row_mask:0xf bank_mask:0xf
v_add_f32_dpp v31, v135, v31 row_ror:8 row_mask:0xf bank_mask:0xf
ds_write_b128 v16, v[24:27]
ds_write_b128 v16, v[28:31] offset:1024
s_waitcnt lgkmcnt(0)
s_barrier
s_cmp_lg_u32 s17, 0
s_cbranch_scc1 G2_NEXT
ds_read_b128 v[64:67], v16 offset:2048
ds_read_b128 v[68:71], v16 offset:3072
ds_read_b128 v[72:75], v16 offset:4096
ds_read_b128 v[76:79], v16 offset:5120
ds_read_b128 v[80:83], v16 offset:6144
ds_read_b128 v[84:87], v16 offset:7168
v_lshlrev_b32 v32, 16, v20
v_and_b32 v33, 0xffff0000, v20
v_pk_add_f32 v[24:25], v[24:25], v[8:9]
v_pk_add_f32 v[24:25], v[24:25], v[32:33]
v_lshlrev_b32 v32, 16, v21
v_and_b32 v33, 0xffff0000, v21
v_pk_add_f32 v[26:27], v[26:27], v[10:11]
v_pk_add_f32 v[26:27], v[26:27], v[32:33]
v_lshlrev_b32 v32, 16, v22
v_and_b32 v33, 0xffff0000, v22
v_pk_add_f32 v[28:29], v[28:29], v[12:13]
v_pk_add_f32 v[28:29], v[28:29], v[32:33]
v_lshlrev_b32 v32, 16, v23
v_and_b32 v33, 0xffff0000, v23
v_pk_add_f32 v[30:31], v[30:31], v[14:15]
v_pk_add_f32 v[30:31], v[30:31], v[32:33]
s_waitcnt lgkmcnt(4)
v_pk_add_f32 v[24:25], v[24:25], v[64:65]
v_pk_add_f32 v[26:27], v[26:27], v[66:67]
v_pk_add_f32 v[28:29], v[28:29], v[68:69]
v_pk_add_f32 v[30:31], v[30:31], v[70:71]
s_waitcnt lgkmcnt(2)
v_pk_add_f32 v[24:25], v[24:25], v[72:73]
v_pk_add_f32 v[26:27], v[26:27], v[74:75]
v_pk_add_f32 v[28:29], v[28:29], v[76:77]
v_pk_add_f32 v[30:31], v[30:31], v[78:79]
s_waitcnt lgkmcnt(0)
v_pk_add_f32 v[24:25], v[24:25], v[80:81]
v_pk_add_f32 v[26:27], v[26:27], v[82:83]
v_pk_add_f32 v[28:29], v[28:29], v[84:85]
v_pk_add_f32 v[30:31], v[30:31], v[86:87]
v_cvt_pk_bf16_f32 v36, v24, v25
v_cvt_pk_bf16_f32 v37, v26, v27
v_cvt_pk_bf16_f32 v38, v28, v29
v_cvt_pk_bf16_f32 v39, v30, v31
s_mov_b64 exec, s[26:27]
buffer_store_dwordx4 v[36:39], v6, s[56:59], s22 offen sc1
s_mov_b64 exec, -1
G2_NEXT:
s_xor_b32 s24, s24, 8192
s_add_u32 s19, s19, 10
s_cmp_lt_u32 s19, 256
s_cbranch_scc1 G2_LOOP
s_branch L_FIN
L_CHAIN:
s_load_dwordx4 s[48:51], s[0:1], 16
s_load_dwordx4 s[52:55], s[0:1], 32
s_load_dwordx2 s[56:57], s[0:1], 8
v_and_b32 v100, 15, v0
v_lshrrev_b32 v101, 4, v0
v_and_b32 v102, 3, v0
v_bfe_u32 v103, v0, 2, 2
s_lshl_b32 s34, s16, 8
s_lshl_b32 s35, s17, 6
s_add_u32 s34, s34, s35
v_lshrrev_b32 v10, 2, v0
v_lshlrev_b32 v11, 13, v10
v_xor_b32 v104, 0, v102
v_lshl_add_u32 v11, v104, 4, v11
v_add_u32 v84, s34, v11
v_mov_b32 v76, v84
v_mov_b32 v80, v84
v_lshlrev_b32 v11, 13, v10
v_xor_b32 v104, 2, v102
v_lshl_add_u32 v11, v104, 4, v11
v_add_u32 v85, s34, v11
v_mov_b32 v77, v85
v_mov_b32 v81, v85
v_lshlrev_b32 v11, 13, v10
v_xor_b32 v104, 0, v102
v_lshl_add_u32 v11, v104, 4, v11
v_add_u32 v86, s34, v11
v_mov_b32 v78, v86
v_mov_b32 v82, v86
v_lshlrev_b32 v11, 13, v10
v_xor_b32 v104, 2, v102
v_lshl_add_u32 v11, v104, 4, v11
v_add_u32 v87, s34, v11
v_mov_b32 v79, v87
v_mov_b32 v83, v87
s_lshl_b32 s34, s16, 17
s_lshl_b32 s35, s17, 8
s_add_u32 s34, s34, s35
v_and_b32 v105, 1, v101
v_lshl_add_u32 v10, v105, 2, 0
v_xor_b32 v10, v10, v100
v_xor_b32 v10, 0, v10
v_lshlrev_b32 v11, 10, v101
v_lshl_add_u32 v10, v10, 4, v11
v_add_u32 v88, s34, v10
v_lshl_add_u32 v10, v105, 2, 0
v_xor_b32 v10, v10, v100
v_xor_b32 v10, 8, v10
v_lshlrev_b32 v11, 10, v101
v_lshl_add_u32 v10, v10, 4, v11
v_add_u32 v89, s34, v10
s_lshl_b32 s76, s17, 15
s_lshl_b32 s77, s17, 13
s_add_u32 s77, s77, 131072
s_mov_b32 s62, 0x400000
s_mov_b32 s63, 0x20000
s_getpc_b64 s[68:69]
s_add_u32 s68, s68, 12
s_addc_u32 s69, s69, 0
s_branch CH_SUBE
s_mov_b32 m0, s64
s_add_u32 s64, s64, 1024
buffer_load_dwordx4 v76, s[60:63], s65 offen  lds
s_add_u32 s65, s65, s66
s_mov_b32 m0, s64
s_add_u32 s64, s64, 1024
buffer_load_dwordx4 v77, s[60:63], s65 offen  lds
s_add_u32 s65, s65, s66
s_mov_b32 m0, s64
s_add_u32 s64, s64, 1024
buffer_load_dwordx4 v78, s[60:63], s65 offen  lds
s_add_u32 s65, s65, s66
s_mov_b32 m0, s64
s_add_u32 s64, s64, 1024
buffer_load_dwordx4 v79, s[60:63], s65 offen  lds
s_add_u32 s65, s65, s66
s_mov_b32 m0, s64
s_add_u32 s64, s64, 1024
buffer_load_dwordx4 v80, s[60:63], s65 offen  lds
s_add_u32 s65, s65, s66
s_mov_b32 m0, s64
s_add_u32 s64, s64, 1024
buffer_load_dwordx4 v81, s[60:63], s65 offen  lds
s_add_u32 s65, s65, s66
s_mov_b32 m0, s64
s_add_u32 s64, s64, 1024
buffer_load_dwordx4 v82, s[60:63], s65 offen  lds
s_add_u32 s65, s65, s66
s_mov_b32 m0, s64
s_add_u32 s64, s64, 1024
buffer_load_dwordx4 v83, s[60:63], s65 offen  lds
s_add_u32 s65, s65, s66
s_setpc_b64 s[70:71]
CH_SUBE:
s_waitcnt lgkmcnt(0)
s_mov_b32 s60, s54
s_mov_b32 s61, s55
s_mov_b32 s65, 0
s_mov_b32 s66, 4096
v_mov_b32 v76, v88
v_mov_b32 v77, v88
v_mov_b32 v78, v88
v_mov_b32 v79, v88
v_mov_b32 v80, v89
v_mov_b32 v81, v89
v_mov_b32 v82, v89
v_mov_b32 v83, v89
s_add_u32 s64, s76, 0
s_swappc_b64 s[70:71], s[68:69]
s_add_u32 s64, s76, 8192
s_swappc_b64 s[70:71], s[68:69]
s_add_u32 s64, s76, 16384
s_swappc_b64 s[70:71], s[68:69]
s_add_u32 s64, s76, 24576
s_swappc_b64 s[70:71], s[68:69]
s_mov_b32 s60, s50
s_mov_b32 s61, s51
s_mov_b32 s65, 0
s_mov_b32 s66, 131072
v_mov_b32 v76, v84
v_mov_b32 v77, v85
v_mov_b32 v78, v86
v_mov_b32 v79, v87
v_mov_b32 v80, v84
v_mov_b32 v81, v85
v_mov_b32 v82, v86
v_mov_b32 v83, v87
s_mov_b32 s64, s77
s_swappc_b64 s[70:71], s[68:69]
v_and_b32 v10, 2, v0
v_cmp_eq_u32 vcc, 0, v10
v_mov_b32 v11, 0xeeee
v_mov_b32 v104, 0x4444
v_cndmask_b32 v1, v11, v104, vcc
v_lshlrev_b32 v10, 4, v0
v_add_u32 v3, 131072, v10
s_lshl_b32 s32, s17, 15
v_add_u32 v4, s32, v10
v_lshrrev_b32 v11, 2, v0
v_lshlrev_b32 v11, 1, v11
v_and_b32 v104, 1, v0
v_add_u32 v11, v11, v104
v_lshlrev_b32 v11, 4, v11
v_add_u32 v9, 144640, v11
v_lshlrev_b32 v10, 14, v101
v_lshl_add_u32 v5, v100, 3, v10
v_lshlrev_b32 v10, 4, v102
v_bfe_u32 v11, v0, 2, 1
v_lshl_add_u32 v10, v11, 3, v10
v_lshrrev_b32 v11, 1, v101
v_lshl_add_u32 v10, v11, 2, v10
v_and_b32 v11, 1, v101
v_lshl_add_u32 v6, v11, 8, v10
v_add_u32 v2, 16384, v3
v_mul_u32_u24 v10, 1088, v101
v_lshl_add_u32 v10, v100, 3, v10
s_lshl_b32 s32, s17, 8
s_add_u32 s32, s32, 139264
v_add_u32 v7, s32, v10
v_mul_u32_u24 v10, 1088, v102
v_lshrrev_b32 v11, 2, v0
v_lshl_add_u32 v10, v11, 3, v10
v_add_u32 v8, 139264, v10
v_bfe_u32 v10, v100, 1, 2
v_and_b32 v11, 1, v100
v_lshlrev_b32 v11, 4, v11
v_mov_b32 v104, 0x3f80
v_lshlrev_b32 v104, v11, v104
v_cmp_eq_u32 vcc, 0, v10
s_nop 1
v_cndmask_b32 v112, 0, v104, vcc
v_cmp_eq_u32 vcc, 1, v10
s_nop 1
v_cndmask_b32 v113, 0, v104, vcc
v_cmp_eq_u32 vcc, 2, v10
s_nop 1
v_cndmask_b32 v114, 0, v104, vcc
v_cmp_eq_u32 vcc, 3, v10
s_nop 1
v_cndmask_b32 v115, 0, v104, vcc
s_mov_b32 s38, 0x00ff00ff
s_mov_b32 s39, 0x00ff00ff
s_mov_b32 s40, 0xcccccccc
s_mov_b32 s41, 0xcccccccc
s_mov_b32 s42, 0x3f803f80
s_mov_b32 s30, 0x3e0293ee
s_mov_b32 s31, 0x3e0293ee
s_lshl_b32 s34, s16, 17
s_lshl_b32 s35, s17, 8
s_add_u32 s34, s34, s35
v_and_b32 v105, 1, v101
v_lshrrev_b32 v106, 1, v101
v_and_b32 v107, 1, v103
v_lshrrev_b32 v108, 1, v103
v_lshl_add_u32 v10, v106, 3, v105
v_lshl_add_u32 v10, v108, 4, v10
v_lshl_add_u32 v109, v107, 1, v10
v_lshlrev_b32 v10, 4, v105
v_lshl_add_u32 v10, v106, 2, v10
v_add_u32 v110, v10, v107
v_lshlrev_b32 v10, 6, v109
v_xor_b32 v11, 0, v108
v_lshl_add_u32 v10, v11, 5, v10
v_lshl_add_u32 v10, v102, 3, v10
v_add_u32 v90, s76, v10
v_add_u32 v94, s77, v10
v_lshlrev_b32 v10, 6, v109
v_xor_b32 v11, 1, v108
v_lshl_add_u32 v10, v11, 5, v10
v_lshl_add_u32 v10, v102, 3, v10
v_add_u32 v91, s76, v10
v_add_u32 v95, s77, v10
v_lshl_add_u32 v11, v105, 1, v107
v_xor_b32 v11, 0, v11
v_lshlrev_b32 v10, 8, v110
v_lshl_add_u32 v10, v11, 6, v10
v_lshl_add_u32 v10, v108, 5, v10
v_lshl_add_u32 v10, v102, 3, v10
v_add_u32 v116, s76, v10
v_add_u32 v120, s77, v10
v_lshl_add_u32 v11, v105, 1, v107
v_xor_b32 v11, 1, v11
v_lshlrev_b32 v10, 8, v110
v_lshl_add_u32 v10, v11, 6, v10
v_lshl_add_u32 v10, v108, 5, v10
v_lshl_add_u32 v10, v102, 3, v10
v_add_u32 v117, s76, v10
v_add_u32 v121, s77, v10
v_lshl_add_u32 v11, v105, 1, v107
v_xor_b32 v11, 2, v11
v_lshlrev_b32 v10, 8, v110
v_lshl_add_u32 v10, v11, 6, v10
v_lshl_add_u32 v10, v108, 5, v10
v_lshl_add_u32 v10, v102, 3, v10
v_add_u32 v118, s76, v10
v_add_u32 v122, s77, v10
v_lshl_add_u32 v11, v105, 1, v107
v_xor_b32 v11, 3, v11
v_lshlrev_b32 v10, 8, v110
v_lshl_add_u32 v10, v11, 6, v10
v_lshl_add_u32 v10, v108, 5, v10
v_lshl_add_u32 v10, v102, 3, v10
v_add_u32 v119, s76, v10
v_add_u32 v123, s77, v10
s_mov_b32 s12, s56
s_mov_b32 s13, s57
s_mov_b32 s14, 8192
s_mov_b32 s15, 0x20000
v_lshrrev_b32 v10, 2, v100
v_lshlrev_b32 v10, 1, v10
v_and_b32 v11, 1, v0
v_add_u32 v10, v10, v11
v_lshlrev_b32 v10, 10, v10
v_bfe_u32 v11, v0, 1, 1
v_lshl_add_u32 v10, v11, 5, v10
v_lshl_add_u32 v10, v106, 6, v10
v_lshl_add_u32 v10, v105, 4, v10
s_lshl_b32 s34, s17, 8
v_add_u32 v10, s34, v10
buffer_load_dwordx4 v[16:19], v10, s[12:15], 0 offen
buffer_load_dwordx4 v[12:15], v10, s[12:15], 0 offen offset:128
s_waitcnt vmcnt(32)
s_cmp_eq_u32 s82, 0
s_cbranch_scc1 CV_62
s_cmp_lg_u32 s17, 0
s_cbranch_scc1 CV_62_B
v_readfirstlane_b32 s33, v250
s_lshl_b32 s3, 1, s83
s_nop 2
s_and_b32 s79, s33, s3
s_or_b32 s33, s33, s3
s_cmp_lg_u32 s79, 0
s_cbranch_scc1 CV_62_B
s_cmp_lg_u32 s33, -1
s_cbranch_scc1 DECL_63
s_mov_b64 exec, 1
v_mov_b32 v20, 1
v_mov_b32 v21, 0
v_mov_b32 v22, 0
buffer_atomic_cmpswap v[20:21], v22, s[4:7], 0 offen
s_mov_b64 exec, -1
DECL_63:
CV_62_B:
CV_62:
ds_read_b64_tr_b16 a[128:129], v116 offset:0
ds_read_b64_tr_b16 a[130:131], v116 offset:512
ds_read_b64_tr_b16 a[132:133], v116 offset:2048
ds_read_b64_tr_b16 a[134:135], v116 offset:2560
ds_read_b64_tr_b16 a[160:161], v117 offset:0
ds_read_b64_tr_b16 a[162:163], v117 offset:512
ds_read_b64_tr_b16 a[164:165], v117 offset:2048
ds_read_b64_tr_b16 a[166:167], v117 offset:2560
ds_read_b64_tr_b16 a[192:193], v118 offset:0
ds_read_b64_tr_b16 a[194:195], v118 offset:512
ds_read_b64_tr_b16 a[196:197], v118 offset:2048
ds_read_b64_tr_b16 a[198:199], v118 offset:2560
ds_read_b64_tr_b16 a[224:225], v119 offset:0
ds_read_b64_tr_b16 a[226:227], v119 offset:512
ds_read_b64_tr_b16 a[228:229], v119 offset:2048
s_waitcnt lgkmcnt(13)
ds_read_b64_tr_b16 a[230:231], v119 offset:2560
s_waitcnt lgkmcnt(0)
s_add_u32 s64, s76, 0
s_swappc_b64 s[70:71], s[68:69]
s_waitcnt vmcnt(32)
ds_read_b64_tr_b16 a[136:137], v116 offset:8192
ds_read_b64_tr_b16 a[138:139], v116 offset:8704
ds_read_b64_tr_b16 a[140:141], v116 offset:10240
ds_read_b64_tr_b16 a[142:143], v116 offset:10752
ds_read_b64_tr_b16 a[168:169], v117 offset:8192
ds_read_b64_tr_b16 a[170:171], v117 offset:8704
ds_read_b64_tr_b16 a[172:173], v117 offset:10240
ds_read_b64_tr_b16 a[174:175], v117 offset:10752
ds_read_b64_tr_b16 a[200:201], v118 offset:8192
ds_read_b64_tr_b16 a[202:203], v118 offset:8704
ds_read_b64_tr_b16 a[204:205], v118 offset:10240
ds_read_b64_tr_b16 a[206:207], v118 offset:10752
ds_read_b64_tr_b16 a[232:233], v119 offset:8192
ds_read_b64_tr_b16 a[234:235], v119 offset:8704
ds_read_b64_tr_b16 a[236:237], v119 offset:10240
s_waitcnt lgkmcnt(13)
ds_read_b64_tr_b16 a[238:239], v119 offset:10752
s_waitcnt lgkmcnt(0)
s_add_u32 s64, s76, 8192
s_swappc_b64 s[70:71], s[68:69]
s_waitcnt vmcnt(32)
ds_read_b64_tr_b16 a[144:145], v116 offset:16384
ds_read_b64_tr_b16 a[146:147], v116 offset:16896
ds_read_b64_tr_b16 a[148:149], v116 offset:18432
ds_read_b64_tr_b16 a[150:151], v116 offset:18944
ds_read_b64_tr_b16 a[176:177], v117 offset:16384
ds_read_b64_tr_b16 a[178:179], v117 offset:16896
ds_read_b64_tr_b16 a[180:181], v117 offset:18432
ds_read_b64_tr_b16 a[182:183], v117 offset:18944
ds_read_b64_tr_b16 a[208:209], v118 offset:16384
ds_read_b64_tr_b16 a[210:211], v118 offset:16896
ds_read_b64_tr_b16 a[212:213], v118 offset:18432
ds_read_b64_tr_b16 a[214:215], v118 offset:18944
ds_read_b64_tr_b16 a[240:241], v119 offset:16384
ds_read_b64_tr_b16 a[242:243], v119 offset:16896
ds_read_b64_tr_b16 a[244:245], v119 offset:18432
s_waitcnt lgkmcnt(13)
ds_read_b64_tr_b16 a[246:247], v119 offset:18944
s_waitcnt lgkmcnt(0)
s_add_u32 s64, s76, 16384
s_swappc_b64 s[70:71], s[68:69]
s_waitcnt vmcnt(32)
ds_read_b64_tr_b16 a[152:153], v116 offset:24576
ds_read_b64_tr_b16 a[154:155], v116 offset:25088
ds_read_b64_tr_b16 a[156:157], v116 offset:26624
ds_read_b64_tr_b16 a[158:159], v116 offset:27136
ds_read_b64_tr_b16 a[184:185], v117 offset:24576
ds_read_b64_tr_b16 a[186:187], v117 offset:25088
ds_read_b64_tr_b16 a[188:189], v117 offset:26624
ds_read_b64_tr_b16 a[190:191], v117 offset:27136
ds_read_b64_tr_b16 a[216:217], v118 offset:24576
ds_read_b64_tr_b16 a[218:219], v118 offset:25088
ds_read_b64_tr_b16 a[220:221], v118 offset:26624
ds_read_b64_tr_b16 a[222:223], v118 offset:27136
ds_read_b64_tr_b16 a[248:249], v119 offset:24576
ds_read_b64_tr_b16 a[250:251], v119 offset:25088
ds_read_b64_tr_b16 a[252:253], v119 offset:26624
s_waitcnt lgkmcnt(13)
ds_read_b64_tr_b16 a[254:255], v119 offset:27136
s_waitcnt lgkmcnt(0)
s_mov_b32 s60, s52
s_mov_b32 s61, s53
s_mov_b32 s65, 0
s_add_u32 s64, s76, 24576
s_swappc_b64 s[70:71], s[68:69]
s_waitcnt vmcnt(32)
ds_read_b64_tr_b16 v[128:129], v94 offset:0
ds_read_b64_tr_b16 v[130:131], v94 offset:256
ds_read_b64_tr_b16 v[132:133], v94 offset:2048
ds_read_b64_tr_b16 v[134:135], v94 offset:2304
ds_read_b64_tr_b16 v[192:193], v95 offset:0
ds_read_b64_tr_b16 v[194:195], v95 offset:256
ds_read_b64_tr_b16 v[196:197], v95 offset:2048
ds_read_b64_tr_b16 v[198:199], v95 offset:2304
ds_read_b64_tr_b16 v[136:137], v94 offset:4096
ds_read_b64_tr_b16 v[138:139], v94 offset:4352
ds_read_b64_tr_b16 v[140:141], v94 offset:6144
ds_read_b64_tr_b16 v[142:143], v94 offset:6400
ds_read_b64_tr_b16 v[200:201], v95 offset:4096
ds_read_b64_tr_b16 v[202:203], v95 offset:4352
ds_read_b64_tr_b16 v[204:205], v95 offset:6144
s_waitcnt lgkmcnt(13)
ds_read_b64_tr_b16 v[206:207], v95 offset:6400
s_waitcnt lgkmcnt(0)
s_cmp_eq_u32 s82, 0
s_cbranch_scc1 CV_64
s_mov_b32 s82, 0
s_barrier
v_mov_b32 v22, 163824
s_cmp_lg_u32 s17, 0
s_cbranch_scc1 BC_65
v_mov_b32 v20, s79
ds_write_b32 v22, v20
s_waitcnt lgkmcnt(0)
BC_65:
s_barrier
ds_read_b32 v20, v22
s_waitcnt lgkmcnt(0)
v_readfirstlane_b32 s79, v20
s_barrier
s_cmp_lg_u32 s79, 0
s_cbranch_scc1 L_CLOST
CV_64:
s_mov_b32 s64, s77
s_swappc_b64 s[70:71], s[68:69]
s_waitcnt vmcnt(32)
ds_read_b64_tr_b16 v[144:145], v90 offset:0
ds_read_b64_tr_b16 v[146:147], v90 offset:256
ds_read_b64_tr_b16 v[148:149], v90 offset:2048
ds_read_b64_tr_b16 v[150:151], v90 offset:2304
ds_read_b64_tr_b16 v[208:209], v91 offset:0
ds_read_b64_tr_b16 v[210:211], v91 offset:256
ds_read_b64_tr_b16 v[212:213], v91 offset:2048
ds_read_b64_tr_b16 v[214:215], v91 offset:2304
ds_read_b64_tr_b16 v[152:153], v90 offset:4096
ds_read_b64_tr_b16 v[154:155], v90 offset:4352
ds_read_b64_tr_b16 v[156:157], v90 offset:6144
ds_read_b64_tr_b16 v[158:159], v90 offset:6400
ds_read_b64_tr_b16 v[216:217], v91 offset:4096
ds_read_b64_tr_b16 v[218:219], v91 offset:4352
ds_read_b64_tr_b16 v[220:221], v91 offset:6144
s_waitcnt lgkmcnt(13)
ds_read_b64_tr_b16 v[222:223], v91 offset:6400
s_waitcnt lgkmcnt(0)
s_add_u32 s64, s76, 0
s_swappc_b64 s[70:71], s[68:69]
s_waitcnt vmcnt(32)
ds_read_b64_tr_b16 v[160:161], v90 offset:8192
ds_read_b64_tr_b16 v[162:163], v90 offset:8448
ds_read_b64_tr_b16 v[164:165], v90 offset:10240
ds_read_b64_tr_b16 v[166:167], v90 offset:10496
ds_read_b64_tr_b16 v[224:225], v91 offset:8192
ds_read_b64_tr_b16 v[226:227], v91 offset:8448
ds_read_b64_tr_b16 v[228:229], v91 offset:10240
ds_read_b64_tr_b16 v[230:231], v91 offset:10496
ds_read_b64_tr_b16 v[168:169], v90 offset:12288
ds_read_b64_tr_b16 v[170:171], v90 offset:12544
ds_read_b64_tr_b16 v[172:173], v90 offset:14336
ds_read_b64_tr_b16 v[174:175], v90 offset:14592
ds_read_b64_tr_b16 v[232:233], v91 offset:12288
ds_read_b64_tr_b16 v[234:235], v91 offset:12544
ds_read_b64_tr_b16 v[236:237], v91 offset:14336
s_waitcnt lgkmcnt(13)
ds_read_b64_tr_b16 v[238:239], v91 offset:14592
s_waitcnt lgkmcnt(0)
buffer_load_dword v29, off, s[4:7], 0 offset:8 sc1
s_add_u32 s64, s76, 8192
s_swappc_b64 s[70:71], s[68:69]
s_waitcnt vmcnt(32)
ds_read_b64_tr_b16 v[176:177], v90 offset:16384
ds_read_b64_tr_b16 v[178:179], v90 offset:16640
ds_read_b64_tr_b16 v[180:181], v90 offset:18432
ds_read_b64_tr_b16 v[182:183], v90 offset:18688
ds_read_b64_tr_b16 v[240:241], v91 offset:16384
ds_read_b64_tr_b16 v[242:243], v91 offset:16640
ds_read_b64_tr_b16 v[244:245], v91 offset:18432
ds_read_b64_tr_b16 v[246:247], v91 offset:18688
ds_read_b64_tr_b16 v[184:185], v90 offset:20480
ds_read_b64_tr_b16 v[186:187], v90 offset:20736
ds_read_b64_tr_b16 v[188:189], v90 offset:22528
ds_read_b64_tr_b16 v[190:191], v90 offset:22784
ds_read_b64_tr_b16 v[248:249], v91 offset:20480
ds_read_b64_tr_b16 v[250:251], v91 offset:20736
ds_read_b64_tr_b16 v[252:253], v91 offset:22528
s_waitcnt lgkmcnt(13)
ds_read_b64_tr_b16 v[254:255], v91 offset:22784
s_waitcnt lgkmcnt(0)
s_waitcnt vmcnt(24)
ds_read_b64_tr_b16 a[0:1], v90 offset:24576
ds_read_b64_tr_b16 a[2:3], v90 offset:24832
ds_read_b64_tr_b16 a[4:5], v90 offset:26624
ds_read_b64_tr_b16 a[6:7], v90 offset:26880
ds_read_b64_tr_b16 a[64:65], v91 offset:24576
ds_read_b64_tr_b16 a[66:67], v91 offset:24832
ds_read_b64_tr_b16 a[68:69], v91 offset:26624
ds_read_b64_tr_b16 a[70:71], v91 offset:26880
ds_read_b64_tr_b16 a[8:9], v90 offset:28672
ds_read_b64_tr_b16 a[10:11], v90 offset:28928
ds_read_b64_tr_b16 a[12:13], v90 offset:30720
ds_read_b64_tr_b16 a[14:15], v90 offset:30976
ds_read_b64_tr_b16 a[72:73], v91 offset:28672
ds_read_b64_tr_b16 a[74:75], v91 offset:28928
ds_read_b64_tr_b16 a[76:77], v91 offset:30720
s_waitcnt lgkmcnt(13)
ds_read_b64_tr_b16 a[78:79], v91 offset:30976
s_waitcnt lgkmcnt(0)
s_waitcnt vmcnt(16)
ds_read_b64_tr_b16 a[16:17], v94 offset:0
ds_read_b64_tr_b16 a[18:19], v94 offset:256
ds_read_b64_tr_b16 a[20:21], v94 offset:2048
ds_read_b64_tr_b16 a[22:23], v94 offset:2304
ds_read_b64_tr_b16 a[80:81], v95 offset:0
ds_read_b64_tr_b16 a[82:83], v95 offset:256
ds_read_b64_tr_b16 a[84:85], v95 offset:2048
ds_read_b64_tr_b16 a[86:87], v95 offset:2304
ds_read_b64_tr_b16 a[24:25], v94 offset:4096
ds_read_b64_tr_b16 a[26:27], v94 offset:4352
ds_read_b64_tr_b16 a[28:29], v94 offset:6144
ds_read_b64_tr_b16 a[30:31], v94 offset:6400
ds_read_b64_tr_b16 a[88:89], v95 offset:4096
ds_read_b64_tr_b16 a[90:91], v95 offset:4352
ds_read_b64_tr_b16 a[92:93], v95 offset:6144
s_waitcnt lgkmcnt(13)
ds_read_b64_tr_b16 a[94:95], v95 offset:6400
s_waitcnt lgkmcnt(0)
s_waitcnt vmcnt(8)
ds_read_b64_tr_b16 a[32:33], v90 offset:0
ds_read_b64_tr_b16 a[34:35], v90 offset:256
ds_read_b64_tr_b16 a[36:37], v90 offset:2048
ds_read_b64_tr_b16 a[38:39], v90 offset:2304
ds_read_b64_tr_b16 a[96:97], v91 offset:0
ds_read_b64_tr_b16 a[98:99], v91 offset:256
ds_read_b64_tr_b16 a[100:101], v91 offset:2048
ds_read_b64_tr_b16 a[102:103], v91 offset:2304
ds_read_b64_tr_b16 a[40:41], v90 offset:4096
ds_read_b64_tr_b16 a[42:43], v90 offset:4352
ds_read_b64_tr_b16 a[44:45], v90 offset:6144
ds_read_b64_tr_b16 a[46:47], v90 offset:6400
ds_read_b64_tr_b16 a[104:105], v91 offset:4096
ds_read_b64_tr_b16 a[106:107], v91 offset:4352
ds_read_b64_tr_b16 a[108:109], v91 offset:6144
s_waitcnt lgkmcnt(13)
ds_read_b64_tr_b16 a[110:111], v91 offset:6400
s_waitcnt lgkmcnt(0)
s_mov_b32 s35, 0
L_QW:
v_readfirstlane_b32 s33, v29
s_nop 3
s_bitcmp1_b32 s33, s16
s_cbranch_scc1 L_QOK
s_add_u32 s35, s35, 1
s_cmp_gt_u32 s35, 65536
s_cbranch_scc1 L_QOK
s_sleep 2
buffer_load_dword v29, off, s[4:7], 0 offset:8 sc1
s_waitcnt vmcnt(0)
s_branch L_QW
L_QOK:
s_mov_b32 s60, s8
s_mov_b32 s61, s9
s_mov_b32 s62, 268435456
s_mov_b32 s66, 1024
s_lshl_b32 s65, s16, 2
s_add_u32 s65, s65, s17
s_lshl_b32 s65, s65, 15
s_add_u32 s65, s65, 100532224
v_mov_b32 v76, v3
v_mov_b32 v77, v3
v_mov_b32 v78, v3
v_mov_b32 v79, v3
v_mov_b32 v80, v3
v_mov_b32 v81, v3
v_mov_b32 v82, v3
v_mov_b32 v83, v3
s_add_u32 s64, s76, 16384
s_swappc_b64 s[70:71], s[68:69]
s_add_u32 s64, s76, 24576
s_swappc_b64 s[70:71], s[68:69]
s_add_u32 s64, s76, 0
s_swappc_b64 s[70:71], s[68:69]
s_waitcnt vmcnt(24)
ds_read_b64_tr_b16 a[48:49], v90 offset:8192
ds_read_b64_tr_b16 a[50:51], v90 offset:8448
ds_read_b64_tr_b16 a[52:53], v90 offset:10240
ds_read_b64_tr_b16 a[54:55], v90 offset:10496
ds_read_b64_tr_b16 a[112:113], v91 offset:8192
ds_read_b64_tr_b16 a[114:115], v91 offset:8448
ds_read_b64_tr_b16 a[116:117], v91 offset:10240
ds_read_b64_tr_b16 a[118:119], v91 offset:10496
ds_read_b64_tr_b16 a[56:57], v90 offset:12288
ds_read_b64_tr_b16 a[58:59], v90 offset:12544
ds_read_b64_tr_b16 a[60:61], v90 offset:14336
ds_read_b64_tr_b16 a[62:63], v90 offset:14592
ds_read_b64_tr_b16 a[120:121], v91 offset:12288
ds_read_b64_tr_b16 a[122:123], v91 offset:12544
ds_read_b64_tr_b16 a[124:125], v91 offset:14336
s_waitcnt lgkmcnt(13)
ds_read_b64_tr_b16 a[126:127], v91 offset:14592
s_waitcnt lgkmcnt(0)
s_add_u32 s64, s76, 8192
s_swappc_b64 s[70:71], s[68:69]
CH_QJOIN:
s_waitcnt vmcnt(16)
s_lshl_b32 s88, s16, 7
s_add_u32 s88, s88, 91320320
s_lshr_b32 s89, s16, 1
s_lshl_b32 s89, s89, 9
s_add_u32 s89, s89, 91291648
v_mov_b32 v124, -1
v_mov_b32 v125, -1
v_mov_b32 v126, -1
v_mov_b32 v127, -1
s_lshl_b32 s3, s16, 2
s_add_u32 s3, s3, s17
s_lshl_b32 s3, s3, 10
s_add_u32 s3, s3, 60162048
buffer_store_dwordx4 v[124:127], v3, s[8:11], s3 offen sc1
s_add_u32 s3, s3, 131072
buffer_store_dwordx4 v[124:127], v3, s[8:11], s3 offen sc1
s_add_u32 s3, s3, 131072
buffer_store_dwordx4 v[124:127], v3, s[8:11], s3 offen sc1
s_add_u32 s3, s3, 131072
buffer_store_dwordx4 v[124:127], v3, s[8:11], s3 offen sc1
s_add_u32 s3, s3, 131072
v_and_b32 v11, 3, v0
v_bfe_u32 v10, v0, 2, 1
v_lshlrev_b32 v10, 13, v10
v_lshl_add_u32 v10, v11, 7, v10
v_mov_b32 v24, 0
buffer_load_dwordx2 v[26:27], v24, s[4:7], 0 offen sc1
buffer_load_dword v25, v10, s[8:11], s89 offen sc1
s_waitcnt vmcnt(0)
s_barrier
ds_write_b128 v3, v[112:115] offset:12544
v_lshlrev_b32 v0, 3, v0
s_waitcnt lgkmcnt(0)
L_ORD1:
s_waitcnt vmcnt(0)
v_readfirstlane_b32 s86, v26
v_readfirstlane_b32 s3, v27
s_nop 1
v_min_u32_dpp v25, v25, v25 quad_perm:[1,0,3,2] row_mask:0xf bank_mask:0xf
s_nop 1
v_min_u32_dpp v25, v25, v25 quad_perm:[2,3,0,1] row_mask:0xf bank_mask:0xf
s_nop 1
v_min_u32_dpp v25, v25, v25 row_half_mirror row_mask:0xf bank_mask:0xf
s_nop 0
v_readfirstlane_b32 s85, v25
s_nop 3
s_lshl_b32 s85, s85, 2
s_cmp_ge_u32 s3, 32
s_cselect_b32 s84, 1, s84
s_cselect_b32 s85, s85, 0
s_cmp_lg_u32 s84, 0
s_cbranch_scc1 INIT_66
v_mov_b32 v10, 4
s_mov_b32 s35, 0
POLL_INIT_67:
s_cmp_lg_u32 s37, 0
s_cbranch_scc1 POLL_INIT_67_E
buffer_load_dword v11, v10, s[4:7], 0 offen sc1
s_add_u32 s35, s35, 1
s_cmp_gt_u32 s35, 65536
s_cselect_b32 s37, 1, 0
s_waitcnt vmcnt(0)
v_cmp_gt_u32 vcc, 32, v11
s_cbranch_vccz POLL_INIT_67_E
s_sleep 4
s_branch POLL_INIT_67
POLL_INIT_67_E:
s_mov_b32 s84, 1
INIT_66:
s_cmp_lg_u32 s86, 0
s_cbranch_scc1 L_MODEOK
v_mov_b32 v10, 0
s_mov_b32 s35, 0
POLL_MODE_68:
s_cmp_lg_u32 s37, 0
s_cbranch_scc1 POLL_MODE_68_E
buffer_load_dword v11, v10, s[4:7], 0 offen sc1
s_add_u32 s35, s35, 1
s_cmp_gt_u32 s35, 65536
s_cselect_b32 s37, 1, 0
s_waitcnt vmcnt(0)
v_cmp_gt_u32 vcc, 1, v11
s_cbranch_vccz POLL_MODE_68_E
s_sleep 1
s_branch POLL_MODE_68
POLL_MODE_68_E:
v_readfirstlane_b32 s86, v11
s_nop 3
L_MODEOK:
s_cmp_eq_u32 s86, 1
s_cbranch_scc0 L_SLOW
s_cmp_eq_u32 s17, 1
s_cbranch_scc1 CH_W1f
s_cmp_eq_u32 s17, 2
s_cbranch_scc1 CH_W2f
s_cmp_eq_u32 s17, 3
s_cbranch_scc1 CH_W3f
CH_W0f:
s_mov_b32 s18, 0
s_mov_b32 s29, 0
s_add_u32 s32, s18, 1
s_min_u32 s32, s32, 63
s_cmp_ge_u32 s32, s85
s_cbranch_scc1 RDY_69_S
RDY_69:
s_mov_b32 s75, 147456
s_lshl_b32 s26, s16, 13
s_add_u32 s26, s26, 18743296
s_add_u32 m0, s75, 0
s_add_u32 s32, s26, 0
buffer_load_dwordx4 v3, s[8:11], s32 offen  lds
s_add_u32 m0, s75, 1024
s_add_u32 s32, s26, 1024
buffer_load_dwordx4 v3, s[8:11], s32 offen  lds
s_mov_b32 s34, 0x05040100
s_mov_b32 s35, 0x07060302
v_perm_b32 v44, v17, v16, s34
v_perm_b32 v45, v19, v18, s34
v_perm_b32 v46, v17, v16, s35
v_perm_b32 v47, v19, v18, s35
v_perm_b32 v48, v13, v12, s34
v_perm_b32 v49, v15, v14, s34
v_perm_b32 v50, v13, v12, s35
v_perm_b32 v51, v15, v14, s35
s_mov_b32 s18, 0
s_mov_b32 s75, 155648
s_and_b32 s32, s18, 3
s_lshl_b32 s33, s32, 18
s_lshl_b32 s34, s16, 7
s_add_u32 s19, s33, s34
s_add_u32 s19, s19, 90177536
s_lshl_b32 s35, s16, 13
s_add_u32 s20, s33, s35
s_add_u32 s20, s20, 90046464
s_add_u32 s32, s18, 3
s_and_b32 s32, s32, 3
s_lshl_b32 s33, s32, 18
s_mov_b32 s21, 0
s_lshr_b32 s34, s16, 3
s_lshl_b32 s34, s34, 11
s_and_b32 s35, s16, 1
s_lshl_b32 s35, s35, 9
s_add_u32 s34, s34, s35
s_bfe_u32 s35, s16, 0x20001
s_lshl_b32 s35, s35, 6
s_add_u32 s34, s34, s35
s_lshl_b32 s33, s32, 13
s_add_u32 s24, s33, s34
s_add_u32 s24, s24, 91226112
s_add_u32 s32, s18, 1
s_and_b32 s32, s32, 3
s_lshl_b32 s33, s32, 13
s_add_u32 s22, s33, s34
s_add_u32 s22, s22, 91226112
s_add_u32 s23, s33, 91095040
s_lshl_b32 s32, s18, 5
s_add_u32 s32, s32, s16
s_lshl_b32 s33, s32, 13
s_add_u32 s25, s33, 35520512
s_add_u32 s26, s33, 19005440
s_lshl_b32 s33, s32, 12
s_add_u32 s27, s33, 52297728
s_lshl_b32 s33, s32, 11
s_add_u32 s28, s33, 60817408
s_mov_b32 s82, s27
s_sub_u32 s24, s24, 0
s_mov_b32 s76, 0
s_mov_b32 s77, 8192
s_mov_b32 s79, s19
s_mov_b32 s80, s20
s_sub_u32 s81, s22, 8192
s_mov_b32 s78, s81
ds_read_b128 v[76:79], v4 offset:16384
ds_read_b128 v[80:83], v4 offset:17408
ds_read_b128 v[84:87], v4 offset:18432
ds_read_b128 v[88:91], v4 offset:19456
ds_read_b128 v[92:95], v4 offset:20480
ds_read_b128 v[96:99], v4 offset:21504
ds_read_b128 v[100:103], v4 offset:22528
ds_read_b128 v[104:107], v4 offset:23552
ds_read_b128 v[108:111], v4 offset:24576
ds_read_b128 v[112:115], v4 offset:25600
ds_read_b128 v[116:119], v4 offset:28672
ds_read_b128 v[120:123], v4 offset:29696
v_mov_b32 v28, 0
v_mov_b32 v29, 0
v_mov_b32 v30, 0
v_mov_b32 v31, 0
v_mov_b32 v32, 0
v_mov_b32 v33, 0
v_mov_b32 v34, 0
v_mov_b32 v35, 0
v_mov_b32 v36, 0
v_mov_b32 v37, 0
v_mov_b32 v38, 0
v_mov_b32 v39, 0
v_mov_b32 v40, 0
v_mov_b32 v41, 0
v_mov_b32 v42, 0
v_mov_b32 v43, 0
v_mov_b32 v12, 0
v_mov_b32 v13, 0
v_mov_b32 v14, 0
v_mov_b32 v15, 0
v_mov_b32 v24, 0
v_mov_b32 v25, 0
v_mov_b32 v26, 0
v_mov_b32 v27, 0
s_waitcnt vmcnt(0)
s_waitcnt lgkmcnt(0)
s_mov_b32 s36, 0
v_min_u32 v44, 0xfffffffe, v44
v_min_u32 v45, 0xfffffffe, v45
v_min_u32 v46, 0xfffffffe, v46
v_min_u32 v47, 0xfffffffe, v47
v_min_u32 v48, 0xfffffffe, v48
v_min_u32 v49, 0xfffffffe, v49
v_min_u32 v50, 0xfffffffe, v50
v_min_u32 v51, 0xfffffffe, v51
.p2align 6
CH_BASE_0f:
.fill (((8 - (. - CH_BASE_0f)) & 15) >> 2), 4, 0xbf800000
CH_RB_0f:
s_waitcnt vmcnt(3)
CH_RBE_0f:
v_max3_u32 v10, v44, v45, v46
v_max_u32 v10, v10, v47
v_cmp_eq_u32 vcc, -1, v10
ds_write_b128 v3, v[44:47] offset:0
s_cbranch_vccnz CH_RBRETRY_0f
CH_RBOK_0f:
v_smfmac_f32_16x16x64_bf16 v[28:31], v[44:47], v[76:83], v1
v_smfmac_f32_16x16x64_bf16 v[32:35], v[44:47], v[128:135], v1
ds_read_b128 v[76:79], v4 offset:0
v_smfmac_f32_16x16x64_bf16 v[36:39], v[44:47], v[84:91], v1
ds_read_b128 v[80:83], v4 offset:1024
v_smfmac_f32_16x16x64_bf16 v[40:43], v[44:47], v[192:199], v1
s_waitcnt vmcnt(2)
CH_RBL_0f:
v_max3_u32 v10, v48, v49, v50
v_max_u32 v10, v10, v51
v_cmp_eq_u32 vcc, -1, v10
ds_write_b128 v3, v[48:51] offset:1024
s_cbranch_vccnz CH_RBLRETRY_0f
CH_RBLOK_0f:
v_smfmac_f32_16x16x64_bf16 v[28:31], v[48:51], v[92:99], v1
buffer_store_dwordx4 v[16:19], v3, s[8:11], s82 offen sc1
v_smfmac_f32_16x16x64_bf16 v[32:35], v[48:51], v[136:143], v1
v_smfmac_f32_16x16x64_bf16 v[36:39], v[48:51], v[100:107], v1
v_smfmac_f32_16x16x64_bf16 v[40:43], v[48:51], v[200:207], v1
s_waitcnt lgkmcnt(0)
s_barrier
ds_read_b128 v[52:55], v3 offset:2048
ds_read_b128 v[56:59], v3 offset:3072
v_smfmac_f32_16x16x64_bf16 v[12:15], v[44:47], a[0:7], v1
ds_read_b128 v[60:63], v3 offset:4096
buffer_load_dwordx4 v[16:19], v3, s[8:11], s25 offen
v_smfmac_f32_16x16x64_bf16 v[24:27], v[44:47], a[64:71], v1
ds_read_b128 v[64:67], v3 offset:5120
v_smfmac_f32_16x16x64_bf16 v[12:15], v[48:51], a[8:15], v1
ds_read_b128 v[68:71], v3 offset:6144
v_smfmac_f32_16x16x64_bf16 v[24:27], v[48:51], a[72:79], v1
ds_read_b128 v[72:75], v3 offset:7168
s_waitcnt lgkmcnt(5)
v_smfmac_f32_16x16x64_bf16 v[28:31], v[52:55], v[108:115], v1
ds_read_b128 v[84:87], v4 offset:4096
buffer_load_dwordx4 v[20:23], v3, s[8:11], s25 offen offset:1024
v_smfmac_f32_16x16x64_bf16 v[32:35], v[52:55], v[144:151], v1
ds_read_b128 v[88:91], v4 offset:5120
s_waitcnt lgkmcnt(6)
v_smfmac_f32_16x16x64_bf16 v[28:31], v[56:59], v[116:123], v1
ds_read_b128 v[92:95], v4 offset:8192
v_smfmac_f32_16x16x64_bf16 v[32:35], v[56:59], v[152:159], v1
ds_read_b128 v[96:99], v4 offset:9216
s_waitcnt lgkmcnt(7)
v_smfmac_f32_16x16x64_bf16 v[28:31], v[60:63], v[76:83], v1
ds_read_b128 v[100:103], v4 offset:12288
v_smfmac_f32_16x16x64_bf16 v[32:35], v[60:63], v[160:167], v1
ds_read_b128 v[104:107], v4 offset:13312
s_waitcnt lgkmcnt(8)
s_waitcnt lgkmcnt(4)
v_smfmac_f32_16x16x64_bf16 v[28:31], v[64:67], v[84:91], v1
ds_read_b128 v[108:111], v4 offset:26624
v_smfmac_f32_16x16x64_bf16 v[32:35], v[64:67], v[168:175], v1
ds_read_b128 v[112:115], v4 offset:27648
s_and_b32 s32, s18, 3
s_cmp_ge_u32 s18, 56
s_cselect_b32 s32, 1, s32
s_cmp_lg_u32 s32, 1
s_cbranch_scc1 FLAG_70
s_sub_u32 s32, s18, 1
s_max_i32 s32, s32, 0
s_cmp_gt_u32 s18, 60
s_cselect_b32 s32, s18, s32
v_mov_b32 v10, s32
s_mov_b64 exec, 1
buffer_store_dword v10, off, s[8:11], s88 sc1
s_mov_b64 exec, -1
FLAG_70:
s_waitcnt lgkmcnt(4)
v_smfmac_f32_16x16x64_bf16 v[28:31], v[68:71], v[92:99], v1
ds_read_b128 v[116:119], v4 offset:30720
v_smfmac_f32_16x16x64_bf16 v[32:35], v[68:71], v[176:183], v1
ds_read_b128 v[120:123], v4 offset:31744
s_waitcnt lgkmcnt(4)
v_smfmac_f32_16x16x64_bf16 v[28:31], v[72:75], v[100:107], v1
ds_read_b128 v[76:79], v4 offset:2048
v_smfmac_f32_16x16x64_bf16 v[32:35], v[72:75], v[184:191], v1
ds_read_b128 v[80:83], v4 offset:3072
s_waitcnt lgkmcnt(4)
v_smfmac_f32_16x16x64_bf16 v[36:39], v[52:55], v[108:115], v1
ds_read_b128 v[84:87], v4 offset:6144
s_nop 1
v_smfmac_f32_16x16x64_bf16 v[40:43], v[52:55], v[208:215], v1
ds_read_b128 v[88:91], v4 offset:7168
s_nop 1
s_waitcnt lgkmcnt(4)
v_smfmac_f32_16x16x64_bf16 v[36:39], v[56:59], v[116:123], v1
ds_read_b128 v[92:95], v4 offset:10240
v_smfmac_f32_16x16x64_bf16 v[40:43], v[56:59], v[216:223], v1
ds_read_b128 v[96:99], v4 offset:11264
s_waitcnt lgkmcnt(4)
v_smfmac_f32_16x16x64_bf16 v[36:39], v[60:63], v[76:83], v1
ds_read_b128 v[100:103], v4 offset:14336
s_add_u32 s23, s77, 91095040
v_smfmac_f32_16x16x64_bf16 v[40:43], v[60:63], v[224:231], v1
ds_read_b128 v[104:107], v4 offset:15360
s_waitcnt lgkmcnt(4)
v_smfmac_f32_16x16x64_bf16 v[36:39], v[64:67], v[84:91], v1
ds_read_b128 v[108:111], v2 offset:0
v_smfmac_f32_16x16x64_bf16 v[40:43], v[64:67], v[232:239], v1
ds_read_b128 v[112:115], v2 offset:1024
s_waitcnt lgkmcnt(4)
v_smfmac_f32_16x16x64_bf16 v[36:39], v[68:71], v[92:99], v1
ds_read_b128 v[116:119], v2 offset:2048
v_smfmac_f32_16x16x64_bf16 v[40:43], v[68:71], v[240:247], v1
ds_read_b128 v[120:123], v2 offset:3072
s_waitcnt lgkmcnt(4)
v_smfmac_f32_16x16x64_bf16 v[36:39], v[72:75], v[100:107], v1
ds_read_b128 v[76:79], v2 offset:4096
s_add_u32 m0, s75, 0
s_add_u32 s32, s26, 0
buffer_load_dwordx4 v3, s[8:11], s32 offen  lds
v_smfmac_f32_16x16x64_bf16 v[40:43], v[72:75], v[248:255], v1
s_nop 0
v_pk_add_f32 v[28:29], v[28:29], v[30:31]
v_pk_add_f32 v[32:33], v[32:33], v[34:35]
v_cvt_pk_bf16_f32 v34, v28, v29
v_cvt_pk_bf16_f32 v35, v32, v33
ds_write_b64 v7, v[34:35] offset:0
s_nop 0
v_pk_add_f32 v[36:37], v[36:37], v[38:39]
v_pk_add_f32 v[40:41], v[40:41], v[42:43]
v_cvt_pk_bf16_f32 v32, v36, v37
v_cvt_pk_bf16_f32 v33, v40, v41
ds_write_b64 v7, v[32:33] offset:128
v_smfmac_f32_16x16x64_bf16 v[12:15], v[52:55], a[16:23], v1
ds_read_b128 v[80:83], v2 offset:5120
v_smfmac_f32_16x16x64_bf16 v[24:27], v[52:55], a[80:87], v1
ds_read_b128 v[84:87], v2 offset:6144
v_smfmac_f32_16x16x64_bf16 v[12:15], v[56:59], a[24:31], v1
ds_read_b128 v[88:91], v2 offset:7168
v_smfmac_f32_16x16x64_bf16 v[24:27], v[56:59], a[88:95], v1
s_waitcnt lgkmcnt(3)
s_barrier
ds_read_b64_tr_b16 v[92:93], v8 offset:0
ds_read_b64_tr_b16 v[94:95], v8 offset:256
v_smfmac_f32_16x16x64_bf16 v[12:15], v[60:63], a[32:39], v1
ds_read_b64_tr_b16 v[96:97], v8 offset:512
ds_read_b64_tr_b16 v[98:99], v8 offset:768
v_smfmac_f32_16x16x64_bf16 v[24:27], v[60:63], a[96:103], v1
ds_read_b64_tr_b16 v[100:101], v8 offset:128
ds_read_b64_tr_b16 v[102:103], v8 offset:384
v_smfmac_f32_16x16x64_bf16 v[12:15], v[64:67], a[40:47], v1
ds_read_b64_tr_b16 v[104:105], v8 offset:640
ds_read_b64_tr_b16 v[106:107], v8 offset:896
v_smfmac_f32_16x16x64_bf16 v[24:27], v[64:67], a[104:111], v1
v_mov_b32 v28, s42
v_smfmac_f32_16x16x64_bf16 v[12:15], v[68:71], a[48:55], v1
v_mov_b32 v29, s42
v_smfmac_f32_16x16x64_bf16 v[24:27], v[68:71], a[112:119], v1
v_mov_b32 v30, s42
v_smfmac_f32_16x16x64_bf16 v[12:15], v[72:75], a[56:63], v1
v_mov_b32 v31, s42
s_add_u32 m0, s75, 1024
s_add_u32 s32, s26, 1024
buffer_load_dwordx4 v3, s[8:11], s32 offen  lds
v_smfmac_f32_16x16x64_bf16 v[24:27], v[72:75], a[120:127], v1
s_waitcnt vmcnt(5)
s_waitcnt lgkmcnt(8)
s_cmp_ge_u32 s18, 63
s_cbranch_scc1 CH_DONE_0f
s_waitcnt lgkmcnt(6)
v_mfma_f32_16x16x32_bf16 v[36:39], v[108:111], v[92:95], 0
s_nop 0
s_waitcnt lgkmcnt(4)
v_mfma_f32_16x16x32_bf16 v[36:39], v[112:115], v[96:99], v[36:39]
s_nop 0
s_waitcnt lgkmcnt(2)
v_mfma_f32_16x16x32_bf16 v[36:39], v[116:119], v[100:103], v[36:39]
s_nop 0
s_waitcnt lgkmcnt(0)
v_mfma_f32_16x16x32_bf16 v[36:39], v[120:123], v[104:107], v[36:39]
s_nop 0
v_mfma_f32_16x16x32_bf16 v[40:43], v[76:79], v[92:95], 0
v_add_f32 v12, v12, v14
v_add_f32 v13, v13, v15
v_mfma_f32_16x16x32_bf16 v[40:43], v[80:83], v[96:99], v[40:43]
v_add_f32 v24, v24, v26
v_add_f32 v25, v25, v27
v_mfma_f32_16x16x32_bf16 v[40:43], v[84:87], v[100:103], v[40:43]
v_cvt_pk_bf16_f32 v14, v12, v13
v_mfma_f32_16x16x32_bf16 v[40:43], v[88:91], v[104:107], v[40:43]
v_cvt_pk_bf16_f32 v15, v24, v25
v_mfma_f32_16x16x32_bf16 v[124:127], v[92:95], v[92:95], 0
v_max3_f32 v10, v36, v37, v38
v_mov_b32 v25, 0
s_nop 1
v_mfma_f32_16x16x32_bf16 v[124:127], v[96:99], v[96:99], v[124:127]
v_max_f32 v10, v10, v39
v_mov_b32 v26, 0
s_nop 1
v_mfma_f32_16x16x32_bf16 v[124:127], v[100:103], v[100:103], v[124:127]
v_max3_f32 v10, v10, v40, v41
v_mfma_f32_16x16x32_bf16 v[124:127], v[104:107], v[104:107], v[124:127]
v_max3_f32 v10, v10, v42, v43
s_not_b64 vcc, s[40:41]
v_cndmask_b32_dpp v36, v40, v36, vcc quad_perm:[0,1,0,1] row_mask:0xf bank_mask:0xf
v_cndmask_b32_dpp v37, v41, v37, vcc quad_perm:[0,1,0,1] row_mask:0xf bank_mask:0xf
v_mov_b32_dpp v10, v10 quad_perm:[0,1,0,1] row_mask:0xf bank_mask:0xf
v_cndmask_b32_dpp v38, v42, v38, vcc quad_perm:[0,1,0,1] row_mask:0xf bank_mask:0xf
v_cndmask_b32_dpp v39, v43, v39, vcc quad_perm:[0,1,0,1] row_mask:0xf bank_mask:0xf
v_mov_b32 v76, 0
v_max_f32_dpp v125, v126, v10 quad_perm:[0,1,0,1] row_mask:0xf bank_mask:0xf
v_max_f32_dpp v10, v127, v10 quad_perm:[0,1,0,1] row_mask:0xf bank_mask:0xf
v_max_f32 v124, v125, v10
v_mov_b32 v11, v124
v_mov_b32 v77, 0
v_mov_b32 v78, 0
v_permlane32_swap_b32 v124, v11
v_max_f32 v124, v124, v11
v_mov_b32 v11, v124
v_mov_b32 v79, 0
v_mov_b32 v80, 0
v_permlane16_swap_b32 v124, v11
v_max_f32 v124, v124, v11
v_mul_f32 v10, s30, v124
v_pk_fma_f32 v[126:127], v[126:127], s[30:31], v[10:11] op_sel_hi:[1,1,0] neg_lo:[0,0,1] neg_hi:[0,0,1]
v_pk_fma_f32 v[36:37], v[36:37], s[30:31], v[10:11] op_sel_hi:[1,1,0] neg_lo:[0,0,1] neg_hi:[0,0,1]
v_pk_fma_f32 v[38:39], v[38:39], s[30:31], v[10:11] op_sel_hi:[1,1,0] neg_lo:[0,0,1] neg_hi:[0,0,1]
v_exp_f32 v126, v126
v_exp_f32 v127, v127
v_exp_f32 v36, v36
v_cvt_pk_bf16_f32 v24, v126, v127
v_cvt_pk_bf16_f32 v27, v126, v127
v_exp_f32 v37, v37
v_exp_f32 v38, v38
v_mfma_f32_16x16x16_bf16 v[68:71], v[28:29], v[24:25], 0
v_exp_f32 v39, v39
v_cvt_pk_bf16_f32 v32, v36, v37
v_cvt_pk_bf16_f32 v33, v38, v39
v_mfma_f32_16x16x16_bf16 v[44:47], v[14:15], v[24:25], 0
v_mov_b32_dpp v34, v32 quad_perm:[2,3,2,3] row_mask:0xf bank_mask:0xf
v_mov_b32_dpp v35, v33 quad_perm:[2,3,2,3] row_mask:0xf bank_mask:0xf
v_mfma_f32_16x16x16_bf16 v[48:51], v[14:15], v[26:27], 0
s_waitcnt vmcnt(2)
v_mfma_f32_16x16x32_bf16 v[68:71], v[28:31], v[32:35], v[68:71]
v_mov_b32 v81, 0
v_mov_b32 v82, 0
v_mfma_f32_16x16x32_bf16 v[44:47], v[16:19], v[32:35], v[44:47]
v_mov_b32 v83, 0
v_mov_b32 v84, 0
v_mfma_f32_16x16x32_bf16 v[48:51], v[20:23], v[32:35], v[48:51]
v_mov_b32 v85, 0
v_mov_b32 v86, 0
v_rcp_f32 v10, v68
v_mov_b32 v87, 0
v_mov_b32 v88, 0
v_mov_b32 v89, 0
v_pk_mul_f32 v[44:45], v[44:45], v[10:11] op_sel_hi:[1,0]
v_pk_mul_f32 v[46:47], v[46:47], v[10:11] op_sel_hi:[1,0]
v_mov_b32 v90, 0
v_pk_mul_f32 v[48:49], v[48:49], v[10:11] op_sel_hi:[1,0]
v_pk_mul_f32 v[50:51], v[50:51], v[10:11] op_sel_hi:[1,0]
v_cvt_pk_bf16_f32 v52, v44, v45
v_cvt_pk_bf16_f32 v53, v46, v47
v_cvt_pk_bf16_f32 v54, v48, v49
v_cvt_pk_bf16_f32 v55, v50, v51
s_not_b64 exec, s[40:41]
ds_write_b128 v9, v[52:55] offset:0
s_mov_b64 exec, -1
v_mov_b32 v91, 0
v_mov_b32_dpp v56, v52 quad_perm:[0,1,0,1] row_mask:0xf bank_mask:0xf
v_mov_b32_dpp v57, v53 quad_perm:[0,1,0,1] row_mask:0xf bank_mask:0xf
v_mov_b32_dpp v58, v54 quad_perm:[0,1,0,1] row_mask:0xf bank_mask:0xf
v_mov_b32_dpp v59, v55 quad_perm:[0,1,0,1] row_mask:0xf bank_mask:0xf
s_nop 1
v_smfmac_f32_16x16x64_bf16 v[76:79], v[56:59], a[128:135], v1
v_mov_b32_dpp v10, v14 quad_perm:[2,3,2,3] row_mask:0xf bank_mask:0xf
v_cndmask_b32 v16, v14, v92, s[40:41]
v_smfmac_f32_16x16x64_bf16 v[80:83], v[56:59], a[160:167], v1
v_mov_b32_dpp v11, v15 quad_perm:[2,3,2,3] row_mask:0xf bank_mask:0xf
v_cndmask_b32 v17, v15, v93, s[40:41]
s_waitcnt lgkmcnt(0)
s_barrier
ds_read_b128 v[60:63], v9 offset:512
ds_read_b128 v[64:67], v9 offset:1024
ds_read_b128 v[68:71], v9 offset:1536
v_smfmac_f32_16x16x64_bf16 v[84:87], v[56:59], a[192:199], v1
v_cndmask_b32 v18, v10, v94, s[40:41]
v_smfmac_f32_16x16x64_bf16 v[88:91], v[56:59], a[224:231], v1
v_cndmask_b32 v19, v11, v95, s[40:41]
s_waitcnt lgkmcnt(2)
v_smfmac_f32_16x16x64_bf16 v[76:79], v[60:63], a[136:143], v1
s_waitcnt lgkmcnt(1)
v_smfmac_f32_16x16x64_bf16 v[76:79], v[64:67], a[144:151], v1
s_waitcnt lgkmcnt(0)
v_smfmac_f32_16x16x64_bf16 v[76:79], v[68:71], a[152:159], v1
v_smfmac_f32_16x16x64_bf16 v[80:83], v[60:63], a[168:175], v1
s_nop 2
v_smfmac_f32_16x16x64_bf16 v[80:83], v[64:67], a[176:183], v1
s_nop 2
v_cvt_pk_bf16_f32 v92, v76, v77
v_smfmac_f32_16x16x64_bf16 v[80:83], v[68:71], a[184:191], v1
v_cvt_pk_bf16_f32 v93, v78, v79
v_and_or_b32 v92, v92, -2, s21
buffer_store_dwordx2 v[92:93], v5, s[8:11], s19 offen
v_smfmac_f32_16x16x64_bf16 v[84:87], v[60:63], a[200:207], v1
s_nop 2
v_smfmac_f32_16x16x64_bf16 v[84:87], v[64:67], a[208:215], v1
s_nop 2
v_cvt_pk_bf16_f32 v94, v80, v81
v_smfmac_f32_16x16x64_bf16 v[84:87], v[68:71], a[216:223], v1
v_cvt_pk_bf16_f32 v95, v82, v83
v_and_or_b32 v94, v94, -2, s21
s_add_u32 s32, s19, 8192
buffer_store_dwordx2 v[94:95], v5, s[8:11], s32 offen
v_smfmac_f32_16x16x64_bf16 v[88:91], v[60:63], a[232:239], v1
s_nop 2
v_smfmac_f32_16x16x64_bf16 v[88:91], v[64:67], a[240:247], v1
s_nop 2
v_cvt_pk_bf16_f32 v96, v84, v85
v_smfmac_f32_16x16x64_bf16 v[88:91], v[68:71], a[248:255], v1
v_cvt_pk_bf16_f32 v97, v86, v87
v_and_or_b32 v96, v96, -2, s21
s_add_u32 s32, s19, 4096
buffer_store_dwordx2 v[96:97], v5, s[8:11], s32 offen
s_nop 4
v_cvt_pk_bf16_f32 v98, v88, v89
v_cvt_pk_bf16_f32 v99, v90, v91
v_and_or_b32 v98, v98, -2, s21
s_add_u32 s32, s19, 12288
buffer_store_dwordx2 v[98:99], v5, s[8:11], s32 offen
s_mov_b32 s36, 0
ds_read_b128 v[68:71], v3 offset:12544
s_nop 15
s_nop 15
s_nop 5
buffer_load_dwordx4 v[52:55], v3, s[8:11], s20 offen offset:0 sc1
buffer_load_dwordx4 v[56:59], v3, s[8:11], s20 offen offset:1024 sc1
buffer_load_dwordx4 v[60:63], v3, s[8:11], s20 offen offset:2048 sc1
buffer_load_dwordx4 v[64:67], v3, s[8:11], s20 offen offset:3072 sc1
v_mov_b32 v28, 0
v_mov_b32 v29, 0
v_mov_b32 v30, 0
v_mov_b32 v31, 0
v_mov_b32 v32, 0
v_mov_b32 v33, 0
v_mov_b32 v34, 0
v_mov_b32 v35, 0
v_mov_b32 v36, 0
v_mov_b32 v37, 0
v_mov_b32 v38, 0
v_mov_b32 v39, 0
v_mov_b32 v40, 0
v_mov_b32 v41, 0
v_mov_b32 v42, 0
v_mov_b32 v43, 0
v_mov_b32 v12, 0
v_mov_b32 v13, 0
v_mov_b32 v14, 0
v_mov_b32 v15, 0
v_mov_b32 v24, 0
v_mov_b32 v25, 0
v_mov_b32 v26, 0
v_mov_b32 v27, 0
v_xor_b32 v2, 8192, v2
s_xor_b32 s75, s75, 8192
ds_read_b128 v[76:79], v4 offset:16384
ds_read_b128 v[80:83], v4 offset:17408
ds_read_b128 v[84:87], v4 offset:18432
ds_read_b128 v[88:91], v4 offset:19456
ds_read_b128 v[92:95], v4 offset:20480
ds_read_b128 v[96:99], v4 offset:21504
s_waitcnt lgkmcnt(6)
CH_RA_0f:
s_waitcnt vmcnt(3)
v_bitop3_b32 v10, v52, v54, s21 bitop3:0x7e
v_mfma_f32_16x16x32_bf16 v[72:75], v[52:55], v[68:71], 0
s_waitcnt vmcnt(2)
v_bitop3_b32 v11, v56, v58, s21 bitop3:0x7e
v_mfma_f32_16x16x32_bf16 v[72:75], v[56:59], v[68:71], v[72:75]
v_or_b32 v10, v10, v11
s_waitcnt vmcnt(1)
v_bitop3_b32 v11, v60, v62, s21 bitop3:0x7e
v_mfma_f32_16x16x32_bf16 v[72:75], v[60:63], v[68:71], v[72:75]
v_or_b32 v10, v10, v11
s_waitcnt vmcnt(0)
v_bitop3_b32 v11, v64, v66, s21 bitop3:0x7e
v_mfma_f32_16x16x32_bf16 v[72:75], v[64:67], v[68:71], v[72:75]
v_bitop3_b32 v10, v10, v11, 1 bitop3:0xa8
v_cmp_ne_u32 vcc, 0, v10
s_cbranch_vccnz CH_RARETRY_0f
CH_RAOK_0f:
s_nop 4
v_permlane32_swap_b32 v72, v74
v_permlane32_swap_b32 v73, v75
s_mov_b64 exec, s[38:39]
v_pk_add_f32 v[72:73], v[72:73], v[74:75]
v_cvt_pk_bf16_f32 v72, v72, v73
buffer_store_dword v72, v6, s[8:11], s22 offen
s_mov_b64 exec, -1
ds_read_b128 v[100:103], v4 offset:22528
ds_read_b128 v[104:107], v4 offset:23552
ds_read_b128 v[108:111], v4 offset:24576
ds_read_b128 v[112:115], v4 offset:25600
ds_read_b128 v[116:119], v4 offset:28672
ds_read_b128 v[120:123], v4 offset:29696
s_mov_b32 s36, 0
s_mov_b32 s82, s27
s_add_u32 s25, s25, 262144
s_add_u32 s26, s26, 262144
s_add_u32 s27, s27, 131072
s_sub_u32 s24, s78, 0
s_mov_b32 s78, s22
s_add_u32 s77, s77, 8192
s_and_b32 s77, s77, 0x7fff
s_add_u32 s22, s77, s81
s_add_u32 s18, s18, 1
s_xor_b32 s21, s21, 1
s_barrier
s_nop 3
buffer_load_dwordx4 v[44:47], v3, s[8:11], s23 offen offset:0 sc1
s_nop 15
buffer_load_dwordx4 v[48:51], v3, s[8:11], s23 offen offset:1024 sc1
s_nop 15
buffer_load_dwordx4 v[44:47], v3, s[8:11], s23 offen offset:0 sc1
buffer_load_dwordx4 v[48:51], v3, s[8:11], s23 offen offset:1024 sc1
s_waitcnt lgkmcnt(0)
s_branch CH_RB_0f
CH_RARETRY_0f:
buffer_load_dwordx4 v[52:55], v3, s[8:11], s20 offen offset:0 sc1
buffer_load_dwordx4 v[56:59], v3, s[8:11], s20 offen offset:1024 sc1
buffer_load_dwordx4 v[60:63], v3, s[8:11], s20 offen offset:2048 sc1
buffer_load_dwordx4 v[64:67], v3, s[8:11], s20 offen offset:3072 sc1
s_add_u32 s36, s36, 1
s_cmp_gt_u32 s36, 65536
s_cbranch_scc1 CH_RAOK_0f
s_branch CH_RA_0f
CH_RBRETRY_0f:
buffer_load_dwordx4 v[44:47], v3, s[8:11], s23 offen offset:0 sc1
buffer_load_dwordx4 v[48:51], v3, s[8:11], s23 offen offset:1024 sc1
s_add_u32 s36, s36, 1
s_cmp_gt_u32 s36, 65536
s_cbranch_scc1 CH_RBOK_0f
s_branch CH_RB_0f
CH_RBLRETRY_0f:
buffer_load_dwordx4 v[48:51], v3, s[8:11], s23 offen offset:1024 sc1
s_add_u32 s36, s36, 1
s_cmp_gt_u32 s36, 65536
s_cbranch_scc1 CH_RBLOK_0f
s_waitcnt vmcnt(1)
s_branch CH_RBL_0f
CH_DONE_0f:
s_waitcnt lgkmcnt(0)
s_nop 4
v_add_f32 v12, v12, v14
v_add_f32 v13, v13, v15
v_add_f32 v24, v24, v26
v_add_f32 v25, v25, v27
v_cvt_pk_bf16_f32 v14, v12, v13
v_cvt_pk_bf16_f32 v15, v24, v25
s_nop 1
v_mov_b32_dpp v10, v14 quad_perm:[2,3,2,3] row_mask:0xf bank_mask:0xf
v_mov_b32_dpp v11, v15 quad_perm:[2,3,2,3] row_mask:0xf bank_mask:0xf
v_cndmask_b32 v36, v14, v92, s[40:41]
v_cndmask_b32 v37, v15, v93, s[40:41]
v_cndmask_b32 v38, v10, v94, s[40:41]
v_cndmask_b32 v39, v11, v95, s[40:41]
buffer_store_dwordx4 v[36:39], v3, s[8:11], s27 offen sc1
s_barrier
v_mov_b32 v10, 64
s_mov_b64 exec, 1
buffer_store_dword v10, off, s[8:11], s88 sc1
s_mov_b64 exec, -1
s_branch L_FIN
RDY_69_S:
s_add_u32 s32, s18, 1
s_min_u32 s32, s32, 63
s_lshr_b32 s32, s32, 2
s_add_u32 s32, s32, 1
v_lshrrev_b32 v10, 3, v0
v_and_b32 v11, 3, v10
v_bfe_u32 v10, v10, 2, 1
v_lshlrev_b32 v10, 13, v10
v_lshl_add_u32 v10, v11, 7, v10
s_mov_b32 s35, 0
POLL_KV_71:
s_cmp_lg_u32 s37, 0
s_cbranch_scc1 POLL_KV_71_E
buffer_load_dword v11, v10, s[8:11], s89 offen sc1
s_add_u32 s35, s35, 1
s_cmp_gt_u32 s35, 65536
s_cselect_b32 s37, 1, 0
s_waitcnt vmcnt(0)
v_cmp_gt_u32 vcc, s32, v11
s_cbranch_vccz POLL_KV_71_E
s_branch POLL_KV_71
POLL_KV_71_E:
s_nop 1
v_min_u32_dpp v11, v11, v11 quad_perm:[1,0,3,2] row_mask:0xf bank_mask:0xf
s_nop 1
v_min_u32_dpp v11, v11, v11 quad_perm:[2,3,0,1] row_mask:0xf bank_mask:0xf
s_nop 1
v_min_u32_dpp v11, v11, v11 row_half_mirror row_mask:0xf bank_mask:0xf
s_nop 0
v_readfirstlane_b32 s85, v11
s_nop 3
s_lshl_b32 s85, s85, 2
s_branch RDY_69
CH_W1f:
s_mov_b32 s18, 0
s_mov_b32 s29, 0
s_add_u32 s32, s18, 1
s_min_u32 s32, s32, 63
s_cmp_ge_u32 s32, s85
s_cbranch_scc1 RDY_72_S
RDY_72:
s_mov_b32 s75, 147456
s_lshl_b32 s26, s16, 13
s_add_u32 s26, s26, 18743296
s_add_u32 m0, s75, 2048
s_add_u32 s32, s26, 2048
buffer_load_dwordx4 v3, s[8:11], s32 offen  lds
s_add_u32 m0, s75, 3072
s_add_u32 s32, s26, 3072
buffer_load_dwordx4 v3, s[8:11], s32 offen  lds
s_mov_b32 s34, 0x05040100
s_mov_b32 s35, 0x07060302
v_perm_b32 v52, v17, v16, s34
v_perm_b32 v53, v19, v18, s34
v_perm_b32 v54, v17, v16, s35
v_perm_b32 v55, v19, v18, s35
v_perm_b32 v56, v13, v12, s34
v_perm_b32 v57, v15, v14, s34
v_perm_b32 v58, v13, v12, s35
v_perm_b32 v59, v15, v14, s35
s_mov_b32 s18, 0
s_mov_b32 s75, 155648
s_and_b32 s32, s18, 3
s_lshl_b32 s33, s32, 18
s_lshl_b32 s34, s16, 7
s_add_u32 s19, s33, s34
s_add_u32 s19, s19, 90243072
s_lshl_b32 s35, s16, 13
s_add_u32 s20, s33, s35
s_add_u32 s20, s20, 90050560
s_add_u32 s32, s18, 3
s_and_b32 s32, s32, 3
s_lshl_b32 s33, s32, 18
s_mov_b32 s21, 0
s_lshr_b32 s34, s16, 3
s_lshl_b32 s34, s34, 11
s_and_b32 s35, s16, 1
s_lshl_b32 s35, s35, 9
s_add_u32 s34, s34, s35
s_bfe_u32 s35, s16, 0x20001
s_lshl_b32 s35, s35, 6
s_add_u32 s34, s34, s35
s_lshl_b32 s33, s32, 13
s_add_u32 s24, s33, s34
s_add_u32 s24, s24, 91227136
s_add_u32 s32, s18, 1
s_and_b32 s32, s32, 3
s_lshl_b32 s33, s32, 13
s_add_u32 s22, s33, s34
s_add_u32 s22, s22, 91227136
s_add_u32 s23, s33, 91097088
s_lshl_b32 s32, s18, 5
s_add_u32 s32, s32, s16
s_lshl_b32 s33, s32, 13
s_add_u32 s25, s33, 35522560
s_add_u32 s26, s33, 19005440
s_lshl_b32 s33, s32, 12
s_add_u32 s27, s33, 52298752
s_lshl_b32 s33, s32, 11
s_add_u32 s28, s33, 60817920
s_mov_b32 s82, s27
s_sub_u32 s24, s24, 1024
s_mov_b32 s76, 0
s_mov_b32 s77, 8192
s_mov_b32 s79, s19
s_mov_b32 s80, s20
s_sub_u32 s81, s22, 8192
s_mov_b32 s78, s81
ds_read_b128 v[76:79], v4 offset:24576
ds_read_b128 v[80:83], v4 offset:25600
ds_read_b128 v[84:87], v4 offset:26624
ds_read_b128 v[88:91], v4 offset:27648
ds_read_b128 v[92:95], v4 offset:28672
ds_read_b128 v[96:99], v4 offset:29696
ds_read_b128 v[100:103], v4 offset:30720
ds_read_b128 v[104:107], v4 offset:31744
ds_read_b128 v[108:111], v4 offset:0
ds_read_b128 v[112:115], v4 offset:1024
ds_read_b128 v[116:119], v4 offset:4096
ds_read_b128 v[120:123], v4 offset:5120
v_mov_b32 v28, 0
v_mov_b32 v29, 0
v_mov_b32 v30, 0
v_mov_b32 v31, 0
v_mov_b32 v32, 0
v_mov_b32 v33, 0
v_mov_b32 v34, 0
v_mov_b32 v35, 0
v_mov_b32 v36, 0
v_mov_b32 v37, 0
v_mov_b32 v38, 0
v_mov_b32 v39, 0
v_mov_b32 v40, 0
v_mov_b32 v41, 0
v_mov_b32 v42, 0
v_mov_b32 v43, 0
v_mov_b32 v12, 0
v_mov_b32 v13, 0
v_mov_b32 v14, 0
v_mov_b32 v15, 0
v_mov_b32 v24, 0
v_mov_b32 v25, 0
v_mov_b32 v26, 0
v_mov_b32 v27, 0
s_waitcnt vmcnt(0)
s_waitcnt lgkmcnt(0)
s_mov_b32 s36, 0
v_min_u32 v52, 0xfffffffe, v52
v_min_u32 v53, 0xfffffffe, v53
v_min_u32 v54, 0xfffffffe, v54
v_min_u32 v55, 0xfffffffe, v55
v_min_u32 v56, 0xfffffffe, v56
v_min_u32 v57, 0xfffffffe, v57
v_min_u32 v58, 0xfffffffe, v58
v_min_u32 v59, 0xfffffffe, v59
.p2align 6
CH_BASE_1f:
.fill (((8 - (. - CH_BASE_1f)) & 15) >> 2), 4, 0xbf800000
CH_RB_1f:
s_waitcnt vmcnt(3)
CH_RBE_1f:
v_max3_u32 v10, v52, v53, v54
v_max_u32 v10, v10, v55
v_cmp_eq_u32 vcc, -1, v10
ds_write_b128 v3, v[52:55] offset:2048
s_cbranch_vccnz CH_RBRETRY_1f
CH_RBOK_1f:
v_smfmac_f32_16x16x64_bf16 v[28:31], v[52:55], v[76:83], v1
v_smfmac_f32_16x16x64_bf16 v[32:35], v[52:55], v[144:151], v1
ds_read_b128 v[76:79], v4 offset:8192
v_smfmac_f32_16x16x64_bf16 v[36:39], v[52:55], v[84:91], v1
ds_read_b128 v[80:83], v4 offset:9216
v_smfmac_f32_16x16x64_bf16 v[40:43], v[52:55], v[208:215], v1
s_waitcnt vmcnt(2)
CH_RBL_1f:
v_max3_u32 v10, v56, v57, v58
v_max_u32 v10, v10, v59
v_cmp_eq_u32 vcc, -1, v10
ds_write_b128 v3, v[56:59] offset:3072
s_cbranch_vccnz CH_RBLRETRY_1f
CH_RBLOK_1f:
v_smfmac_f32_16x16x64_bf16 v[28:31], v[56:59], v[92:99], v1
v_smfmac_f32_16x16x64_bf16 v[32:35], v[56:59], v[152:159], v1
buffer_store_dwordx4 v[16:19], v3, s[8:11], s82 offen sc1
v_smfmac_f32_16x16x64_bf16 v[36:39], v[56:59], v[100:107], v1
v_smfmac_f32_16x16x64_bf16 v[40:43], v[56:59], v[216:223], v1
s_waitcnt lgkmcnt(0)
s_barrier
ds_read_b128 v[60:63], v3 offset:4096
ds_read_b128 v[64:67], v3 offset:5120
v_smfmac_f32_16x16x64_bf16 v[12:15], v[52:55], a[16:23], v1
ds_read_b128 v[68:71], v3 offset:6144
v_smfmac_f32_16x16x64_bf16 v[24:27], v[52:55], a[80:87], v1
ds_read_b128 v[72:75], v3 offset:7168
buffer_load_dwordx4 v[16:19], v3, s[8:11], s25 offen
v_smfmac_f32_16x16x64_bf16 v[12:15], v[56:59], a[24:31], v1
ds_read_b128 v[44:47], v3 offset:0
v_smfmac_f32_16x16x64_bf16 v[24:27], v[56:59], a[88:95], v1
ds_read_b128 v[48:51], v3 offset:1024
s_waitcnt lgkmcnt(5)
v_smfmac_f32_16x16x64_bf16 v[28:31], v[60:63], v[108:115], v1
ds_read_b128 v[84:87], v4 offset:12288
v_smfmac_f32_16x16x64_bf16 v[32:35], v[60:63], v[160:167], v1
ds_read_b128 v[88:91], v4 offset:13312
buffer_load_dwordx4 v[20:23], v3, s[8:11], s25 offen offset:1024
s_waitcnt lgkmcnt(6)
v_smfmac_f32_16x16x64_bf16 v[28:31], v[64:67], v[116:123], v1
ds_read_b128 v[92:95], v4 offset:16384
v_smfmac_f32_16x16x64_bf16 v[32:35], v[64:67], v[168:175], v1
ds_read_b128 v[96:99], v4 offset:17408
s_waitcnt lgkmcnt(7)
v_smfmac_f32_16x16x64_bf16 v[28:31], v[68:71], v[76:83], v1
ds_read_b128 v[100:103], v4 offset:20480
v_smfmac_f32_16x16x64_bf16 v[32:35], v[68:71], v[176:183], v1
ds_read_b128 v[104:107], v4 offset:21504
s_waitcnt lgkmcnt(8)
s_waitcnt lgkmcnt(4)
v_smfmac_f32_16x16x64_bf16 v[28:31], v[72:75], v[84:91], v1
ds_read_b128 v[108:111], v4 offset:2048
v_smfmac_f32_16x16x64_bf16 v[32:35], v[72:75], v[184:191], v1
ds_read_b128 v[112:115], v4 offset:3072
s_waitcnt lgkmcnt(4)
v_smfmac_f32_16x16x64_bf16 v[28:31], v[44:47], v[92:99], v1
ds_read_b128 v[116:119], v4 offset:6144
v_smfmac_f32_16x16x64_bf16 v[32:35], v[44:47], v[128:135], v1
ds_read_b128 v[120:123], v4 offset:7168
s_waitcnt lgkmcnt(4)
v_smfmac_f32_16x16x64_bf16 v[28:31], v[48:51], v[100:107], v1
ds_read_b128 v[76:79], v4 offset:10240
v_smfmac_f32_16x16x64_bf16 v[32:35], v[48:51], v[136:143], v1
ds_read_b128 v[80:83], v4 offset:11264
s_waitcnt lgkmcnt(4)
v_smfmac_f32_16x16x64_bf16 v[36:39], v[60:63], v[108:115], v1
ds_read_b128 v[84:87], v4 offset:14336
s_nop 1
v_smfmac_f32_16x16x64_bf16 v[40:43], v[60:63], v[224:231], v1
ds_read_b128 v[88:91], v4 offset:15360
s_nop 1
s_waitcnt lgkmcnt(4)
v_smfmac_f32_16x16x64_bf16 v[36:39], v[64:67], v[116:123], v1
ds_read_b128 v[92:95], v4 offset:18432
v_smfmac_f32_16x16x64_bf16 v[40:43], v[64:67], v[232:239], v1
ds_read_b128 v[96:99], v4 offset:19456
s_waitcnt lgkmcnt(4)
v_smfmac_f32_16x16x64_bf16 v[36:39], v[68:71], v[76:83], v1
ds_read_b128 v[100:103], v4 offset:22528
s_add_u32 s23, s77, 91097088
v_smfmac_f32_16x16x64_bf16 v[40:43], v[68:71], v[240:247], v1
ds_read_b128 v[104:107], v4 offset:23552
s_waitcnt lgkmcnt(4)
v_smfmac_f32_16x16x64_bf16 v[36:39], v[72:75], v[84:91], v1
ds_read_b128 v[108:111], v2 offset:0
v_smfmac_f32_16x16x64_bf16 v[40:43], v[72:75], v[248:255], v1
ds_read_b128 v[112:115], v2 offset:1024
s_waitcnt lgkmcnt(4)
v_smfmac_f32_16x16x64_bf16 v[36:39], v[44:47], v[92:99], v1
ds_read_b128 v[116:119], v2 offset:2048
v_smfmac_f32_16x16x64_bf16 v[40:43], v[44:47], v[192:199], v1
ds_read_b128 v[120:123], v2 offset:3072
s_waitcnt lgkmcnt(4)
v_smfmac_f32_16x16x64_bf16 v[36:39], v[48:51], v[100:107], v1
ds_read_b128 v[76:79], v2 offset:4096
v_smfmac_f32_16x16x64_bf16 v[40:43], v[48:51], v[200:207], v1
s_nop 0
v_pk_add_f32 v[28:29], v[28:29], v[30:31]
v_pk_add_f32 v[32:33], v[32:33], v[34:35]
v_cvt_pk_bf16_f32 v34, v28, v29
v_cvt_pk_bf16_f32 v35, v32, v33
ds_write_b64 v7, v[34:35] offset:0
s_nop 0
v_pk_add_f32 v[36:37], v[36:37], v[38:39]
v_pk_add_f32 v[40:41], v[40:41], v[42:43]
v_cvt_pk_bf16_f32 v32, v36, v37
v_cvt_pk_bf16_f32 v33, v40, v41
ds_write_b64 v7, v[32:33] offset:128
v_smfmac_f32_16x16x64_bf16 v[12:15], v[60:63], a[32:39], v1
ds_read_b128 v[80:83], v2 offset:5120
v_smfmac_f32_16x16x64_bf16 v[24:27], v[60:63], a[96:103], v1
ds_read_b128 v[84:87], v2 offset:6144
v_smfmac_f32_16x16x64_bf16 v[12:15], v[64:67], a[40:47], v1
ds_read_b128 v[88:91], v2 offset:7168
s_add_u32 m0, s75, 2048
s_add_u32 s32, s26, 2048
buffer_load_dwordx4 v3, s[8:11], s32 offen  lds
v_smfmac_f32_16x16x64_bf16 v[24:27], v[64:67], a[104:111], v1
s_waitcnt lgkmcnt(3)
s_barrier
ds_read_b64_tr_b16 v[92:93], v8 offset:0
ds_read_b64_tr_b16 v[94:95], v8 offset:256
v_smfmac_f32_16x16x64_bf16 v[12:15], v[68:71], a[48:55], v1
ds_read_b64_tr_b16 v[96:97], v8 offset:512
ds_read_b64_tr_b16 v[98:99], v8 offset:768
v_smfmac_f32_16x16x64_bf16 v[24:27], v[68:71], a[112:119], v1
ds_read_b64_tr_b16 v[100:101], v8 offset:128
ds_read_b64_tr_b16 v[102:103], v8 offset:384
v_smfmac_f32_16x16x64_bf16 v[12:15], v[72:75], a[56:63], v1
ds_read_b64_tr_b16 v[104:105], v8 offset:640
ds_read_b64_tr_b16 v[106:107], v8 offset:896
v_smfmac_f32_16x16x64_bf16 v[24:27], v[72:75], a[120:127], v1
v_mov_b32 v28, s42
v_smfmac_f32_16x16x64_bf16 v[12:15], v[44:47], a[0:7], v1
v_mov_b32 v29, s42
v_smfmac_f32_16x16x64_bf16 v[24:27], v[44:47], a[64:71], v1
v_mov_b32 v30, s42
v_smfmac_f32_16x16x64_bf16 v[12:15], v[48:51], a[8:15], v1
v_mov_b32 v31, s42
v_smfmac_f32_16x16x64_bf16 v[24:27], v[48:51], a[72:79], v1
s_waitcnt vmcnt(4)
s_waitcnt lgkmcnt(8)
s_cmp_ge_u32 s18, 63
s_cbranch_scc1 CH_DONE_1f
s_waitcnt lgkmcnt(6)
v_mfma_f32_16x16x32_bf16 v[36:39], v[108:111], v[92:95], 0
s_add_u32 m0, s75, 3072
s_add_u32 s32, s26, 3072
buffer_load_dwordx4 v3, s[8:11], s32 offen  lds
s_nop 0
s_waitcnt lgkmcnt(4)
v_mfma_f32_16x16x32_bf16 v[36:39], v[112:115], v[96:99], v[36:39]
s_nop 0
s_waitcnt lgkmcnt(2)
v_mfma_f32_16x16x32_bf16 v[36:39], v[116:119], v[100:103], v[36:39]
s_nop 0
s_waitcnt lgkmcnt(0)
v_mfma_f32_16x16x32_bf16 v[36:39], v[120:123], v[104:107], v[36:39]
s_nop 0
v_mfma_f32_16x16x32_bf16 v[40:43], v[76:79], v[92:95], 0
v_add_f32 v12, v12, v14
v_add_f32 v13, v13, v15
v_mfma_f32_16x16x32_bf16 v[40:43], v[80:83], v[96:99], v[40:43]
v_add_f32 v24, v24, v26
v_add_f32 v25, v25, v27
v_mfma_f32_16x16x32_bf16 v[40:43], v[84:87], v[100:103], v[40:43]
v_cvt_pk_bf16_f32 v14, v12, v13
v_mfma_f32_16x16x32_bf16 v[40:43], v[88:91], v[104:107], v[40:43]
v_cvt_pk_bf16_f32 v15, v24, v25
v_mfma_f32_16x16x32_bf16 v[124:127], v[92:95], v[92:95], 0
v_max3_f32 v10, v36, v37, v38
v_mov_b32 v25, 0
s_nop 1
v_mfma_f32_16x16x32_bf16 v[124:127], v[96:99], v[96:99], v[124:127]
v_max_f32 v10, v10, v39
v_mov_b32 v26, 0
s_nop 1
v_mfma_f32_16x16x32_bf16 v[124:127], v[100:103], v[100:103], v[124:127]
v_max3_f32 v10, v10, v40, v41
v_mfma_f32_16x16x32_bf16 v[124:127], v[104:107], v[104:107], v[124:127]
v_max3_f32 v10, v10, v42, v43
s_not_b64 vcc, s[40:41]
v_cndmask_b32_dpp v36, v40, v36, vcc quad_perm:[0,1,0,1] row_mask:0xf bank_mask:0xf
v_cndmask_b32_dpp v37, v41, v37, vcc quad_perm:[0,1,0,1] row_mask:0xf bank_mask:0xf
v_mov_b32_dpp v10, v10 quad_perm:[0,1,0,1] row_mask:0xf bank_mask:0xf
v_cndmask_b32_dpp v38, v42, v38, vcc quad_perm:[0,1,0,1] row_mask:0xf bank_mask:0xf
v_cndmask_b32_dpp v39, v43, v39, vcc quad_perm:[0,1,0,1] row_mask:0xf bank_mask:0xf
v_mov_b32 v76, 0
v_max_f32_dpp v125, v126, v10 quad_perm:[0,1,0,1] row_mask:0xf bank_mask:0xf
v_max_f32_dpp v10, v127, v10 quad_perm:[0,1,0,1] row_mask:0xf bank_mask:0xf
v_max_f32 v124, v125, v10
v_mov_b32 v11, v124
v_mov_b32 v77, 0
v_mov_b32 v78, 0
v_permlane32_swap_b32 v124, v11
v_max_f32 v124, v124, v11
v_mov_b32 v11, v124
v_mov_b32 v79, 0
v_mov_b32 v80, 0
v_permlane16_swap_b32 v124, v11
v_max_f32 v124, v124, v11
v_mul_f32 v10, s30, v124
v_pk_fma_f32 v[126:127], v[126:127], s[30:31], v[10:11] op_sel_hi:[1,1,0] neg_lo:[0,0,1] neg_hi:[0,0,1]
v_pk_fma_f32 v[36:37], v[36:37], s[30:31], v[10:11] op_sel_hi:[1,1,0] neg_lo:[0,0,1] neg_hi:[0,0,1]
v_pk_fma_f32 v[38:39], v[38:39], s[30:31], v[10:11] op_sel_hi:[1,1,0] neg_lo:[0,0,1] neg_hi:[0,0,1]
v_exp_f32 v126, v126
v_exp_f32 v127, v127
v_exp_f32 v36, v36
v_cvt_pk_bf16_f32 v24, v126, v127
v_cvt_pk_bf16_f32 v27, v126, v127
v_exp_f32 v37, v37
v_exp_f32 v38, v38
v_mfma_f32_16x16x16_bf16 v[68:71], v[28:29], v[24:25], 0
v_exp_f32 v39, v39
v_cvt_pk_bf16_f32 v32, v36, v37
v_cvt_pk_bf16_f32 v33, v38, v39
v_mfma_f32_16x16x16_bf16 v[44:47], v[14:15], v[24:25], 0
v_mov_b32_dpp v34, v32 quad_perm:[2,3,2,3] row_mask:0xf bank_mask:0xf
v_mov_b32_dpp v35, v33 quad_perm:[2,3,2,3] row_mask:0xf bank_mask:0xf
v_mfma_f32_16x16x16_bf16 v[48:51], v[14:15], v[26:27], 0
s_waitcnt vmcnt(2)
v_mfma_f32_16x16x32_bf16 v[68:71], v[28:31], v[32:35], v[68:71]
v_mov_b32 v81, 0
v_mov_b32 v82, 0
v_mfma_f32_16x16x32_bf16 v[44:47], v[16:19], v[32:35], v[44:47]
v_mov_b32 v83, 0
v_mov_b32 v84, 0
v_mfma_f32_16x16x32_bf16 v[48:51], v[20:23], v[32:35], v[48:51]
v_mov_b32 v85, 0
v_mov_b32 v86, 0
v_rcp_f32 v10, v68
v_mov_b32 v87, 0
v_mov_b32 v88, 0
v_mov_b32 v89, 0
v_pk_mul_f32 v[44:45], v[44:45], v[10:11] op_sel_hi:[1,0]
v_pk_mul_f32 v[46:47], v[46:47], v[10:11] op_sel_hi:[1,0]
v_mov_b32 v90, 0
v_pk_mul_f32 v[48:49], v[48:49], v[10:11] op_sel_hi:[1,0]
v_pk_mul_f32 v[50:51], v[50:51], v[10:11] op_sel_hi:[1,0]
v_cvt_pk_bf16_f32 v52, v44, v45
v_cvt_pk_bf16_f32 v53, v46, v47
v_cvt_pk_bf16_f32 v54, v48, v49
v_cvt_pk_bf16_f32 v55, v50, v51
s_not_b64 exec, s[40:41]
ds_write_b128 v9, v[52:55] offset:512
s_mov_b64 exec, -1
v_mov_b32 v91, 0
v_mov_b32_dpp v60, v52 quad_perm:[0,1,0,1] row_mask:0xf bank_mask:0xf
v_mov_b32_dpp v61, v53 quad_perm:[0,1,0,1] row_mask:0xf bank_mask:0xf
v_mov_b32_dpp v62, v54 quad_perm:[0,1,0,1] row_mask:0xf bank_mask:0xf
v_mov_b32_dpp v63, v55 quad_perm:[0,1,0,1] row_mask:0xf bank_mask:0xf
s_nop 1
v_smfmac_f32_16x16x64_bf16 v[76:79], v[60:63], a[136:143], v1
v_mov_b32_dpp v10, v14 quad_perm:[2,3,2,3] row_mask:0xf bank_mask:0xf
v_cndmask_b32 v16, v14, v96, s[40:41]
v_smfmac_f32_16x16x64_bf16 v[80:83], v[60:63], a[168:175], v1
v_mov_b32_dpp v11, v15 quad_perm:[2,3,2,3] row_mask:0xf bank_mask:0xf
v_cndmask_b32 v17, v15, v97, s[40:41]
s_waitcnt lgkmcnt(0)
s_barrier
ds_read_b128 v[64:67], v9 offset:1024
ds_read_b128 v[68:71], v9 offset:1536
ds_read_b128 v[56:59], v9 offset:0
v_smfmac_f32_16x16x64_bf16 v[84:87], v[60:63], a[200:207], v1
v_cndmask_b32 v18, v10, v98, s[40:41]
v_smfmac_f32_16x16x64_bf16 v[88:91], v[60:63], a[232:239], v1
v_cndmask_b32 v19, v11, v99, s[40:41]
s_waitcnt lgkmcnt(2)
v_smfmac_f32_16x16x64_bf16 v[76:79], v[64:67], a[144:151], v1
s_waitcnt lgkmcnt(1)
v_smfmac_f32_16x16x64_bf16 v[76:79], v[68:71], a[152:159], v1
s_waitcnt lgkmcnt(0)
v_smfmac_f32_16x16x64_bf16 v[76:79], v[56:59], a[128:135], v1
v_smfmac_f32_16x16x64_bf16 v[80:83], v[64:67], a[176:183], v1
s_nop 2
v_smfmac_f32_16x16x64_bf16 v[80:83], v[68:71], a[184:191], v1
s_nop 2
v_cvt_pk_bf16_f32 v92, v76, v77
v_smfmac_f32_16x16x64_bf16 v[80:83], v[56:59], a[160:167], v1
v_cvt_pk_bf16_f32 v93, v78, v79
v_and_or_b32 v92, v92, -2, s21
buffer_store_dwordx2 v[92:93], v5, s[8:11], s19 offen
v_smfmac_f32_16x16x64_bf16 v[84:87], v[64:67], a[208:215], v1
s_nop 2
v_smfmac_f32_16x16x64_bf16 v[84:87], v[68:71], a[216:223], v1
s_nop 2
v_cvt_pk_bf16_f32 v94, v80, v81
v_smfmac_f32_16x16x64_bf16 v[84:87], v[56:59], a[192:199], v1
v_cvt_pk_bf16_f32 v95, v82, v83
v_and_or_b32 v94, v94, -2, s21
s_add_u32 s32, s19, 8192
buffer_store_dwordx2 v[94:95], v5, s[8:11], s32 offen
v_smfmac_f32_16x16x64_bf16 v[88:91], v[64:67], a[240:247], v1
s_nop 2
v_smfmac_f32_16x16x64_bf16 v[88:91], v[68:71], a[248:255], v1
s_nop 2
v_cvt_pk_bf16_f32 v96, v84, v85
v_smfmac_f32_16x16x64_bf16 v[88:91], v[56:59], a[224:231], v1
v_cvt_pk_bf16_f32 v97, v86, v87
v_and_or_b32 v96, v96, -2, s21
s_add_u32 s32, s19, 4096
buffer_store_dwordx2 v[96:97], v5, s[8:11], s32 offen
s_nop 4
v_cvt_pk_bf16_f32 v98, v88, v89
v_cvt_pk_bf16_f32 v99, v90, v91
v_and_or_b32 v98, v98, -2, s21
s_add_u32 s32, s19, 12288
buffer_store_dwordx2 v[98:99], v5, s[8:11], s32 offen
s_mov_b32 s36, 0
ds_read_b128 v[44:47], v3 offset:12544
v_mov_b32 v28, 0
v_mov_b32 v29, 0
v_mov_b32 v30, 0
v_mov_b32 v31, 0
v_mov_b32 v32, 0
v_mov_b32 v33, 0
v_mov_b32 v34, 0
v_mov_b32 v35, 0
v_mov_b32 v36, 0
v_mov_b32 v37, 0
v_mov_b32 v38, 0
v_mov_b32 v39, 0
v_mov_b32 v40, 0
v_mov_b32 v41, 0
v_mov_b32 v42, 0
v_mov_b32 v43, 0
v_mov_b32 v12, 0
v_mov_b32 v13, 0
v_mov_b32 v14, 0
v_mov_b32 v15, 0
v_mov_b32 v24, 0
v_mov_b32 v25, 0
v_mov_b32 v26, 0
v_mov_b32 v27, 0
v_xor_b32 v2, 8192, v2
s_xor_b32 s75, s75, 8192
s_nop 15
s_nop 15
s_nop 7
buffer_load_dwordx4 v[60:63], v3, s[8:11], s20 offen offset:0 sc1
buffer_load_dwordx4 v[64:67], v3, s[8:11], s20 offen offset:1024 sc1
buffer_load_dwordx4 v[68:71], v3, s[8:11], s20 offen offset:2048 sc1
buffer_load_dwordx4 v[72:75], v3, s[8:11], s20 offen offset:3072 sc1
ds_read_b128 v[76:79], v4 offset:24576
ds_read_b128 v[80:83], v4 offset:25600
ds_read_b128 v[84:87], v4 offset:26624
ds_read_b128 v[88:91], v4 offset:27648
ds_read_b128 v[92:95], v4 offset:28672
ds_read_b128 v[96:99], v4 offset:29696
s_nop 15
s_nop 3
buffer_load_dwordx4 v[60:63], v3, s[8:11], s20 offen offset:0 sc1
buffer_load_dwordx4 v[64:67], v3, s[8:11], s20 offen offset:1024 sc1
buffer_load_dwordx4 v[68:71], v3, s[8:11], s20 offen offset:2048 sc1
buffer_load_dwordx4 v[72:75], v3, s[8:11], s20 offen offset:3072 sc1
s_waitcnt lgkmcnt(6)
CH_RA_1f:
s_waitcnt vmcnt(7)
v_bitop3_b32 v10, v60, v62, s21 bitop3:0x7e
v_mfma_f32_16x16x32_bf16 v[48:51], v[60:63], v[44:47], 0
s_waitcnt vmcnt(6)
v_bitop3_b32 v11, v64, v66, s21 bitop3:0x7e
v_mfma_f32_16x16x32_bf16 v[48:51], v[64:67], v[44:47], v[48:51]
v_or_b32 v10, v10, v11
s_waitcnt vmcnt(5)
v_bitop3_b32 v11, v68, v70, s21 bitop3:0x7e
v_mfma_f32_16x16x32_bf16 v[48:51], v[68:71], v[44:47], v[48:51]
v_or_b32 v10, v10, v11
s_waitcnt vmcnt(4)
v_bitop3_b32 v11, v72, v74, s21 bitop3:0x7e
v_mfma_f32_16x16x32_bf16 v[48:51], v[72:75], v[44:47], v[48:51]
v_bitop3_b32 v10, v10, v11, 1 bitop3:0xa8
v_cmp_ne_u32 vcc, 0, v10
s_cbranch_vccnz CH_RARETRY_1f
CH_RAOK_1f:
s_nop 4
v_permlane32_swap_b32 v48, v50
v_permlane32_swap_b32 v49, v51
s_mov_b64 exec, s[38:39]
v_pk_add_f32 v[48:49], v[48:49], v[50:51]
v_cvt_pk_bf16_f32 v48, v48, v49
buffer_store_dword v48, v6, s[8:11], s22 offen
s_mov_b64 exec, -1
s_barrier
s_nop 3
buffer_load_dwordx4 v[52:55], v3, s[8:11], s23 offen offset:0 sc1
s_nop 15
buffer_load_dwordx4 v[56:59], v3, s[8:11], s23 offen offset:1024 sc1
s_mov_b32 s36, 0
s_mov_b32 s82, s27
s_add_u32 s25, s25, 262144
s_add_u32 s26, s26, 262144
s_add_u32 s27, s27, 131072
s_sub_u32 s24, s78, 1024
s_mov_b32 s78, s22
s_add_u32 s77, s77, 8192
s_and_b32 s77, s77, 0x7fff
s_add_u32 s22, s77, s81
s_add_u32 s18, s18, 1
s_xor_b32 s21, s21, 1
buffer_load_dwordx4 v[52:55], v3, s[8:11], s23 offen offset:0 sc1
buffer_load_dwordx4 v[56:59], v3, s[8:11], s23 offen offset:1024 sc1
ds_read_b128 v[100:103], v4 offset:30720
ds_read_b128 v[104:107], v4 offset:31744
ds_read_b128 v[108:111], v4 offset:0
ds_read_b128 v[112:115], v4 offset:1024
ds_read_b128 v[116:119], v4 offset:4096
ds_read_b128 v[120:123], v4 offset:5120
s_waitcnt lgkmcnt(0)
s_branch CH_RB_1f
CH_RARETRY_1f:
buffer_load_dwordx4 v[60:63], v3, s[8:11], s20 offen offset:0 sc1
buffer_load_dwordx4 v[64:67], v3, s[8:11], s20 offen offset:1024 sc1
buffer_load_dwordx4 v[68:71], v3, s[8:11], s20 offen offset:2048 sc1
buffer_load_dwordx4 v[72:75], v3, s[8:11], s20 offen offset:3072 sc1
s_add_u32 s36, s36, 1
s_cmp_gt_u32 s36, 65536
s_cbranch_scc1 CH_RAOK_1f
s_branch CH_RA_1f
CH_RBRETRY_1f:
buffer_load_dwordx4 v[52:55], v3, s[8:11], s23 offen offset:0 sc1
buffer_load_dwordx4 v[56:59], v3, s[8:11], s23 offen offset:1024 sc1
s_add_u32 s36, s36, 1
s_cmp_gt_u32 s36, 65536
s_cbranch_scc1 CH_RBOK_1f
s_branch CH_RB_1f
CH_RBLRETRY_1f:
buffer_load_dwordx4 v[56:59], v3, s[8:11], s23 offen offset:1024 sc1
s_add_u32 s36, s36, 1
s_cmp_gt_u32 s36, 65536
s_cbranch_scc1 CH_RBLOK_1f
s_waitcnt vmcnt(1)
s_branch CH_RBL_1f
CH_DONE_1f:
s_waitcnt lgkmcnt(0)
s_nop 4
v_add_f32 v12, v12, v14
v_add_f32 v13, v13, v15
v_add_f32 v24, v24, v26
v_add_f32 v25, v25, v27
v_cvt_pk_bf16_f32 v14, v12, v13
v_cvt_pk_bf16_f32 v15, v24, v25
s_nop 1
v_mov_b32_dpp v10, v14 quad_perm:[2,3,2,3] row_mask:0xf bank_mask:0xf
v_mov_b32_dpp v11, v15 quad_perm:[2,3,2,3] row_mask:0xf bank_mask:0xf
v_cndmask_b32 v36, v14, v96, s[40:41]
v_cndmask_b32 v37, v15, v97, s[40:41]
v_cndmask_b32 v38, v10, v98, s[40:41]
v_cndmask_b32 v39, v11, v99, s[40:41]
buffer_store_dwordx4 v[36:39], v3, s[8:11], s27 offen sc1
s_barrier
s_branch L_FIN
RDY_72_S:
s_add_u32 s32, s18, 1
s_min_u32 s32, s32, 63
s_lshr_b32 s32, s32, 2
s_add_u32 s32, s32, 1
v_lshrrev_b32 v10, 3, v0
v_and_b32 v11, 3, v10
v_bfe_u32 v10, v10, 2, 1
v_lshlrev_b32 v10, 13, v10
v_lshl_add_u32 v10, v11, 7, v10
s_mov_b32 s35, 0
POLL_KV_73:
s_cmp_lg_u32 s37, 0
s_cbranch_scc1 POLL_KV_73_E
buffer_load_dword v11, v10, s[8:11], s89 offen sc1
s_add_u32 s35, s35, 1
s_cmp_gt_u32 s35, 65536
s_cselect_b32 s37, 1, 0
s_waitcnt vmcnt(0)
v_cmp_gt_u32 vcc, s32, v11
s_cbranch_vccz POLL_KV_73_E
s_branch POLL_KV_73
POLL_KV_73_E:
s_nop 1
v_min_u32_dpp v11, v11, v11 quad_perm:[1,0,3,2] row_mask:0xf bank_mask:0xf
s_nop 1
v_min_u32_dpp v11, v11, v11 quad_perm:[2,3,0,1] row_mask:0xf bank_mask:0xf
s_nop 1
v_min_u32_dpp v11, v11, v11 row_half_mirror row_mask:0xf bank_mask:0xf
s_nop 0
v_readfirstlane_b32 s85, v11
s_nop 3
s_lshl_b32 s85, s85, 2
s_branch RDY_72
CH_W2f:
s_mov_b32 s18, 0
s_mov_b32 s29, 0
s_add_u32 s32, s18, 1
s_min_u32 s32, s32, 63
s_cmp_ge_u32 s32, s85
s_cbranch_scc1 RDY_74_S
RDY_74:
s_mov_b32 s75, 147456
s_lshl_b32 s26, s16, 13
s_add_u32 s26, s26, 18743296
s_add_u32 m0, s75, 4096
s_add_u32 s32, s26, 4096
buffer_load_dwordx4 v3, s[8:11], s32 offen  lds
s_add_u32 m0, s75, 5120
s_add_u32 s32, s26, 5120
buffer_load_dwordx4 v3, s[8:11], s32 offen  lds
s_mov_b32 s34, 0x05040100
s_mov_b32 s35, 0x07060302
v_perm_b32 v60, v17, v16, s34
v_perm_b32 v61, v19, v18, s34
v_perm_b32 v62, v17, v16, s35
v_perm_b32 v63, v19, v18, s35
v_perm_b32 v64, v13, v12, s34
v_perm_b32 v65, v15, v14, s34
v_perm_b32 v66, v13, v12, s35
v_perm_b32 v67, v15, v14, s35
s_mov_b32 s18, 0
s_mov_b32 s75, 155648
s_and_b32 s32, s18, 3
s_lshl_b32 s33, s32, 18
s_lshl_b32 s34, s16, 7
s_add_u32 s19, s33, s34
s_add_u32 s19, s19, 90308608
s_lshl_b32 s35, s16, 13
s_add_u32 s20, s33, s35
s_add_u32 s20, s20, 90046464
s_add_u32 s32, s18, 3
s_and_b32 s32, s32, 3
s_lshl_b32 s33, s32, 18
s_mov_b32 s21, 0
s_lshr_b32 s34, s16, 3
s_lshl_b32 s34, s34, 11
s_and_b32 s35, s16, 1
s_lshl_b32 s35, s35, 9
s_add_u32 s34, s34, s35
s_bfe_u32 s35, s16, 0x20001
s_lshl_b32 s35, s35, 6
s_add_u32 s34, s34, s35
s_lshl_b32 s33, s32, 13
s_add_u32 s24, s33, s34
s_add_u32 s24, s24, 91226112
s_add_u32 s32, s18, 1
s_and_b32 s32, s32, 3
s_lshl_b32 s33, s32, 13
s_add_u32 s22, s33, s34
s_add_u32 s22, s22, 91226112
s_add_u32 s23, s33, 91099136
s_lshl_b32 s32, s18, 5
s_add_u32 s32, s32, s16
s_lshl_b32 s33, s32, 13
s_add_u32 s25, s33, 35524608
s_add_u32 s26, s33, 19005440
s_lshl_b32 s33, s32, 12
s_add_u32 s27, s33, 52299776
s_lshl_b32 s33, s32, 11
s_add_u32 s28, s33, 60818432
s_mov_b32 s82, s27
s_sub_u32 s24, s24, 0
s_mov_b32 s76, 0
s_mov_b32 s77, 8192
s_mov_b32 s79, s19
s_mov_b32 s80, s20
s_sub_u32 s81, s22, 8192
s_mov_b32 s78, s81
ds_read_b128 v[76:79], v4 offset:0
ds_read_b128 v[80:83], v4 offset:1024
ds_read_b128 v[84:87], v4 offset:2048
ds_read_b128 v[88:91], v4 offset:3072
ds_read_b128 v[92:95], v4 offset:4096
ds_read_b128 v[96:99], v4 offset:5120
ds_read_b128 v[100:103], v4 offset:6144
ds_read_b128 v[104:107], v4 offset:7168
ds_read_b128 v[108:111], v4 offset:8192
ds_read_b128 v[112:115], v4 offset:9216
ds_read_b128 v[116:119], v4 offset:12288
ds_read_b128 v[120:123], v4 offset:13312
v_mov_b32 v28, 0
v_mov_b32 v29, 0
v_mov_b32 v30, 0
v_mov_b32 v31, 0
v_mov_b32 v32, 0
v_mov_b32 v33, 0
v_mov_b32 v34, 0
v_mov_b32 v35, 0
v_mov_b32 v36, 0
v_mov_b32 v37, 0
v_mov_b32 v38, 0
v_mov_b32 v39, 0
v_mov_b32 v40, 0
v_mov_b32 v41, 0
v_mov_b32 v42, 0
v_mov_b32 v43, 0
v_mov_b32 v12, 0
v_mov_b32 v13, 0
v_mov_b32 v14, 0
v_mov_b32 v15, 0
v_mov_b32 v24, 0
v_mov_b32 v25, 0
v_mov_b32 v26, 0
v_mov_b32 v27, 0
s_waitcnt vmcnt(0)
s_waitcnt lgkmcnt(0)
s_mov_b32 s36, 0
v_min_u32 v60, 0xfffffffe, v60
v_min_u32 v61, 0xfffffffe, v61
v_min_u32 v62, 0xfffffffe, v62
v_min_u32 v63, 0xfffffffe, v63
v_min_u32 v64, 0xfffffffe, v64
v_min_u32 v65, 0xfffffffe, v65
v_min_u32 v66, 0xfffffffe, v66
v_min_u32 v67, 0xfffffffe, v67
.p2align 6
CH_BASE_2f:
.fill (((8 - (. - CH_BASE_2f)) & 15) >> 2), 4, 0xbf800000
CH_RB_2f:
s_waitcnt vmcnt(3)
CH_RBE_2f:
v_max3_u32 v10, v60, v61, v62
v_max_u32 v10, v10, v63
v_cmp_eq_u32 vcc, -1, v10
ds_write_b128 v3, v[60:63] offset:4096
s_cbranch_vccnz CH_RBRETRY_2f
CH_RBOK_2f:
v_smfmac_f32_16x16x64_bf16 v[28:31], v[60:63], v[76:83], v1
v_smfmac_f32_16x16x64_bf16 v[32:35], v[60:63], v[160:167], v1
ds_read_b128 v[76:79], v4 offset:16384
v_smfmac_f32_16x16x64_bf16 v[36:39], v[60:63], v[84:91], v1
ds_read_b128 v[80:83], v4 offset:17408
v_smfmac_f32_16x16x64_bf16 v[40:43], v[60:63], v[224:231], v1
s_waitcnt vmcnt(2)
CH_RBL_2f:
v_max3_u32 v10, v64, v65, v66
v_max_u32 v10, v10, v67
v_cmp_eq_u32 vcc, -1, v10
ds_write_b128 v3, v[64:67] offset:5120
s_cbranch_vccnz CH_RBLRETRY_2f
CH_RBLOK_2f:
v_smfmac_f32_16x16x64_bf16 v[28:31], v[64:67], v[92:99], v1
v_smfmac_f32_16x16x64_bf16 v[32:35], v[64:67], v[168:175], v1
v_smfmac_f32_16x16x64_bf16 v[36:39], v[64:67], v[100:107], v1
buffer_store_dwordx4 v[16:19], v3, s[8:11], s82 offen sc1
v_smfmac_f32_16x16x64_bf16 v[40:43], v[64:67], v[232:239], v1
s_waitcnt lgkmcnt(0)
s_barrier
ds_read_b128 v[68:71], v3 offset:6144
ds_read_b128 v[72:75], v3 offset:7168
v_smfmac_f32_16x16x64_bf16 v[12:15], v[60:63], a[32:39], v1
ds_read_b128 v[44:47], v3 offset:0
v_smfmac_f32_16x16x64_bf16 v[24:27], v[60:63], a[96:103], v1
ds_read_b128 v[48:51], v3 offset:1024
v_smfmac_f32_16x16x64_bf16 v[12:15], v[64:67], a[40:47], v1
ds_read_b128 v[52:55], v3 offset:2048
buffer_load_dwordx4 v[16:19], v3, s[8:11], s25 offen
v_smfmac_f32_16x16x64_bf16 v[24:27], v[64:67], a[104:111], v1
ds_read_b128 v[56:59], v3 offset:3072
s_waitcnt lgkmcnt(5)
v_smfmac_f32_16x16x64_bf16 v[28:31], v[68:71], v[108:115], v1
ds_read_b128 v[84:87], v4 offset:20480
v_smfmac_f32_16x16x64_bf16 v[32:35], v[68:71], v[176:183], v1
ds_read_b128 v[88:91], v4 offset:21504
s_add_u32 s32, s18, 6
s_min_u32 s32, s32, 63
s_cmp_lt_u32 s32, s85
s_cbranch_scc1 LOOK_75
v_lshrrev_b32 v10, 3, v0
v_and_b32 v11, 3, v10
v_bfe_u32 v10, v10, 2, 1
v_lshlrev_b32 v10, 13, v10
v_lshl_add_u32 v10, v11, 7, v10
buffer_load_dword v6, v10, s[8:11], s89 offen sc1
s_mov_b32 s29, 1
LOOK_75:
s_waitcnt lgkmcnt(6)
v_smfmac_f32_16x16x64_bf16 v[28:31], v[72:75], v[116:123], v1
ds_read_b128 v[92:95], v4 offset:24576
buffer_load_dwordx4 v[20:23], v3, s[8:11], s25 offen offset:1024
v_smfmac_f32_16x16x64_bf16 v[32:35], v[72:75], v[184:191], v1
ds_read_b128 v[96:99], v4 offset:25600
s_waitcnt lgkmcnt(7)
v_smfmac_f32_16x16x64_bf16 v[28:31], v[44:47], v[76:83], v1
ds_read_b128 v[100:103], v4 offset:28672
v_smfmac_f32_16x16x64_bf16 v[32:35], v[44:47], v[128:135], v1
ds_read_b128 v[104:107], v4 offset:29696
s_waitcnt lgkmcnt(8)
s_waitcnt lgkmcnt(4)
v_smfmac_f32_16x16x64_bf16 v[28:31], v[48:51], v[84:91], v1
ds_read_b128 v[108:111], v4 offset:10240
v_smfmac_f32_16x16x64_bf16 v[32:35], v[48:51], v[136:143], v1
ds_read_b128 v[112:115], v4 offset:11264
s_waitcnt lgkmcnt(4)
v_smfmac_f32_16x16x64_bf16 v[28:31], v[52:55], v[92:99], v1
ds_read_b128 v[116:119], v4 offset:14336
v_smfmac_f32_16x16x64_bf16 v[32:35], v[52:55], v[144:151], v1
ds_read_b128 v[120:123], v4 offset:15360
s_waitcnt lgkmcnt(4)
v_smfmac_f32_16x16x64_bf16 v[28:31], v[56:59], v[100:107], v1
ds_read_b128 v[76:79], v4 offset:18432
v_smfmac_f32_16x16x64_bf16 v[32:35], v[56:59], v[152:159], v1
ds_read_b128 v[80:83], v4 offset:19456
s_waitcnt lgkmcnt(4)
v_smfmac_f32_16x16x64_bf16 v[36:39], v[68:71], v[108:115], v1
ds_read_b128 v[84:87], v4 offset:22528
s_nop 1
v_smfmac_f32_16x16x64_bf16 v[40:43], v[68:71], v[240:247], v1
ds_read_b128 v[88:91], v4 offset:23552
s_nop 1
s_waitcnt lgkmcnt(4)
v_smfmac_f32_16x16x64_bf16 v[36:39], v[72:75], v[116:123], v1
ds_read_b128 v[92:95], v4 offset:26624
v_smfmac_f32_16x16x64_bf16 v[40:43], v[72:75], v[248:255], v1
ds_read_b128 v[96:99], v4 offset:27648
s_waitcnt lgkmcnt(4)
v_smfmac_f32_16x16x64_bf16 v[36:39], v[44:47], v[76:83], v1
ds_read_b128 v[100:103], v4 offset:30720
s_add_u32 s23, s77, 91099136
v_smfmac_f32_16x16x64_bf16 v[40:43], v[44:47], v[192:199], v1
ds_read_b128 v[104:107], v4 offset:31744
s_waitcnt lgkmcnt(4)
v_smfmac_f32_16x16x64_bf16 v[36:39], v[48:51], v[84:91], v1
ds_read_b128 v[108:111], v2 offset:0
v_smfmac_f32_16x16x64_bf16 v[40:43], v[48:51], v[200:207], v1
ds_read_b128 v[112:115], v2 offset:1024
s_waitcnt lgkmcnt(4)
v_smfmac_f32_16x16x64_bf16 v[36:39], v[52:55], v[92:99], v1
ds_read_b128 v[116:119], v2 offset:2048
v_smfmac_f32_16x16x64_bf16 v[40:43], v[52:55], v[208:215], v1
ds_read_b128 v[120:123], v2 offset:3072
s_waitcnt lgkmcnt(4)
v_smfmac_f32_16x16x64_bf16 v[36:39], v[56:59], v[100:107], v1
ds_read_b128 v[76:79], v2 offset:4096
v_smfmac_f32_16x16x64_bf16 v[40:43], v[56:59], v[216:223], v1
s_nop 0
v_pk_add_f32 v[28:29], v[28:29], v[30:31]
v_pk_add_f32 v[32:33], v[32:33], v[34:35]
v_cvt_pk_bf16_f32 v34, v28, v29
v_cvt_pk_bf16_f32 v35, v32, v33
ds_write_b64 v7, v[34:35] offset:0
s_nop 0
v_pk_add_f32 v[36:37], v[36:37], v[38:39]
v_pk_add_f32 v[40:41], v[40:41], v[42:43]
v_cvt_pk_bf16_f32 v32, v36, v37
v_cvt_pk_bf16_f32 v33, v40, v41
ds_write_b64 v7, v[32:33] offset:128
v_smfmac_f32_16x16x64_bf16 v[12:15], v[68:71], a[48:55], v1
ds_read_b128 v[80:83], v2 offset:5120
v_smfmac_f32_16x16x64_bf16 v[24:27], v[68:71], a[112:119], v1
ds_read_b128 v[84:87], v2 offset:6144
v_smfmac_f32_16x16x64_bf16 v[12:15], v[72:75], a[56:63], v1
ds_read_b128 v[88:91], v2 offset:7168
v_smfmac_f32_16x16x64_bf16 v[24:27], v[72:75], a[120:127], v1
s_waitcnt lgkmcnt(3)
s_barrier
ds_read_b64_tr_b16 v[92:93], v8 offset:0
ds_read_b64_tr_b16 v[94:95], v8 offset:256
v_smfmac_f32_16x16x64_bf16 v[12:15], v[44:47], a[0:7], v1
ds_read_b64_tr_b16 v[96:97], v8 offset:512
ds_read_b64_tr_b16 v[98:99], v8 offset:768
s_add_u32 m0, s75, 4096
s_add_u32 s32, s26, 4096
buffer_load_dwordx4 v3, s[8:11], s32 offen  lds
v_smfmac_f32_16x16x64_bf16 v[24:27], v[44:47], a[64:71], v1
ds_read_b64_tr_b16 v[100:101], v8 offset:128
ds_read_b64_tr_b16 v[102:103], v8 offset:384
v_smfmac_f32_16x16x64_bf16 v[12:15], v[48:51], a[8:15], v1
ds_read_b64_tr_b16 v[104:105], v8 offset:640
ds_read_b64_tr_b16 v[106:107], v8 offset:896
v_smfmac_f32_16x16x64_bf16 v[24:27], v[48:51], a[72:79], v1
v_mov_b32 v28, s42
v_smfmac_f32_16x16x64_bf16 v[12:15], v[52:55], a[16:23], v1
v_mov_b32 v29, s42
v_smfmac_f32_16x16x64_bf16 v[24:27], v[52:55], a[80:87], v1
v_mov_b32 v30, s42
v_smfmac_f32_16x16x64_bf16 v[12:15], v[56:59], a[24:31], v1
v_mov_b32 v31, s42
v_smfmac_f32_16x16x64_bf16 v[24:27], v[56:59], a[88:95], v1
s_waitcnt vmcnt(4)
s_waitcnt lgkmcnt(8)
s_cmp_ge_u32 s18, 63
s_cbranch_scc1 CH_DONE_2f
s_waitcnt lgkmcnt(6)
v_mfma_f32_16x16x32_bf16 v[36:39], v[108:111], v[92:95], 0
s_nop 0
s_waitcnt lgkmcnt(4)
v_mfma_f32_16x16x32_bf16 v[36:39], v[112:115], v[96:99], v[36:39]
s_nop 0
s_waitcnt lgkmcnt(2)
v_mfma_f32_16x16x32_bf16 v[36:39], v[116:119], v[100:103], v[36:39]
s_add_u32 m0, s75, 5120
s_add_u32 s32, s26, 5120
buffer_load_dwordx4 v3, s[8:11], s32 offen  lds
s_nop 0
s_waitcnt lgkmcnt(0)
v_mfma_f32_16x16x32_bf16 v[36:39], v[120:123], v[104:107], v[36:39]
s_nop 0
v_mfma_f32_16x16x32_bf16 v[40:43], v[76:79], v[92:95], 0
v_add_f32 v12, v12, v14
v_add_f32 v13, v13, v15
v_mfma_f32_16x16x32_bf16 v[40:43], v[80:83], v[96:99], v[40:43]
v_add_f32 v24, v24, v26
v_add_f32 v25, v25, v27
v_mfma_f32_16x16x32_bf16 v[40:43], v[84:87], v[100:103], v[40:43]
v_cvt_pk_bf16_f32 v14, v12, v13
v_mfma_f32_16x16x32_bf16 v[40:43], v[88:91], v[104:107], v[40:43]
v_cvt_pk_bf16_f32 v15, v24, v25
v_mfma_f32_16x16x32_bf16 v[124:127], v[92:95], v[92:95], 0
v_max3_f32 v10, v36, v37, v38
v_mov_b32 v25, 0
s_nop 1
v_mfma_f32_16x16x32_bf16 v[124:127], v[96:99], v[96:99], v[124:127]
v_max_f32 v10, v10, v39
v_mov_b32 v26, 0
s_nop 1
v_mfma_f32_16x16x32_bf16 v[124:127], v[100:103], v[100:103], v[124:127]
v_max3_f32 v10, v10, v40, v41
v_mfma_f32_16x16x32_bf16 v[124:127], v[104:107], v[104:107], v[124:127]
v_max3_f32 v10, v10, v42, v43
s_not_b64 vcc, s[40:41]
v_cndmask_b32_dpp v36, v40, v36, vcc quad_perm:[0,1,0,1] row_mask:0xf bank_mask:0xf
v_cndmask_b32_dpp v37, v41, v37, vcc quad_perm:[0,1,0,1] row_mask:0xf bank_mask:0xf
v_mov_b32_dpp v10, v10 quad_perm:[0,1,0,1] row_mask:0xf bank_mask:0xf
v_cndmask_b32_dpp v38, v42, v38, vcc quad_perm:[0,1,0,1] row_mask:0xf bank_mask:0xf
v_cndmask_b32_dpp v39, v43, v39, vcc quad_perm:[0,1,0,1] row_mask:0xf bank_mask:0xf
v_mov_b32 v76, 0
v_max_f32_dpp v125, v126, v10 quad_perm:[0,1,0,1] row_mask:0xf bank_mask:0xf
v_max_f32_dpp v10, v127, v10 quad_perm:[0,1,0,1] row_mask:0xf bank_mask:0xf
v_max_f32 v124, v125, v10
v_mov_b32 v11, v124
v_mov_b32 v77, 0
v_mov_b32 v78, 0
v_permlane32_swap_b32 v124, v11
v_max_f32 v124, v124, v11
v_mov_b32 v11, v124
v_mov_b32 v79, 0
v_mov_b32 v80, 0
v_permlane16_swap_b32 v124, v11
v_max_f32 v124, v124, v11
v_mul_f32 v10, s30, v124
v_pk_fma_f32 v[126:127], v[126:127], s[30:31], v[10:11] op_sel_hi:[1,1,0] neg_lo:[0,0,1] neg_hi:[0,0,1]
v_pk_fma_f32 v[36:37], v[36:37], s[30:31], v[10:11] op_sel_hi:[1,1,0] neg_lo:[0,0,1] neg_hi:[0,0,1]
v_pk_fma_f32 v[38:39], v[38:39], s[30:31], v[10:11] op_sel_hi:[1,1,0] neg_lo:[0,0,1] neg_hi:[0,0,1]
v_exp_f32 v126, v126
v_exp_f32 v127, v127
v_exp_f32 v36, v36
v_cvt_pk_bf16_f32 v24, v126, v127
v_cvt_pk_bf16_f32 v27, v126, v127
v_exp_f32 v37, v37
v_exp_f32 v38, v38
v_mfma_f32_16x16x16_bf16 v[68:71], v[28:29], v[24:25], 0
v_exp_f32 v39, v39
v_cvt_pk_bf16_f32 v32, v36, v37
v_cvt_pk_bf16_f32 v33, v38, v39
v_mfma_f32_16x16x16_bf16 v[44:47], v[14:15], v[24:25], 0
v_mov_b32_dpp v34, v32 quad_perm:[2,3,2,3] row_mask:0xf bank_mask:0xf
v_mov_b32_dpp v35, v33 quad_perm:[2,3,2,3] row_mask:0xf bank_mask:0xf
v_mfma_f32_16x16x16_bf16 v[48:51], v[14:15], v[26:27], 0
s_waitcnt vmcnt(2)
v_mfma_f32_16x16x32_bf16 v[68:71], v[28:31], v[32:35], v[68:71]
v_mov_b32 v81, 0
v_mov_b32 v82, 0
v_mfma_f32_16x16x32_bf16 v[44:47], v[16:19], v[32:35], v[44:47]
v_mov_b32 v83, 0
v_mov_b32 v84, 0
v_mfma_f32_16x16x32_bf16 v[48:51], v[20:23], v[32:35], v[48:51]
v_mov_b32 v85, 0
v_mov_b32 v86, 0
v_rcp_f32 v10, v68
v_mov_b32 v87, 0
v_mov_b32 v88, 0
v_mov_b32 v89, 0
v_pk_mul_f32 v[44:45], v[44:45], v[10:11] op_sel_hi:[1,0]
v_pk_mul_f32 v[46:47], v[46:47], v[10:11] op_sel_hi:[1,0]
v_mov_b32 v90, 0
v_pk_mul_f32 v[48:49], v[48:49], v[10:11] op_sel_hi:[1,0]
v_pk_mul_f32 v[50:51], v[50:51], v[10:11] op_sel_hi:[1,0]
v_cvt_pk_bf16_f32 v52, v44, v45
v_cvt_pk_bf16_f32 v53, v46, v47
v_cvt_pk_bf16_f32 v54, v48, v49
v_cvt_pk_bf16_f32 v55, v50, v51
s_not_b64 exec, s[40:41]
ds_write_b128 v9, v[52:55] offset:1024
s_mov_b64 exec, -1
v_mov_b32 v91, 0
v_mov_b32_dpp v64, v52 quad_perm:[0,1,0,1] row_mask:0xf bank_mask:0xf
v_mov_b32_dpp v65, v53 quad_perm:[0,1,0,1] row_mask:0xf bank_mask:0xf
v_mov_b32_dpp v66, v54 quad_perm:[0,1,0,1] row_mask:0xf bank_mask:0xf
v_mov_b32_dpp v67, v55 quad_perm:[0,1,0,1] row_mask:0xf bank_mask:0xf
s_nop 1
v_smfmac_f32_16x16x64_bf16 v[76:79], v[64:67], a[144:151], v1
v_mov_b32_dpp v10, v14 quad_perm:[2,3,2,3] row_mask:0xf bank_mask:0xf
v_cndmask_b32 v16, v14, v100, s[40:41]
v_smfmac_f32_16x16x64_bf16 v[80:83], v[64:67], a[176:183], v1
v_mov_b32_dpp v11, v15 quad_perm:[2,3,2,3] row_mask:0xf bank_mask:0xf
v_cndmask_b32 v17, v15, v101, s[40:41]
s_waitcnt lgkmcnt(0)
s_barrier
ds_read_b128 v[68:71], v9 offset:1536
ds_read_b128 v[56:59], v9 offset:0
ds_read_b128 v[60:63], v9 offset:512
v_smfmac_f32_16x16x64_bf16 v[84:87], v[64:67], a[208:215], v1
v_cndmask_b32 v18, v10, v102, s[40:41]
v_smfmac_f32_16x16x64_bf16 v[88:91], v[64:67], a[240:247], v1
v_cndmask_b32 v19, v11, v103, s[40:41]
s_waitcnt lgkmcnt(2)
v_smfmac_f32_16x16x64_bf16 v[76:79], v[68:71], a[152:159], v1
s_waitcnt lgkmcnt(1)
v_smfmac_f32_16x16x64_bf16 v[76:79], v[56:59], a[128:135], v1
s_waitcnt lgkmcnt(0)
v_smfmac_f32_16x16x64_bf16 v[76:79], v[60:63], a[136:143], v1
v_smfmac_f32_16x16x64_bf16 v[80:83], v[68:71], a[184:191], v1
s_nop 2
v_smfmac_f32_16x16x64_bf16 v[80:83], v[56:59], a[160:167], v1
s_nop 2
v_cvt_pk_bf16_f32 v92, v76, v77
v_smfmac_f32_16x16x64_bf16 v[80:83], v[60:63], a[168:175], v1
v_cvt_pk_bf16_f32 v93, v78, v79
v_and_or_b32 v92, v92, -2, s21
buffer_store_dwordx2 v[92:93], v5, s[8:11], s19 offen
v_smfmac_f32_16x16x64_bf16 v[84:87], v[68:71], a[216:223], v1
s_nop 2
v_smfmac_f32_16x16x64_bf16 v[84:87], v[56:59], a[192:199], v1
s_nop 2
v_cvt_pk_bf16_f32 v94, v80, v81
v_smfmac_f32_16x16x64_bf16 v[84:87], v[60:63], a[200:207], v1
v_cvt_pk_bf16_f32 v95, v82, v83
v_and_or_b32 v94, v94, -2, s21
s_add_u32 s32, s19, 8192
buffer_store_dwordx2 v[94:95], v5, s[8:11], s32 offen
v_smfmac_f32_16x16x64_bf16 v[88:91], v[68:71], a[248:255], v1
s_nop 2
v_smfmac_f32_16x16x64_bf16 v[88:91], v[56:59], a[224:231], v1
s_nop 2
v_cvt_pk_bf16_f32 v96, v84, v85
v_smfmac_f32_16x16x64_bf16 v[88:91], v[60:63], a[232:239], v1
v_cvt_pk_bf16_f32 v97, v86, v87
v_and_or_b32 v96, v96, -2, s21
s_add_u32 s32, s19, 4096
buffer_store_dwordx2 v[96:97], v5, s[8:11], s32 offen
s_nop 4
v_cvt_pk_bf16_f32 v98, v88, v89
v_cvt_pk_bf16_f32 v99, v90, v91
v_and_or_b32 v98, v98, -2, s21
s_add_u32 s32, s19, 12288
buffer_store_dwordx2 v[98:99], v5, s[8:11], s32 offen
s_mov_b32 s36, 0
v_mov_b32 v28, 0
v_mov_b32 v29, 0
v_mov_b32 v30, 0
v_mov_b32 v31, 0
v_mov_b32 v32, 0
v_mov_b32 v33, 0
v_mov_b32 v34, 0
v_mov_b32 v35, 0
v_mov_b32 v36, 0
v_mov_b32 v37, 0
v_mov_b32 v38, 0
v_mov_b32 v39, 0
v_mov_b32 v40, 0
v_mov_b32 v41, 0
v_mov_b32 v42, 0
v_mov_b32 v43, 0
v_mov_b32 v12, 0
v_mov_b32 v13, 0
v_mov_b32 v14, 0
v_mov_b32 v15, 0
v_mov_b32 v24, 0
v_mov_b32 v25, 0
v_mov_b32 v26, 0
v_mov_b32 v27, 0
v_xor_b32 v2, 8192, v2
s_xor_b32 s75, s75, 8192
ds_read_b128 v[76:79], v4 offset:0
ds_read_b128 v[80:83], v4 offset:1024
ds_read_b128 v[84:87], v4 offset:2048
ds_read_b128 v[88:91], v4 offset:3072
ds_read_b128 v[92:95], v4 offset:4096
ds_read_b128 v[96:99], v4 offset:5120
ds_read_b128 v[100:103], v4 offset:6144
ds_read_b128 v[104:107], v4 offset:7168
ds_read_b128 v[108:111], v4 offset:8192
ds_read_b128 v[112:115], v4 offset:9216
ds_read_b128 v[116:119], v4 offset:12288
ds_read_b128 v[120:123], v4 offset:13312
s_mov_b32 s36, 0
s_mov_b32 s82, s27
s_add_u32 s25, s25, 262144
s_add_u32 s26, s26, 262144
s_add_u32 s27, s27, 131072
s_sub_u32 s24, s78, 0
s_mov_b32 s78, s22
s_add_u32 s77, s77, 8192
s_and_b32 s77, s77, 0x7fff
s_add_u32 s22, s77, s81
s_add_u32 s18, s18, 1
s_xor_b32 s21, s21, 1
s_cmp_eq_u32 s29, 0
s_cbranch_scc1 RDY_76_P
s_mov_b32 s29, 0
s_waitcnt vmcnt(4)
s_nop 1
v_min_u32_dpp v6, v6, v6 quad_perm:[1,0,3,2] row_mask:0xf bank_mask:0xf
s_nop 1
v_min_u32_dpp v6, v6, v6 quad_perm:[2,3,0,1] row_mask:0xf bank_mask:0xf
s_nop 1
v_min_u32_dpp v6, v6, v6 row_half_mirror row_mask:0xf bank_mask:0xf
s_nop 0
v_readfirstlane_b32 s85, v6
s_nop 3
s_lshl_b32 s85, s85, 2
RDY_76_P:
s_add_u32 s32, s18, 1
s_min_u32 s32, s32, 63
s_cmp_ge_u32 s32, s85
s_cbranch_scc1 RDY_76_S
RDY_76:
s_barrier
s_nop 3
buffer_load_dwordx4 v[60:63], v3, s[8:11], s23 offen offset:0 sc1
s_nop 15
buffer_load_dwordx4 v[64:67], v3, s[8:11], s23 offen offset:1024 sc1
s_nop 15
buffer_load_dwordx4 v[60:63], v3, s[8:11], s23 offen offset:0 sc1
buffer_load_dwordx4 v[64:67], v3, s[8:11], s23 offen offset:1024 sc1
s_waitcnt lgkmcnt(0)
s_branch CH_RB_2f
CH_RBRETRY_2f:
buffer_load_dwordx4 v[60:63], v3, s[8:11], s23 offen offset:0 sc1
buffer_load_dwordx4 v[64:67], v3, s[8:11], s23 offen offset:1024 sc1
s_add_u32 s36, s36, 1
s_cmp_gt_u32 s36, 65536
s_cbranch_scc1 CH_RBOK_2f
s_branch CH_RB_2f
CH_RBLRETRY_2f:
buffer_load_dwordx4 v[64:67], v3, s[8:11], s23 offen offset:1024 sc1
s_add_u32 s36, s36, 1
s_cmp_gt_u32 s36, 65536
s_cbranch_scc1 CH_RBLOK_2f
s_waitcnt vmcnt(1)
s_branch CH_RBL_2f
CH_DONE_2f:
s_waitcnt lgkmcnt(0)
s_nop 4
v_add_f32 v12, v12, v14
v_add_f32 v13, v13, v15
v_add_f32 v24, v24, v26
v_add_f32 v25, v25, v27
v_cvt_pk_bf16_f32 v14, v12, v13
v_cvt_pk_bf16_f32 v15, v24, v25
s_nop 1
v_mov_b32_dpp v10, v14 quad_perm:[2,3,2,3] row_mask:0xf bank_mask:0xf
v_mov_b32_dpp v11, v15 quad_perm:[2,3,2,3] row_mask:0xf bank_mask:0xf
v_cndmask_b32 v36, v14, v100, s[40:41]
v_cndmask_b32 v37, v15, v101, s[40:41]
v_cndmask_b32 v38, v10, v102, s[40:41]
v_cndmask_b32 v39, v11, v103, s[40:41]
buffer_store_dwordx4 v[36:39], v3, s[8:11], s27 offen sc1
s_barrier
s_branch L_FIN
RDY_74_S:
s_add_u32 s32, s18, 1
s_min_u32 s32, s32, 63
s_lshr_b32 s32, s32, 2
s_add_u32 s32, s32, 1
v_lshrrev_b32 v10, 3, v0
v_and_b32 v11, 3, v10
v_bfe_u32 v10, v10, 2, 1
v_lshlrev_b32 v10, 13, v10
v_lshl_add_u32 v10, v11, 7, v10
s_mov_b32 s35, 0
POLL_KV_77:
s_cmp_lg_u32 s37, 0
s_cbranch_scc1 POLL_KV_77_E
buffer_load_dword v11, v10, s[8:11], s89 offen sc1
s_add_u32 s35, s35, 1
s_cmp_gt_u32 s35, 65536
s_cselect_b32 s37, 1, 0
s_waitcnt vmcnt(0)
v_cmp_gt_u32 vcc, s32, v11
s_cbranch_vccz POLL_KV_77_E
s_branch POLL_KV_77
POLL_KV_77_E:
s_nop 1
v_min_u32_dpp v11, v11, v11 quad_perm:[1,0,3,2] row_mask:0xf bank_mask:0xf
s_nop 1
v_min_u32_dpp v11, v11, v11 quad_perm:[2,3,0,1] row_mask:0xf bank_mask:0xf
s_nop 1
v_min_u32_dpp v11, v11, v11 row_half_mirror row_mask:0xf bank_mask:0xf
s_nop 0
v_readfirstlane_b32 s85, v11
s_nop 3
s_lshl_b32 s85, s85, 2
s_branch RDY_74
RDY_76_S:
s_add_u32 s32, s18, 1
s_min_u32 s32, s32, 63
s_lshr_b32 s32, s32, 2
s_add_u32 s32, s32, 1
v_lshrrev_b32 v10, 3, v0
v_and_b32 v11, 3, v10
v_bfe_u32 v10, v10, 2, 1
v_lshlrev_b32 v10, 13, v10
v_lshl_add_u32 v10, v11, 7, v10
s_mov_b32 s35, 0
POLL_KV_78:
s_cmp_lg_u32 s37, 0
s_cbranch_scc1 POLL_KV_78_E
buffer_load_dword v11, v10, s[8:11], s89 offen sc1
s_add_u32 s35, s35, 1
s_cmp_gt_u32 s35, 65536
s_cselect_b32 s37, 1, 0
s_waitcnt vmcnt(0)
v_cmp_gt_u32 vcc, s32, v11
s_cbranch_vccz POLL_KV_78_E
s_branch POLL_KV_78
POLL_KV_78_E:
s_nop 1
v_min_u32_dpp v11, v11, v11 quad_perm:[1,0,3,2] row_mask:0xf bank_mask:0xf
s_nop 1
v_min_u32_dpp v11, v11, v11 quad_perm:[2,3,0,1] row_mask:0xf bank_mask:0xf
s_nop 1
v_min_u32_dpp v11, v11, v11 row_half_mirror row_mask:0xf bank_mask:0xf
s_nop 0
v_readfirstlane_b32 s85, v11
s_nop 3
s_lshl_b32 s85, s85, 2
s_branch RDY_76
CH_W3f:
s_mov_b32 s18, 0
s_mov_b32 s29, 0
s_add_u32 s32, s18, 1
s_min_u32 s32, s32, 63
s_cmp_ge_u32 s32, s85
s_cbranch_scc1 RDY_79_S
RDY_79:
s_mov_b32 s75, 147456
s_lshl_b32 s26, s16, 13
s_add_u32 s26, s26, 18743296
s_add_u32 m0, s75, 6144
s_add_u32 s32, s26, 6144
buffer_load_dwordx4 v3, s[8:11], s32 offen  lds
s_add_u32 m0, s75, 7168
s_add_u32 s32, s26, 7168
buffer_load_dwordx4 v3, s[8:11], s32 offen  lds
s_mov_b32 s34, 0x05040100
s_mov_b32 s35, 0x07060302
v_perm_b32 v68, v17, v16, s34
v_perm_b32 v69, v19, v18, s34
v_perm_b32 v70, v17, v16, s35
v_perm_b32 v71, v19, v18, s35
v_perm_b32 v72, v13, v12, s34
v_perm_b32 v73, v15, v14, s34
v_perm_b32 v74, v13, v12, s35
v_perm_b32 v75, v15, v14, s35
s_mov_b32 s18, 0
s_mov_b32 s75, 155648
s_and_b32 s32, s18, 3
s_lshl_b32 s33, s32, 18
s_lshl_b32 s34, s16, 7
s_add_u32 s19, s33, s34
s_add_u32 s19, s19, 90374144
s_lshl_b32 s35, s16, 13
s_add_u32 s20, s33, s35
s_add_u32 s20, s20, 90050560
s_add_u32 s32, s18, 3
s_and_b32 s32, s32, 3
s_lshl_b32 s33, s32, 18
s_mov_b32 s21, 0
s_lshr_b32 s34, s16, 3
s_lshl_b32 s34, s34, 11
s_and_b32 s35, s16, 1
s_lshl_b32 s35, s35, 9
s_add_u32 s34, s34, s35
s_bfe_u32 s35, s16, 0x20001
s_lshl_b32 s35, s35, 6
s_add_u32 s34, s34, s35
s_lshl_b32 s33, s32, 13
s_add_u32 s24, s33, s34
s_add_u32 s24, s24, 91227136
s_add_u32 s32, s18, 1
s_and_b32 s32, s32, 3
s_lshl_b32 s33, s32, 13
s_add_u32 s22, s33, s34
s_add_u32 s22, s22, 91227136
s_add_u32 s23, s33, 91101184
s_lshl_b32 s32, s18, 5
s_add_u32 s32, s32, s16
s_lshl_b32 s33, s32, 13
s_add_u32 s25, s33, 35526656
s_add_u32 s26, s33, 19005440
s_lshl_b32 s33, s32, 12
s_add_u32 s27, s33, 52300800
s_lshl_b32 s33, s32, 11
s_add_u32 s28, s33, 60818944
s_mov_b32 s82, s27
s_sub_u32 s24, s24, 1024
s_mov_b32 s76, 0
s_mov_b32 s77, 8192
s_mov_b32 s79, s19
s_mov_b32 s80, s20
s_sub_u32 s81, s22, 8192
s_mov_b32 s78, s81
v_lshlrev_b32 v6, 4, v0
ds_read_b128 v[76:79], v4 offset:8192
ds_read_b128 v[80:83], v4 offset:9216
ds_read_b128 v[84:87], v4 offset:10240
ds_read_b128 v[88:91], v4 offset:11264
ds_read_b128 v[92:95], v4 offset:12288
ds_read_b128 v[96:99], v4 offset:13312
ds_read_b128 v[100:103], v4 offset:14336
ds_read_b128 v[104:107], v4 offset:15360
ds_read_b128 v[108:111], v4 offset:16384
ds_read_b128 v[112:115], v4 offset:17408
ds_read_b128 v[116:119], v4 offset:20480
ds_read_b128 v[120:123], v4 offset:21504
v_mov_b32 v124, -1
v_lshrrev_b32 v125, 8, v0
v_bfe_u32 v126, v0, 7, 1
v_lshl_add_u32 v125, v125, 2, v126
v_bfe_u32 v126, v0, 1, 6
v_lshl_add_u32 v125, v125, 8, v126
v_mov_b32 v28, 0
v_mov_b32 v29, 0
v_mov_b32 v30, 0
v_mov_b32 v31, 0
v_mov_b32 v32, 0
v_mov_b32 v33, 0
v_mov_b32 v34, 0
v_mov_b32 v35, 0
v_mov_b32 v36, 0
v_mov_b32 v37, 0
v_mov_b32 v38, 0
v_mov_b32 v39, 0
v_mov_b32 v40, 0
v_mov_b32 v41, 0
v_mov_b32 v42, 0
v_mov_b32 v43, 0
v_mov_b32 v12, 0
v_mov_b32 v13, 0
v_mov_b32 v14, 0
v_mov_b32 v15, 0
v_mov_b32 v24, 0
v_mov_b32 v25, 0
v_mov_b32 v26, 0
v_mov_b32 v27, 0
s_waitcnt vmcnt(0)
s_waitcnt lgkmcnt(0)
s_mov_b32 s36, 0
v_min_u32 v68, 0xfffffffe, v68
v_min_u32 v69, 0xfffffffe, v69
v_min_u32 v70, 0xfffffffe, v70
v_min_u32 v71, 0xfffffffe, v71
v_min_u32 v72, 0xfffffffe, v72
v_min_u32 v73, 0xfffffffe, v73
v_min_u32 v74, 0xfffffffe, v74
v_min_u32 v75, 0xfffffffe, v75
.p2align 6
CH_BASE_3f:
.fill (((8 - (. - CH_BASE_3f)) & 15) >> 2), 4, 0xbf800000
CH_RB_3f:
s_waitcnt vmcnt(3)
CH_RBE_3f:
v_max3_u32 v10, v68, v69, v70
v_max_u32 v10, v10, v71
v_cmp_eq_u32 vcc, -1, v10
ds_write_b128 v3, v[68:71] offset:6144
s_cbranch_vccnz CH_RBRETRY_3f
CH_RBOK_3f:
v_smfmac_f32_16x16x64_bf16 v[28:31], v[68:71], v[76:83], v1
v_smfmac_f32_16x16x64_bf16 v[32:35], v[68:71], v[176:183], v1
ds_read_b128 v[76:79], v4 offset:24576
v_smfmac_f32_16x16x64_bf16 v[36:39], v[68:71], v[84:91], v1
ds_read_b128 v[80:83], v4 offset:25600
v_smfmac_f32_16x16x64_bf16 v[40:43], v[68:71], v[240:247], v1
s_waitcnt vmcnt(2)
CH_RBL_3f:
v_max3_u32 v10, v72, v73, v74
v_max_u32 v10, v10, v75
v_cmp_eq_u32 vcc, -1, v10
ds_write_b128 v3, v[72:75] offset:7168
s_cbranch_vccnz CH_RBLRETRY_3f
CH_RBLOK_3f:
v_smfmac_f32_16x16x64_bf16 v[28:31], v[72:75], v[92:99], v1
v_smfmac_f32_16x16x64_bf16 v[32:35], v[72:75], v[184:191], v1
v_smfmac_f32_16x16x64_bf16 v[36:39], v[72:75], v[100:107], v1
v_smfmac_f32_16x16x64_bf16 v[40:43], v[72:75], v[248:255], v1
s_waitcnt lgkmcnt(0)
s_barrier
ds_read_b128 v[44:47], v3 offset:0
ds_read_b128 v[48:51], v3 offset:1024
buffer_store_dwordx4 v[16:19], v3, s[8:11], s82 offen sc1
v_smfmac_f32_16x16x64_bf16 v[12:15], v[68:71], a[48:55], v1
ds_read_b128 v[52:55], v3 offset:2048
v_smfmac_f32_16x16x64_bf16 v[24:27], v[68:71], a[112:119], v1
ds_read_b128 v[56:59], v3 offset:3072
v_smfmac_f32_16x16x64_bf16 v[12:15], v[72:75], a[56:63], v1
ds_read_b128 v[60:63], v3 offset:4096
v_smfmac_f32_16x16x64_bf16 v[24:27], v[72:75], a[120:127], v1
ds_read_b128 v[64:67], v3 offset:5120
buffer_load_dwordx4 v[16:19], v3, s[8:11], s25 offen
s_waitcnt lgkmcnt(5)
v_smfmac_f32_16x16x64_bf16 v[28:31], v[44:47], v[108:115], v1
ds_read_b128 v[84:87], v4 offset:28672
v_smfmac_f32_16x16x64_bf16 v[32:35], v[44:47], v[128:135], v1
ds_read_b128 v[88:91], v4 offset:29696
s_waitcnt lgkmcnt(6)
v_smfmac_f32_16x16x64_bf16 v[28:31], v[48:51], v[116:123], v1
ds_read_b128 v[92:95], v4 offset:0
v_smfmac_f32_16x16x64_bf16 v[32:35], v[48:51], v[136:143], v1
ds_read_b128 v[96:99], v4 offset:1024
buffer_load_dwordx4 v[20:23], v3, s[8:11], s25 offen offset:1024
s_waitcnt lgkmcnt(7)
v_smfmac_f32_16x16x64_bf16 v[28:31], v[52:55], v[76:83], v1
ds_read_b128 v[100:103], v4 offset:4096
v_smfmac_f32_16x16x64_bf16 v[32:35], v[52:55], v[144:151], v1
ds_read_b128 v[104:107], v4 offset:5120
s_waitcnt lgkmcnt(8)
s_waitcnt lgkmcnt(4)
v_smfmac_f32_16x16x64_bf16 v[28:31], v[56:59], v[84:91], v1
ds_read_b128 v[108:111], v4 offset:18432
v_smfmac_f32_16x16x64_bf16 v[32:35], v[56:59], v[152:159], v1
ds_read_b128 v[112:115], v4 offset:19456
s_waitcnt lgkmcnt(4)
v_smfmac_f32_16x16x64_bf16 v[28:31], v[60:63], v[92:99], v1
ds_read_b128 v[116:119], v4 offset:22528
v_smfmac_f32_16x16x64_bf16 v[32:35], v[60:63], v[160:167], v1
ds_read_b128 v[120:123], v4 offset:23552
s_waitcnt lgkmcnt(4)
v_smfmac_f32_16x16x64_bf16 v[28:31], v[64:67], v[100:107], v1
ds_read_b128 v[76:79], v4 offset:26624
v_smfmac_f32_16x16x64_bf16 v[32:35], v[64:67], v[168:175], v1
ds_read_b128 v[80:83], v4 offset:27648
s_waitcnt lgkmcnt(4)
v_smfmac_f32_16x16x64_bf16 v[36:39], v[44:47], v[108:115], v1
ds_read_b128 v[84:87], v4 offset:30720
s_nop 1
v_smfmac_f32_16x16x64_bf16 v[40:43], v[44:47], v[192:199], v1
ds_read_b128 v[88:91], v4 offset:31744
s_nop 1
s_waitcnt lgkmcnt(4)
v_smfmac_f32_16x16x64_bf16 v[36:39], v[48:51], v[116:123], v1
ds_read_b128 v[92:95], v4 offset:2048
v_smfmac_f32_16x16x64_bf16 v[40:43], v[48:51], v[200:207], v1
ds_read_b128 v[96:99], v4 offset:3072
s_waitcnt lgkmcnt(4)
v_smfmac_f32_16x16x64_bf16 v[36:39], v[52:55], v[76:83], v1
ds_read_b128 v[100:103], v4 offset:6144
s_add_u32 s23, s77, 91101184
v_smfmac_f32_16x16x64_bf16 v[40:43], v[52:55], v[208:215], v1
ds_read_b128 v[104:107], v4 offset:7168
s_waitcnt lgkmcnt(4)
v_smfmac_f32_16x16x64_bf16 v[36:39], v[56:59], v[84:91], v1
ds_read_b128 v[108:111], v2 offset:0
v_smfmac_f32_16x16x64_bf16 v[40:43], v[56:59], v[216:223], v1
ds_read_b128 v[112:115], v2 offset:1024
s_waitcnt lgkmcnt(4)
v_smfmac_f32_16x16x64_bf16 v[36:39], v[60:63], v[92:99], v1
ds_read_b128 v[116:119], v2 offset:2048
v_smfmac_f32_16x16x64_bf16 v[40:43], v[60:63], v[224:231], v1
ds_read_b128 v[120:123], v2 offset:3072
s_waitcnt lgkmcnt(4)
v_smfmac_f32_16x16x64_bf16 v[36:39], v[64:67], v[100:107], v1
ds_read_b128 v[76:79], v2 offset:4096
v_smfmac_f32_16x16x64_bf16 v[40:43], v[64:67], v[232:239], v1
buffer_store_dword v124, v125, s[8:11], s24 offen
v_pk_add_f32 v[28:29], v[28:29], v[30:31]
v_pk_add_f32 v[32:33], v[32:33], v[34:35]
v_cvt_pk_bf16_f32 v34, v28, v29
v_cvt_pk_bf16_f32 v35, v32, v33
ds_write_b64 v7, v[34:35] offset:0
s_nop 0
v_pk_add_f32 v[36:37], v[36:37], v[38:39]
v_pk_add_f32 v[40:41], v[40:41], v[42:43]
v_cvt_pk_bf16_f32 v32, v36, v37
v_cvt_pk_bf16_f32 v33, v40, v41
ds_write_b64 v7, v[32:33] offset:128
v_smfmac_f32_16x16x64_bf16 v[12:15], v[44:47], a[0:7], v1
ds_read_b128 v[80:83], v2 offset:5120
v_smfmac_f32_16x16x64_bf16 v[24:27], v[44:47], a[64:71], v1
ds_read_b128 v[84:87], v2 offset:6144
v_smfmac_f32_16x16x64_bf16 v[12:15], v[48:51], a[8:15], v1
ds_read_b128 v[88:91], v2 offset:7168
v_smfmac_f32_16x16x64_bf16 v[24:27], v[48:51], a[72:79], v1
s_waitcnt lgkmcnt(3)
s_barrier
ds_read_b64_tr_b16 v[92:93], v8 offset:0
ds_read_b64_tr_b16 v[94:95], v8 offset:256
v_smfmac_f32_16x16x64_bf16 v[12:15], v[52:55], a[16:23], v1
ds_read_b64_tr_b16 v[96:97], v8 offset:512
ds_read_b64_tr_b16 v[98:99], v8 offset:768
v_smfmac_f32_16x16x64_bf16 v[24:27], v[52:55], a[80:87], v1
ds_read_b64_tr_b16 v[100:101], v8 offset:128
ds_read_b64_tr_b16 v[102:103], v8 offset:384
v_smfmac_f32_16x16x64_bf16 v[12:15], v[56:59], a[24:31], v1
ds_read_b64_tr_b16 v[104:105], v8 offset:640
ds_read_b64_tr_b16 v[106:107], v8 offset:896
s_add_u32 m0, s75, 6144
s_add_u32 s32, s26, 6144
buffer_load_dwordx4 v3, s[8:11], s32 offen  lds
v_smfmac_f32_16x16x64_bf16 v[24:27], v[56:59], a[88:95], v1
v_mov_b32 v28, s42
v_smfmac_f32_16x16x64_bf16 v[12:15], v[60:63], a[32:39], v1
v_mov_b32 v29, s42
v_smfmac_f32_16x16x64_bf16 v[24:27], v[60:63], a[96:103], v1
v_mov_b32 v30, s42
v_smfmac_f32_16x16x64_bf16 v[12:15], v[64:67], a[40:47], v1
v_mov_b32 v31, s42
v_smfmac_f32_16x16x64_bf16 v[24:27], v[64:67], a[104:111], v1
s_waitcnt vmcnt(5)
s_waitcnt lgkmcnt(8)
s_cmp_ge_u32 s18, 63
s_cbranch_scc1 CH_DONE_3f
s_waitcnt lgkmcnt(6)
v_mfma_f32_16x16x32_bf16 v[36:39], v[108:111], v[92:95], 0
s_nop 0
s_waitcnt lgkmcnt(4)
v_mfma_f32_16x16x32_bf16 v[36:39], v[112:115], v[96:99], v[36:39]
s_nop 0
s_waitcnt lgkmcnt(2)
v_mfma_f32_16x16x32_bf16 v[36:39], v[116:119], v[100:103], v[36:39]
s_nop 0
s_waitcnt lgkmcnt(0)
v_mfma_f32_16x16x32_bf16 v[36:39], v[120:123], v[104:107], v[36:39]
s_nop 0
v_mfma_f32_16x16x32_bf16 v[40:43], v[76:79], v[92:95], 0
s_add_u32 m0, s75, 7168
s_add_u32 s32, s26, 7168
buffer_load_dwordx4 v3, s[8:11], s32 offen  lds
v_add_f32 v12, v12, v14
v_add_f32 v13, v13, v15
v_mfma_f32_16x16x32_bf16 v[40:43], v[80:83], v[96:99], v[40:43]
v_add_f32 v24, v24, v26
v_add_f32 v25, v25, v27
v_mfma_f32_16x16x32_bf16 v[40:43], v[84:87], v[100:103], v[40:43]
v_cvt_pk_bf16_f32 v14, v12, v13
v_mfma_f32_16x16x32_bf16 v[40:43], v[88:91], v[104:107], v[40:43]
v_cvt_pk_bf16_f32 v15, v24, v25
v_mfma_f32_16x16x32_bf16 v[124:127], v[92:95], v[92:95], 0
v_max3_f32 v10, v36, v37, v38
v_mov_b32 v25, 0
s_nop 1
v_mfma_f32_16x16x32_bf16 v[124:127], v[96:99], v[96:99], v[124:127]
v_max_f32 v10, v10, v39
v_mov_b32 v26, 0
s_nop 1
v_mfma_f32_16x16x32_bf16 v[124:127], v[100:103], v[100:103], v[124:127]
v_max3_f32 v10, v10, v40, v41
v_mfma_f32_16x16x32_bf16 v[124:127], v[104:107], v[104:107], v[124:127]
v_max3_f32 v10, v10, v42, v43
s_not_b64 vcc, s[40:41]
v_cndmask_b32_dpp v36, v40, v36, vcc quad_perm:[0,1,0,1] row_mask:0xf bank_mask:0xf
v_cndmask_b32_dpp v37, v41, v37, vcc quad_perm:[0,1,0,1] row_mask:0xf bank_mask:0xf
v_mov_b32_dpp v10, v10 quad_perm:[0,1,0,1] row_mask:0xf bank_mask:0xf
v_cndmask_b32_dpp v38, v42, v38, vcc quad_perm:[0,1,0,1] row_mask:0xf bank_mask:0xf
v_cndmask_b32_dpp v39, v43, v39, vcc quad_perm:[0,1,0,1] row_mask:0xf bank_mask:0xf
v_mov_b32 v76, 0
v_max_f32_dpp v125, v126, v10 quad_perm:[0,1,0,1] row_mask:0xf bank_mask:0xf
v_max_f32_dpp v10, v127, v10 quad_perm:[0,1,0,1] row_mask:0xf bank_mask:0xf
v_max_f32 v124, v125, v10
v_mov_b32 v11, v124
v_mov_b32 v77, 0
v_mov_b32 v78, 0
v_permlane32_swap_b32 v124, v11
v_max_f32 v124, v124, v11
v_mov_b32 v11, v124
v_mov_b32 v79, 0
v_mov_b32 v80, 0
v_permlane16_swap_b32 v124, v11
v_max_f32 v124, v124, v11
v_mul_f32 v10, s30, v124
v_pk_fma_f32 v[126:127], v[126:127], s[30:31], v[10:11] op_sel_hi:[1,1,0] neg_lo:[0,0,1] neg_hi:[0,0,1]
v_pk_fma_f32 v[36:37], v[36:37], s[30:31], v[10:11] op_sel_hi:[1,1,0] neg_lo:[0,0,1] neg_hi:[0,0,1]
v_pk_fma_f32 v[38:39], v[38:39], s[30:31], v[10:11] op_sel_hi:[1,1,0] neg_lo:[0,0,1] neg_hi:[0,0,1]
v_exp_f32 v126, v126
v_exp_f32 v127, v127
v_exp_f32 v36, v36
v_cvt_pk_bf16_f32 v24, v126, v127
v_cvt_pk_bf16_f32 v27, v126, v127
v_exp_f32 v37, v37
v_exp_f32 v38, v38
v_mfma_f32_16x16x16_bf16 v[68:71], v[28:29], v[24:25], 0
v_exp_f32 v39, v39
v_cvt_pk_bf16_f32 v32, v36, v37
v_cvt_pk_bf16_f32 v33, v38, v39
v_mfma_f32_16x16x16_bf16 v[44:47], v[14:15], v[24:25], 0
v_mov_b32_dpp v34, v32 quad_perm:[2,3,2,3] row_mask:0xf bank_mask:0xf
v_mov_b32_dpp v35, v33 quad_perm:[2,3,2,3] row_mask:0xf bank_mask:0xf
v_mfma_f32_16x16x16_bf16 v[48:51], v[14:15], v[26:27], 0
s_waitcnt vmcnt(3)
v_mfma_f32_16x16x32_bf16 v[68:71], v[28:31], v[32:35], v[68:71]
v_mov_b32 v81, 0
v_mov_b32 v82, 0
v_mfma_f32_16x16x32_bf16 v[44:47], v[16:19], v[32:35], v[44:47]
v_mov_b32 v83, 0
v_mov_b32 v84, 0
v_mfma_f32_16x16x32_bf16 v[48:51], v[20:23], v[32:35], v[48:51]
v_mov_b32 v85, 0
v_mov_b32 v86, 0
v_rcp_f32 v10, v68
v_mov_b32 v87, 0
v_mov_b32 v88, 0
v_mov_b32 v89, 0
v_pk_mul_f32 v[44:45], v[44:45], v[10:11] op_sel_hi:[1,0]
v_pk_mul_f32 v[46:47], v[46:47], v[10:11] op_sel_hi:[1,0]
v_mov_b32 v90, 0
v_pk_mul_f32 v[48:49], v[48:49], v[10:11] op_sel_hi:[1,0]
v_pk_mul_f32 v[50:51], v[50:51], v[10:11] op_sel_hi:[1,0]
v_cvt_pk_bf16_f32 v52, v44, v45
v_cvt_pk_bf16_f32 v53, v46, v47
v_cvt_pk_bf16_f32 v54, v48, v49
v_cvt_pk_bf16_f32 v55, v50, v51
s_not_b64 exec, s[40:41]
ds_write_b128 v9, v[52:55] offset:1536
s_mov_b64 exec, -1
v_mov_b32 v91, 0
v_mov_b32_dpp v68, v52 quad_perm:[0,1,0,1] row_mask:0xf bank_mask:0xf
v_mov_b32_dpp v69, v53 quad_perm:[0,1,0,1] row_mask:0xf bank_mask:0xf
v_mov_b32_dpp v70, v54 quad_perm:[0,1,0,1] row_mask:0xf bank_mask:0xf
v_mov_b32_dpp v71, v55 quad_perm:[0,1,0,1] row_mask:0xf bank_mask:0xf
s_nop 1
v_smfmac_f32_16x16x64_bf16 v[76:79], v[68:71], a[152:159], v1
v_mov_b32_dpp v10, v14 quad_perm:[2,3,2,3] row_mask:0xf bank_mask:0xf
v_cndmask_b32 v16, v14, v104, s[40:41]
v_smfmac_f32_16x16x64_bf16 v[80:83], v[68:71], a[184:191], v1
v_mov_b32_dpp v11, v15 quad_perm:[2,3,2,3] row_mask:0xf bank_mask:0xf
v_cndmask_b32 v17, v15, v105, s[40:41]
s_waitcnt lgkmcnt(0)
s_barrier
ds_read_b128 v[56:59], v9 offset:0
ds_read_b128 v[60:63], v9 offset:512
ds_read_b128 v[64:67], v9 offset:1024
v_smfmac_f32_16x16x64_bf16 v[84:87], v[68:71], a[216:223], v1
v_cndmask_b32 v18, v10, v106, s[40:41]
v_smfmac_f32_16x16x64_bf16 v[88:91], v[68:71], a[248:255], v1
v_cndmask_b32 v19, v11, v107, s[40:41]
s_waitcnt lgkmcnt(2)
v_smfmac_f32_16x16x64_bf16 v[76:79], v[56:59], a[128:135], v1
s_waitcnt lgkmcnt(1)
v_smfmac_f32_16x16x64_bf16 v[76:79], v[60:63], a[136:143], v1
s_waitcnt lgkmcnt(0)
v_smfmac_f32_16x16x64_bf16 v[76:79], v[64:67], a[144:151], v1
v_smfmac_f32_16x16x64_bf16 v[80:83], v[56:59], a[160:167], v1
s_nop 2
v_smfmac_f32_16x16x64_bf16 v[80:83], v[60:63], a[168:175], v1
s_nop 2
v_cvt_pk_bf16_f32 v92, v76, v77
v_smfmac_f32_16x16x64_bf16 v[80:83], v[64:67], a[176:183], v1
v_cvt_pk_bf16_f32 v93, v78, v79
v_and_or_b32 v92, v92, -2, s21
buffer_store_dwordx2 v[92:93], v5, s[8:11], s19 offen
v_smfmac_f32_16x16x64_bf16 v[84:87], v[56:59], a[192:199], v1
s_nop 2
v_smfmac_f32_16x16x64_bf16 v[84:87], v[60:63], a[200:207], v1
s_nop 2
v_cvt_pk_bf16_f32 v94, v80, v81
v_smfmac_f32_16x16x64_bf16 v[84:87], v[64:67], a[208:215], v1
v_cvt_pk_bf16_f32 v95, v82, v83
v_and_or_b32 v94, v94, -2, s21
s_add_u32 s32, s19, 8192
buffer_store_dwordx2 v[94:95], v5, s[8:11], s32 offen
v_smfmac_f32_16x16x64_bf16 v[88:91], v[56:59], a[224:231], v1
s_nop 2
v_smfmac_f32_16x16x64_bf16 v[88:91], v[60:63], a[232:239], v1
s_nop 2
v_cvt_pk_bf16_f32 v96, v84, v85
v_smfmac_f32_16x16x64_bf16 v[88:91], v[64:67], a[240:247], v1
v_cvt_pk_bf16_f32 v97, v86, v87
v_and_or_b32 v96, v96, -2, s21
s_add_u32 s32, s19, 4096
buffer_store_dwordx2 v[96:97], v5, s[8:11], s32 offen
s_nop 4
v_cvt_pk_bf16_f32 v98, v88, v89
v_cvt_pk_bf16_f32 v99, v90, v91
v_and_or_b32 v98, v98, -2, s21
s_add_u32 s32, s19, 12288
buffer_store_dwordx2 v[98:99], v5, s[8:11], s32 offen
s_mov_b32 s36, 0
v_mov_b32 v124, -1
v_lshrrev_b32 v125, 8, v0
v_bfe_u32 v126, v0, 7, 1
v_lshl_add_u32 v125, v125, 2, v126
v_bfe_u32 v126, v0, 1, 6
v_lshl_add_u32 v125, v125, 8, v126
v_mov_b32 v28, 0
v_mov_b32 v29, 0
v_mov_b32 v30, 0
v_mov_b32 v31, 0
v_mov_b32 v32, 0
v_mov_b32 v33, 0
v_mov_b32 v34, 0
v_mov_b32 v35, 0
v_mov_b32 v36, 0
v_mov_b32 v37, 0
v_mov_b32 v38, 0
v_mov_b32 v39, 0
v_mov_b32 v40, 0
v_mov_b32 v41, 0
v_mov_b32 v42, 0
v_mov_b32 v43, 0
v_mov_b32 v12, 0
v_mov_b32 v13, 0
v_mov_b32 v14, 0
v_mov_b32 v15, 0
v_mov_b32 v24, 0
v_mov_b32 v25, 0
v_mov_b32 v26, 0
v_mov_b32 v27, 0
v_xor_b32 v2, 8192, v2
s_xor_b32 s75, s75, 8192
ds_read_b128 v[76:79], v4 offset:8192
ds_read_b128 v[80:83], v4 offset:9216
ds_read_b128 v[84:87], v4 offset:10240
ds_read_b128 v[88:91], v4 offset:11264
ds_read_b128 v[92:95], v4 offset:12288
ds_read_b128 v[96:99], v4 offset:13312
ds_read_b128 v[100:103], v4 offset:14336
ds_read_b128 v[104:107], v4 offset:15360
ds_read_b128 v[108:111], v4 offset:16384
ds_read_b128 v[112:115], v4 offset:17408
ds_read_b128 v[116:119], v4 offset:20480
ds_read_b128 v[120:123], v4 offset:21504
s_mov_b32 s36, 0
s_mov_b32 s82, s27
s_add_u32 s25, s25, 262144
s_add_u32 s26, s26, 262144
s_add_u32 s27, s27, 131072
s_sub_u32 s24, s78, 1024
s_mov_b32 s78, s22
s_add_u32 s77, s77, 8192
s_and_b32 s77, s77, 0x7fff
s_add_u32 s22, s77, s81
s_add_u32 s18, s18, 1
s_xor_b32 s21, s21, 1
s_barrier
s_nop 3
buffer_load_dwordx4 v[68:71], v3, s[8:11], s23 offen offset:0 sc1
s_nop 15
buffer_load_dwordx4 v[72:75], v3, s[8:11], s23 offen offset:1024 sc1
s_nop 15
buffer_load_dwordx4 v[68:71], v3, s[8:11], s23 offen offset:0 sc1
buffer_load_dwordx4 v[72:75], v3, s[8:11], s23 offen offset:1024 sc1
s_waitcnt lgkmcnt(0)
s_branch CH_RB_3f
CH_RBRETRY_3f:
buffer_load_dwordx4 v[68:71], v3, s[8:11], s23 offen offset:0 sc1
buffer_load_dwordx4 v[72:75], v3, s[8:11], s23 offen offset:1024 sc1
s_add_u32 s36, s36, 1
s_cmp_gt_u32 s36, 65536
s_cbranch_scc1 CH_RBOK_3f
s_branch CH_RB_3f
CH_RBLRETRY_3f:
buffer_load_dwordx4 v[72:75], v3, s[8:11], s23 offen offset:1024 sc1
s_add_u32 s36, s36, 1
s_cmp_gt_u32 s36, 65536
s_cbranch_scc1 CH_RBLOK_3f
s_waitcnt vmcnt(1)
s_branch CH_RBL_3f
CH_DONE_3f:
s_waitcnt lgkmcnt(0)
s_nop 4
v_add_f32 v12, v12, v14
v_add_f32 v13, v13, v15
v_add_f32 v24, v24, v26
v_add_f32 v25, v25, v27
v_cvt_pk_bf16_f32 v14, v12, v13
v_cvt_pk_bf16_f32 v15, v24, v25
s_nop 1
v_mov_b32_dpp v10, v14 quad_perm:[2,3,2,3] row_mask:0xf bank_mask:0xf
v_mov_b32_dpp v11, v15 quad_perm:[2,3,2,3] row_mask:0xf bank_mask:0xf
v_cndmask_b32 v36, v14, v104, s[40:41]
v_cndmask_b32 v37, v15, v105, s[40:41]
v_cndmask_b32 v38, v10, v106, s[40:41]
v_cndmask_b32 v39, v11, v107, s[40:41]
buffer_store_dwordx4 v[36:39], v3, s[8:11], s27 offen sc1
s_barrier
s_branch L_FIN
RDY_79_S:
s_add_u32 s32, s18, 1
s_min_u32 s32, s32, 63
s_lshr_b32 s32, s32, 2
s_add_u32 s32, s32, 1
v_lshrrev_b32 v10, 3, v0
v_and_b32 v11, 3, v10
v_bfe_u32 v10, v10, 2, 1
v_lshlrev_b32 v10, 13, v10
v_lshl_add_u32 v10, v11, 7, v10
s_mov_b32 s35, 0
POLL_KV_80:
s_cmp_lg_u32 s37, 0
s_cbranch_scc1 POLL_KV_80_E
buffer_load_dword v11, v10, s[8:11], s89 offen sc1
s_add_u32 s35, s35, 1
s_cmp_gt_u32 s35, 65536
s_cselect_b32 s37, 1, 0
s_waitcnt vmcnt(0)
v_cmp_gt_u32 vcc, s32, v11
s_cbranch_vccz POLL_KV_80_E
s_branch POLL_KV_80
POLL_KV_80_E:
s_nop 1
v_min_u32_dpp v11, v11, v11 quad_perm:[1,0,3,2] row_mask:0xf bank_mask:0xf
s_nop 1
v_min_u32_dpp v11, v11, v11 quad_perm:[2,3,0,1] row_mask:0xf bank_mask:0xf
s_nop 1
v_min_u32_dpp v11, v11, v11 row_half_mirror row_mask:0xf bank_mask:0xf
s_nop 0
v_readfirstlane_b32 s85, v11
s_nop 3
s_lshl_b32 s85, s85, 2
s_branch RDY_79
L_SLOW:
s_cmp_eq_u32 s17, 1
s_cbranch_scc1 CH_W1s
s_cmp_eq_u32 s17, 2
s_cbranch_scc1 CH_W2s
s_cmp_eq_u32 s17, 3
s_cbranch_scc1 CH_W3s
CH_W0s:
s_mov_b32 s18, 0
s_mov_b32 s29, 0
s_add_u32 s32, s18, 1
s_min_u32 s32, s32, 63
s_cmp_ge_u32 s32, s85
s_cbranch_scc1 RDY_81_S
RDY_81:
s_mov_b32 s75, 147456
s_lshl_b32 s26, s16, 13
s_add_u32 s26, s26, 18743296
s_add_u32 m0, s75, 0
s_add_u32 s32, s26, 0
buffer_load_dwordx4 v3, s[8:11], s32 offen  lds
s_add_u32 m0, s75, 1024
s_add_u32 s32, s26, 1024
buffer_load_dwordx4 v3, s[8:11], s32 offen  lds
s_mov_b32 s34, 0x05040100
s_mov_b32 s35, 0x07060302
v_perm_b32 v44, v17, v16, s34
v_perm_b32 v45, v19, v18, s34
v_perm_b32 v46, v17, v16, s35
v_perm_b32 v47, v19, v18, s35
v_perm_b32 v48, v13, v12, s34
v_perm_b32 v49, v15, v14, s34
v_perm_b32 v50, v13, v12, s35
v_perm_b32 v51, v15, v14, s35
s_mov_b32 s18, 0
s_mov_b32 s75, 155648
s_and_b32 s32, s18, 3
s_lshl_b32 s33, s32, 18
s_lshl_b32 s34, s16, 7
s_add_u32 s19, s33, s34
s_add_u32 s19, s19, 90177536
s_lshl_b32 s35, s16, 13
s_add_u32 s20, s33, s35
s_add_u32 s20, s20, 90046464
s_add_u32 s32, s18, 3
s_and_b32 s32, s32, 3
s_lshl_b32 s33, s32, 18
s_mov_b32 s21, 0
s_lshr_b32 s34, s16, 3
s_lshl_b32 s34, s34, 11
s_and_b32 s35, s16, 1
s_lshl_b32 s35, s35, 9
s_add_u32 s34, s34, s35
s_bfe_u32 s35, s16, 0x20001
s_lshl_b32 s35, s35, 6
s_add_u32 s34, s34, s35
s_lshl_b32 s33, s32, 13
s_add_u32 s24, s33, s34
s_add_u32 s24, s24, 91226112
s_add_u32 s32, s18, 1
s_and_b32 s32, s32, 3
s_lshl_b32 s33, s32, 13
s_add_u32 s22, s33, s34
s_add_u32 s22, s22, 91226112
s_add_u32 s23, s33, 91095040
s_lshl_b32 s32, s18, 5
s_add_u32 s32, s32, s16
s_lshl_b32 s33, s32, 13
s_add_u32 s25, s33, 35520512
s_add_u32 s26, s33, 19005440
s_lshl_b32 s33, s32, 12
s_add_u32 s27, s33, 52297728
s_lshl_b32 s33, s32, 11
s_add_u32 s28, s33, 60817408
s_mov_b32 s82, s27
s_sub_u32 s24, s24, 0
s_mov_b32 s76, 0
s_mov_b32 s77, 8192
s_mov_b32 s79, s19
s_mov_b32 s80, s20
s_sub_u32 s81, s22, 8192
s_mov_b32 s78, s81
ds_read_b128 v[76:79], v4 offset:16384
ds_read_b128 v[80:83], v4 offset:17408
ds_read_b128 v[84:87], v4 offset:18432
ds_read_b128 v[88:91], v4 offset:19456
ds_read_b128 v[92:95], v4 offset:20480
ds_read_b128 v[96:99], v4 offset:21504
ds_read_b128 v[100:103], v4 offset:22528
ds_read_b128 v[104:107], v4 offset:23552
ds_read_b128 v[108:111], v4 offset:24576
ds_read_b128 v[112:115], v4 offset:25600
ds_read_b128 v[116:119], v4 offset:28672
ds_read_b128 v[120:123], v4 offset:29696
v_mov_b32 v28, 0
v_mov_b32 v29, 0
v_mov_b32 v30, 0
v_mov_b32 v31, 0
v_mov_b32 v32, 0
v_mov_b32 v33, 0
v_mov_b32 v34, 0
v_mov_b32 v35, 0
v_mov_b32 v36, 0
v_mov_b32 v37, 0
v_mov_b32 v38, 0
v_mov_b32 v39, 0
v_mov_b32 v40, 0
v_mov_b32 v41, 0
v_mov_b32 v42, 0
v_mov_b32 v43, 0
v_mov_b32 v12, 0
v_mov_b32 v13, 0
v_mov_b32 v14, 0
v_mov_b32 v15, 0
v_mov_b32 v24, 0
v_mov_b32 v25, 0
v_mov_b32 v26, 0
v_mov_b32 v27, 0
s_waitcnt vmcnt(0)
s_waitcnt lgkmcnt(0)
s_mov_b32 s36, 0
v_min_u32 v44, 0xfffffffe, v44
v_min_u32 v45, 0xfffffffe, v45
v_min_u32 v46, 0xfffffffe, v46
v_min_u32 v47, 0xfffffffe, v47
v_min_u32 v48, 0xfffffffe, v48
v_min_u32 v49, 0xfffffffe, v49
v_min_u32 v50, 0xfffffffe, v50
v_min_u32 v51, 0xfffffffe, v51
.p2align 6
CH_BASE_0s:
.fill (((8 - (. - CH_BASE_0s)) & 15) >> 2), 4, 0xbf800000
CH_RB_0s:
s_waitcnt vmcnt(3)
CH_RBE_0s:
v_max3_u32 v10, v44, v45, v46
v_max_u32 v10, v10, v47
v_cmp_eq_u32 vcc, -1, v10
ds_write_b128 v3, v[44:47] offset:0
s_cbranch_vccnz CH_RBRETRY_0s
CH_RBOK_0s:
v_smfmac_f32_16x16x64_bf16 v[28:31], v[44:47], v[76:83], v1
v_smfmac_f32_16x16x64_bf16 v[32:35], v[44:47], v[128:135], v1
ds_read_b128 v[76:79], v4 offset:0
v_smfmac_f32_16x16x64_bf16 v[36:39], v[44:47], v[84:91], v1
ds_read_b128 v[80:83], v4 offset:1024
v_smfmac_f32_16x16x64_bf16 v[40:43], v[44:47], v[192:199], v1
s_waitcnt vmcnt(2)
CH_RBL_0s:
v_max3_u32 v10, v48, v49, v50
v_max_u32 v10, v10, v51
v_cmp_eq_u32 vcc, -1, v10
ds_write_b128 v3, v[48:51] offset:1024
s_cbranch_vccnz CH_RBLRETRY_0s
CH_RBLOK_0s:
v_smfmac_f32_16x16x64_bf16 v[28:31], v[48:51], v[92:99], v1
buffer_store_dwordx4 v[16:19], v3, s[8:11], s82 offen sc1
v_smfmac_f32_16x16x64_bf16 v[32:35], v[48:51], v[136:143], v1
v_smfmac_f32_16x16x64_bf16 v[36:39], v[48:51], v[100:107], v1
v_smfmac_f32_16x16x64_bf16 v[40:43], v[48:51], v[200:207], v1
s_waitcnt lgkmcnt(0)
s_barrier
ds_read_b128 v[52:55], v3 offset:2048
ds_read_b128 v[56:59], v3 offset:3072
v_smfmac_f32_16x16x64_bf16 v[12:15], v[44:47], a[0:7], v1
ds_read_b128 v[60:63], v3 offset:4096
buffer_load_dwordx4 v[16:19], v3, s[8:11], s25 offen
v_smfmac_f32_16x16x64_bf16 v[24:27], v[44:47], a[64:71], v1
ds_read_b128 v[64:67], v3 offset:5120
v_smfmac_f32_16x16x64_bf16 v[12:15], v[48:51], a[8:15], v1
ds_read_b128 v[68:71], v3 offset:6144
v_smfmac_f32_16x16x64_bf16 v[24:27], v[48:51], a[72:79], v1
ds_read_b128 v[72:75], v3 offset:7168
s_waitcnt lgkmcnt(5)
v_smfmac_f32_16x16x64_bf16 v[28:31], v[52:55], v[108:115], v1
ds_read_b128 v[84:87], v4 offset:4096
buffer_load_dwordx4 v[20:23], v3, s[8:11], s25 offen offset:1024
v_smfmac_f32_16x16x64_bf16 v[32:35], v[52:55], v[144:151], v1
ds_read_b128 v[88:91], v4 offset:5120
s_waitcnt lgkmcnt(6)
v_smfmac_f32_16x16x64_bf16 v[28:31], v[56:59], v[116:123], v1
ds_read_b128 v[92:95], v4 offset:8192
v_smfmac_f32_16x16x64_bf16 v[32:35], v[56:59], v[152:159], v1
ds_read_b128 v[96:99], v4 offset:9216
s_waitcnt lgkmcnt(7)
v_smfmac_f32_16x16x64_bf16 v[28:31], v[60:63], v[76:83], v1
ds_read_b128 v[100:103], v4 offset:12288
v_smfmac_f32_16x16x64_bf16 v[32:35], v[60:63], v[160:167], v1
ds_read_b128 v[104:107], v4 offset:13312
s_waitcnt lgkmcnt(8)
s_waitcnt lgkmcnt(4)
v_smfmac_f32_16x16x64_bf16 v[28:31], v[64:67], v[84:91], v1
ds_read_b128 v[108:111], v4 offset:26624
v_smfmac_f32_16x16x64_bf16 v[32:35], v[64:67], v[168:175], v1
ds_read_b128 v[112:115], v4 offset:27648
s_and_b32 s32, s18, 3
s_cmp_ge_u32 s18, 56
s_cselect_b32 s32, 1, s32
s_cmp_lg_u32 s32, 1
s_cbranch_scc1 FLAG_82
s_sub_u32 s32, s18, 1
s_max_i32 s32, s32, 0
s_cmp_gt_u32 s18, 60
s_cselect_b32 s32, s18, s32
v_mov_b32 v10, s32
s_mov_b64 exec, 1
buffer_store_dword v10, off, s[8:11], s88 sc1
s_mov_b64 exec, -1
FLAG_82:
s_waitcnt lgkmcnt(4)
v_smfmac_f32_16x16x64_bf16 v[28:31], v[68:71], v[92:99], v1
ds_read_b128 v[116:119], v4 offset:30720
v_smfmac_f32_16x16x64_bf16 v[32:35], v[68:71], v[176:183], v1
ds_read_b128 v[120:123], v4 offset:31744
s_waitcnt lgkmcnt(4)
v_smfmac_f32_16x16x64_bf16 v[28:31], v[72:75], v[100:107], v1
ds_read_b128 v[76:79], v4 offset:2048
v_smfmac_f32_16x16x64_bf16 v[32:35], v[72:75], v[184:191], v1
ds_read_b128 v[80:83], v4 offset:3072
s_waitcnt lgkmcnt(4)
v_smfmac_f32_16x16x64_bf16 v[36:39], v[52:55], v[108:115], v1
ds_read_b128 v[84:87], v4 offset:6144
s_nop 1
v_smfmac_f32_16x16x64_bf16 v[40:43], v[52:55], v[208:215], v1
ds_read_b128 v[88:91], v4 offset:7168
s_nop 1
s_waitcnt lgkmcnt(4)
v_smfmac_f32_16x16x64_bf16 v[36:39], v[56:59], v[116:123], v1
ds_read_b128 v[92:95], v4 offset:10240
v_smfmac_f32_16x16x64_bf16 v[40:43], v[56:59], v[216:223], v1
ds_read_b128 v[96:99], v4 offset:11264
s_waitcnt lgkmcnt(4)
v_smfmac_f32_16x16x64_bf16 v[36:39], v[60:63], v[76:83], v1
ds_read_b128 v[100:103], v4 offset:14336
s_add_u32 s23, s77, 91095040
v_smfmac_f32_16x16x64_bf16 v[40:43], v[60:63], v[224:231], v1
ds_read_b128 v[104:107], v4 offset:15360
s_waitcnt lgkmcnt(4)
v_smfmac_f32_16x16x64_bf16 v[36:39], v[64:67], v[84:91], v1
ds_read_b128 v[108:111], v2 offset:0
v_smfmac_f32_16x16x64_bf16 v[40:43], v[64:67], v[232:239], v1
ds_read_b128 v[112:115], v2 offset:1024
s_waitcnt lgkmcnt(4)
v_smfmac_f32_16x16x64_bf16 v[36:39], v[68:71], v[92:99], v1
ds_read_b128 v[116:119], v2 offset:2048
v_smfmac_f32_16x16x64_bf16 v[40:43], v[68:71], v[240:247], v1
ds_read_b128 v[120:123], v2 offset:3072
s_waitcnt lgkmcnt(4)
v_smfmac_f32_16x16x64_bf16 v[36:39], v[72:75], v[100:107], v1
ds_read_b128 v[76:79], v2 offset:4096
s_add_u32 m0, s75, 0
s_add_u32 s32, s26, 0
buffer_load_dwordx4 v3, s[8:11], s32 offen  lds
v_smfmac_f32_16x16x64_bf16 v[40:43], v[72:75], v[248:255], v1
s_nop 0
v_pk_add_f32 v[28:29], v[28:29], v[30:31]
v_pk_add_f32 v[32:33], v[32:33], v[34:35]
v_cvt_pk_bf16_f32 v34, v28, v29
v_cvt_pk_bf16_f32 v35, v32, v33
ds_write_b64 v7, v[34:35] offset:0
s_nop 0
v_pk_add_f32 v[36:37], v[36:37], v[38:39]
v_pk_add_f32 v[40:41], v[40:41], v[42:43]
v_cvt_pk_bf16_f32 v32, v36, v37
v_cvt_pk_bf16_f32 v33, v40, v41
ds_write_b64 v7, v[32:33] offset:128
v_smfmac_f32_16x16x64_bf16 v[12:15], v[52:55], a[16:23], v1
ds_read_b128 v[80:83], v2 offset:5120
v_smfmac_f32_16x16x64_bf16 v[24:27], v[52:55], a[80:87], v1
ds_read_b128 v[84:87], v2 offset:6144
v_smfmac_f32_16x16x64_bf16 v[12:15], v[56:59], a[24:31], v1
ds_read_b128 v[88:91], v2 offset:7168
v_smfmac_f32_16x16x64_bf16 v[24:27], v[56:59], a[88:95], v1
s_waitcnt lgkmcnt(3)
s_barrier
ds_read_b64_tr_b16 v[92:93], v8 offset:0
ds_read_b64_tr_b16 v[94:95], v8 offset:256
v_smfmac_f32_16x16x64_bf16 v[12:15], v[60:63], a[32:39], v1
ds_read_b64_tr_b16 v[96:97], v8 offset:512
ds_read_b64_tr_b16 v[98:99], v8 offset:768
v_smfmac_f32_16x16x64_bf16 v[24:27], v[60:63], a[96:103], v1
ds_read_b64_tr_b16 v[100:101], v8 offset:128
ds_read_b64_tr_b16 v[102:103], v8 offset:384
v_smfmac_f32_16x16x64_bf16 v[12:15], v[64:67], a[40:47], v1
ds_read_b64_tr_b16 v[104:105], v8 offset:640
ds_read_b64_tr_b16 v[106:107], v8 offset:896
v_smfmac_f32_16x16x64_bf16 v[24:27], v[64:67], a[104:111], v1
v_mov_b32 v28, s42
v_smfmac_f32_16x16x64_bf16 v[12:15], v[68:71], a[48:55], v1
v_mov_b32 v29, s42
v_smfmac_f32_16x16x64_bf16 v[24:27], v[68:71], a[112:119], v1
v_mov_b32 v30, s42
v_smfmac_f32_16x16x64_bf16 v[12:15], v[72:75], a[56:63], v1
v_mov_b32 v31, s42
s_add_u32 m0, s75, 1024
s_add_u32 s32, s26, 1024
buffer_load_dwordx4 v3, s[8:11], s32 offen  lds
v_smfmac_f32_16x16x64_bf16 v[24:27], v[72:75], a[120:127], v1
s_waitcnt vmcnt(5)
s_waitcnt lgkmcnt(8)
s_cmp_ge_u32 s18, 63
s_cbranch_scc1 CH_DONE_0s
s_waitcnt lgkmcnt(6)
v_mfma_f32_16x16x32_bf16 v[36:39], v[108:111], v[92:95], 0
s_nop 0
s_waitcnt lgkmcnt(4)
v_mfma_f32_16x16x32_bf16 v[36:39], v[112:115], v[96:99], v[36:39]
s_nop 0
s_waitcnt lgkmcnt(2)
v_mfma_f32_16x16x32_bf16 v[36:39], v[116:119], v[100:103], v[36:39]
s_nop 0
s_waitcnt lgkmcnt(0)
v_mfma_f32_16x16x32_bf16 v[36:39], v[120:123], v[104:107], v[36:39]
s_nop 0
v_mfma_f32_16x16x32_bf16 v[40:43], v[76:79], v[92:95], 0
v_add_f32 v12, v12, v14
v_add_f32 v13, v13, v15
v_mfma_f32_16x16x32_bf16 v[40:43], v[80:83], v[96:99], v[40:43]
v_add_f32 v24, v24, v26
v_add_f32 v25, v25, v27
v_mfma_f32_16x16x32_bf16 v[40:43], v[84:87], v[100:103], v[40:43]
v_cvt_pk_bf16_f32 v14, v12, v13
v_mfma_f32_16x16x32_bf16 v[40:43], v[88:91], v[104:107], v[40:43]
v_cvt_pk_bf16_f32 v15, v24, v25
v_mfma_f32_16x16x32_bf16 v[124:127], v[92:95], v[92:95], 0
v_max3_f32 v10, v36, v37, v38
v_mov_b32 v25, 0
s_nop 1
v_mfma_f32_16x16x32_bf16 v[124:127], v[96:99], v[96:99], v[124:127]
v_max_f32 v10, v10, v39
v_mov_b32 v26, 0
s_nop 1
v_mfma_f32_16x16x32_bf16 v[124:127], v[100:103], v[100:103], v[124:127]
v_max3_f32 v10, v10, v40, v41
v_mfma_f32_16x16x32_bf16 v[124:127], v[104:107], v[104:107], v[124:127]
v_max3_f32 v10, v10, v42, v43
s_not_b64 vcc, s[40:41]
v_cndmask_b32_dpp v36, v40, v36, vcc quad_perm:[0,1,0,1] row_mask:0xf bank_mask:0xf
v_cndmask_b32_dpp v37, v41, v37, vcc quad_perm:[0,1,0,1] row_mask:0xf bank_mask:0xf
v_mov_b32_dpp v10, v10 quad_perm:[0,1,0,1] row_mask:0xf bank_mask:0xf
v_cndmask_b32_dpp v38, v42, v38, vcc quad_perm:[0,1,0,1] row_mask:0xf bank_mask:0xf
v_cndmask_b32_dpp v39, v43, v39, vcc quad_perm:[0,1,0,1] row_mask:0xf bank_mask:0xf
v_mov_b32 v76, 0
v_max_f32_dpp v125, v126, v10 quad_perm:[0,1,0,1] row_mask:0xf bank_mask:0xf
v_max_f32_dpp v10, v127, v10 quad_perm:[0,1,0,1] row_mask:0xf bank_mask:0xf
v_max_f32 v124, v125, v10
v_mov_b32 v11, v124
v_mov_b32 v77, 0
v_mov_b32 v78, 0
v_permlane32_swap_b32 v124, v11
v_max_f32 v124, v124, v11
v_mov_b32 v11, v124
v_mov_b32 v79, 0
v_mov_b32 v80, 0
v_permlane16_swap_b32 v124, v11
v_max_f32 v124, v124, v11
v_mul_f32 v10, s30, v124
v_pk_fma_f32 v[126:127], v[126:127], s[30:31], v[10:11] op_sel_hi:[1,1,0] neg_lo:[0,0,1] neg_hi:[0,0,1]
v_pk_fma_f32 v[36:37], v[36:37], s[30:31], v[10:11] op_sel_hi:[1,1,0] neg_lo:[0,0,1] neg_hi:[0,0,1]
v_pk_fma_f32 v[38:39], v[38:39], s[30:31], v[10:11] op_sel_hi:[1,1,0] neg_lo:[0,0,1] neg_hi:[0,0,1]
v_exp_f32 v126, v126
v_exp_f32 v127, v127
v_exp_f32 v36, v36
v_cvt_pk_bf16_f32 v24, v126, v127
v_cvt_pk_bf16_f32 v27, v126, v127
v_exp_f32 v37, v37
v_exp_f32 v38, v38
v_mfma_f32_16x16x16_bf16 v[68:71], v[28:29], v[24:25], 0
v_exp_f32 v39, v39
v_cvt_pk_bf16_f32 v32, v36, v37
v_cvt_pk_bf16_f32 v33, v38, v39
v_mfma_f32_16x16x16_bf16 v[44:47], v[14:15], v[24:25], 0
v_mov_b32_dpp v34, v32 quad_perm:[2,3,2,3] row_mask:0xf bank_mask:0xf
v_mov_b32_dpp v35, v33 quad_perm:[2,3,2,3] row_mask:0xf bank_mask:0xf
v_mfma_f32_16x16x16_bf16 v[48:51], v[14:15], v[26:27], 0
s_waitcnt vmcnt(2)
v_mfma_f32_16x16x32_bf16 v[68:71], v[28:31], v[32:35], v[68:71]
v_mov_b32 v81, 0
v_mov_b32 v82, 0
v_mfma_f32_16x16x32_bf16 v[44:47], v[16:19], v[32:35], v[44:47]
v_mov_b32 v83, 0
v_mov_b32 v84, 0
v_mfma_f32_16x16x32_bf16 v[48:51], v[20:23], v[32:35], v[48:51]
v_mov_b32 v85, 0
v_mov_b32 v86, 0
v_rcp_f32 v10, v68
v_mov_b32 v87, 0
v_mov_b32 v88, 0
v_mov_b32 v89, 0
v_pk_mul_f32 v[44:45], v[44:45], v[10:11] op_sel_hi:[1,0]
v_pk_mul_f32 v[46:47], v[46:47], v[10:11] op_sel_hi:[1,0]
v_mov_b32 v90, 0
v_pk_mul_f32 v[48:49], v[48:49], v[10:11] op_sel_hi:[1,0]
v_pk_mul_f32 v[50:51], v[50:51], v[10:11] op_sel_hi:[1,0]
v_cvt_pk_bf16_f32 v52, v44, v45
v_cvt_pk_bf16_f32 v53, v46, v47
v_cvt_pk_bf16_f32 v54, v48, v49
v_cvt_pk_bf16_f32 v55, v50, v51
s_not_b64 exec, s[40:41]
ds_write_b128 v9, v[52:55] offset:0
s_mov_b64 exec, -1
v_mov_b32 v91, 0
v_mov_b32_dpp v56, v52 quad_perm:[0,1,0,1] row_mask:0xf bank_mask:0xf
v_mov_b32_dpp v57, v53 quad_perm:[0,1,0,1] row_mask:0xf bank_mask:0xf
v_mov_b32_dpp v58, v54 quad_perm:[0,1,0,1] row_mask:0xf bank_mask:0xf
v_mov_b32_dpp v59, v55 quad_perm:[0,1,0,1] row_mask:0xf bank_mask:0xf
s_nop 1
v_smfmac_f32_16x16x64_bf16 v[76:79], v[56:59], a[128:135], v1
v_mov_b32_dpp v10, v14 quad_perm:[2,3,2,3] row_mask:0xf bank_mask:0xf
v_cndmask_b32 v16, v14, v92, s[40:41]
v_smfmac_f32_16x16x64_bf16 v[80:83], v[56:59], a[160:167], v1
v_mov_b32_dpp v11, v15 quad_perm:[2,3,2,3] row_mask:0xf bank_mask:0xf
v_cndmask_b32 v17, v15, v93, s[40:41]
s_waitcnt lgkmcnt(0)
s_barrier
ds_read_b128 v[60:63], v9 offset:512
ds_read_b128 v[64:67], v9 offset:1024
ds_read_b128 v[68:71], v9 offset:1536
v_smfmac_f32_16x16x64_bf16 v[84:87], v[56:59], a[192:199], v1
v_cndmask_b32 v18, v10, v94, s[40:41]
v_smfmac_f32_16x16x64_bf16 v[88:91], v[56:59], a[224:231], v1
v_cndmask_b32 v19, v11, v95, s[40:41]
s_waitcnt lgkmcnt(2)
v_smfmac_f32_16x16x64_bf16 v[76:79], v[60:63], a[136:143], v1
s_waitcnt lgkmcnt(1)
v_smfmac_f32_16x16x64_bf16 v[76:79], v[64:67], a[144:151], v1
s_waitcnt lgkmcnt(0)
v_smfmac_f32_16x16x64_bf16 v[76:79], v[68:71], a[152:159], v1
v_smfmac_f32_16x16x64_bf16 v[80:83], v[60:63], a[168:175], v1
s_nop 2
v_smfmac_f32_16x16x64_bf16 v[80:83], v[64:67], a[176:183], v1
s_nop 2
v_cvt_pk_bf16_f32 v92, v76, v77
v_smfmac_f32_16x16x64_bf16 v[80:83], v[68:71], a[184:191], v1
v_cvt_pk_bf16_f32 v93, v78, v79
v_and_or_b32 v92, v92, -2, s21
buffer_store_dwordx2 v[92:93], v5, s[8:11], s19 offen sc1
v_smfmac_f32_16x16x64_bf16 v[84:87], v[60:63], a[200:207], v1
s_nop 2
v_smfmac_f32_16x16x64_bf16 v[84:87], v[64:67], a[208:215], v1
s_nop 2
v_cvt_pk_bf16_f32 v94, v80, v81
v_smfmac_f32_16x16x64_bf16 v[84:87], v[68:71], a[216:223], v1
v_cvt_pk_bf16_f32 v95, v82, v83
v_and_or_b32 v94, v94, -2, s21
s_add_u32 s32, s19, 8192
buffer_store_dwordx2 v[94:95], v5, s[8:11], s32 offen sc1
v_smfmac_f32_16x16x64_bf16 v[88:91], v[60:63], a[232:239], v1
s_nop 2
v_smfmac_f32_16x16x64_bf16 v[88:91], v[64:67], a[240:247], v1
s_nop 2
v_cvt_pk_bf16_f32 v96, v84, v85
v_smfmac_f32_16x16x64_bf16 v[88:91], v[68:71], a[248:255], v1
v_cvt_pk_bf16_f32 v97, v86, v87
v_and_or_b32 v96, v96, -2, s21
s_add_u32 s32, s19, 4096
buffer_store_dwordx2 v[96:97], v5, s[8:11], s32 offen sc1
s_nop 4
v_cvt_pk_bf16_f32 v98, v88, v89
v_cvt_pk_bf16_f32 v99, v90, v91
v_and_or_b32 v98, v98, -2, s21
s_add_u32 s32, s19, 12288
buffer_store_dwordx2 v[98:99], v5, s[8:11], s32 offen sc1
s_mov_b32 s36, 0
ds_read_b128 v[68:71], v3 offset:12544
s_nop 15
s_nop 15
s_nop 5
buffer_load_dwordx4 v[52:55], v3, s[8:11], s20 offen offset:0 sc1
buffer_load_dwordx4 v[56:59], v3, s[8:11], s20 offen offset:1024 sc1
buffer_load_dwordx4 v[60:63], v3, s[8:11], s20 offen offset:2048 sc1
buffer_load_dwordx4 v[64:67], v3, s[8:11], s20 offen offset:3072 sc1
v_mov_b32 v28, 0
v_mov_b32 v29, 0
v_mov_b32 v30, 0
v_mov_b32 v31, 0
v_mov_b32 v32, 0
v_mov_b32 v33, 0
v_mov_b32 v34, 0
v_mov_b32 v35, 0
v_mov_b32 v36, 0
v_mov_b32 v37, 0
v_mov_b32 v38, 0
v_mov_b32 v39, 0
v_mov_b32 v40, 0
v_mov_b32 v41, 0
v_mov_b32 v42, 0
v_mov_b32 v43, 0
v_mov_b32 v12, 0
v_mov_b32 v13, 0
v_mov_b32 v14, 0
v_mov_b32 v15, 0
v_mov_b32 v24, 0
v_mov_b32 v25, 0
v_mov_b32 v26, 0
v_mov_b32 v27, 0
v_xor_b32 v2, 8192, v2
s_xor_b32 s75, s75, 8192
ds_read_b128 v[76:79], v4 offset:16384
ds_read_b128 v[80:83], v4 offset:17408
ds_read_b128 v[84:87], v4 offset:18432
ds_read_b128 v[88:91], v4 offset:19456
ds_read_b128 v[92:95], v4 offset:20480
ds_read_b128 v[96:99], v4 offset:21504
s_waitcnt lgkmcnt(6)
CH_RA_0s:
s_waitcnt vmcnt(3)
v_bitop3_b32 v10, v52, v54, s21 bitop3:0x7e
v_mfma_f32_16x16x32_bf16 v[72:75], v[52:55], v[68:71], 0
s_waitcnt vmcnt(2)
v_bitop3_b32 v11, v56, v58, s21 bitop3:0x7e
v_mfma_f32_16x16x32_bf16 v[72:75], v[56:59], v[68:71], v[72:75]
v_or_b32 v10, v10, v11
s_waitcnt vmcnt(1)
v_bitop3_b32 v11, v60, v62, s21 bitop3:0x7e
v_mfma_f32_16x16x32_bf16 v[72:75], v[60:63], v[68:71], v[72:75]
v_or_b32 v10, v10, v11
s_waitcnt vmcnt(0)
v_bitop3_b32 v11, v64, v66, s21 bitop3:0x7e
v_mfma_f32_16x16x32_bf16 v[72:75], v[64:67], v[68:71], v[72:75]
v_bitop3_b32 v10, v10, v11, 1 bitop3:0xa8
v_cmp_ne_u32 vcc, 0, v10
s_cbranch_vccnz CH_RARETRY_0s
CH_RAOK_0s:
s_nop 4
v_permlane32_swap_b32 v72, v74
v_permlane32_swap_b32 v73, v75
s_mov_b64 exec, s[38:39]
v_pk_add_f32 v[72:73], v[72:73], v[74:75]
v_cvt_pk_bf16_f32 v72, v72, v73
buffer_store_dword v72, v6, s[8:11], s22 offen sc1
s_mov_b64 exec, -1
ds_read_b128 v[100:103], v4 offset:22528
ds_read_b128 v[104:107], v4 offset:23552
ds_read_b128 v[108:111], v4 offset:24576
ds_read_b128 v[112:115], v4 offset:25600
ds_read_b128 v[116:119], v4 offset:28672
ds_read_b128 v[120:123], v4 offset:29696
s_mov_b32 s36, 0
s_mov_b32 s82, s27
s_add_u32 s25, s25, 262144
s_add_u32 s26, s26, 262144
s_add_u32 s27, s27, 131072
s_sub_u32 s24, s78, 0
s_mov_b32 s78, s22
s_add_u32 s77, s77, 8192
s_and_b32 s77, s77, 0x7fff
s_add_u32 s22, s77, s81
s_add_u32 s18, s18, 1
s_xor_b32 s21, s21, 1
s_barrier
s_nop 3
buffer_load_dwordx4 v[44:47], v3, s[8:11], s23 offen offset:0 sc1
s_nop 15
buffer_load_dwordx4 v[48:51], v3, s[8:11], s23 offen offset:1024 sc1
s_nop 15
buffer_load_dwordx4 v[44:47], v3, s[8:11], s23 offen offset:0 sc1
buffer_load_dwordx4 v[48:51], v3, s[8:11], s23 offen offset:1024 sc1
s_waitcnt lgkmcnt(0)
s_branch CH_RB_0s
CH_RARETRY_0s:
buffer_load_dwordx4 v[52:55], v3, s[8:11], s20 offen offset:0 sc1
buffer_load_dwordx4 v[56:59], v3, s[8:11], s20 offen offset:1024 sc1
buffer_load_dwordx4 v[60:63], v3, s[8:11], s20 offen offset:2048 sc1
buffer_load_dwordx4 v[64:67], v3, s[8:11], s20 offen offset:3072 sc1
s_add_u32 s36, s36, 1
s_cmp_gt_u32 s36, 65536
s_cbranch_scc1 CH_RAOK_0s
s_branch CH_RA_0s
CH_RBRETRY_0s:
buffer_load_dwordx4 v[44:47], v3, s[8:11], s23 offen offset:0 sc1
buffer_load_dwordx4 v[48:51], v3, s[8:11], s23 offen offset:1024 sc1
s_add_u32 s36, s36, 1
s_cmp_gt_u32 s36, 65536
s_cbranch_scc1 CH_RBOK_0s
s_branch CH_RB_0s
CH_RBLRETRY_0s:
buffer_load_dwordx4 v[48:51], v3, s[8:11], s23 offen offset:1024 sc1
s_add_u32 s36, s36, 1
s_cmp_gt_u32 s36, 65536
s_cbranch_scc1 CH_RBLOK_0s
s_waitcnt vmcnt(1)
s_branch CH_RBL_0s
CH_DONE_0s:
s_waitcnt lgkmcnt(0)
s_nop 4
v_add_f32 v12, v12, v14
v_add_f32 v13, v13, v15
v_add_f32 v24, v24, v26
v_add_f32 v25, v25, v27
v_cvt_pk_bf16_f32 v14, v12, v13
v_cvt_pk_bf16_f32 v15, v24, v25
s_nop 1
v_mov_b32_dpp v10, v14 quad_perm:[2,3,2,3] row_mask:0xf bank_mask:0xf
v_mov_b32_dpp v11, v15 quad_perm:[2,3,2,3] row_mask:0xf bank_mask:0xf
v_cndmask_b32 v36, v14, v92, s[40:41]
v_cndmask_b32 v37, v15, v93, s[40:41]
v_cndmask_b32 v38, v10, v94, s[40:41]
v_cndmask_b32 v39, v11, v95, s[40:41]
buffer_store_dwordx4 v[36:39], v3, s[8:11], s27 offen sc1
s_barrier
v_mov_b32 v10, 64
s_mov_b64 exec, 1
buffer_store_dword v10, off, s[8:11], s88 sc1
s_mov_b64 exec, -1
s_branch L_FIN
RDY_81_S:
s_add_u32 s32, s18, 1
s_min_u32 s32, s32, 63
s_lshr_b32 s32, s32, 2
s_add_u32 s32, s32, 1
v_lshrrev_b32 v10, 3, v0
v_and_b32 v11, 3, v10
v_bfe_u32 v10, v10, 2, 1
v_lshlrev_b32 v10, 13, v10
v_lshl_add_u32 v10, v11, 7, v10
s_mov_b32 s35, 0
POLL_KV_83:
s_cmp_lg_u32 s37, 0
s_cbranch_scc1 POLL_KV_83_E
buffer_load_dword v11, v10, s[8:11], s89 offen sc1
s_add_u32 s35, s35, 1
s_cmp_gt_u32 s35, 65536
s_cselect_b32 s37, 1, 0
s_waitcnt vmcnt(0)
v_cmp_gt_u32 vcc, s32, v11
s_cbranch_vccz POLL_KV_83_E
s_branch POLL_KV_83
POLL_KV_83_E:
s_nop 1
v_min_u32_dpp v11, v11, v11 quad_perm:[1,0,3,2] row_mask:0xf bank_mask:0xf
s_nop 1
v_min_u32_dpp v11, v11, v11 quad_perm:[2,3,0,1] row_mask:0xf bank_mask:0xf
s_nop 1
v_min_u32_dpp v11, v11, v11 row_half_mirror row_mask:0xf bank_mask:0xf
s_nop 0
v_readfirstlane_b32 s85, v11
s_nop 3
s_lshl_b32 s85, s85, 2
s_branch RDY_81
CH_W1s:
s_mov_b32 s18, 0
s_mov_b32 s29, 0
s_add_u32 s32, s18, 1
s_min_u32 s32, s32, 63
s_cmp_ge_u32 s32, s85
s_cbranch_scc1 RDY_84_S
RDY_84:
s_mov_b32 s75, 147456
s_lshl_b32 s26, s16, 13
s_add_u32 s26, s26, 18743296
s_add_u32 m0, s75, 2048
s_add_u32 s32, s26, 2048
buffer_load_dwordx4 v3, s[8:11], s32 offen  lds
s_add_u32 m0, s75, 3072
s_add_u32 s32, s26, 3072
buffer_load_dwordx4 v3, s[8:11], s32 offen  lds
s_mov_b32 s34, 0x05040100
s_mov_b32 s35, 0x07060302
v_perm_b32 v52, v17, v16, s34
v_perm_b32 v53, v19, v18, s34
v_perm_b32 v54, v17, v16, s35
v_perm_b32 v55, v19, v18, s35
v_perm_b32 v56, v13, v12, s34
v_perm_b32 v57, v15, v14, s34
v_perm_b32 v58, v13, v12, s35
v_perm_b32 v59, v15, v14, s35
s_mov_b32 s18, 0
s_mov_b32 s75, 155648
s_and_b32 s32, s18, 3
s_lshl_b32 s33, s32, 18
s_lshl_b32 s34, s16, 7
s_add_u32 s19, s33, s34
s_add_u32 s19, s19, 90243072
s_lshl_b32 s35, s16, 13
s_add_u32 s20, s33, s35
s_add_u32 s20, s20, 90050560
s_add_u32 s32, s18, 3
s_and_b32 s32, s32, 3
s_lshl_b32 s33, s32, 18
s_mov_b32 s21, 0
s_lshr_b32 s34, s16, 3
s_lshl_b32 s34, s34, 11
s_and_b32 s35, s16, 1
s_lshl_b32 s35, s35, 9
s_add_u32 s34, s34, s35
s_bfe_u32 s35, s16, 0x20001
s_lshl_b32 s35, s35, 6
s_add_u32 s34, s34, s35
s_lshl_b32 s33, s32, 13
s_add_u32 s24, s33, s34
s_add_u32 s24, s24, 91227136
s_add_u32 s32, s18, 1
s_and_b32 s32, s32, 3
s_lshl_b32 s33, s32, 13
s_add_u32 s22, s33, s34
s_add_u32 s22, s22, 91227136
s_add_u32 s23, s33, 91097088
s_lshl_b32 s32, s18, 5
s_add_u32 s32, s32, s16
s_lshl_b32 s33, s32, 13
s_add_u32 s25, s33, 35522560
s_add_u32 s26, s33, 19005440
s_lshl_b32 s33, s32, 12
s_add_u32 s27, s33, 52298752
s_lshl_b32 s33, s32, 11
s_add_u32 s28, s33, 60817920
s_mov_b32 s82, s27
s_sub_u32 s24, s24, 1024
s_mov_b32 s76, 0
s_mov_b32 s77, 8192
s_mov_b32 s79, s19
s_mov_b32 s80, s20
s_sub_u32 s81, s22, 8192
s_mov_b32 s78, s81
ds_read_b128 v[76:79], v4 offset:24576
ds_read_b128 v[80:83], v4 offset:25600
ds_read_b128 v[84:87], v4 offset:26624
ds_read_b128 v[88:91], v4 offset:27648
ds_read_b128 v[92:95], v4 offset:28672
ds_read_b128 v[96:99], v4 offset:29696
ds_read_b128 v[100:103], v4 offset:30720
ds_read_b128 v[104:107], v4 offset:31744
ds_read_b128 v[108:111], v4 offset:0
ds_read_b128 v[112:115], v4 offset:1024
ds_read_b128 v[116:119], v4 offset:4096
ds_read_b128 v[120:123], v4 offset:5120
v_mov_b32 v28, 0
v_mov_b32 v29, 0
v_mov_b32 v30, 0
v_mov_b32 v31, 0
v_mov_b32 v32, 0
v_mov_b32 v33, 0
v_mov_b32 v34, 0
v_mov_b32 v35, 0
v_mov_b32 v36, 0
v_mov_b32 v37, 0
v_mov_b32 v38, 0
v_mov_b32 v39, 0
v_mov_b32 v40, 0
v_mov_b32 v41, 0
v_mov_b32 v42, 0
v_mov_b32 v43, 0
v_mov_b32 v12, 0
v_mov_b32 v13, 0
v_mov_b32 v14, 0
v_mov_b32 v15, 0
v_mov_b32 v24, 0
v_mov_b32 v25, 0
v_mov_b32 v26, 0
v_mov_b32 v27, 0
s_waitcnt vmcnt(0)
s_waitcnt lgkmcnt(0)
s_mov_b32 s36, 0
v_min_u32 v52, 0xfffffffe, v52
v_min_u32 v53, 0xfffffffe, v53
v_min_u32 v54, 0xfffffffe, v54
v_min_u32 v55, 0xfffffffe, v55
v_min_u32 v56, 0xfffffffe, v56
v_min_u32 v57, 0xfffffffe, v57
v_min_u32 v58, 0xfffffffe, v58
v_min_u32 v59, 0xfffffffe, v59
.p2align 6
CH_BASE_1s:
.fill (((8 - (. - CH_BASE_1s)) & 15) >> 2), 4, 0xbf800000
CH_RB_1s:
s_waitcnt vmcnt(3)
CH_RBE_1s:
v_max3_u32 v10, v52, v53, v54
v_max_u32 v10, v10, v55
v_cmp_eq_u32 vcc, -1, v10
ds_write_b128 v3, v[52:55] offset:2048
s_cbranch_vccnz CH_RBRETRY_1s
CH_RBOK_1s:
v_smfmac_f32_16x16x64_bf16 v[28:31], v[52:55], v[76:83], v1
v_smfmac_f32_16x16x64_bf16 v[32:35], v[52:55], v[144:151], v1
ds_read_b128 v[76:79], v4 offset:8192
v_smfmac_f32_16x16x64_bf16 v[36:39], v[52:55], v[84:91], v1
ds_read_b128 v[80:83], v4 offset:9216
v_smfmac_f32_16x16x64_bf16 v[40:43], v[52:55], v[208:215], v1
s_waitcnt vmcnt(2)
CH_RBL_1s:
v_max3_u32 v10, v56, v57, v58
v_max_u32 v10, v10, v59
v_cmp_eq_u32 vcc, -1, v10
ds_write_b128 v3, v[56:59] offset:3072
s_cbranch_vccnz CH_RBLRETRY_1s
CH_RBLOK_1s:
v_smfmac_f32_16x16x64_bf16 v[28:31], v[56:59], v[92:99], v1
v_smfmac_f32_16x16x64_bf16 v[32:35], v[56:59], v[152:159], v1
buffer_store_dwordx4 v[16:19], v3, s[8:11], s82 offen sc1
v_smfmac_f32_16x16x64_bf16 v[36:39], v[56:59], v[100:107], v1
v_smfmac_f32_16x16x64_bf16 v[40:43], v[56:59], v[216:223], v1
s_waitcnt lgkmcnt(0)
s_barrier
ds_read_b128 v[60:63], v3 offset:4096
ds_read_b128 v[64:67], v3 offset:5120
v_smfmac_f32_16x16x64_bf16 v[12:15], v[52:55], a[16:23], v1
ds_read_b128 v[68:71], v3 offset:6144
v_smfmac_f32_16x16x64_bf16 v[24:27], v[52:55], a[80:87], v1
ds_read_b128 v[72:75], v3 offset:7168
buffer_load_dwordx4 v[16:19], v3, s[8:11], s25 offen
v_smfmac_f32_16x16x64_bf16 v[12:15], v[56:59], a[24:31], v1
ds_read_b128 v[44:47], v3 offset:0
v_smfmac_f32_16x16x64_bf16 v[24:27], v[56:59], a[88:95], v1
ds_read_b128 v[48:51], v3 offset:1024
s_waitcnt lgkmcnt(5)
v_smfmac_f32_16x16x64_bf16 v[28:31], v[60:63], v[108:115], v1
ds_read_b128 v[84:87], v4 offset:12288
v_smfmac_f32_16x16x64_bf16 v[32:35], v[60:63], v[160:167], v1
ds_read_b128 v[88:91], v4 offset:13312
buffer_load_dwordx4 v[20:23], v3, s[8:11], s25 offen offset:1024
s_waitcnt lgkmcnt(6)
v_smfmac_f32_16x16x64_bf16 v[28:31], v[64:67], v[116:123], v1
ds_read_b128 v[92:95], v4 offset:16384
v_smfmac_f32_16x16x64_bf16 v[32:35], v[64:67], v[168:175], v1
ds_read_b128 v[96:99], v4 offset:17408
s_waitcnt lgkmcnt(7)
v_smfmac_f32_16x16x64_bf16 v[28:31], v[68:71], v[76:83], v1
ds_read_b128 v[100:103], v4 offset:20480
v_smfmac_f32_16x16x64_bf16 v[32:35], v[68:71], v[176:183], v1
ds_read_b128 v[104:107], v4 offset:21504
s_waitcnt lgkmcnt(8)
s_waitcnt lgkmcnt(4)
v_smfmac_f32_16x16x64_bf16 v[28:31], v[72:75], v[84:91], v1
ds_read_b128 v[108:111], v4 offset:2048
v_smfmac_f32_16x16x64_bf16 v[32:35], v[72:75], v[184:191], v1
ds_read_b128 v[112:115], v4 offset:3072
s_waitcnt lgkmcnt(4)
v_smfmac_f32_16x16x64_bf16 v[28:31], v[44:47], v[92:99], v1
ds_read_b128 v[116:119], v4 offset:6144
v_smfmac_f32_16x16x64_bf16 v[32:35], v[44:47], v[128:135], v1
ds_read_b128 v[120:123], v4 offset:7168
s_waitcnt lgkmcnt(4)
v_smfmac_f32_16x16x64_bf16 v[28:31], v[48:51], v[100:107], v1
ds_read_b128 v[76:79], v4 offset:10240
v_smfmac_f32_16x16x64_bf16 v[32:35], v[48:51], v[136:143], v1
ds_read_b128 v[80:83], v4 offset:11264
s_waitcnt lgkmcnt(4)
v_smfmac_f32_16x16x64_bf16 v[36:39], v[60:63], v[108:115], v1
ds_read_b128 v[84:87], v4 offset:14336
s_nop 1
v_smfmac_f32_16x16x64_bf16 v[40:43], v[60:63], v[224:231], v1
ds_read_b128 v[88:91], v4 offset:15360
s_nop 1
s_waitcnt lgkmcnt(4)
v_smfmac_f32_16x16x64_bf16 v[36:39], v[64:67], v[116:123], v1
ds_read_b128 v[92:95], v4 offset:18432
v_smfmac_f32_16x16x64_bf16 v[40:43], v[64:67], v[232:239], v1
ds_read_b128 v[96:99], v4 offset:19456
s_waitcnt lgkmcnt(4)
v_smfmac_f32_16x16x64_bf16 v[36:39], v[68:71], v[76:83], v1
ds_read_b128 v[100:103], v4 offset:22528
s_add_u32 s23, s77, 91097088
v_smfmac_f32_16x16x64_bf16 v[40:43], v[68:71], v[240:247], v1
ds_read_b128 v[104:107], v4 offset:23552
s_waitcnt lgkmcnt(4)
v_smfmac_f32_16x16x64_bf16 v[36:39], v[72:75], v[84:91], v1
ds_read_b128 v[108:111], v2 offset:0
v_smfmac_f32_16x16x64_bf16 v[40:43], v[72:75], v[248:255], v1
ds_read_b128 v[112:115], v2 offset:1024
s_waitcnt lgkmcnt(4)
v_smfmac_f32_16x16x64_bf16 v[36:39], v[44:47], v[92:99], v1
ds_read_b128 v[116:119], v2 offset:2048
v_smfmac_f32_16x16x64_bf16 v[40:43], v[44:47], v[192:199], v1
ds_read_b128 v[120:123], v2 offset:3072
s_waitcnt lgkmcnt(4)
v_smfmac_f32_16x16x64_bf16 v[36:39], v[48:51], v[100:107], v1
ds_read_b128 v[76:79], v2 offset:4096
v_smfmac_f32_16x16x64_bf16 v[40:43], v[48:51], v[200:207], v1
s_nop 0
v_pk_add_f32 v[28:29], v[28:29], v[30:31]
v_pk_add_f32 v[32:33], v[32:33], v[34:35]
v_cvt_pk_bf16_f32 v34, v28, v29
v_cvt_pk_bf16_f32 v35, v32, v33
ds_write_b64 v7, v[34:35] offset:0
s_nop 0
v_pk_add_f32 v[36:37], v[36:37], v[38:39]
v_pk_add_f32 v[40:41], v[40:41], v[42:43]
v_cvt_pk_bf16_f32 v32, v36, v37
v_cvt_pk_bf16_f32 v33, v40, v41
ds_write_b64 v7, v[32:33] offset:128
v_smfmac_f32_16x16x64_bf16 v[12:15], v[60:63], a[32:39], v1
ds_read_b128 v[80:83], v2 offset:5120
v_smfmac_f32_16x16x64_bf16 v[24:27], v[60:63], a[96:103], v1
ds_read_b128 v[84:87], v2 offset:6144
v_smfmac_f32_16x16x64_bf16 v[12:15], v[64:67], a[40:47], v1
ds_read_b128 v[88:91], v2 offset:7168
s_add_u32 m0, s75, 2048
s_add_u32 s32, s26, 2048
buffer_load_dwordx4 v3, s[8:11], s32 offen  lds
v_smfmac_f32_16x16x64_bf16 v[24:27], v[64:67], a[104:111], v1
s_waitcnt lgkmcnt(3)
s_barrier
ds_read_b64_tr_b16 v[92:93], v8 offset:0
ds_read_b64_tr_b16 v[94:95], v8 offset:256
v_smfmac_f32_16x16x64_bf16 v[12:15], v[68:71], a[48:55], v1
ds_read_b64_tr_b16 v[96:97], v8 offset:512
ds_read_b64_tr_b16 v[98:99], v8 offset:768
v_smfmac_f32_16x16x64_bf16 v[24:27], v[68:71], a[112:119], v1
ds_read_b64_tr_b16 v[100:101], v8 offset:128
ds_read_b64_tr_b16 v[102:103], v8 offset:384
v_smfmac_f32_16x16x64_bf16 v[12:15], v[72:75], a[56:63], v1
ds_read_b64_tr_b16 v[104:105], v8 offset:640
ds_read_b64_tr_b16 v[106:107], v8 offset:896
v_smfmac_f32_16x16x64_bf16 v[24:27], v[72:75], a[120:127], v1
v_mov_b32 v28, s42
v_smfmac_f32_16x16x64_bf16 v[12:15], v[44:47], a[0:7], v1
v_mov_b32 v29, s42
v_smfmac_f32_16x16x64_bf16 v[24:27], v[44:47], a[64:71], v1
v_mov_b32 v30, s42
v_smfmac_f32_16x16x64_bf16 v[12:15], v[48:51], a[8:15], v1
v_mov_b32 v31, s42
v_smfmac_f32_16x16x64_bf16 v[24:27], v[48:51], a[72:79], v1
s_waitcnt vmcnt(4)
s_waitcnt lgkmcnt(8)
s_cmp_ge_u32 s18, 63
s_cbranch_scc1 CH_DONE_1s
s_waitcnt lgkmcnt(6)
v_mfma_f32_16x16x32_bf16 v[36:39], v[108:111], v[92:95], 0
s_add_u32 m0, s75, 3072
s_add_u32 s32, s26, 3072
buffer_load_dwordx4 v3, s[8:11], s32 offen  lds
s_nop 0
s_waitcnt lgkmcnt(4)
v_mfma_f32_16x16x32_bf16 v[36:39], v[112:115], v[96:99], v[36:39]
s_nop 0
s_waitcnt lgkmcnt(2)
v_mfma_f32_16x16x32_bf16 v[36:39], v[116:119], v[100:103], v[36:39]
s_nop 0
s_waitcnt lgkmcnt(0)
v_mfma_f32_16x16x32_bf16 v[36:39], v[120:123], v[104:107], v[36:39]
s_nop 0
v_mfma_f32_16x16x32_bf16 v[40:43], v[76:79], v[92:95], 0
v_add_f32 v12, v12, v14
v_add_f32 v13, v13, v15
v_mfma_f32_16x16x32_bf16 v[40:43], v[80:83], v[96:99], v[40:43]
v_add_f32 v24, v24, v26
v_add_f32 v25, v25, v27
v_mfma_f32_16x16x32_bf16 v[40:43], v[84:87], v[100:103], v[40:43]
v_cvt_pk_bf16_f32 v14, v12, v13
v_mfma_f32_16x16x32_bf16 v[40:43], v[88:91], v[104:107], v[40:43]
v_cvt_pk_bf16_f32 v15, v24, v25
v_mfma_f32_16x16x32_bf16 v[124:127], v[92:95], v[92:95], 0
v_max3_f32 v10, v36, v37, v38
v_mov_b32 v25, 0
s_nop 1
v_mfma_f32_16x16x32_bf16 v[124:127], v[96:99], v[96:99], v[124:127]
v_max_f32 v10, v10, v39
v_mov_b32 v26, 0
s_nop 1
v_mfma_f32_16x16x32_bf16 v[124:127], v[100:103], v[100:103], v[124:127]
v_max3_f32 v10, v10, v40, v41
v_mfma_f32_16x16x32_bf16 v[124:127], v[104:107], v[104:107], v[124:127]
v_max3_f32 v10, v10, v42, v43
s_not_b64 vcc, s[40:41]
v_cndmask_b32_dpp v36, v40, v36, vcc quad_perm:[0,1,0,1] row_mask:0xf bank_mask:0xf
v_cndmask_b32_dpp v37, v41, v37, vcc quad_perm:[0,1,0,1] row_mask:0xf bank_mask:0xf
v_mov_b32_dpp v10, v10 quad_perm:[0,1,0,1] row_mask:0xf bank_mask:0xf
v_cndmask_b32_dpp v38, v42, v38, vcc quad_perm:[0,1,0,1] row_mask:0xf bank_mask:0xf
v_cndmask_b32_dpp v39, v43, v39, vcc quad_perm:[0,1,0,1] row_mask:0xf bank_mask:0xf
v_mov_b32 v76, 0
v_max_f32_dpp v125, v126, v10 quad_perm:[0,1,0,1] row_mask:0xf bank_mask:0xf
v_max_f32_dpp v10, v127, v10 quad_perm:[0,1,0,1] row_mask:0xf bank_mask:0xf
v_max_f32 v124, v125, v10
v_mov_b32 v11, v124
v_mov_b32 v77, 0
v_mov_b32 v78, 0
v_permlane32_swap_b32 v124, v11
v_max_f32 v124, v124, v11
v_mov_b32 v11, v124
v_mov_b32 v79, 0
v_mov_b32 v80, 0
v_permlane16_swap_b32 v124, v11
v_max_f32 v124, v124, v11
v_mul_f32 v10, s30, v124
v_pk_fma_f32 v[126:127], v[126:127], s[30:31], v[10:11] op_sel_hi:[1,1,0] neg_lo:[0,0,1] neg_hi:[0,0,1]
v_pk_fma_f32 v[36:37], v[36:37], s[30:31], v[10:11] op_sel_hi:[1,1,0] neg_lo:[0,0,1] neg_hi:[0,0,1]
v_pk_fma_f32 v[38:39], v[38:39], s[30:31], v[10:11] op_sel_hi:[1,1,0] neg_lo:[0,0,1] neg_hi:[0,0,1]
v_exp_f32 v126, v126
v_exp_f32 v127, v127
v_exp_f32 v36, v36
v_cvt_pk_bf16_f32 v24, v126, v127
v_cvt_pk_bf16_f32 v27, v126, v127
v_exp_f32 v37, v37
v_exp_f32 v38, v38
v_mfma_f32_16x16x16_bf16 v[68:71], v[28:29], v[24:25], 0
v_exp_f32 v39, v39
v_cvt_pk_bf16_f32 v32, v36, v37
v_cvt_pk_bf16_f32 v33, v38, v39
v_mfma_f32_16x16x16_bf16 v[44:47], v[14:15], v[24:25], 0
v_mov_b32_dpp v34, v32 quad_perm:[2,3,2,3] row_mask:0xf bank_mask:0xf
v_mov_b32_dpp v35, v33 quad_perm:[2,3,2,3] row_mask:0xf bank_mask:0xf
v_mfma_f32_16x16x16_bf16 v[48:51], v[14:15], v[26:27], 0
s_waitcnt vmcnt(2)
v_mfma_f32_16x16x32_bf16 v[68:71], v[28:31], v[32:35], v[68:71]
v_mov_b32 v81, 0
v_mov_b32 v82, 0
v_mfma_f32_16x16x32_bf16 v[44:47], v[16:19], v[32:35], v[44:47]
v_mov_b32 v83, 0
v_mov_b32 v84, 0
v_mfma_f32_16x16x32_bf16 v[48:51], v[20:23], v[32:35], v[48:51]
v_mov_b32 v85, 0
v_mov_b32 v86, 0
v_rcp_f32 v10, v68
v_mov_b32 v87, 0
v_mov_b32 v88, 0
v_mov_b32 v89, 0
v_pk_mul_f32 v[44:45], v[44:45], v[10:11] op_sel_hi:[1,0]
v_pk_mul_f32 v[46:47], v[46:47], v[10:11] op_sel_hi:[1,0]
v_mov_b32 v90, 0
v_pk_mul_f32 v[48:49], v[48:49], v[10:11] op_sel_hi:[1,0]
v_pk_mul_f32 v[50:51], v[50:51], v[10:11] op_sel_hi:[1,0]
v_cvt_pk_bf16_f32 v52, v44, v45
v_cvt_pk_bf16_f32 v53, v46, v47
v_cvt_pk_bf16_f32 v54, v48, v49
v_cvt_pk_bf16_f32 v55, v50, v51
s_not_b64 exec, s[40:41]
ds_write_b128 v9, v[52:55] offset:512
s_mov_b64 exec, -1
v_mov_b32 v91, 0
v_mov_b32_dpp v60, v52 quad_perm:[0,1,0,1] row_mask:0xf bank_mask:0xf
v_mov_b32_dpp v61, v53 quad_perm:[0,1,0,1] row_mask:0xf bank_mask:0xf
v_mov_b32_dpp v62, v54 quad_perm:[0,1,0,1] row_mask:0xf bank_mask:0xf
v_mov_b32_dpp v63, v55 quad_perm:[0,1,0,1] row_mask:0xf bank_mask:0xf
s_nop 1
v_smfmac_f32_16x16x64_bf16 v[76:79], v[60:63], a[136:143], v1
v_mov_b32_dpp v10, v14 quad_perm:[2,3,2,3] row_mask:0xf bank_mask:0xf
v_cndmask_b32 v16, v14, v96, s[40:41]
v_smfmac_f32_16x16x64_bf16 v[80:83], v[60:63], a[168:175], v1
v_mov_b32_dpp v11, v15 quad_perm:[2,3,2,3] row_mask:0xf bank_mask:0xf
v_cndmask_b32 v17, v15, v97, s[40:41]
s_waitcnt lgkmcnt(0)
s_barrier
ds_read_b128 v[64:67], v9 offset:1024
ds_read_b128 v[68:71], v9 offset:1536
ds_read_b128 v[56:59], v9 offset:0
v_smfmac_f32_16x16x64_bf16 v[84:87], v[60:63], a[200:207], v1
v_cndmask_b32 v18, v10, v98, s[40:41]
v_smfmac_f32_16x16x64_bf16 v[88:91], v[60:63], a[232:239], v1
v_cndmask_b32 v19, v11, v99, s[40:41]
s_waitcnt lgkmcnt(2)
v_smfmac_f32_16x16x64_bf16 v[76:79], v[64:67], a[144:151], v1
s_waitcnt lgkmcnt(1)
v_smfmac_f32_16x16x64_bf16 v[76:79], v[68:71], a[152:159], v1
s_waitcnt lgkmcnt(0)
v_smfmac_f32_16x16x64_bf16 v[76:79], v[56:59], a[128:135], v1
v_smfmac_f32_16x16x64_bf16 v[80:83], v[64:67], a[176:183], v1
s_nop 2
v_smfmac_f32_16x16x64_bf16 v[80:83], v[68:71], a[184:191], v1
s_nop 2
v_cvt_pk_bf16_f32 v92, v76, v77
v_smfmac_f32_16x16x64_bf16 v[80:83], v[56:59], a[160:167], v1
v_cvt_pk_bf16_f32 v93, v78, v79
v_and_or_b32 v92, v92, -2, s21
buffer_store_dwordx2 v[92:93], v5, s[8:11], s19 offen sc1
v_smfmac_f32_16x16x64_bf16 v[84:87], v[64:67], a[208:215], v1
s_nop 2
v_smfmac_f32_16x16x64_bf16 v[84:87], v[68:71], a[216:223], v1
s_nop 2
v_cvt_pk_bf16_f32 v94, v80, v81
v_smfmac_f32_16x16x64_bf16 v[84:87], v[56:59], a[192:199], v1
v_cvt_pk_bf16_f32 v95, v82, v83
v_and_or_b32 v94, v94, -2, s21
s_add_u32 s32, s19, 8192
buffer_store_dwordx2 v[94:95], v5, s[8:11], s32 offen sc1
v_smfmac_f32_16x16x64_bf16 v[88:91], v[64:67], a[240:247], v1
s_nop 2
v_smfmac_f32_16x16x64_bf16 v[88:91], v[68:71], a[248:255], v1
s_nop 2
v_cvt_pk_bf16_f32 v96, v84, v85
v_smfmac_f32_16x16x64_bf16 v[88:91], v[56:59], a[224:231], v1
v_cvt_pk_bf16_f32 v97, v86, v87
v_and_or_b32 v96, v96, -2, s21
s_add_u32 s32, s19, 4096
buffer_store_dwordx2 v[96:97], v5, s[8:11], s32 offen sc1
s_nop 4
v_cvt_pk_bf16_f32 v98, v88, v89
v_cvt_pk_bf16_f32 v99, v90, v91
v_and_or_b32 v98, v98, -2, s21
s_add_u32 s32, s19, 12288
buffer_store_dwordx2 v[98:99], v5, s[8:11], s32 offen sc1
s_mov_b32 s36, 0
ds_read_b128 v[44:47], v3 offset:12544
v_mov_b32 v28, 0
v_mov_b32 v29, 0
v_mov_b32 v30, 0
v_mov_b32 v31, 0
v_mov_b32 v32, 0
v_mov_b32 v33, 0
v_mov_b32 v34, 0
v_mov_b32 v35, 0
v_mov_b32 v36, 0
v_mov_b32 v37, 0
v_mov_b32 v38, 0
v_mov_b32 v39, 0
v_mov_b32 v40, 0
v_mov_b32 v41, 0
v_mov_b32 v42, 0
v_mov_b32 v43, 0
v_mov_b32 v12, 0
v_mov_b32 v13, 0
v_mov_b32 v14, 0
v_mov_b32 v15, 0
v_mov_b32 v24, 0
v_mov_b32 v25, 0
v_mov_b32 v26, 0
v_mov_b32 v27, 0
v_xor_b32 v2, 8192, v2
s_xor_b32 s75, s75, 8192
s_nop 15
s_nop 15
s_nop 7
buffer_load_dwordx4 v[60:63], v3, s[8:11], s20 offen offset:0 sc1
buffer_load_dwordx4 v[64:67], v3, s[8:11], s20 offen offset:1024 sc1
buffer_load_dwordx4 v[68:71], v3, s[8:11], s20 offen offset:2048 sc1
buffer_load_dwordx4 v[72:75], v3, s[8:11], s20 offen offset:3072 sc1
ds_read_b128 v[76:79], v4 offset:24576
ds_read_b128 v[80:83], v4 offset:25600
ds_read_b128 v[84:87], v4 offset:26624
ds_read_b128 v[88:91], v4 offset:27648
ds_read_b128 v[92:95], v4 offset:28672
ds_read_b128 v[96:99], v4 offset:29696
s_nop 15
s_nop 3
buffer_load_dwordx4 v[60:63], v3, s[8:11], s20 offen offset:0 sc1
buffer_load_dwordx4 v[64:67], v3, s[8:11], s20 offen offset:1024 sc1
buffer_load_dwordx4 v[68:71], v3, s[8:11], s20 offen offset:2048 sc1
buffer_load_dwordx4 v[72:75], v3, s[8:11], s20 offen offset:3072 sc1
s_waitcnt lgkmcnt(6)
CH_RA_1s:
s_waitcnt vmcnt(7)
v_bitop3_b32 v10, v60, v62, s21 bitop3:0x7e
v_mfma_f32_16x16x32_bf16 v[48:51], v[60:63], v[44:47], 0
s_waitcnt vmcnt(6)
v_bitop3_b32 v11, v64, v66, s21 bitop3:0x7e
v_mfma_f32_16x16x32_bf16 v[48:51], v[64:67], v[44:47], v[48:51]
v_or_b32 v10, v10, v11
s_waitcnt vmcnt(5)
v_bitop3_b32 v11, v68, v70, s21 bitop3:0x7e
v_mfma_f32_16x16x32_bf16 v[48:51], v[68:71], v[44:47], v[48:51]
v_or_b32 v10, v10, v11
s_waitcnt vmcnt(4)
v_bitop3_b32 v11, v72, v74, s21 bitop3:0x7e
v_mfma_f32_16x16x32_bf16 v[48:51], v[72:75], v[44:47], v[48:51]
v_bitop3_b32 v10, v10, v11, 1 bitop3:0xa8
v_cmp_ne_u32 vcc, 0, v10
s_cbranch_vccnz CH_RARETRY_1s
CH_RAOK_1s:
s_nop 4
v_permlane32_swap_b32 v48, v50
v_permlane32_swap_b32 v49, v51
s_mov_b64 exec, s[38:39]
v_pk_add_f32 v[48:49], v[48:49], v[50:51]
v_cvt_pk_bf16_f32 v48, v48, v49
buffer_store_dword v48, v6, s[8:11], s22 offen sc1
s_mov_b64 exec, -1
s_barrier
s_nop 3
buffer_load_dwordx4 v[52:55], v3, s[8:11], s23 offen offset:0 sc1
s_nop 15
buffer_load_dwordx4 v[56:59], v3, s[8:11], s23 offen offset:1024 sc1
s_mov_b32 s36, 0
s_mov_b32 s82, s27
s_add_u32 s25, s25, 262144
s_add_u32 s26, s26, 262144
s_add_u32 s27, s27, 131072
s_sub_u32 s24, s78, 1024
s_mov_b32 s78, s22
s_add_u32 s77, s77, 8192
s_and_b32 s77, s77, 0x7fff
s_add_u32 s22, s77, s81
s_add_u32 s18, s18, 1
s_xor_b32 s21, s21, 1
buffer_load_dwordx4 v[52:55], v3, s[8:11], s23 offen offset:0 sc1
buffer_load_dwordx4 v[56:59], v3, s[8:11], s23 offen offset:1024 sc1
ds_read_b128 v[100:103], v4 offset:30720
ds_read_b128 v[104:107], v4 offset:31744
ds_read_b128 v[108:111], v4 offset:0
ds_read_b128 v[112:115], v4 offset:1024
ds_read_b128 v[116:119], v4 offset:4096
ds_read_b128 v[120:123], v4 offset:5120
s_waitcnt lgkmcnt(0)
s_branch CH_RB_1s
CH_RARETRY_1s:
buffer_load_dwordx4 v[60:63], v3, s[8:11], s20 offen offset:0 sc1
buffer_load_dwordx4 v[64:67], v3, s[8:11], s20 offen offset:1024 sc1
buffer_load_dwordx4 v[68:71], v3, s[8:11], s20 offen offset:2048 sc1
buffer_load_dwordx4 v[72:75], v3, s[8:11], s20 offen offset:3072 sc1
s_add_u32 s36, s36, 1
s_cmp_gt_u32 s36, 65536
s_cbranch_scc1 CH_RAOK_1s
s_branch CH_RA_1s
CH_RBRETRY_1s:
buffer_load_dwordx4 v[52:55], v3, s[8:11], s23 offen offset:0 sc1
buffer_load_dwordx4 v[56:59], v3, s[8:11], s23 offen offset:1024 sc1
s_add_u32 s36, s36, 1
s_cmp_gt_u32 s36, 65536
s_cbranch_scc1 CH_RBOK_1s
s_branch CH_RB_1s
CH_RBLRETRY_1s:
buffer_load_dwordx4 v[56:59], v3, s[8:11], s23 offen offset:1024 sc1
s_add_u32 s36, s36, 1
s_cmp_gt_u32 s36, 65536
s_cbranch_scc1 CH_RBLOK_1s
s_waitcnt vmcnt(1)
s_branch CH_RBL_1s
CH_DONE_1s:
s_waitcnt lgkmcnt(0)
s_nop 4
v_add_f32 v12, v12, v14
v_add_f32 v13, v13, v15
v_add_f32 v24, v24, v26
v_add_f32 v25, v25, v27
v_cvt_pk_bf16_f32 v14, v12, v13
v_cvt_pk_bf16_f32 v15, v24, v25
s_nop 1
v_mov_b32_dpp v10, v14 quad_perm:[2,3,2,3] row_mask:0xf bank_mask:0xf
v_mov_b32_dpp v11, v15 quad_perm:[2,3,2,3] row_mask:0xf bank_mask:0xf
v_cndmask_b32 v36, v14, v96, s[40:41]
v_cndmask_b32 v37, v15, v97, s[40:41]
v_cndmask_b32 v38, v10, v98, s[40:41]
v_cndmask_b32 v39, v11, v99, s[40:41]
buffer_store_dwordx4 v[36:39], v3, s[8:11], s27 offen sc1
s_barrier
s_branch L_FIN
RDY_84_S:
s_add_u32 s32, s18, 1
s_min_u32 s32, s32, 63
s_lshr_b32 s32, s32, 2
s_add_u32 s32, s32, 1
v_lshrrev_b32 v10, 3, v0
v_and_b32 v11, 3, v10
v_bfe_u32 v10, v10, 2, 1
v_lshlrev_b32 v10, 13, v10
v_lshl_add_u32 v10, v11, 7, v10
s_mov_b32 s35, 0
POLL_KV_85:
s_cmp_lg_u32 s37, 0
s_cbranch_scc1 POLL_KV_85_E
buffer_load_dword v11, v10, s[8:11], s89 offen sc1
s_add_u32 s35, s35, 1
s_cmp_gt_u32 s35, 65536
s_cselect_b32 s37, 1, 0
s_waitcnt vmcnt(0)
v_cmp_gt_u32 vcc, s32, v11
s_cbranch_vccz POLL_KV_85_E
s_branch POLL_KV_85
POLL_KV_85_E:
s_nop 1
v_min_u32_dpp v11, v11, v11 quad_perm:[1,0,3,2] row_mask:0xf bank_mask:0xf
s_nop 1
v_min_u32_dpp v11, v11, v11 quad_perm:[2,3,0,1] row_mask:0xf bank_mask:0xf
s_nop 1
v_min_u32_dpp v11, v11, v11 row_half_mirror row_mask:0xf bank_mask:0xf
s_nop 0
v_readfirstlane_b32 s85, v11
s_nop 3
s_lshl_b32 s85, s85, 2
s_branch RDY_84
CH_W2s:
s_mov_b32 s18, 0
s_mov_b32 s29, 0
s_add_u32 s32, s18, 1
s_min_u32 s32, s32, 63
s_cmp_ge_u32 s32, s85
s_cbranch_scc1 RDY_86_S
RDY_86:
s_mov_b32 s75, 147456
s_lshl_b32 s26, s16, 13
s_add_u32 s26, s26, 18743296
s_add_u32 m0, s75, 4096
s_add_u32 s32, s26, 4096
buffer_load_dwordx4 v3, s[8:11], s32 offen  lds
s_add_u32 m0, s75, 5120
s_add_u32 s32, s26, 5120
buffer_load_dwordx4 v3, s[8:11], s32 offen  lds
s_mov_b32 s34, 0x05040100
s_mov_b32 s35, 0x07060302
v_perm_b32 v60, v17, v16, s34
v_perm_b32 v61, v19, v18, s34
v_perm_b32 v62, v17, v16, s35
v_perm_b32 v63, v19, v18, s35
v_perm_b32 v64, v13, v12, s34
v_perm_b32 v65, v15, v14, s34
v_perm_b32 v66, v13, v12, s35
v_perm_b32 v67, v15, v14, s35
s_mov_b32 s18, 0
s_mov_b32 s75, 155648
s_and_b32 s32, s18, 3
s_lshl_b32 s33, s32, 18
s_lshl_b32 s34, s16, 7
s_add_u32 s19, s33, s34
s_add_u32 s19, s19, 90308608
s_lshl_b32 s35, s16, 13
s_add_u32 s20, s33, s35
s_add_u32 s20, s20, 90046464
s_add_u32 s32, s18, 3
s_and_b32 s32, s32, 3
s_lshl_b32 s33, s32, 18
s_mov_b32 s21, 0
s_lshr_b32 s34, s16, 3
s_lshl_b32 s34, s34, 11
s_and_b32 s35, s16, 1
s_lshl_b32 s35, s35, 9
s_add_u32 s34, s34, s35
s_bfe_u32 s35, s16, 0x20001
s_lshl_b32 s35, s35, 6
s_add_u32 s34, s34, s35
s_lshl_b32 s33, s32, 13
s_add_u32 s24, s33, s34
s_add_u32 s24, s24, 91226112
s_add_u32 s32, s18, 1
s_and_b32 s32, s32, 3
s_lshl_b32 s33, s32, 13
s_add_u32 s22, s33, s34
s_add_u32 s22, s22, 91226112
s_add_u32 s23, s33, 91099136
s_lshl_b32 s32, s18, 5
s_add_u32 s32, s32, s16
s_lshl_b32 s33, s32, 13
s_add_u32 s25, s33, 35524608
s_add_u32 s26, s33, 19005440
s_lshl_b32 s33, s32, 12
s_add_u32 s27, s33, 52299776
s_lshl_b32 s33, s32, 11
s_add_u32 s28, s33, 60818432
s_mov_b32 s82, s27
s_sub_u32 s24, s24, 0
s_mov_b32 s76, 0
s_mov_b32 s77, 8192
s_mov_b32 s79, s19
s_mov_b32 s80, s20
s_sub_u32 s81, s22, 8192
s_mov_b32 s78, s81
ds_read_b128 v[76:79], v4 offset:0
ds_read_b128 v[80:83], v4 offset:1024
ds_read_b128 v[84:87], v4 offset:2048
ds_read_b128 v[88:91], v4 offset:3072
ds_read_b128 v[92:95], v4 offset:4096
ds_read_b128 v[96:99], v4 offset:5120
ds_read_b128 v[100:103], v4 offset:6144
ds_read_b128 v[104:107], v4 offset:7168
ds_read_b128 v[108:111], v4 offset:8192
ds_read_b128 v[112:115], v4 offset:9216
ds_read_b128 v[116:119], v4 offset:12288
ds_read_b128 v[120:123], v4 offset:13312
v_mov_b32 v28, 0
v_mov_b32 v29, 0
v_mov_b32 v30, 0
v_mov_b32 v31, 0
v_mov_b32 v32, 0
v_mov_b32 v33, 0
v_mov_b32 v34, 0
v_mov_b32 v35, 0
v_mov_b32 v36, 0
v_mov_b32 v37, 0
v_mov_b32 v38, 0
v_mov_b32 v39, 0
v_mov_b32 v40, 0
v_mov_b32 v41, 0
v_mov_b32 v42, 0
v_mov_b32 v43, 0
v_mov_b32 v12, 0
v_mov_b32 v13, 0
v_mov_b32 v14, 0
v_mov_b32 v15, 0
v_mov_b32 v24, 0
v_mov_b32 v25, 0
v_mov_b32 v26, 0
v_mov_b32 v27, 0
s_waitcnt vmcnt(0)
s_waitcnt lgkmcnt(0)
s_mov_b32 s36, 0
v_min_u32 v60, 0xfffffffe, v60
v_min_u32 v61, 0xfffffffe, v61
v_min_u32 v62, 0xfffffffe, v62
v_min_u32 v63, 0xfffffffe, v63
v_min_u32 v64, 0xfffffffe, v64
v_min_u32 v65, 0xfffffffe, v65
v_min_u32 v66, 0xfffffffe, v66
v_min_u32 v67, 0xfffffffe, v67
.p2align 6
CH_BASE_2s:
.fill (((8 - (. - CH_BASE_2s)) & 15) >> 2), 4, 0xbf800000
CH_RB_2s:
s_waitcnt vmcnt(3)
CH_RBE_2s:
v_max3_u32 v10, v60, v61, v62
v_max_u32 v10, v10, v63
v_cmp_eq_u32 vcc, -1, v10
ds_write_b128 v3, v[60:63] offset:4096
s_cbranch_vccnz CH_RBRETRY_2s
CH_RBOK_2s:
v_smfmac_f32_16x16x64_bf16 v[28:31], v[60:63], v[76:83], v1
v_smfmac_f32_16x16x64_bf16 v[32:35], v[60:63], v[160:167], v1
ds_read_b128 v[76:79], v4 offset:16384
v_smfmac_f32_16x16x64_bf16 v[36:39], v[60:63], v[84:91], v1
ds_read_b128 v[80:83], v4 offset:17408
v_smfmac_f32_16x16x64_bf16 v[40:43], v[60:63], v[224:231], v1
s_waitcnt vmcnt(2)
CH_RBL_2s:
v_max3_u32 v10, v64, v65, v66
v_max_u32 v10, v10, v67
v_cmp_eq_u32 vcc, -1, v10
ds_write_b128 v3, v[64:67] offset:5120
s_cbranch_vccnz CH_RBLRETRY_2s
CH_RBLOK_2s:
v_smfmac_f32_16x16x64_bf16 v[28:31], v[64:67], v[92:99], v1
v_smfmac_f32_16x16x64_bf16 v[32:35], v[64:67], v[168:175], v1
v_smfmac_f32_16x16x64_bf16 v[36:39], v[64:67], v[100:107], v1
buffer_store_dwordx4 v[16:19], v3, s[8:11], s82 offen sc1
v_smfmac_f32_16x16x64_bf16 v[40:43], v[64:67], v[232:239], v1
s_waitcnt lgkmcnt(0)
s_barrier
ds_read_b128 v[68:71], v3 offset:6144
ds_read_b128 v[72:75], v3 offset:7168
v_smfmac_f32_16x16x64_bf16 v[12:15], v[60:63], a[32:39], v1
ds_read_b128 v[44:47], v3 offset:0
v_smfmac_f32_16x16x64_bf16 v[24:27], v[60:63], a[96:103], v1
ds_read_b128 v[48:51], v3 offset:1024
v_smfmac_f32_16x16x64_bf16 v[12:15], v[64:67], a[40:47], v1
ds_read_b128 v[52:55], v3 offset:2048
buffer_load_dwordx4 v[16:19], v3, s[8:11], s25 offen
v_smfmac_f32_16x16x64_bf16 v[24:27], v[64:67], a[104:111], v1
ds_read_b128 v[56:59], v3 offset:3072
s_waitcnt lgkmcnt(5)
v_smfmac_f32_16x16x64_bf16 v[28:31], v[68:71], v[108:115], v1
ds_read_b128 v[84:87], v4 offset:20480
v_smfmac_f32_16x16x64_bf16 v[32:35], v[68:71], v[176:183], v1
ds_read_b128 v[88:91], v4 offset:21504
s_add_u32 s32, s18, 6
s_min_u32 s32, s32, 63
s_cmp_lt_u32 s32, s85
s_cbranch_scc1 LOOK_87
v_lshrrev_b32 v10, 3, v0
v_and_b32 v11, 3, v10
v_bfe_u32 v10, v10, 2, 1
v_lshlrev_b32 v10, 13, v10
v_lshl_add_u32 v10, v11, 7, v10
buffer_load_dword v6, v10, s[8:11], s89 offen sc1
s_mov_b32 s29, 1
LOOK_87:
s_waitcnt lgkmcnt(6)
v_smfmac_f32_16x16x64_bf16 v[28:31], v[72:75], v[116:123], v1
ds_read_b128 v[92:95], v4 offset:24576
buffer_load_dwordx4 v[20:23], v3, s[8:11], s25 offen offset:1024
v_smfmac_f32_16x16x64_bf16 v[32:35], v[72:75], v[184:191], v1
ds_read_b128 v[96:99], v4 offset:25600
s_waitcnt lgkmcnt(7)
v_smfmac_f32_16x16x64_bf16 v[28:31], v[44:47], v[76:83], v1
ds_read_b128 v[100:103], v4 offset:28672
v_smfmac_f32_16x16x64_bf16 v[32:35], v[44:47], v[128:135], v1
ds_read_b128 v[104:107], v4 offset:29696
s_waitcnt lgkmcnt(8)
s_waitcnt lgkmcnt(4)
v_smfmac_f32_16x16x64_bf16 v[28:31], v[48:51], v[84:91], v1
ds_read_b128 v[108:111], v4 offset:10240
v_smfmac_f32_16x16x64_bf16 v[32:35], v[48:51], v[136:143], v1
ds_read_b128 v[112:115], v4 offset:11264
s_waitcnt lgkmcnt(4)
v_smfmac_f32_16x16x64_bf16 v[28:31], v[52:55], v[92:99], v1
ds_read_b128 v[116:119], v4 offset:14336
v_smfmac_f32_16x16x64_bf16 v[32:35], v[52:55], v[144:151], v1
ds_read_b128 v[120:123], v4 offset:15360
s_waitcnt lgkmcnt(4)
v_smfmac_f32_16x16x64_bf16 v[28:31], v[56:59], v[100:107], v1
ds_read_b128 v[76:79], v4 offset:18432
v_smfmac_f32_16x16x64_bf16 v[32:35], v[56:59], v[152:159], v1
ds_read_b128 v[80:83], v4 offset:19456
s_waitcnt lgkmcnt(4)
v_smfmac_f32_16x16x64_bf16 v[36:39], v[68:71], v[108:115], v1
ds_read_b128 v[84:87], v4 offset:22528
s_nop 1
v_smfmac_f32_16x16x64_bf16 v[40:43], v[68:71], v[240:247], v1
ds_read_b128 v[88:91], v4 offset:23552
s_nop 1
s_waitcnt lgkmcnt(4)
v_smfmac_f32_16x16x64_bf16 v[36:39], v[72:75], v[116:123], v1
ds_read_b128 v[92:95], v4 offset:26624
v_smfmac_f32_16x16x64_bf16 v[40:43], v[72:75], v[248:255], v1
ds_read_b128 v[96:99], v4 offset:27648
s_waitcnt lgkmcnt(4)
v_smfmac_f32_16x16x64_bf16 v[36:39], v[44:47], v[76:83], v1
ds_read_b128 v[100:103], v4 offset:30720
s_add_u32 s23, s77, 91099136
v_smfmac_f32_16x16x64_bf16 v[40:43], v[44:47], v[192:199], v1
ds_read_b128 v[104:107], v4 offset:31744
s_waitcnt lgkmcnt(4)
v_smfmac_f32_16x16x64_bf16 v[36:39], v[48:51], v[84:91], v1
ds_read_b128 v[108:111], v2 offset:0
v_smfmac_f32_16x16x64_bf16 v[40:43], v[48:51], v[200:207], v1
ds_read_b128 v[112:115], v2 offset:1024
s_waitcnt lgkmcnt(4)
v_smfmac_f32_16x16x64_bf16 v[36:39], v[52:55], v[92:99], v1
ds_read_b128 v[116:119], v2 offset:2048
v_smfmac_f32_16x16x64_bf16 v[40:43], v[52:55], v[208:215], v1
ds_read_b128 v[120:123], v2 offset:3072
s_waitcnt lgkmcnt(4)
v_smfmac_f32_16x16x64_bf16 v[36:39], v[56:59], v[100:107], v1
ds_read_b128 v[76:79], v2 offset:4096
v_smfmac_f32_16x16x64_bf16 v[40:43], v[56:59], v[216:223], v1
s_nop 0
v_pk_add_f32 v[28:29], v[28:29], v[30:31]
v_pk_add_f32 v[32:33], v[32:33], v[34:35]
v_cvt_pk_bf16_f32 v34, v28, v29
v_cvt_pk_bf16_f32 v35, v32, v33
ds_write_b64 v7, v[34:35] offset:0
s_nop 0
v_pk_add_f32 v[36:37], v[36:37], v[38:39]
v_pk_add_f32 v[40:41], v[40:41], v[42:43]
v_cvt_pk_bf16_f32 v32, v36, v37
v_cvt_pk_bf16_f32 v33, v40, v41
ds_write_b64 v7, v[32:33] offset:128
v_smfmac_f32_16x16x64_bf16 v[12:15], v[68:71], a[48:55], v1
ds_read_b128 v[80:83], v2 offset:5120
v_smfmac_f32_16x16x64_bf16 v[24:27], v[68:71], a[112:119], v1
ds_read_b128 v[84:87], v2 offset:6144
v_smfmac_f32_16x16x64_bf16 v[12:15], v[72:75], a[56:63], v1
ds_read_b128 v[88:91], v2 offset:7168
v_smfmac_f32_16x16x64_bf16 v[24:27], v[72:75], a[120:127], v1
s_waitcnt lgkmcnt(3)
s_barrier
ds_read_b64_tr_b16 v[92:93], v8 offset:0
ds_read_b64_tr_b16 v[94:95], v8 offset:256
v_smfmac_f32_16x16x64_bf16 v[12:15], v[44:47], a[0:7], v1
ds_read_b64_tr_b16 v[96:97], v8 offset:512
ds_read_b64_tr_b16 v[98:99], v8 offset:768
s_add_u32 m0, s75, 4096
s_add_u32 s32, s26, 4096
buffer_load_dwordx4 v3, s[8:11], s32 offen  lds
v_smfmac_f32_16x16x64_bf16 v[24:27], v[44:47], a[64:71], v1
ds_read_b64_tr_b16 v[100:101], v8 offset:128
ds_read_b64_tr_b16 v[102:103], v8 offset:384
v_smfmac_f32_16x16x64_bf16 v[12:15], v[48:51], a[8:15], v1
ds_read_b64_tr_b16 v[104:105], v8 offset:640
ds_read_b64_tr_b16 v[106:107], v8 offset:896
v_smfmac_f32_16x16x64_bf16 v[24:27], v[48:51], a[72:79], v1
v_mov_b32 v28, s42
v_smfmac_f32_16x16x64_bf16 v[12:15], v[52:55], a[16:23], v1
v_mov_b32 v29, s42
v_smfmac_f32_16x16x64_bf16 v[24:27], v[52:55], a[80:87], v1
v_mov_b32 v30, s42
v_smfmac_f32_16x16x64_bf16 v[12:15], v[56:59], a[24:31], v1
v_mov_b32 v31, s42
v_smfmac_f32_16x16x64_bf16 v[24:27], v[56:59], a[88:95], v1
s_waitcnt vmcnt(4)
s_waitcnt lgkmcnt(8)
s_cmp_ge_u32 s18, 63
s_cbranch_scc1 CH_DONE_2s
s_waitcnt lgkmcnt(6)
v_mfma_f32_16x16x32_bf16 v[36:39], v[108:111], v[92:95], 0
s_nop 0
s_waitcnt lgkmcnt(4)
v_mfma_f32_16x16x32_bf16 v[36:39], v[112:115], v[96:99], v[36:39]
s_nop 0
s_waitcnt lgkmcnt(2)
v_mfma_f32_16x16x32_bf16 v[36:39], v[116:119], v[100:103], v[36:39]
s_add_u32 m0, s75, 5120
s_add_u32 s32, s26, 5120
buffer_load_dwordx4 v3, s[8:11], s32 offen  lds
s_nop 0
s_waitcnt lgkmcnt(0)
v_mfma_f32_16x16x32_bf16 v[36:39], v[120:123], v[104:107], v[36:39]
s_nop 0
v_mfma_f32_16x16x32_bf16 v[40:43], v[76:79], v[92:95], 0
v_add_f32 v12, v12, v14
v_add_f32 v13, v13, v15
v_mfma_f32_16x16x32_bf16 v[40:43], v[80:83], v[96:99], v[40:43]
v_add_f32 v24, v24, v26
v_add_f32 v25, v25, v27
v_mfma_f32_16x16x32_bf16 v[40:43], v[84:87], v[100:103], v[40:43]
v_cvt_pk_bf16_f32 v14, v12, v13
v_mfma_f32_16x16x32_bf16 v[40:43], v[88:91], v[104:107], v[40:43]
v_cvt_pk_bf16_f32 v15, v24, v25
v_mfma_f32_16x16x32_bf16 v[124:127], v[92:95], v[92:95], 0
v_max3_f32 v10, v36, v37, v38
v_mov_b32 v25, 0
s_nop 1
v_mfma_f32_16x16x32_bf16 v[124:127], v[96:99], v[96:99], v[124:127]
v_max_f32 v10, v10, v39
v_mov_b32 v26, 0
s_nop 1
v_mfma_f32_16x16x32_bf16 v[124:127], v[100:103], v[100:103], v[124:127]
v_max3_f32 v10, v10, v40, v41
v_mfma_f32_16x16x32_bf16 v[124:127], v[104:107], v[104:107], v[124:127]
v_max3_f32 v10, v10, v42, v43
s_not_b64 vcc, s[40:41]
v_cndmask_b32_dpp v36, v40, v36, vcc quad_perm:[0,1,0,1] row_mask:0xf bank_mask:0xf
v_cndmask_b32_dpp v37, v41, v37, vcc quad_perm:[0,1,0,1] row_mask:0xf bank_mask:0xf
v_mov_b32_dpp v10, v10 quad_perm:[0,1,0,1] row_mask:0xf bank_mask:0xf
v_cndmask_b32_dpp v38, v42, v38, vcc quad_perm:[0,1,0,1] row_mask:0xf bank_mask:0xf
v_cndmask_b32_dpp v39, v43, v39, vcc quad_perm:[0,1,0,1] row_mask:0xf bank_mask:0xf
v_mov_b32 v76, 0
v_max_f32_dpp v125, v126, v10 quad_perm:[0,1,0,1] row_mask:0xf bank_mask:0xf
v_max_f32_dpp v10, v127, v10 quad_perm:[0,1,0,1] row_mask:0xf bank_mask:0xf
v_max_f32 v124, v125, v10
v_mov_b32 v11, v124
v_mov_b32 v77, 0
v_mov_b32 v78, 0
v_permlane32_swap_b32 v124, v11
v_max_f32 v124, v124, v11
v_mov_b32 v11, v124
v_mov_b32 v79, 0
v_mov_b32 v80, 0
v_permlane16_swap_b32 v124, v11
v_max_f32 v124, v124, v11
v_mul_f32 v10, s30, v124
v_pk_fma_f32 v[126:127], v[126:127], s[30:31], v[10:11] op_sel_hi:[1,1,0] neg_lo:[0,0,1] neg_hi:[0,0,1]
v_pk_fma_f32 v[36:37], v[36:37], s[30:31], v[10:11] op_sel_hi:[1,1,0] neg_lo:[0,0,1] neg_hi:[0,0,1]
v_pk_fma_f32 v[38:39], v[38:39], s[30:31], v[10:11] op_sel_hi:[1,1,0] neg_lo:[0,0,1] neg_hi:[0,0,1]
v_exp_f32 v126, v126
v_exp_f32 v127, v127
v_exp_f32 v36, v36
v_cvt_pk_bf16_f32 v24, v126, v127
v_cvt_pk_bf16_f32 v27, v126, v127
v_exp_f32 v37, v37
v_exp_f32 v38, v38
v_mfma_f32_16x16x16_bf16 v[68:71], v[28:29], v[24:25], 0
v_exp_f32 v39, v39
v_cvt_pk_bf16_f32 v32, v36, v37
v_cvt_pk_bf16_f32 v33, v38, v39
v_mfma_f32_16x16x16_bf16 v[44:47], v[14:15], v[24:25], 0
v_mov_b32_dpp v34, v32 quad_perm:[2,3,2,3] row_mask:0xf bank_mask:0xf
v_mov_b32_dpp v35, v33 quad_perm:[2,3,2,3] row_mask:0xf bank_mask:0xf
v_mfma_f32_16x16x16_bf16 v[48:51], v[14:15], v[26:27], 0
s_waitcnt vmcnt(2)
v_mfma_f32_16x16x32_bf16 v[68:71], v[28:31], v[32:35], v[68:71]
v_mov_b32 v81, 0
v_mov_b32 v82, 0
v_mfma_f32_16x16x32_bf16 v[44:47], v[16:19], v[32:35], v[44:47]
v_mov_b32 v83, 0
v_mov_b32 v84, 0
v_mfma_f32_16x16x32_bf16 v[48:51], v[20:23], v[32:35], v[48:51]
v_mov_b32 v85, 0
v_mov_b32 v86, 0
v_rcp_f32 v10, v68
v_mov_b32 v87, 0
v_mov_b32 v88, 0
v_mov_b32 v89, 0
v_pk_mul_f32 v[44:45], v[44:45], v[10:11] op_sel_hi:[1,0]
v_pk_mul_f32 v[46:47], v[46:47], v[10:11] op_sel_hi:[1,0]
v_mov_b32 v90, 0
v_pk_mul_f32 v[48:49], v[48:49], v[10:11] op_sel_hi:[1,0]
v_pk_mul_f32 v[50:51], v[50:51], v[10:11] op_sel_hi:[1,0]
v_cvt_pk_bf16_f32 v52, v44, v45
v_cvt_pk_bf16_f32 v53, v46, v47
v_cvt_pk_bf16_f32 v54, v48, v49
v_cvt_pk_bf16_f32 v55, v50, v51
s_not_b64 exec, s[40:41]
ds_write_b128 v9, v[52:55] offset:1024
s_mov_b64 exec, -1
v_mov_b32 v91, 0
v_mov_b32_dpp v64, v52 quad_perm:[0,1,0,1] row_mask:0xf bank_mask:0xf
v_mov_b32_dpp v65, v53 quad_perm:[0,1,0,1] row_mask:0xf bank_mask:0xf
v_mov_b32_dpp v66, v54 quad_perm:[0,1,0,1] row_mask:0xf bank_mask:0xf
v_mov_b32_dpp v67, v55 quad_perm:[0,1,0,1] row_mask:0xf bank_mask:0xf
s_nop 1
v_smfmac_f32_16x16x64_bf16 v[76:79], v[64:67], a[144:151], v1
v_mov_b32_dpp v10, v14 quad_perm:[2,3,2,3] row_mask:0xf bank_mask:0xf
v_cndmask_b32 v16, v14, v100, s[40:41]
v_smfmac_f32_16x16x64_bf16 v[80:83], v[64:67], a[176:183], v1
v_mov_b32_dpp v11, v15 quad_perm:[2,3,2,3] row_mask:0xf bank_mask:0xf
v_cndmask_b32 v17, v15, v101, s[40:41]
s_waitcnt lgkmcnt(0)
s_barrier
ds_read_b128 v[68:71], v9 offset:1536
ds_read_b128 v[56:59], v9 offset:0
ds_read_b128 v[60:63], v9 offset:512
v_smfmac_f32_16x16x64_bf16 v[84:87], v[64:67], a[208:215], v1
v_cndmask_b32 v18, v10, v102, s[40:41]
v_smfmac_f32_16x16x64_bf16 v[88:91], v[64:67], a[240:247], v1
v_cndmask_b32 v19, v11, v103, s[40:41]
s_waitcnt lgkmcnt(2)
v_smfmac_f32_16x16x64_bf16 v[76:79], v[68:71], a[152:159], v1
s_waitcnt lgkmcnt(1)
v_smfmac_f32_16x16x64_bf16 v[76:79], v[56:59], a[128:135], v1
s_waitcnt lgkmcnt(0)
v_smfmac_f32_16x16x64_bf16 v[76:79], v[60:63], a[136:143], v1
v_smfmac_f32_16x16x64_bf16 v[80:83], v[68:71], a[184:191], v1
s_nop 2
v_smfmac_f32_16x16x64_bf16 v[80:83], v[56:59], a[160:167], v1
s_nop 2
v_cvt_pk_bf16_f32 v92, v76, v77
v_smfmac_f32_16x16x64_bf16 v[80:83], v[60:63], a[168:175], v1
v_cvt_pk_bf16_f32 v93, v78, v79
v_and_or_b32 v92, v92, -2, s21
buffer_store_dwordx2 v[92:93], v5, s[8:11], s19 offen sc1
v_smfmac_f32_16x16x64_bf16 v[84:87], v[68:71], a[216:223], v1
s_nop 2
v_smfmac_f32_16x16x64_bf16 v[84:87], v[56:59], a[192:199], v1
s_nop 2
v_cvt_pk_bf16_f32 v94, v80, v81
v_smfmac_f32_16x16x64_bf16 v[84:87], v[60:63], a[200:207], v1
v_cvt_pk_bf16_f32 v95, v82, v83
v_and_or_b32 v94, v94, -2, s21
s_add_u32 s32, s19, 8192
buffer_store_dwordx2 v[94:95], v5, s[8:11], s32 offen sc1
v_smfmac_f32_16x16x64_bf16 v[88:91], v[68:71], a[248:255], v1
s_nop 2
v_smfmac_f32_16x16x64_bf16 v[88:91], v[56:59], a[224:231], v1
s_nop 2
v_cvt_pk_bf16_f32 v96, v84, v85
v_smfmac_f32_16x16x64_bf16 v[88:91], v[60:63], a[232:239], v1
v_cvt_pk_bf16_f32 v97, v86, v87
v_and_or_b32 v96, v96, -2, s21
s_add_u32 s32, s19, 4096
buffer_store_dwordx2 v[96:97], v5, s[8:11], s32 offen sc1
s_nop 4
v_cvt_pk_bf16_f32 v98, v88, v89
v_cvt_pk_bf16_f32 v99, v90, v91
v_and_or_b32 v98, v98, -2, s21
s_add_u32 s32, s19, 12288
buffer_store_dwordx2 v[98:99], v5, s[8:11], s32 offen sc1
s_mov_b32 s36, 0
v_mov_b32 v28, 0
v_mov_b32 v29, 0
v_mov_b32 v30, 0
v_mov_b32 v31, 0
v_mov_b32 v32, 0
v_mov_b32 v33, 0
v_mov_b32 v34, 0
v_mov_b32 v35, 0
v_mov_b32 v36, 0
v_mov_b32 v37, 0
v_mov_b32 v38, 0
v_mov_b32 v39, 0
v_mov_b32 v40, 0
v_mov_b32 v41, 0
v_mov_b32 v42, 0
v_mov_b32 v43, 0
v_mov_b32 v12, 0
v_mov_b32 v13, 0
v_mov_b32 v14, 0
v_mov_b32 v15, 0
v_mov_b32 v24, 0
v_mov_b32 v25, 0
v_mov_b32 v26, 0
v_mov_b32 v27, 0
v_xor_b32 v2, 8192, v2
s_xor_b32 s75, s75, 8192
ds_read_b128 v[76:79], v4 offset:0
ds_read_b128 v[80:83], v4 offset:1024
ds_read_b128 v[84:87], v4 offset:2048
ds_read_b128 v[88:91], v4 offset:3072
ds_read_b128 v[92:95], v4 offset:4096
ds_read_b128 v[96:99], v4 offset:5120
ds_read_b128 v[100:103], v4 offset:6144
ds_read_b128 v[104:107], v4 offset:7168
ds_read_b128 v[108:111], v4 offset:8192
ds_read_b128 v[112:115], v4 offset:9216
ds_read_b128 v[116:119], v4 offset:12288
ds_read_b128 v[120:123], v4 offset:13312
s_mov_b32 s36, 0
s_mov_b32 s82, s27
s_add_u32 s25, s25, 262144
s_add_u32 s26, s26, 262144
s_add_u32 s27, s27, 131072
s_sub_u32 s24, s78, 0
s_mov_b32 s78, s22
s_add_u32 s77, s77, 8192
s_and_b32 s77, s77, 0x7fff
s_add_u32 s22, s77, s81
s_add_u32 s18, s18, 1
s_xor_b32 s21, s21, 1
s_cmp_eq_u32 s29, 0
s_cbranch_scc1 RDY_88_P
s_mov_b32 s29, 0
s_waitcnt vmcnt(4)
s_nop 1
v_min_u32_dpp v6, v6, v6 quad_perm:[1,0,3,2] row_mask:0xf bank_mask:0xf
s_nop 1
v_min_u32_dpp v6, v6, v6 quad_perm:[2,3,0,1] row_mask:0xf bank_mask:0xf
s_nop 1
v_min_u32_dpp v6, v6, v6 row_half_mirror row_mask:0xf bank_mask:0xf
s_nop 0
v_readfirstlane_b32 s85, v6
s_nop 3
s_lshl_b32 s85, s85, 2
RDY_88_P:
s_add_u32 s32, s18, 1
s_min_u32 s32, s32, 63
s_cmp_ge_u32 s32, s85
s_cbranch_scc1 RDY_88_S
RDY_88:
s_barrier
s_nop 3
buffer_load_dwordx4 v[60:63], v3, s[8:11], s23 offen offset:0 sc1
s_nop 15
buffer_load_dwordx4 v[64:67], v3, s[8:11], s23 offen offset:1024 sc1
s_nop 15
buffer_load_dwordx4 v[60:63], v3, s[8:11], s23 offen offset:0 sc1
buffer_load_dwordx4 v[64:67], v3, s[8:11], s23 offen offset:1024 sc1
s_waitcnt lgkmcnt(0)
s_branch CH_RB_2s
CH_RBRETRY_2s:
buffer_load_dwordx4 v[60:63], v3, s[8:11], s23 offen offset:0 sc1
buffer_load_dwordx4 v[64:67], v3, s[8:11], s23 offen offset:1024 sc1
s_add_u32 s36, s36, 1
s_cmp_gt_u32 s36, 65536
s_cbranch_scc1 CH_RBOK_2s
s_branch CH_RB_2s
CH_RBLRETRY_2s:
buffer_load_dwordx4 v[64:67], v3, s[8:11], s23 offen offset:1024 sc1
s_add_u32 s36, s36, 1
s_cmp_gt_u32 s36, 65536
s_cbranch_scc1 CH_RBLOK_2s
s_waitcnt vmcnt(1)
s_branch CH_RBL_2s
CH_DONE_2s:
s_waitcnt lgkmcnt(0)
s_nop 4
v_add_f32 v12, v12, v14
v_add_f32 v13, v13, v15
v_add_f32 v24, v24, v26
v_add_f32 v25, v25, v27
v_cvt_pk_bf16_f32 v14, v12, v13
v_cvt_pk_bf16_f32 v15, v24, v25
s_nop 1
v_mov_b32_dpp v10, v14 quad_perm:[2,3,2,3] row_mask:0xf bank_mask:0xf
v_mov_b32_dpp v11, v15 quad_perm:[2,3,2,3] row_mask:0xf bank_mask:0xf
v_cndmask_b32 v36, v14, v100, s[40:41]
v_cndmask_b32 v37, v15, v101, s[40:41]
v_cndmask_b32 v38, v10, v102, s[40:41]
v_cndmask_b32 v39, v11, v103, s[40:41]
buffer_store_dwordx4 v[36:39], v3, s[8:11], s27 offen sc1
s_barrier
s_branch L_FIN
RDY_86_S:
s_add_u32 s32, s18, 1
s_min_u32 s32, s32, 63
s_lshr_b32 s32, s32, 2
s_add_u32 s32, s32, 1
v_lshrrev_b32 v10, 3, v0
v_and_b32 v11, 3, v10
v_bfe_u32 v10, v10, 2, 1
v_lshlrev_b32 v10, 13, v10
v_lshl_add_u32 v10, v11, 7, v10
s_mov_b32 s35, 0
POLL_KV_89:
s_cmp_lg_u32 s37, 0
s_cbranch_scc1 POLL_KV_89_E
buffer_load_dword v11, v10, s[8:11], s89 offen sc1
s_add_u32 s35, s35, 1
s_cmp_gt_u32 s35, 65536
s_cselect_b32 s37, 1, 0
s_waitcnt vmcnt(0)
v_cmp_gt_u32 vcc, s32, v11
s_cbranch_vccz POLL_KV_89_E
s_branch POLL_KV_89
POLL_KV_89_E:
s_nop 1
v_min_u32_dpp v11, v11, v11 quad_perm:[1,0,3,2] row_mask:0xf bank_mask:0xf
s_nop 1
v_min_u32_dpp v11, v11, v11 quad_perm:[2,3,0,1] row_mask:0xf bank_mask:0xf
s_nop 1
v_min_u32_dpp v11, v11, v11 row_half_mirror row_mask:0xf bank_mask:0xf
s_nop 0
v_readfirstlane_b32 s85, v11
s_nop 3
s_lshl_b32 s85, s85, 2
s_branch RDY_86
RDY_88_S:
s_add_u32 s32, s18, 1
s_min_u32 s32, s32, 63
s_lshr_b32 s32, s32, 2
s_add_u32 s32, s32, 1
v_lshrrev_b32 v10, 3, v0
v_and_b32 v11, 3, v10
v_bfe_u32 v10, v10, 2, 1
v_lshlrev_b32 v10, 13, v10
v_lshl_add_u32 v10, v11, 7, v10
s_mov_b32 s35, 0
POLL_KV_90:
s_cmp_lg_u32 s37, 0
s_cbranch_scc1 POLL_KV_90_E
buffer_load_dword v11, v10, s[8:11], s89 offen sc1
s_add_u32 s35, s35, 1
s_cmp_gt_u32 s35, 65536
s_cselect_b32 s37, 1, 0
s_waitcnt vmcnt(0)
v_cmp_gt_u32 vcc, s32, v11
s_cbranch_vccz POLL_KV_90_E
s_branch POLL_KV_90
POLL_KV_90_E:
s_nop 1
v_min_u32_dpp v11, v11, v11 quad_perm:[1,0,3,2] row_mask:0xf bank_mask:0xf
s_nop 1
v_min_u32_dpp v11, v11, v11 quad_perm:[2,3,0,1] row_mask:0xf bank_mask:0xf
s_nop 1
v_min_u32_dpp v11, v11, v11 row_half_mirror row_mask:0xf bank_mask:0xf
s_nop 0
v_readfirstlane_b32 s85, v11
s_nop 3
s_lshl_b32 s85, s85, 2
s_branch RDY_88
CH_W3s:
s_mov_b32 s18, 0
s_mov_b32 s29, 0
s_add_u32 s32, s18, 1
s_min_u32 s32, s32, 63
s_cmp_ge_u32 s32, s85
s_cbranch_scc1 RDY_91_S
RDY_91:
s_mov_b32 s75, 147456
s_lshl_b32 s26, s16, 13
s_add_u32 s26, s26, 18743296
s_add_u32 m0, s75, 6144
s_add_u32 s32, s26, 6144
buffer_load_dwordx4 v3, s[8:11], s32 offen  lds
s_add_u32 m0, s75, 7168
s_add_u32 s32, s26, 7168
buffer_load_dwordx4 v3, s[8:11], s32 offen  lds
s_mov_b32 s34, 0x05040100
s_mov_b32 s35, 0x07060302
v_perm_b32 v68, v17, v16, s34
v_perm_b32 v69, v19, v18, s34
v_perm_b32 v70, v17, v16, s35
v_perm_b32 v71, v19, v18, s35
v_perm_b32 v72, v13, v12, s34
v_perm_b32 v73, v15, v14, s34
v_perm_b32 v74, v13, v12, s35
v_perm_b32 v75, v15, v14, s35
s_mov_b32 s18, 0
s_mov_b32 s75, 155648
s_and_b32 s32, s18, 3
s_lshl_b32 s33, s32, 18
s_lshl_b32 s34, s16, 7
s_add_u32 s19, s33, s34
s_add_u32 s19, s19, 90374144
s_lshl_b32 s35, s16, 13
s_add_u32 s20, s33, s35
s_add_u32 s20, s20, 90050560
s_add_u32 s32, s18, 3
s_and_b32 s32, s32, 3
s_lshl_b32 s33, s32, 18
s_mov_b32 s21, 0
s_lshr_b32 s34, s16, 3
s_lshl_b32 s34, s34, 11
s_and_b32 s35, s16, 1
s_lshl_b32 s35, s35, 9
s_add_u32 s34, s34, s35
s_bfe_u32 s35, s16, 0x20001
s_lshl_b32 s35, s35, 6
s_add_u32 s34, s34, s35
s_lshl_b32 s33, s32, 13
s_add_u32 s24, s33, s34
s_add_u32 s24, s24, 91227136
s_add_u32 s32, s18, 1
s_and_b32 s32, s32, 3
s_lshl_b32 s33, s32, 13
s_add_u32 s22, s33, s34
s_add_u32 s22, s22, 91227136
s_add_u32 s23, s33, 91101184
s_lshl_b32 s32, s18, 5
s_add_u32 s32, s32, s16
s_lshl_b32 s33, s32, 13
s_add_u32 s25, s33, 35526656
s_add_u32 s26, s33, 19005440
s_lshl_b32 s33, s32, 12
s_add_u32 s27, s33, 52300800
s_lshl_b32 s33, s32, 11
s_add_u32 s28, s33, 60818944
s_mov_b32 s82, s27
s_sub_u32 s24, s24, 1024
s_mov_b32 s76, 0
s_mov_b32 s77, 8192
s_mov_b32 s79, s19
s_mov_b32 s80, s20
s_sub_u32 s81, s22, 8192
s_mov_b32 s78, s81
v_lshlrev_b32 v6, 4, v0
ds_read_b128 v[76:79], v4 offset:8192
ds_read_b128 v[80:83], v4 offset:9216
ds_read_b128 v[84:87], v4 offset:10240
ds_read_b128 v[88:91], v4 offset:11264
ds_read_b128 v[92:95], v4 offset:12288
ds_read_b128 v[96:99], v4 offset:13312
ds_read_b128 v[100:103], v4 offset:14336
ds_read_b128 v[104:107], v4 offset:15360
ds_read_b128 v[108:111], v4 offset:16384
ds_read_b128 v[112:115], v4 offset:17408
ds_read_b128 v[116:119], v4 offset:20480
ds_read_b128 v[120:123], v4 offset:21504
v_mov_b32 v124, -1
v_lshrrev_b32 v125, 8, v0
v_bfe_u32 v126, v0, 7, 1
v_lshl_add_u32 v125, v125, 2, v126
v_bfe_u32 v126, v0, 1, 6
v_lshl_add_u32 v125, v125, 8, v126
v_mov_b32 v28, 0
v_mov_b32 v29, 0
v_mov_b32 v30, 0
v_mov_b32 v31, 0
v_mov_b32 v32, 0
v_mov_b32 v33, 0
v_mov_b32 v34, 0
v_mov_b32 v35, 0
v_mov_b32 v36, 0
v_mov_b32 v37, 0
v_mov_b32 v38, 0
v_mov_b32 v39, 0
v_mov_b32 v40, 0
v_mov_b32 v41, 0
v_mov_b32 v42, 0
v_mov_b32 v43, 0
v_mov_b32 v12, 0
v_mov_b32 v13, 0
v_mov_b32 v14, 0
v_mov_b32 v15, 0
v_mov_b32 v24, 0
v_mov_b32 v25, 0
v_mov_b32 v26, 0
v_mov_b32 v27, 0
s_waitcnt vmcnt(0)
s_waitcnt lgkmcnt(0)
s_mov_b32 s36, 0
v_min_u32 v68, 0xfffffffe, v68
v_min_u32 v69, 0xfffffffe, v69
v_min_u32 v70, 0xfffffffe, v70
v_min_u32 v71, 0xfffffffe, v71
v_min_u32 v72, 0xfffffffe, v72
v_min_u32 v73, 0xfffffffe, v73
v_min_u32 v74, 0xfffffffe, v74
v_min_u32 v75, 0xfffffffe, v75
.p2align 6
CH_BASE_3s:
.fill (((8 - (. - CH_BASE_3s)) & 15) >> 2), 4, 0xbf800000
CH_RB_3s:
s_waitcnt vmcnt(3)
CH_RBE_3s:
v_max3_u32 v10, v68, v69, v70
v_max_u32 v10, v10, v71
v_cmp_eq_u32 vcc, -1, v10
ds_write_b128 v3, v[68:71] offset:6144
s_cbranch_vccnz CH_RBRETRY_3s
CH_RBOK_3s:
v_smfmac_f32_16x16x64_bf16 v[28:31], v[68:71], v[76:83], v1
v_smfmac_f32_16x16x64_bf16 v[32:35], v[68:71], v[176:183], v1
ds_read_b128 v[76:79], v4 offset:24576
v_smfmac_f32_16x16x64_bf16 v[36:39], v[68:71], v[84:91], v1
ds_read_b128 v[80:83], v4 offset:25600
v_smfmac_f32_16x16x64_bf16 v[40:43], v[68:71], v[240:247], v1
s_waitcnt vmcnt(2)
CH_RBL_3s:
v_max3_u32 v10, v72, v73, v74
v_max_u32 v10, v10, v75
v_cmp_eq_u32 vcc, -1, v10
ds_write_b128 v3, v[72:75] offset:7168
s_cbranch_vccnz CH_RBLRETRY_3s
CH_RBLOK_3s:
v_smfmac_f32_16x16x64_bf16 v[28:31], v[72:75], v[92:99], v1
v_smfmac_f32_16x16x64_bf16 v[32:35], v[72:75], v[184:191], v1
v_smfmac_f32_16x16x64_bf16 v[36:39], v[72:75], v[100:107], v1
v_smfmac_f32_16x16x64_bf16 v[40:43], v[72:75], v[248:255], v1
s_waitcnt lgkmcnt(0)
s_barrier
ds_read_b128 v[44:47], v3 offset:0
ds_read_b128 v[48:51], v3 offset:1024
buffer_store_dwordx4 v[16:19], v3, s[8:11], s82 offen sc1
v_smfmac_f32_16x16x64_bf16 v[12:15], v[68:71], a[48:55], v1
ds_read_b128 v[52:55], v3 offset:2048
v_smfmac_f32_16x16x64_bf16 v[24:27], v[68:71], a[112:119], v1
ds_read_b128 v[56:59], v3 offset:3072
v_smfmac_f32_16x16x64_bf16 v[12:15], v[72:75], a[56:63], v1
ds_read_b128 v[60:63], v3 offset:4096
v_smfmac_f32_16x16x64_bf16 v[24:27], v[72:75], a[120:127], v1
ds_read_b128 v[64:67], v3 offset:5120
buffer_load_dwordx4 v[16:19], v3, s[8:11], s25 offen
s_waitcnt lgkmcnt(5)
v_smfmac_f32_16x16x64_bf16 v[28:31], v[44:47], v[108:115], v1
ds_read_b128 v[84:87], v4 offset:28672
v_smfmac_f32_16x16x64_bf16 v[32:35], v[44:47], v[128:135], v1
ds_read_b128 v[88:91], v4 offset:29696
s_waitcnt lgkmcnt(6)
v_smfmac_f32_16x16x64_bf16 v[28:31], v[48:51], v[116:123], v1
ds_read_b128 v[92:95], v4 offset:0
v_smfmac_f32_16x16x64_bf16 v[32:35], v[48:51], v[136:143], v1
ds_read_b128 v[96:99], v4 offset:1024
buffer_load_dwordx4 v[20:23], v3, s[8:11], s25 offen offset:1024
s_waitcnt lgkmcnt(7)
v_smfmac_f32_16x16x64_bf16 v[28:31], v[52:55], v[76:83], v1
ds_read_b128 v[100:103], v4 offset:4096
v_smfmac_f32_16x16x64_bf16 v[32:35], v[52:55], v[144:151], v1
ds_read_b128 v[104:107], v4 offset:5120
s_waitcnt lgkmcnt(8)
s_waitcnt lgkmcnt(4)
v_smfmac_f32_16x16x64_bf16 v[28:31], v[56:59], v[84:91], v1
ds_read_b128 v[108:111], v4 offset:18432
v_smfmac_f32_16x16x64_bf16 v[32:35], v[56:59], v[152:159], v1
ds_read_b128 v[112:115], v4 offset:19456
s_waitcnt lgkmcnt(4)
v_smfmac_f32_16x16x64_bf16 v[28:31], v[60:63], v[92:99], v1
ds_read_b128 v[116:119], v4 offset:22528
v_smfmac_f32_16x16x64_bf16 v[32:35], v[60:63], v[160:167], v1
ds_read_b128 v[120:123], v4 offset:23552
s_waitcnt lgkmcnt(4)
v_smfmac_f32_16x16x64_bf16 v[28:31], v[64:67], v[100:107], v1
ds_read_b128 v[76:79], v4 offset:26624
v_smfmac_f32_16x16x64_bf16 v[32:35], v[64:67], v[168:175], v1
ds_read_b128 v[80:83], v4 offset:27648
s_waitcnt lgkmcnt(4)
v_smfmac_f32_16x16x64_bf16 v[36:39], v[44:47], v[108:115], v1
ds_read_b128 v[84:87], v4 offset:30720
s_nop 1
v_smfmac_f32_16x16x64_bf16 v[40:43], v[44:47], v[192:199], v1
ds_read_b128 v[88:91], v4 offset:31744
s_nop 1
s_waitcnt lgkmcnt(4)
v_smfmac_f32_16x16x64_bf16 v[36:39], v[48:51], v[116:123], v1
ds_read_b128 v[92:95], v4 offset:2048
v_smfmac_f32_16x16x64_bf16 v[40:43], v[48:51], v[200:207], v1
ds_read_b128 v[96:99], v4 offset:3072
s_waitcnt lgkmcnt(4)
v_smfmac_f32_16x16x64_bf16 v[36:39], v[52:55], v[76:83], v1
ds_read_b128 v[100:103], v4 offset:6144
s_add_u32 s23, s77, 91101184
v_smfmac_f32_16x16x64_bf16 v[40:43], v[52:55], v[208:215], v1
ds_read_b128 v[104:107], v4 offset:7168
s_waitcnt lgkmcnt(4)
v_smfmac_f32_16x16x64_bf16 v[36:39], v[56:59], v[84:91], v1
ds_read_b128 v[108:111], v2 offset:0
v_smfmac_f32_16x16x64_bf16 v[40:43], v[56:59], v[216:223], v1
ds_read_b128 v[112:115], v2 offset:1024
s_waitcnt lgkmcnt(4)
v_smfmac_f32_16x16x64_bf16 v[36:39], v[60:63], v[92:99], v1
ds_read_b128 v[116:119], v2 offset:2048
v_smfmac_f32_16x16x64_bf16 v[40:43], v[60:63], v[224:231], v1
ds_read_b128 v[120:123], v2 offset:3072
s_waitcnt lgkmcnt(4)
v_smfmac_f32_16x16x64_bf16 v[36:39], v[64:67], v[100:107], v1
ds_read_b128 v[76:79], v2 offset:4096
v_smfmac_f32_16x16x64_bf16 v[40:43], v[64:67], v[232:239], v1
buffer_store_dword v124, v125, s[8:11], s24 offen sc1
v_pk_add_f32 v[28:29], v[28:29], v[30:31]
v_pk_add_f32 v[32:33], v[32:33], v[34:35]
v_cvt_pk_bf16_f32 v34, v28, v29
v_cvt_pk_bf16_f32 v35, v32, v33
ds_write_b64 v7, v[34:35] offset:0
s_nop 0
v_pk_add_f32 v[36:37], v[36:37], v[38:39]
v_pk_add_f32 v[40:41], v[40:41], v[42:43]
v_cvt_pk_bf16_f32 v32, v36, v37
v_cvt_pk_bf16_f32 v33, v40, v41
ds_write_b64 v7, v[32:33] offset:128
v_smfmac_f32_16x16x64_bf16 v[12:15], v[44:47], a[0:7], v1
ds_read_b128 v[80:83], v2 offset:5120
v_smfmac_f32_16x16x64_bf16 v[24:27], v[44:47], a[64:71], v1
ds_read_b128 v[84:87], v2 offset:6144
v_smfmac_f32_16x16x64_bf16 v[12:15], v[48:51], a[8:15], v1
ds_read_b128 v[88:91], v2 offset:7168
v_smfmac_f32_16x16x64_bf16 v[24:27], v[48:51], a[72:79], v1
s_waitcnt lgkmcnt(3)
s_barrier
ds_read_b64_tr_b16 v[92:93], v8 offset:0
ds_read_b64_tr_b16 v[94:95], v8 offset:256
v_smfmac_f32_16x16x64_bf16 v[12:15], v[52:55], a[16:23], v1
ds_read_b64_tr_b16 v[96:97], v8 offset:512
ds_read_b64_tr_b16 v[98:99], v8 offset:768
v_smfmac_f32_16x16x64_bf16 v[24:27], v[52:55], a[80:87], v1
ds_read_b64_tr_b16 v[100:101], v8 offset:128
ds_read_b64_tr_b16 v[102:103], v8 offset:384
v_smfmac_f32_16x16x64_bf16 v[12:15], v[56:59], a[24:31], v1
ds_read_b64_tr_b16 v[104:105], v8 offset:640
ds_read_b64_tr_b16 v[106:107], v8 offset:896
s_add_u32 m0, s75, 6144
s_add_u32 s32, s26, 6144
buffer_load_dwordx4 v3, s[8:11], s32 offen  lds
v_smfmac_f32_16x16x64_bf16 v[24:27], v[56:59], a[88:95], v1
v_mov_b32 v28, s42
v_smfmac_f32_16x16x64_bf16 v[12:15], v[60:63], a[32:39], v1
v_mov_b32 v29, s42
v_smfmac_f32_16x16x64_bf16 v[24:27], v[60:63], a[96:103], v1
v_mov_b32 v30, s42
v_smfmac_f32_16x16x64_bf16 v[12:15], v[64:67], a[40:47], v1
v_mov_b32 v31, s42
v_smfmac_f32_16x16x64_bf16 v[24:27], v[64:67], a[104:111], v1
s_waitcnt vmcnt(5)
s_waitcnt lgkmcnt(8)
s_cmp_ge_u32 s18, 63
s_cbranch_scc1 CH_DONE_3s
s_waitcnt lgkmcnt(6)
v_mfma_f32_16x16x32_bf16 v[36:39], v[108:111], v[92:95], 0
s_nop 0
s_waitcnt lgkmcnt(4)
v_mfma_f32_16x16x32_bf16 v[36:39], v[112:115], v[96:99], v[36:39]
s_nop 0
s_waitcnt lgkmcnt(2)
v_mfma_f32_16x16x32_bf16 v[36:39], v[116:119], v[100:103], v[36:39]
s_nop 0
s_waitcnt lgkmcnt(0)
v_mfma_f32_16x16x32_bf16 v[36:39], v[120:123], v[104:107], v[36:39]
s_nop 0
v_mfma_f32_16x16x32_bf16 v[40:43], v[76:79], v[92:95], 0
s_add_u32 m0, s75, 7168
s_add_u32 s32, s26, 7168
buffer_load_dwordx4 v3, s[8:11], s32 offen  lds
v_add_f32 v12, v12, v14
v_add_f32 v13, v13, v15
v_mfma_f32_16x16x32_bf16 v[40:43], v[80:83], v[96:99], v[40:43]
v_add_f32 v24, v24, v26
v_add_f32 v25, v25, v27
v_mfma_f32_16x16x32_bf16 v[40:43], v[84:87], v[100:103], v[40:43]
v_cvt_pk_bf16_f32 v14, v12, v13
v_mfma_f32_16x16x32_bf16 v[40:43], v[88:91], v[104:107], v[40:43]
v_cvt_pk_bf16_f32 v15, v24, v25
v_mfma_f32_16x16x32_bf16 v[124:127], v[92:95], v[92:95], 0
v_max3_f32 v10, v36, v37, v38
v_mov_b32 v25, 0
s_nop 1
v_mfma_f32_16x16x32_bf16 v[124:127], v[96:99], v[96:99], v[124:127]
v_max_f32 v10, v10, v39
v_mov_b32 v26, 0
s_nop 1
v_mfma_f32_16x16x32_bf16 v[124:127], v[100:103], v[100:103], v[124:127]
v_max3_f32 v10, v10, v40, v41
v_mfma_f32_16x16x32_bf16 v[124:127], v[104:107], v[104:107], v[124:127]
v_max3_f32 v10, v10, v42, v43
s_not_b64 vcc, s[40:41]
v_cndmask_b32_dpp v36, v40, v36, vcc quad_perm:[0,1,0,1] row_mask:0xf bank_mask:0xf
v_cndmask_b32_dpp v37, v41, v37, vcc quad_perm:[0,1,0,1] row_mask:0xf bank_mask:0xf
v_mov_b32_dpp v10, v10 quad_perm:[0,1,0,1] row_mask:0xf bank_mask:0xf
v_cndmask_b32_dpp v38, v42, v38, vcc quad_perm:[0,1,0,1] row_mask:0xf bank_mask:0xf
v_cndmask_b32_dpp v39, v43, v39, vcc quad_perm:[0,1,0,1] row_mask:0xf bank_mask:0xf
v_mov_b32 v76, 0
v_max_f32_dpp v125, v126, v10 quad_perm:[0,1,0,1] row_mask:0xf bank_mask:0xf
v_max_f32_dpp v10, v127, v10 quad_perm:[0,1,0,1] row_mask:0xf bank_mask:0xf
v_max_f32 v124, v125, v10
v_mov_b32 v11, v124
v_mov_b32 v77, 0
v_mov_b32 v78, 0
v_permlane32_swap_b32 v124, v11
v_max_f32 v124, v124, v11
v_mov_b32 v11, v124
v_mov_b32 v79, 0
v_mov_b32 v80, 0
v_permlane16_swap_b32 v124, v11
v_max_f32 v124, v124, v11
v_mul_f32 v10, s30, v124
v_pk_fma_f32 v[126:127], v[126:127], s[30:31], v[10:11] op_sel_hi:[1,1,0] neg_lo:[0,0,1] neg_hi:[0,0,1]
v_pk_fma_f32 v[36:37], v[36:37], s[30:31], v[10:11] op_sel_hi:[1,1,0] neg_lo:[0,0,1] neg_hi:[0,0,1]
v_pk_fma_f32 v[38:39], v[38:39], s[30:31], v[10:11] op_sel_hi:[1,1,0] neg_lo:[0,0,1] neg_hi:[0,0,1]
v_exp_f32 v126, v126
v_exp_f32 v127, v127
v_exp_f32 v36, v36
v_cvt_pk_bf16_f32 v24, v126, v127
v_cvt_pk_bf16_f32 v27, v126, v127
v_exp_f32 v37, v37
v_exp_f32 v38, v38
v_mfma_f32_16x16x16_bf16 v[68:71], v[28:29], v[24:25], 0
v_exp_f32 v39, v39
v_cvt_pk_bf16_f32 v32, v36, v37
v_cvt_pk_bf16_f32 v33, v38, v39
v_mfma_f32_16x16x16_bf16 v[44:47], v[14:15], v[24:25], 0
v_mov_b32_dpp v34, v32 quad_perm:[2,3,2,3] row_mask:0xf bank_mask:0xf
v_mov_b32_dpp v35, v33 quad_perm:[2,3,2,3] row_mask:0xf bank_mask:0xf
v_mfma_f32_16x16x16_bf16 v[48:51], v[14:15], v[26:27], 0
s_waitcnt vmcnt(3)
v_mfma_f32_16x16x32_bf16 v[68:71], v[28:31], v[32:35], v[68:71]
v_mov_b32 v81, 0
v_mov_b32 v82, 0
v_mfma_f32_16x16x32_bf16 v[44:47], v[16:19], v[32:35], v[44:47]
v_mov_b32 v83, 0
v_mov_b32 v84, 0
v_mfma_f32_16x16x32_bf16 v[48:51], v[20:23], v[32:35], v[48:51]
v_mov_b32 v85, 0
v_mov_b32 v86, 0
v_rcp_f32 v10, v68
v_mov_b32 v87, 0
v_mov_b32 v88, 0
v_mov_b32 v89, 0
v_pk_mul_f32 v[44:45], v[44:45], v[10:11] op_sel_hi:[1,0]
v_pk_mul_f32 v[46:47], v[46:47], v[10:11] op_sel_hi:[1,0]
v_mov_b32 v90, 0
v_pk_mul_f32 v[48:49], v[48:49], v[10:11] op_sel_hi:[1,0]
v_pk_mul_f32 v[50:51], v[50:51], v[10:11] op_sel_hi:[1,0]
v_cvt_pk_bf16_f32 v52, v44, v45
v_cvt_pk_bf16_f32 v53, v46, v47
v_cvt_pk_bf16_f32 v54, v48, v49
v_cvt_pk_bf16_f32 v55, v50, v51
s_not_b64 exec, s[40:41]
ds_write_b128 v9, v[52:55] offset:1536
s_mov_b64 exec, -1
v_mov_b32 v91, 0
v_mov_b32_dpp v68, v52 quad_perm:[0,1,0,1] row_mask:0xf bank_mask:0xf
v_mov_b32_dpp v69, v53 quad_perm:[0,1,0,1] row_mask:0xf bank_mask:0xf
v_mov_b32_dpp v70, v54 quad_perm:[0,1,0,1] row_mask:0xf bank_mask:0xf
v_mov_b32_dpp v71, v55 quad_perm:[0,1,0,1] row_mask:0xf bank_mask:0xf
s_nop 1
v_smfmac_f32_16x16x64_bf16 v[76:79], v[68:71], a[152:159], v1
v_mov_b32_dpp v10, v14 quad_perm:[2,3,2,3] row_mask:0xf bank_mask:0xf
v_cndmask_b32 v16, v14, v104, s[40:41]
v_smfmac_f32_16x16x64_bf16 v[80:83], v[68:71], a[184:191], v1
v_mov_b32_dpp v11, v15 quad_perm:[2,3,2,3] row_mask:0xf bank_mask:0xf
v_cndmask_b32 v17, v15, v105, s[40:41]
s_waitcnt lgkmcnt(0)
s_barrier
ds_read_b128 v[56:59], v9 offset:0
ds_read_b128 v[60:63], v9 offset:512
ds_read_b128 v[64:67], v9 offset:1024
v_smfmac_f32_16x16x64_bf16 v[84:87], v[68:71], a[216:223], v1
v_cndmask_b32 v18, v10, v106, s[40:41]
v_smfmac_f32_16x16x64_bf16 v[88:91], v[68:71], a[248:255], v1
v_cndmask_b32 v19, v11, v107, s[40:41]
s_waitcnt lgkmcnt(2)
v_smfmac_f32_16x16x64_bf16 v[76:79], v[56:59], a[128:135], v1
s_waitcnt lgkmcnt(1)
v_smfmac_f32_16x16x64_bf16 v[76:79], v[60:63], a[136:143], v1
s_waitcnt lgkmcnt(0)
v_smfmac_f32_16x16x64_bf16 v[76:79], v[64:67], a[144:151], v1
v_smfmac_f32_16x16x64_bf16 v[80:83], v[56:59], a[160:167], v1
s_nop 2
v_smfmac_f32_16x16x64_bf16 v[80:83], v[60:63], a[168:175], v1
s_nop 2
v_cvt_pk_bf16_f32 v92, v76, v77
v_smfmac_f32_16x16x64_bf16 v[80:83], v[64:67], a[176:183], v1
v_cvt_pk_bf16_f32 v93, v78, v79
v_and_or_b32 v92, v92, -2, s21
buffer_store_dwordx2 v[92:93], v5, s[8:11], s19 offen sc1
v_smfmac_f32_16x16x64_bf16 v[84:87], v[56:59], a[192:199], v1
s_nop 2
v_smfmac_f32_16x16x64_bf16 v[84:87], v[60:63], a[200:207], v1
s_nop 2
v_cvt_pk_bf16_f32 v94, v80, v81
v_smfmac_f32_16x16x64_bf16 v[84:87], v[64:67], a[208:215], v1
v_cvt_pk_bf16_f32 v95, v82, v83
v_and_or_b32 v94, v94, -2, s21
s_add_u32 s32, s19, 8192
buffer_store_dwordx2 v[94:95], v5, s[8:11], s32 offen sc1
v_smfmac_f32_16x16x64_bf16 v[88:91], v[56:59], a[224:231], v1
s_nop 2
v_smfmac_f32_16x16x64_bf16 v[88:91], v[60:63], a[232:239], v1
s_nop 2
v_cvt_pk_bf16_f32 v96, v84, v85
v_smfmac_f32_16x16x64_bf16 v[88:91], v[64:67], a[240:247], v1
v_cvt_pk_bf16_f32 v97, v86, v87
v_and_or_b32 v96, v96, -2, s21
s_add_u32 s32, s19, 4096
buffer_store_dwordx2 v[96:97], v5, s[8:11], s32 offen sc1
s_nop 4
v_cvt_pk_bf16_f32 v98, v88, v89
v_cvt_pk_bf16_f32 v99, v90, v91
v_and_or_b32 v98, v98, -2, s21
s_add_u32 s32, s19, 12288
buffer_store_dwordx2 v[98:99], v5, s[8:11], s32 offen sc1
s_mov_b32 s36, 0
v_mov_b32 v124, -1
v_lshrrev_b32 v125, 8, v0
v_bfe_u32 v126, v0, 7, 1
v_lshl_add_u32 v125, v125, 2, v126
v_bfe_u32 v126, v0, 1, 6
v_lshl_add_u32 v125, v125, 8, v126
v_mov_b32 v28, 0
v_mov_b32 v29, 0
v_mov_b32 v30, 0
v_mov_b32 v31, 0
v_mov_b32 v32, 0
v_mov_b32 v33, 0
v_mov_b32 v34, 0
v_mov_b32 v35, 0
v_mov_b32 v36, 0
v_mov_b32 v37, 0
v_mov_b32 v38, 0
v_mov_b32 v39, 0
v_mov_b32 v40, 0
v_mov_b32 v41, 0
v_mov_b32 v42, 0
v_mov_b32 v43, 0
v_mov_b32 v12, 0
v_mov_b32 v13, 0
v_mov_b32 v14, 0
v_mov_b32 v15, 0
v_mov_b32 v24, 0
v_mov_b32 v25, 0
v_mov_b32 v26, 0
v_mov_b32 v27, 0
v_xor_b32 v2, 8192, v2
s_xor_b32 s75, s75, 8192
ds_read_b128 v[76:79], v4 offset:8192
ds_read_b128 v[80:83], v4 offset:9216
ds_read_b128 v[84:87], v4 offset:10240
ds_read_b128 v[88:91], v4 offset:11264
ds_read_b128 v[92:95], v4 offset:12288
ds_read_b128 v[96:99], v4 offset:13312
ds_read_b128 v[100:103], v4 offset:14336
ds_read_b128 v[104:107], v4 offset:15360
ds_read_b128 v[108:111], v4 offset:16384
ds_read_b128 v[112:115], v4 offset:17408
ds_read_b128 v[116:119], v4 offset:20480
ds_read_b128 v[120:123], v4 offset:21504
s_mov_b32 s36, 0
s_mov_b32 s82, s27
s_add_u32 s25, s25, 262144
s_add_u32 s26, s26, 262144
s_add_u32 s27, s27, 131072
s_sub_u32 s24, s78, 1024
s_mov_b32 s78, s22
s_add_u32 s77, s77, 8192
s_and_b32 s77, s77, 0x7fff
s_add_u32 s22, s77, s81
s_add_u32 s18, s18, 1
s_xor_b32 s21, s21, 1
s_barrier
s_nop 3
buffer_load_dwordx4 v[68:71], v3, s[8:11], s23 offen offset:0 sc1
s_nop 15
buffer_load_dwordx4 v[72:75], v3, s[8:11], s23 offen offset:1024 sc1
s_nop 15
buffer_load_dwordx4 v[68:71], v3, s[8:11], s23 offen offset:0 sc1
buffer_load_dwordx4 v[72:75], v3, s[8:11], s23 offen offset:1024 sc1
s_waitcnt lgkmcnt(0)
s_branch CH_RB_3s
CH_RBRETRY_3s:
buffer_load_dwordx4 v[68:71], v3, s[8:11], s23 offen offset:0 sc1
buffer_load_dwordx4 v[72:75], v3, s[8:11], s23 offen offset:1024 sc1
s_add_u32 s36, s36, 1
s_cmp_gt_u32 s36, 65536
s_cbranch_scc1 CH_RBOK_3s
s_branch CH_RB_3s
CH_RBLRETRY_3s:
buffer_load_dwordx4 v[72:75], v3, s[8:11], s23 offen offset:1024 sc1
s_add_u32 s36, s36, 1
s_cmp_gt_u32 s36, 65536
s_cbranch_scc1 CH_RBLOK_3s
s_waitcnt vmcnt(1)
s_branch CH_RBL_3s
CH_DONE_3s:
s_waitcnt lgkmcnt(0)
s_nop 4
v_add_f32 v12, v12, v14
v_add_f32 v13, v13, v15
v_add_f32 v24, v24, v26
v_add_f32 v25, v25, v27
v_cvt_pk_bf16_f32 v14, v12, v13
v_cvt_pk_bf16_f32 v15, v24, v25
s_nop 1
v_mov_b32_dpp v10, v14 quad_perm:[2,3,2,3] row_mask:0xf bank_mask:0xf
v_mov_b32_dpp v11, v15 quad_perm:[2,3,2,3] row_mask:0xf bank_mask:0xf
v_cndmask_b32 v36, v14, v104, s[40:41]
v_cndmask_b32 v37, v15, v105, s[40:41]
v_cndmask_b32 v38, v10, v106, s[40:41]
v_cndmask_b32 v39, v11, v107, s[40:41]
buffer_store_dwordx4 v[36:39], v3, s[8:11], s27 offen sc1
s_barrier
s_branch L_FIN
RDY_91_S:
s_add_u32 s32, s18, 1
s_min_u32 s32, s32, 63
s_lshr_b32 s32, s32, 2
s_add_u32 s32, s32, 1
v_lshrrev_b32 v10, 3, v0
v_and_b32 v11, 3, v10
v_bfe_u32 v10, v10, 2, 1
v_lshlrev_b32 v10, 13, v10
v_lshl_add_u32 v10, v11, 7, v10
s_mov_b32 s35, 0
POLL_KV_92:
s_cmp_lg_u32 s37, 0
s_cbranch_scc1 POLL_KV_92_E
buffer_load_dword v11, v10, s[8:11], s89 offen sc1
s_add_u32 s35, s35, 1
s_cmp_gt_u32 s35, 65536
s_cselect_b32 s37, 1, 0
s_waitcnt vmcnt(0)
v_cmp_gt_u32 vcc, s32, v11
s_cbranch_vccz POLL_KV_92_E
s_branch POLL_KV_92
POLL_KV_92_E:
s_nop 1
v_min_u32_dpp v11, v11, v11 quad_perm:[1,0,3,2] row_mask:0xf bank_mask:0xf
s_nop 1
v_min_u32_dpp v11, v11, v11 quad_perm:[2,3,0,1] row_mask:0xf bank_mask:0xf
s_nop 1
v_min_u32_dpp v11, v11, v11 row_half_mirror row_mask:0xf bank_mask:0xf
s_nop 0
v_readfirstlane_b32 s85, v11
s_nop 3
s_lshl_b32 s85, s85, 2
s_branch RDY_91
L_FIN:
s_waitcnt vmcnt(0)
L_END:
s_endpgm
.section .rodata,"a"
.p2align 6
.amdhsa_kernel parallel_sum__memory_aug_recurrent_mem_tr__dense_activation_squared_relu__prompt_kernel
  .amdhsa_next_free_vgpr 512
  .amdhsa_next_free_sgpr 102
  .amdhsa_accum_offset 256
  .amdhsa_group_segment_fixed_size 0
  .amdhsa_kernarg_size 120
  .amdhsa_user_sgpr_count 2
  .amdhsa_user_sgpr_kernarg_segment_ptr 1
  .amdhsa_system_sgpr_workgroup_id_x 1
.end_amdhsa_kernel
```
